```python
import torch

def _softmax(x, axis=-1):
    return torch.softmax(x, dim=axis)
def _gelu(x):
    return torch.nn.functional.gelu(x, approximate="tanh")
def _silu(x):
    return torch.nn.functional.silu(x)
def _sigmoid(x):
    return torch.sigmoid(x)
def _layernorm(x, axis=-1, eps=1e-5):
    m = x.mean(dim=axis, keepdim=True)
    v = x.var(dim=axis, keepdim=True, unbiased=False)
    return (x - m) / torch.sqrt(v + eps)
def _scatter_add(tgt, idx, src, axis=0):
    return tgt.clone().index_add_(axis, idx, src)
def _segment_sum(src, seg, n):
    out = torch.zeros((n,) + src.shape[1:], dtype=src.dtype)
    return out.index_add_(0, seg, src)
def _pad(x, pw):
    flat = tuple(v for pair in reversed(pw) for v in pair)
    return torch.nn.functional.pad(x, flat)

kernel_name = 'recurrent_scan__sliding_block_cached__dense_activation_silu__prompt'

def setup_inputs():

    _w = (lambda a: (lambda t: t.to(torch.bfloat16) if t.is_floating_point() else t)(torch.as_tensor(a)))
    def _A_setup():
        B, Sq, D = 1, 2048, 1024
        Hq, Hkv, Sk, Dh = 32, 4, 2048, 128
        assert Hq % Hkv == 0, (Hq, Hkv)
        return {
            "x": _w((lambda *s: torch.randn(*s, dtype=torch.bfloat16) * 0.05)(B, Sq, D)),
            "k_cache": _w((lambda *s: torch.randn(*s, dtype=torch.bfloat16) * 3.2)(B, Hkv, Sk, Dh)),
            "v_cache": _w((lambda *s: torch.randn(*s, dtype=torch.bfloat16) * 3.2)(B, Hkv, Sk, Dh)),
            "wq": _w((lambda *s: torch.randn(*s, dtype=torch.bfloat16) * 3.2)(D, Hq * Dh) * (D ** -0.5)),
            "wo": _w((lambda *s: torch.randn(*s, dtype=torch.bfloat16) * 3.2)(Hq * Dh, D) * ((Hq * Dh) ** -0.5)),
        }
    _A_in = _A_setup()

    def _B_setup():
        B, S, D, F = 1, 2048, 1024, 3584
        return {
            "x": _w((lambda *s: torch.randn(*s, dtype=torch.bfloat16) * 0.05)(B, S, D)),
            "w1": _w((lambda *s: torch.randn(*s, dtype=torch.bfloat16) * 3.2)(D, F) * (D ** -0.5)),
            "w2": _w((lambda *s: torch.randn(*s, dtype=torch.bfloat16) * 0.4)(F, D) * (F ** -0.5)),
        }
    _B_in = _B_setup()

    return {
        "A_x": _A_in["x"],
        "A_k_cache": _A_in["k_cache"],
        "A_v_cache": _A_in["v_cache"],
        "A_wq": _A_in["wq"],
        "A_wo": _A_in["wo"],
        "B_x": _B_in["x"],
        "B_w1": _B_in["w1"],
        "B_w2": _B_in["w2"],
    }

def reference(A_x, A_k_cache, A_v_cache, A_wq, A_wo, B_x, B_w1, B_w2):
    def _A_ref(x, k_cache, v_cache, wq, wo):
        B, Sq, D = x.shape
        Hq, Dh = 32, 128
        Hkv, Sk = k_cache.shape[1], k_cache.shape[2]
        W = min(4096, max(256, Sk // 4))
        rep = Hq // Hkv
        q = (lambda x, *d: x.permute(*d))((x @ wq).reshape(B, Sq, Hq, Dh), 0, 2, 1, 3)
        k = (lambda x, n, axis: torch.repeat_interleave(x, n, dim=axis))(k_cache[:, :, Sk - W:, :], rep, axis=1)
        v = (lambda x, n, axis: torch.repeat_interleave(x, n, dim=axis))(v_cache[:, :, Sk - W:, :], rep, axis=1)
        scores = torch.einsum("bhqd,bhkd->bhqk", q, k) * (Dh ** -0.5)
        p = _softmax(scores, axis=-1)
        o = torch.einsum("bhqk,bhkd->bhqd", p, v)
        return (lambda x, *d: x.permute(*d))(o, 0, 2, 1, 3).reshape(B, Sq, Hq * Dh) @ wo

    def _B_ref(x, w1, w2):
        h = torch.einsum("bsd,df->bsf", x, w1)
        h = _silu(h)
        out = torch.einsum("bsf,fd->bsd", h, w2)
        return out

    x = A_x
    xn = _layernorm(x, axis=-1)
    s = _A_ref(xn, A_k_cache, A_v_cache, A_wq, A_wo)
    g = _silu(_B_ref(xn, B_w1, B_w2))
    return x + s * g
```

```asm
; @launch grid=(256,1,1) block=(256,1,1) lds=163840
.amdgcn_target "amdgcn-amd-amdhsa--gfx950"
.text
.globl recurrent_scan__sliding_block_cached__dense_activation_silu__prompt_kernel
.p2align 8
.type recurrent_scan__sliding_block_cached__dense_activation_silu__prompt_kernel,@function
recurrent_scan__sliding_block_cached__dense_activation_silu__prompt_kernel:
    s_cmp_ge_u32 s2, 256
    s_cbranch_scc1 L_m_end
    s_load_dwordx2 s[10:11], s[0:1], 0
    s_load_dwordx4 s[76:79], s[0:1], 64
    s_load_dwordx2 s[8:9], s[0:1], 80
    s_load_dwordx4 s[44:47], s[0:1], 8
    s_load_dwordx2 s[4:5], s[0:1], 24
    s_load_dwordx2 s[6:7], s[0:1], 48
    s_load_dwordx2 s[66:67], s[0:1], 32
    s_load_dwordx2 s[68:69], s[0:1], 56
    s_getpc_b64 s[14:15]
L_m_pc0:
    s_bfe_u32 s16, s2, 0x30003
    s_lshl_b32 s16, s16, 14
    v_lshl_add_u32 v3, v0, 6, s16
    v_min_u32 v3, L_text_end-L_m_pc0-4, v3
    global_load_dword v100, v3, s[14:15]
    v_and_b32 v1, 63, v0
    v_lshrrev_b32 v2, 6, v0
    v_and_b32 v18, 7, v1
    v_lshrrev_b32 v19, 3, v1
    v_lshl_add_u32 v20, v2, 5, v19
    v_lshlrev_b32 v20, 4, v20
    v_lshl_add_u32 v20, v18, 11, v20
    s_lshl_b32 s64, s2, 14
    s_mov_b32 s26, 0x400000
    s_mov_b32 s27, 0x00020000
    s_waitcnt lgkmcnt(0)
    s_mov_b32 s24, s10
    s_and_b32 s25, s11, 0xffff
    buffer_load_dwordx4 v[32:35], v20, s[24:27], s64 offen offset:0
    buffer_load_dwordx4 v[36:39], v20, s[24:27], s64 offen offset:128
    buffer_load_dwordx4 v[40:43], v20, s[24:27], s64 offen offset:256
    buffer_load_dwordx4 v[44:47], v20, s[24:27], s64 offen offset:384
    s_and_b32 s40, s2, 7
    s_lshr_b32 s41, s2, 3
    v_readfirstlane_b32 s34, v2
    s_lshr_b32 s35, s40, 2
    s_lshl_b32 s35, s35, 2
    s_and_b32 s42, s41, 3
    s_add_u32 s35, s35, s42
    s_and_b32 s36, s40, 3
    s_lshr_b32 s51, s41, 4
    s_lshl_b32 s37, s36, 3
    s_lshr_b32 s42, s41, 2
    s_add_u32 s37, s37, s42
    s_lshl_b32 s30, s35, 2
    s_add_u32 s30, s30, s34
    s_lshl_b32 s30, s30, 17
    s_lshl_b32 s48, s36, 18
    s_add_u32 s48, s48, 0x400000
    s_lshl_b32 s32, s34, 10
    s_add_u32 s31, s48, s32
    s_lshl_b32 s28, s37, 8
    s_lshl_b32 s33, s36, 2
    s_and_b32 s42, s37, 3
    s_add_u32 s33, s33, s42
    s_lshl_b32 s42, s51, 4
    s_add_u32 s33, s33, s42
    s_lshr_b32 s43, s33, 1
    s_mul_i32 s29, s43, 448
    s_and_b32 s49, s37, 1
    s_lshl_b32 s42, s49, 8
    s_lshl_b32 s38, s49, 11
    s_add_u32 s39, s30, 2048
    s_sub_u32 s39, s39, s38
    s_add_u32 s30, s30, s38
    v_lshrrev_b32 v8, 5, v1
    v_bfe_u32 v9, v1, 2, 3
    v_bfe_u32 v10, v1, 1, 1
    v_lshrrev_b32 v11, 2, v9
    v_xor_b32 v10, v10, v11
    v_and_b32 v12, 1, v1
    v_lshlrev_b32 v13, 6, v8
    v_lshl_add_u32 v13, v10, 5, v13
    v_lshl_add_u32 v13, v12, 4, v13
    v_and_b32 v14, 1, v2
    v_lshlrev_b32 v14, 4, v14
    v_lshl_add_u32 v14, v11, 3, v14
    v_lshrrev_b32 v15, 1, v2
    v_lshl_add_u32 v14, v15, 2, v14
    v_and_b32 v15, 3, v9
    v_add_u32 v14, v14, v15
    v_lshl_add_u32 v3, v14, 13, v13
    v_mul_u32_u24 v4, 7168, v14
    v_add3_u32 v4, v4, v13, s42
    v_mul_u32_u24 v9, s42, v8
    v_sub_u32 v5, v4, v9
    v_lshlrev_b32 v6, 4, v1
    s_waitcnt lgkmcnt(0)
    s_mov_b32 s12, s4
    s_and_b32 s13, s5, 0xffff
    s_mov_b32 s14, 0x800000
    s_mov_b32 s15, 0x00020000
    s_mov_b32 s16, s6
    s_and_b32 s17, s7, 0xffff
    s_mov_b32 s18, 0x700000
    s_mov_b32 s19, 0x00020000
    s_mov_b32 s20, s8
    s_and_b32 s21, s9, 0xffff
    s_mov_b32 s22, 0x8000000
    s_mov_b32 s23, 0x00020000
    s_mov_b32 s60, s78
    s_and_b32 s61, s79, 0xffff
    s_mov_b32 s62, 0x100
    s_mov_b32 s63, 0x00020000
    s_lshl_b32 s74, s35, 5
    s_lshl_b32 s65, s35, 9
    s_add_u32 s65, s65, 0x3014000
    v_bfe_u32 v21, v1, 3, 2
    v_lshlrev_b32 v21, 7, v21
    v_lshl_add_u32 v101, v18, 2, v21
    buffer_load_dword v16, v101, s[20:23], s65 offen sc1
    s_lshr_b32 s75, s2, 3
    s_lshl_b32 s75, s75, 7
    s_and_b32 s64, s2, 7
    s_lshl_b32 s64, s64, 2
    s_add_u32 s75, s75, s64
    s_add_u32 s75, s75, 0x3014000
    buffer_load_dword v17, off, s[20:23], s75 sc1
    s_mov_b32 s52, s44
    s_and_b32 s53, s45, 0xffff
    s_mov_b32 s54, 0x200000
    s_mov_b32 s55, 0x00020000
    s_mov_b32 s56, s46
    s_and_b32 s57, s47, 0xffff
    s_mov_b32 s58, 0x200000
    s_mov_b32 s59, 0x00020000
    s_lshl_b32 s44, s2, 1
    s_and_b32 s45, s34, 1
    s_add_u32 s44, s44, s45
    s_lshr_b32 s45, s44, 7
    s_lshl_b32 s45, s45, 11
    s_bfe_u32 s46, s44, 0x40003
    s_lshl_b32 s46, s46, 5
    s_add_u32 s45, s45, s46
    s_add_u32 s45, s45, 1536
    s_lshl_b32 s45, s45, 8
    s_and_b32 s46, s44, 7
    s_lshr_b32 s47, s46, 2
    s_lshl_b32 s47, s47, 12
    s_and_b32 s64, s46, 3
    s_lshl_b32 s64, s64, 6
    s_add_u32 s47, s47, s64
    s_add_u32 s47, s47, s45
    s_lshl_b32 s64, s46, 5
    s_add_u32 s45, s45, s64
    s_lshr_b32 s64, s44, 3
    s_lshl_b32 s64, s64, 14
    s_lshl_b32 s46, s46, 10
    s_add_u32 s46, s46, s64
    s_add_u32 s46, s46, 0x400000
    s_add_u32 s44, s46, 8192
    s_cmp_lt_u32 s34, 2
    s_cselect_b32 s47, s47, 0x7f000000
    s_cselect_b32 s46, s46, 0x7f000000
    s_cselect_b32 s45, 0x7f000000, s45
    s_cselect_b32 s44, 0x7f000000, s44
    v_and_b32 v22, 15, v1
    v_lshrrev_b32 v23, 4, v1
    v_lshlrev_b32 v24, 8, v22
    v_lshl_add_u32 v24, v23, 3, v24
    buffer_load_dwordx2 v[80:81], v24, s[52:55], s47 offen
    buffer_load_dwordx2 v[82:83], v24, s[52:55], s47 offen offset:32
    v_lshlrev_b32 v25, 1, v22
    v_lshl_add_u32 v25, v23, 10, v25
    s_add_u32 s64, s45, 4096
    buffer_load_ushort v84, v25, s[56:59], s45 offen offset:0
    buffer_load_ushort v85, v25, s[56:59], s45 offen offset:256
    buffer_load_ushort v86, v25, s[56:59], s45 offen offset:512
    buffer_load_ushort v87, v25, s[56:59], s45 offen offset:768
    buffer_load_ushort v88, v25, s[56:59], s64 offen offset:0
    buffer_load_ushort v89, v25, s[56:59], s64 offen offset:256
    buffer_load_ushort v90, v25, s[56:59], s64 offen offset:512
    buffer_load_ushort v91, v25, s[56:59], s64 offen offset:768
    v_lshrrev_b32 v8, 5, v1
    v_lshlrev_b32 v8, 10, v8
    v_bfe_u32 v7, v1, 2, 3
    v_lshl_add_u32 v8, v7, 6, v8
    v_and_b32 v7, 3, v1
    v_lshl_add_u32 v8, v7, 3, v8
    v_bfe_u32 v7, v1, 4, 1
    v_lshl_add_u32 v7, v7, 5, v8
    v_add_u32 v7, 32768, v7
    v_xor_b32 v8, 32, v7
    v_add_u32 v9, 0x10000, v7
    v_add_u32 v10, 0x10000, v8
    v_lshl_add_u32 v11, v2, 11, v6
    v_mul_u32_u24 v12, 1792, v2
    v_add_u32 v12, v12, v6
    s_lshl_b32 s72, s2, 13
    s_mul_i32 s73, s2, 7168
    s_getpc_b64 s[80:81]
L_m_pc:
    s_lshr_b32 s78, s2, 3
    s_and_b32 s78, s78, 15
    s_lshl_b32 s78, s78, 10
    v_lshlrev_b32 v0, 2, v0
    v_add_u32 v0, s78, v0
    v_lshrrev_b32 v27, 2, v19
    v_lshl_add_u32 v27, v2, 3, v27
    v_lshlrev_b32 v27, 12, v27
    v_and_b32 v28, 3, v19
    v_lshl_add_u32 v27, v28, 8, v27
    v_lshl_add_u32 v27, v18, 4, v27
    s_lshr_b32 s82, s2, 3
    s_lshl_b32 s82, s82, 17
    s_bfe_u32 s64, s2, 0x20001
    s_lshl_b32 s64, s64, 10
    s_add_u32 s82, s82, s64
    s_and_b32 s64, s2, 1
    s_lshl_b32 s64, s64, 7
    s_add_u32 s82, s82, s64
    v_lshl_add_u32 v28, v18, 2, v2
    v_lshlrev_b32 v28, 2, v28
    v_lshlrev_b32 v29, 4, v18
    s_mov_b32 s50, 0xffff0000
    s_waitcnt vmcnt(15)
    v_lshlrev_b32 v48, 16, v32
    v_and_b32 v49, s50, v32
    v_lshlrev_b32 v50, 16, v33
    v_and_b32 v51, s50, v33
    v_lshlrev_b32 v52, 16, v34
    v_and_b32 v53, s50, v34
    v_lshlrev_b32 v54, 16, v35
    v_and_b32 v55, s50, v35
    s_waitcnt vmcnt(14)
    v_lshlrev_b32 v56, 16, v36
    v_and_b32 v57, s50, v36
    v_lshlrev_b32 v58, 16, v37
    v_and_b32 v59, s50, v37
    v_lshlrev_b32 v60, 16, v38
    v_and_b32 v61, s50, v38
    v_lshlrev_b32 v62, 16, v39
    v_and_b32 v63, s50, v39
    s_waitcnt vmcnt(13)
    v_lshlrev_b32 v64, 16, v40
    v_and_b32 v65, s50, v40
    v_lshlrev_b32 v66, 16, v41
    v_and_b32 v67, s50, v41
    v_lshlrev_b32 v68, 16, v42
    v_and_b32 v69, s50, v42
    v_lshlrev_b32 v70, 16, v43
    v_and_b32 v71, s50, v43
    s_waitcnt vmcnt(12)
    v_lshlrev_b32 v72, 16, v44
    v_and_b32 v73, s50, v44
    v_lshlrev_b32 v74, 16, v45
    v_and_b32 v75, s50, v45
    v_lshlrev_b32 v76, 16, v46
    v_and_b32 v77, s50, v46
    v_lshlrev_b32 v78, 16, v47
    v_and_b32 v79, s50, v47
    s_add_u32 m0, s32, 0x8000
    s_nop 0
    buffer_load_dwordx4 v3, s[12:15], s28 offen offset:0 lds
    s_add_u32 m0, s32, 0x8f80
    s_nop 0
    buffer_load_dwordx4 v3, s[12:15], s28 offen offset:128 lds
    s_add_u32 s28, s28, 0x40000
    s_add_u32 m0, s32, 0xa000
    s_nop 0
    buffer_load_dwordx4 v4, s[16:19], s29 offen offset:0 lds
    s_add_u32 m0, s32, 0xaf80
    s_nop 0
    buffer_load_dwordx4 v5, s[16:19], s29 offen offset:128 lds
    s_add_u32 s29, s29, 0x38000
    s_getpc_b64 s[80:81]
    global_load_dword a255, v0, s[80:81] offset:2048
    v_pk_add_f32 v[20:21], v[48:49], v[52:53]
    v_pk_add_f32 v[22:23], v[50:51], v[54:55]
    v_pk_add_f32 v[20:21], v[20:21], v[56:57]
    v_pk_add_f32 v[22:23], v[22:23], v[58:59]
    v_pk_add_f32 v[20:21], v[20:21], v[60:61]
    v_pk_add_f32 v[22:23], v[22:23], v[62:63]
    v_pk_add_f32 v[20:21], v[20:21], v[64:65]
    v_pk_add_f32 v[22:23], v[22:23], v[66:67]
    v_pk_add_f32 v[20:21], v[20:21], v[68:69]
    v_pk_add_f32 v[22:23], v[22:23], v[70:71]
    v_pk_add_f32 v[20:21], v[20:21], v[72:73]
    v_pk_add_f32 v[22:23], v[22:23], v[74:75]
    v_pk_add_f32 v[20:21], v[20:21], v[76:77]
    v_pk_add_f32 v[22:23], v[22:23], v[78:79]
    v_pk_add_f32 v[20:21], v[20:21], v[22:23]
    v_add_f32 v20, v20, v21
    s_nop 1
    v_add_f32_dpp v20, v20, v20 row_ror:8 row_mask:0xf bank_mask:0xf
    v_mov_b32 v21, v20
    s_nop 1
    v_permlane16_swap_b32 v20, v21
    s_nop 1
    v_add_f32 v20, v20, v21
    v_mov_b32 v21, v20
    s_nop 1
    v_permlane32_swap_b32 v20, v21
    s_nop 1
    v_add_f32 v20, v20, v21
    v_mul_f32 v30, 0xbb800000, v20
    v_mov_b32 v31, v30
    ds_write_b32 v28, v30
    v_pk_add_f32 v[32:33], v[48:49], v[30:31]
    v_pk_mul_f32 v[20:21], v[32:33], v[32:33]
    v_pk_add_f32 v[34:35], v[50:51], v[30:31]
    v_pk_mul_f32 v[22:23], v[34:35], v[34:35]
    v_pk_add_f32 v[32:33], v[52:53], v[30:31]
    v_pk_fma_f32 v[20:21], v[32:33], v[32:33], v[20:21]
    v_pk_add_f32 v[34:35], v[54:55], v[30:31]
    v_pk_fma_f32 v[22:23], v[34:35], v[34:35], v[22:23]
    v_pk_add_f32 v[32:33], v[56:57], v[30:31]
    v_pk_fma_f32 v[20:21], v[32:33], v[32:33], v[20:21]
    v_pk_add_f32 v[34:35], v[58:59], v[30:31]
    v_pk_fma_f32 v[22:23], v[34:35], v[34:35], v[22:23]
    v_pk_add_f32 v[32:33], v[60:61], v[30:31]
    v_pk_fma_f32 v[20:21], v[32:33], v[32:33], v[20:21]
    v_pk_add_f32 v[34:35], v[62:63], v[30:31]
    v_pk_fma_f32 v[22:23], v[34:35], v[34:35], v[22:23]
    v_pk_add_f32 v[32:33], v[64:65], v[30:31]
    v_pk_fma_f32 v[20:21], v[32:33], v[32:33], v[20:21]
    v_pk_add_f32 v[34:35], v[66:67], v[30:31]
    v_pk_fma_f32 v[22:23], v[34:35], v[34:35], v[22:23]
    v_pk_add_f32 v[32:33], v[68:69], v[30:31]
    v_pk_fma_f32 v[20:21], v[32:33], v[32:33], v[20:21]
    v_pk_add_f32 v[34:35], v[70:71], v[30:31]
    v_pk_fma_f32 v[22:23], v[34:35], v[34:35], v[22:23]
    v_pk_add_f32 v[32:33], v[72:73], v[30:31]
    v_pk_fma_f32 v[20:21], v[32:33], v[32:33], v[20:21]
    v_pk_add_f32 v[34:35], v[74:75], v[30:31]
    v_pk_fma_f32 v[22:23], v[34:35], v[34:35], v[22:23]
    v_pk_add_f32 v[32:33], v[76:77], v[30:31]
    v_pk_fma_f32 v[20:21], v[32:33], v[32:33], v[20:21]
    v_pk_add_f32 v[34:35], v[78:79], v[30:31]
    v_pk_fma_f32 v[22:23], v[34:35], v[34:35], v[22:23]
    v_pk_add_f32 v[20:21], v[20:21], v[22:23]
    v_add_f32 v20, v20, v21
    s_nop 1
    v_add_f32_dpp v20, v20, v20 row_ror:8 row_mask:0xf bank_mask:0xf
    v_mov_b32 v21, v20
    s_nop 1
    v_permlane16_swap_b32 v20, v21
    s_nop 1
    v_add_f32 v20, v20, v21
    v_mov_b32 v21, v20
    s_nop 1
    v_permlane32_swap_b32 v20, v21
    s_nop 1
    v_add_f32 v20, v20, v21
    ds_write_b32 v28, v20 offset:128
    s_waitcnt lgkmcnt(0)
    s_barrier
    ds_read_b128 v[104:107], v29
    ds_read_b128 v[20:23], v29 offset:128
    s_add_u32 m0, s32, 0xc000
    s_nop 0
    buffer_load_dwordx4 v3, s[12:15], s28 offen offset:0 lds
    s_add_u32 m0, s32, 0xcf80
    s_nop 0
    buffer_load_dwordx4 v3, s[12:15], s28 offen offset:128 lds
    s_add_u32 s28, s28, 0x40000
    s_add_u32 m0, s32, 0xe000
    s_nop 0
    buffer_load_dwordx4 v4, s[16:19], s29 offen offset:0 lds
    s_add_u32 m0, s32, 0xef80
    s_nop 0
    buffer_load_dwordx4 v5, s[16:19], s29 offen offset:128 lds
    s_add_u32 s29, s29, 0x38000
    s_waitcnt lgkmcnt(0)
    v_pk_add_f32 v[108:109], v[104:105], v[106:107]
    v_pk_add_f32 v[20:21], v[20:21], v[22:23]
    v_add_f32 v30, v108, v109
    v_add_f32 v20, v20, v21
    v_mul_f32 v30, 0.25, v30
    v_sub_f32 v104, v104, v30
    v_sub_f32 v105, v105, v30
    v_sub_f32 v106, v106, v30
    v_sub_f32 v107, v107, v30
    v_mul_f32 v108, v104, v104
    v_fmac_f32 v108, v105, v105
    v_fmac_f32 v108, v106, v106
    v_fmac_f32 v108, v107, v107
    v_mul_f32 v20, 0x3a800000, v20
    v_fmac_f32 v20, 0.25, v108
    v_cvt_pk_bf16_f32 v30, v30, v30
    v_lshlrev_b32 v30, 16, v30
    v_mov_b32 v31, v30
    v_pk_add_f32 v[48:49], v[48:49], v[30:31]
    v_cvt_pk_bf16_f32 v32, v48, v49
    v_pk_add_f32 v[50:51], v[50:51], v[30:31]
    v_cvt_pk_bf16_f32 v33, v50, v51
    v_pk_add_f32 v[52:53], v[52:53], v[30:31]
    v_cvt_pk_bf16_f32 v34, v52, v53
    v_pk_add_f32 v[54:55], v[54:55], v[30:31]
    v_cvt_pk_bf16_f32 v35, v54, v55
    v_pk_add_f32 v[56:57], v[56:57], v[30:31]
    v_cvt_pk_bf16_f32 v36, v56, v57
    v_pk_add_f32 v[58:59], v[58:59], v[30:31]
    v_cvt_pk_bf16_f32 v37, v58, v59
    v_pk_add_f32 v[60:61], v[60:61], v[30:31]
    v_cvt_pk_bf16_f32 v38, v60, v61
    v_pk_add_f32 v[62:63], v[62:63], v[30:31]
    v_cvt_pk_bf16_f32 v39, v62, v63
    v_pk_add_f32 v[64:65], v[64:65], v[30:31]
    v_cvt_pk_bf16_f32 v40, v64, v65
    v_pk_add_f32 v[66:67], v[66:67], v[30:31]
    v_cvt_pk_bf16_f32 v41, v66, v67
    v_pk_add_f32 v[68:69], v[68:69], v[30:31]
    v_cvt_pk_bf16_f32 v42, v68, v69
    v_pk_add_f32 v[70:71], v[70:71], v[30:31]
    v_cvt_pk_bf16_f32 v43, v70, v71
    v_pk_add_f32 v[72:73], v[72:73], v[30:31]
    v_cvt_pk_bf16_f32 v44, v72, v73
    v_pk_add_f32 v[74:75], v[74:75], v[30:31]
    v_cvt_pk_bf16_f32 v45, v74, v75
    v_pk_add_f32 v[76:77], v[76:77], v[30:31]
    v_cvt_pk_bf16_f32 v46, v76, v77
    v_pk_add_f32 v[78:79], v[78:79], v[30:31]
    v_cvt_pk_bf16_f32 v47, v78, v79
    v_lshlrev_b32 v48, 16, v32
    v_and_b32 v49, s50, v32
    v_lshlrev_b32 v50, 16, v33
    v_and_b32 v51, s50, v33
    v_lshlrev_b32 v52, 16, v34
    v_and_b32 v53, s50, v34
    v_lshlrev_b32 v54, 16, v35
    v_and_b32 v55, s50, v35
    v_lshlrev_b32 v56, 16, v36
    v_and_b32 v57, s50, v36
    v_lshlrev_b32 v58, 16, v37
    v_and_b32 v59, s50, v37
    v_lshlrev_b32 v60, 16, v38
    v_and_b32 v61, s50, v38
    v_lshlrev_b32 v62, 16, v39
    v_and_b32 v63, s50, v39
    v_lshlrev_b32 v64, 16, v40
    v_and_b32 v65, s50, v40
    v_lshlrev_b32 v66, 16, v41
    v_and_b32 v67, s50, v41
    v_lshlrev_b32 v68, 16, v42
    v_and_b32 v69, s50, v42
    v_lshlrev_b32 v70, 16, v43
    v_and_b32 v71, s50, v43
    v_lshlrev_b32 v72, 16, v44
    v_and_b32 v73, s50, v44
    v_lshlrev_b32 v74, 16, v45
    v_and_b32 v75, s50, v45
    v_lshlrev_b32 v76, 16, v46
    v_and_b32 v77, s50, v46
    v_lshlrev_b32 v78, 16, v47
    v_and_b32 v79, s50, v47
    v_cvt_pk_bf16_f32 v20, v20, v20
    v_lshlrev_b32 v20, 16, v20
    v_add_f32 v20, 0x3727c5ac, v20
    v_cvt_pk_bf16_f32 v20, v20, v20
    v_lshlrev_b32 v20, 16, v20
    v_sqrt_f32 v20, v20
    s_nop 0
    v_cvt_pk_bf16_f32 v20, v20, v20
    v_lshlrev_b32 v20, 16, v20
    v_rcp_f32 v20, v20
    s_nop 0
    v_mov_b32 v21, v20
    v_pk_mul_f32 v[48:49], v[48:49], v[20:21]
    v_cvt_pk_bf16_f32 v32, v48, v49
    v_pk_mul_f32 v[50:51], v[50:51], v[20:21]
    v_cvt_pk_bf16_f32 v33, v50, v51
    v_pk_mul_f32 v[52:53], v[52:53], v[20:21]
    v_cvt_pk_bf16_f32 v34, v52, v53
    v_pk_mul_f32 v[54:55], v[54:55], v[20:21]
    v_cvt_pk_bf16_f32 v35, v54, v55
    buffer_store_dwordx4 v[32:35], v27, s[20:23], s82 offen sc1
    s_add_u32 s82, s82, 8192
    v_pk_mul_f32 v[56:57], v[56:57], v[20:21]
    v_cvt_pk_bf16_f32 v36, v56, v57
    v_pk_mul_f32 v[58:59], v[58:59], v[20:21]
    v_cvt_pk_bf16_f32 v37, v58, v59
    v_pk_mul_f32 v[60:61], v[60:61], v[20:21]
    v_cvt_pk_bf16_f32 v38, v60, v61
    v_pk_mul_f32 v[62:63], v[62:63], v[20:21]
    v_cvt_pk_bf16_f32 v39, v62, v63
    buffer_store_dwordx4 v[36:39], v27, s[20:23], s82 offen sc1
    s_add_u32 s82, s82, 8192
    v_pk_mul_f32 v[64:65], v[64:65], v[20:21]
    v_cvt_pk_bf16_f32 v40, v64, v65
    v_pk_mul_f32 v[66:67], v[66:67], v[20:21]
    v_cvt_pk_bf16_f32 v41, v66, v67
    v_pk_mul_f32 v[68:69], v[68:69], v[20:21]
    v_cvt_pk_bf16_f32 v42, v68, v69
    v_pk_mul_f32 v[70:71], v[70:71], v[20:21]
    v_cvt_pk_bf16_f32 v43, v70, v71
    buffer_store_dwordx4 v[40:43], v27, s[20:23], s82 offen sc1
    s_add_u32 s82, s82, 8192
    v_pk_mul_f32 v[72:73], v[72:73], v[20:21]
    v_cvt_pk_bf16_f32 v44, v72, v73
    v_pk_mul_f32 v[74:75], v[74:75], v[20:21]
    v_cvt_pk_bf16_f32 v45, v74, v75
    v_pk_mul_f32 v[76:77], v[76:77], v[20:21]
    v_cvt_pk_bf16_f32 v46, v76, v77
    v_pk_mul_f32 v[78:79], v[78:79], v[20:21]
    v_cvt_pk_bf16_f32 v47, v78, v79
    buffer_store_dwordx4 v[44:47], v27, s[20:23], s82 offen sc1
    s_add_u32 s82, s82, 8192
    s_lshl_b32 s64, s2, 2
    s_add_u32 s64, s64, s34
    s_lshl_b32 s47, s64, 7
    s_add_u32 s47, s47, 0x3000000
    s_lshl_b32 s45, s64, 4
    s_add_u32 s45, s45, 0x300e000
    s_cmp_lt_u32 s64, 512
    s_cselect_b32 s47, s47, s45
    v_mov_b32 v96, 0
    v_mov_b32 v97, 0
    v_mov_b32 v98, 0
    v_mov_b32 v99, 0
    s_mov_b32 s45, s47
    v_mov_b32 v20, 1
    v_and_b32 v21, 31, v1
    v_mov_b32 v23, 0
    v_mov_b32 v24, 0
    v_lshlrev_b32 v25, 2, v1
    ds_write_b32 v24, v23 offset:256
    ds_write_b32 v25, v23 offset:512
    s_waitcnt vmcnt(0) lgkmcnt(0)
    v_add_u32 v17, 1, v17
    s_barrier
    s_cmp_eq_u32 s34, 0
    s_cbranch_scc1 L_m_sig
    s_cmp_eq_u32 s34, 2
    s_cbranch_scc0 L_m_xok
    s_mov_b32 s64, 0
L_m_fb:
    s_sleep 4
    ds_read_b32 v22, v24 offset:256
    s_add_u32 s64, s64, 1
    s_waitcnt lgkmcnt(0)
    v_readfirstlane_b32 s47, v22
    s_cmp_lg_u32 s47, 0
    s_cbranch_scc1 L_m_xok
    s_cmp_lt_u32 s64, 20
    s_cbranch_scc1 L_m_fb
    s_cmp_lg_u32 s64, 20
    s_cbranch_scc1 L_m_fb2
    s_mov_b64 exec, 1
    buffer_store_byte v20, off, s[60:63], s2 sc1
    s_mov_b64 exec, -1
L_m_fb2:
    buffer_load_ubyte v23, v21, s[60:63], s74 offen sc1
    s_waitcnt vmcnt(0)
    ds_write_b32 v25, v23 offset:512
    s_sleep 16
    s_branch L_m_fb
L_m_sig:
    s_mov_b64 exec, 1
    buffer_store_dword v17, off, s[20:23], s75 sc1
    s_mov_b64 exec, -1
    s_mov_b32 s64, 0
L_m_xw:
    buffer_load_dword v22, v101, s[20:23], s65 offen sc1
    ds_read_b32 v23, v25 offset:512
    s_add_u32 s64, s64, 1
    s_waitcnt vmcnt(0) lgkmcnt(0)
    v_xor_b32 v22, v22, v16
    v_or_b32 v22, v22, v23
    v_cmp_eq_u32 vcc, 0, v22
    s_nop 4
    s_cbranch_vccz L_m_xd
    s_cmp_lt_u32 s64, 0x100000
    s_cbranch_scc1 L_m_xw
L_m_xd:
    ds_write_b32 v24, v20 offset:256
    s_waitcnt lgkmcnt(0)
L_m_xok:
    s_barrier
    buffer_load_dwordx4 a[32:35], v6, s[20:23], s30 offen offset:0 sc1
    buffer_load_dwordx4 a[36:39], v6, s[20:23], s30 offen offset:1024 sc1
    buffer_load_dwordx4 a[40:43], v6, s[20:23], s39 offen offset:0 sc1
    buffer_load_dwordx4 a[44:47], v6, s[20:23], s39 offen offset:1024 sc1
    s_add_u32 s30, s30, 4096
    s_add_u32 s39, s39, 4096
    buffer_load_dwordx4 a[48:51], v6, s[20:23], s30 offen offset:0 sc1
    buffer_load_dwordx4 a[52:55], v6, s[20:23], s30 offen offset:1024 sc1
    buffer_load_dwordx4 a[56:59], v6, s[20:23], s39 offen offset:0 sc1
    buffer_load_dwordx4 a[60:63], v6, s[20:23], s39 offen offset:1024 sc1
    s_add_u32 s30, s30, 4096
    s_add_u32 s39, s39, 4096
    v_lshl_or_b32 v92, v85, 16, v84
    v_lshl_or_b32 v93, v87, 16, v86
    v_lshl_or_b32 v94, v89, 16, v88
    v_lshl_or_b32 v95, v91, 16, v90
    buffer_store_dwordx4 v[80:83], v6, s[20:23], s46 offen sc1
    buffer_store_dwordx4 v[92:95], v6, s[20:23], s44 offen sc1
    s_mov_b64 exec, 1
    buffer_store_dwordx4 v[96:99], off, s[20:23], s45 sc1
    s_mov_b64 exec, -1
    s_cmp_eq_u32 s34, 2
    s_cselect_b32 s74, s2, 0x7f000000
    s_bfe_u32 s75, s2, 0x20003
    s_cmp_eq_u32 s34, 3
    s_cselect_b32 s65, 0, 0x7f000000
    s_cselect_b32 s47, 0x03030303, 0
    buffer_load_dwordx4 a[224:227], v11, s[12:15], s72 offen offset:0
    buffer_load_dwordx4 a[232:235], v12, s[16:19], s73 offen offset:0
    buffer_load_dwordx4 a[228:231], v11, s[12:15], s72 offen offset:1024
    buffer_load_dwordx4 a[236:239], v12, s[16:19], s73 offen offset:896
    s_add_u32 s72, s72, 0x200000
    s_add_u32 s73, s73, 0x1c0000
    s_lshl_b32 s64, s2, 2
    s_add_u32 s64, s64, s34
    s_lshl_b32 s46, s64, 10
    s_add_u32 s46, s46, 0x3600000
    s_and_b32 s38, s64, 511
    s_lshl_b32 s38, s38, 14
    s_lshr_b32 s64, s64, 9
    s_lshl_b32 s64, s64, 10
    s_add_u32 s38, s38, s64
    s_add_u32 s38, s38, 384
    s_lshl_b32 s3, s2, 1
    s_add_u32 s3, s3, 0x3016000
    s_cmp_eq_u32 s34, 1
    s_cselect_b32 s3, s3, 0x7f000000
    s_mov_b64 exec, 1
    buffer_store_short v96, off, s[20:23], s3 sc1
    s_mov_b64 exec, -1
    v_lshlrev_b32 v13, 2, v1
    s_mov_b32 s52, s66
    s_and_b32 s53, s67, 0xffff
    s_mov_b32 s54, 0x800000
    s_mov_b32 s55, 0x00020000
    s_mov_b32 s56, s68
    s_and_b32 s57, s69, 0xffff
    s_mov_b32 s58, 0x700000
    s_mov_b32 s59, 0x00020000
    s_lshl_b32 s44, s2, 13
    s_and_b32 s45, s2, 128
    s_lshl_b32 s45, s45, 13
    s_add_u32 s44, s44, s45
    s_add_u32 s44, s44, 0x100000
    s_mul_i32 s45, s2, 7168
    s_waitcnt vmcnt(12)
    s_waitcnt vmcnt(8)
    ds_read_b64_tr_b16 a[0:1], v7 offset:0
    ds_read_b64_tr_b16 a[2:3], v7 offset:2048
    ds_read_b64_tr_b16 a[4:5], v7 offset:16384
    ds_read_b64_tr_b16 a[6:7], v7 offset:18432
    ds_read_b64_tr_b16 a[8:9], v8 offset:0
    ds_read_b64_tr_b16 a[10:11], v8 offset:2048
    ds_read_b64_tr_b16 a[12:13], v8 offset:16384
    ds_read_b64_tr_b16 a[14:15], v8 offset:18432
    s_waitcnt lgkmcnt(4)
    v_mfma_f32_16x16x32_bf16 v[16:19], a[0:3], a[32:35], 0
    ds_read_b64_tr_b16 a[16:17], v7 offset:512
    s_add_u32 m0, s32, 0x10000
    v_mfma_f32_16x16x32_bf16 v[16:19], a[4:7], a[48:51], v[16:19]
    buffer_load_dwordx4 v3, s[12:15], s28 offen offset:0 lds
    v_mfma_f32_16x16x32_bf16 v[20:23], a[0:3], a[36:39], 0
    ds_read_b64_tr_b16 a[18:19], v7 offset:2560
    s_add_u32 m0, s32, 0x10f80
    v_mfma_f32_16x16x32_bf16 v[20:23], a[4:7], a[52:55], v[20:23]
    buffer_load_dwordx4 v3, s[12:15], s28 offen offset:128 lds
    s_add_u32 s28, s28, 0x40000
    v_mfma_f32_16x16x32_bf16 v[24:27], a[0:3], a[40:43], 0
    ds_read_b64_tr_b16 a[20:21], v7 offset:16896
    v_mfma_f32_16x16x32_bf16 v[24:27], a[4:7], a[56:59], v[24:27]
    v_mfma_f32_16x16x32_bf16 v[28:31], a[0:3], a[44:47], 0
    ds_read_b64_tr_b16 a[22:23], v7 offset:18944
    v_mfma_f32_16x16x32_bf16 v[28:31], a[4:7], a[60:63], v[28:31]
    s_waitcnt lgkmcnt(4)
    v_mfma_f32_16x16x32_bf16 v[32:35], a[8:11], a[32:35], 0
    ds_read_b64_tr_b16 a[0:1], v8 offset:512
    s_add_u32 m0, s32, 0x12000
    v_mfma_f32_16x16x32_bf16 v[32:35], a[12:15], a[48:51], v[32:35]
    buffer_load_dwordx4 v4, s[16:19], s29 offen offset:0 lds
    v_mfma_f32_16x16x32_bf16 v[36:39], a[8:11], a[36:39], 0
    ds_read_b64_tr_b16 a[2:3], v8 offset:2560
    s_add_u32 m0, s32, 0x12f80
    v_mfma_f32_16x16x32_bf16 v[36:39], a[12:15], a[52:55], v[36:39]
    buffer_load_dwordx4 v5, s[16:19], s29 offen offset:128 lds
    s_add_u32 s29, s29, 0x38000
    v_mfma_f32_16x16x32_bf16 v[40:43], a[8:11], a[40:43], 0
    ds_read_b64_tr_b16 a[4:5], v8 offset:16896
    v_mfma_f32_16x16x32_bf16 v[40:43], a[12:15], a[56:59], v[40:43]
    v_mfma_f32_16x16x32_bf16 v[44:47], a[8:11], a[44:47], 0
    ds_read_b64_tr_b16 a[6:7], v8 offset:18944
    v_mfma_f32_16x16x32_bf16 v[44:47], a[12:15], a[60:63], v[44:47]
    s_waitcnt lgkmcnt(4)
    v_mfma_f32_16x16x32_bf16 v[48:51], a[16:19], a[32:35], 0
    ds_read_b64_tr_b16 a[8:9], v7 offset:4096
    v_mfma_f32_16x16x32_bf16 v[48:51], a[20:23], a[48:51], v[48:51]
    buffer_load_dwordx4 a[64:67], v6, s[20:23], s30 offen offset:0 sc1
    v_mfma_f32_16x16x32_bf16 v[52:55], a[16:19], a[36:39], 0
    ds_read_b64_tr_b16 a[10:11], v7 offset:6144
    v_mfma_f32_16x16x32_bf16 v[52:55], a[20:23], a[52:55], v[52:55]
    buffer_load_dwordx4 a[68:71], v6, s[20:23], s30 offen offset:1024 sc1
    v_mfma_f32_16x16x32_bf16 v[56:59], a[16:19], a[40:43], 0
    ds_read_b64_tr_b16 a[12:13], v7 offset:20480
    v_mfma_f32_16x16x32_bf16 v[56:59], a[20:23], a[56:59], v[56:59]
    v_mfma_f32_16x16x32_bf16 v[60:63], a[16:19], a[44:47], 0
    ds_read_b64_tr_b16 a[14:15], v7 offset:22528
    v_mfma_f32_16x16x32_bf16 v[60:63], a[20:23], a[60:63], v[60:63]
    s_waitcnt lgkmcnt(4)
    v_mfma_f32_16x16x32_bf16 v[64:67], a[0:3], a[32:35], 0
    ds_read_b64_tr_b16 a[16:17], v8 offset:4096
    v_mfma_f32_16x16x32_bf16 v[64:67], a[4:7], a[48:51], v[64:67]
    buffer_load_dwordx4 a[72:75], v6, s[20:23], s39 offen offset:0 sc1
    v_mfma_f32_16x16x32_bf16 v[68:71], a[0:3], a[36:39], 0
    ds_read_b64_tr_b16 a[18:19], v8 offset:6144
    v_mfma_f32_16x16x32_bf16 v[68:71], a[4:7], a[52:55], v[68:71]
    buffer_load_dwordx4 a[76:79], v6, s[20:23], s39 offen offset:1024 sc1
    s_add_u32 s30, s30, 4096
    s_add_u32 s39, s39, 4096
    v_mfma_f32_16x16x32_bf16 v[72:75], a[0:3], a[40:43], 0
    ds_read_b64_tr_b16 a[20:21], v8 offset:20480
    s_add_u32 m0, s32, 0x14000
    v_mfma_f32_16x16x32_bf16 v[72:75], a[4:7], a[56:59], v[72:75]
    buffer_load_dwordx4 v3, s[12:15], s28 offen offset:0 lds
    v_mfma_f32_16x16x32_bf16 v[76:79], a[0:3], a[44:47], 0
    ds_read_b64_tr_b16 a[22:23], v8 offset:22528
    v_mfma_f32_16x16x32_bf16 v[76:79], a[4:7], a[60:63], v[76:79]
    s_waitcnt lgkmcnt(4)
    v_mfma_f32_16x16x32_bf16 v[80:83], a[8:11], a[32:35], 0
    ds_read_b64_tr_b16 a[0:1], v7 offset:4608
    s_add_u32 m0, s32, 0x14f80
    v_mfma_f32_16x16x32_bf16 v[80:83], a[12:15], a[48:51], v[80:83]
    buffer_load_dwordx4 v3, s[12:15], s28 offen offset:128 lds
    s_add_u32 s28, s28, 0x40000
    v_mfma_f32_16x16x32_bf16 v[84:87], a[8:11], a[36:39], 0
    ds_read_b64_tr_b16 a[2:3], v7 offset:6656
    s_add_u32 m0, s32, 0x16000
    v_mfma_f32_16x16x32_bf16 v[84:87], a[12:15], a[52:55], v[84:87]
    buffer_load_dwordx4 v4, s[16:19], s29 offen offset:0 lds
    v_mfma_f32_16x16x32_bf16 v[88:91], a[8:11], a[40:43], 0
    ds_read_b64_tr_b16 a[4:5], v7 offset:20992
    v_mfma_f32_16x16x32_bf16 v[88:91], a[12:15], a[56:59], v[88:91]
    v_mfma_f32_16x16x32_bf16 v[92:95], a[8:11], a[44:47], 0
    ds_read_b64_tr_b16 a[6:7], v7 offset:23040
    v_mfma_f32_16x16x32_bf16 v[92:95], a[12:15], a[60:63], v[92:95]
    s_waitcnt lgkmcnt(4)
    v_mfma_f32_16x16x32_bf16 v[96:99], a[16:19], a[32:35], 0
    ds_read_b64_tr_b16 a[8:9], v8 offset:4608
    s_add_u32 m0, s32, 0x16f80
    v_mfma_f32_16x16x32_bf16 v[96:99], a[20:23], a[48:51], v[96:99]
    buffer_load_dwordx4 v5, s[16:19], s29 offen offset:128 lds
    s_add_u32 s29, s29, 0x38000
    v_mfma_f32_16x16x32_bf16 v[100:103], a[16:19], a[36:39], 0
    ds_read_b64_tr_b16 a[10:11], v8 offset:6656
    v_mfma_f32_16x16x32_bf16 v[100:103], a[20:23], a[52:55], v[100:103]
    buffer_load_dwordx4 a[80:83], v6, s[20:23], s30 offen offset:0 sc1
    v_mfma_f32_16x16x32_bf16 v[104:107], a[16:19], a[40:43], 0
    ds_read_b64_tr_b16 a[12:13], v8 offset:20992
    v_mfma_f32_16x16x32_bf16 v[104:107], a[20:23], a[56:59], v[104:107]
    v_mfma_f32_16x16x32_bf16 v[108:111], a[16:19], a[44:47], 0
    ds_read_b64_tr_b16 a[14:15], v8 offset:23040
    v_mfma_f32_16x16x32_bf16 v[108:111], a[20:23], a[60:63], v[108:111]
    s_waitcnt lgkmcnt(4)
    v_mfma_f32_16x16x32_bf16 v[112:115], a[0:3], a[32:35], 0
    ds_read_b64_tr_b16 a[16:17], v7 offset:8192
    v_mfma_f32_16x16x32_bf16 v[112:115], a[4:7], a[48:51], v[112:115]
    buffer_load_dwordx4 a[84:87], v6, s[20:23], s30 offen offset:1024 sc1
    v_mfma_f32_16x16x32_bf16 v[116:119], a[0:3], a[36:39], 0
    ds_read_b64_tr_b16 a[18:19], v7 offset:10240
    v_mfma_f32_16x16x32_bf16 v[116:119], a[4:7], a[52:55], v[116:119]
    buffer_load_dwordx4 a[88:91], v6, s[20:23], s39 offen offset:0 sc1
    v_mfma_f32_16x16x32_bf16 v[120:123], a[0:3], a[40:43], 0
    ds_read_b64_tr_b16 a[20:21], v7 offset:24576
    v_mfma_f32_16x16x32_bf16 v[120:123], a[4:7], a[56:59], v[120:123]
    buffer_load_dwordx4 a[92:95], v6, s[20:23], s39 offen offset:1024 sc1
    s_add_u32 s30, s30, 4096
    s_add_u32 s39, s39, 4096
    v_mfma_f32_16x16x32_bf16 v[124:127], a[0:3], a[44:47], 0
    ds_read_b64_tr_b16 a[22:23], v7 offset:26624
    v_mfma_f32_16x16x32_bf16 v[124:127], a[4:7], a[60:63], v[124:127]
    s_waitcnt lgkmcnt(4)
    v_mfma_f32_16x16x32_bf16 v[128:131], a[8:11], a[32:35], 0
    ds_read_b64_tr_b16 a[0:1], v8 offset:8192
    s_add_u32 m0, s32, 0x18000
    v_mfma_f32_16x16x32_bf16 v[128:131], a[12:15], a[48:51], v[128:131]
    buffer_load_dwordx4 v3, s[12:15], s28 offen offset:0 lds
    v_mfma_f32_16x16x32_bf16 v[132:135], a[8:11], a[36:39], 0
    ds_read_b64_tr_b16 a[2:3], v8 offset:10240
    s_add_u32 m0, s32, 0x18f80
    v_mfma_f32_16x16x32_bf16 v[132:135], a[12:15], a[52:55], v[132:135]
    buffer_load_dwordx4 v3, s[12:15], s28 offen offset:128 lds
    s_add_u32 s28, s28, 0x40000
    v_mfma_f32_16x16x32_bf16 v[136:139], a[8:11], a[40:43], 0
    ds_read_b64_tr_b16 a[4:5], v8 offset:24576
    v_mfma_f32_16x16x32_bf16 v[136:139], a[12:15], a[56:59], v[136:139]
    v_mfma_f32_16x16x32_bf16 v[140:143], a[8:11], a[44:47], 0
    ds_read_b64_tr_b16 a[6:7], v8 offset:26624
    v_mfma_f32_16x16x32_bf16 v[140:143], a[12:15], a[60:63], v[140:143]
    s_waitcnt lgkmcnt(4)
    v_mfma_f32_16x16x32_bf16 v[144:147], a[16:19], a[32:35], 0
    ds_read_b64_tr_b16 a[8:9], v7 offset:8704
    s_add_u32 m0, s32, 0x1a000
    v_mfma_f32_16x16x32_bf16 v[144:147], a[20:23], a[48:51], v[144:147]
    buffer_load_dwordx4 v4, s[16:19], s29 offen offset:0 lds
    v_mfma_f32_16x16x32_bf16 v[148:151], a[16:19], a[36:39], 0
    ds_read_b64_tr_b16 a[10:11], v7 offset:10752
    s_add_u32 m0, s32, 0x1af80
    v_mfma_f32_16x16x32_bf16 v[148:151], a[20:23], a[52:55], v[148:151]
    buffer_load_dwordx4 v5, s[16:19], s29 offen offset:128 lds
    s_add_u32 s29, s29, 0x38000
    v_mfma_f32_16x16x32_bf16 v[152:155], a[16:19], a[40:43], 0
    ds_read_b64_tr_b16 a[12:13], v7 offset:25088
    v_mfma_f32_16x16x32_bf16 v[152:155], a[20:23], a[56:59], v[152:155]
    v_mfma_f32_16x16x32_bf16 v[156:159], a[16:19], a[44:47], 0
    ds_read_b64_tr_b16 a[14:15], v7 offset:27136
    v_mfma_f32_16x16x32_bf16 v[156:159], a[20:23], a[60:63], v[156:159]
    s_waitcnt lgkmcnt(4)
    v_mfma_f32_16x16x32_bf16 v[160:163], a[0:3], a[32:35], 0
    ds_read_b64_tr_b16 a[16:17], v8 offset:8704
    v_mfma_f32_16x16x32_bf16 v[160:163], a[4:7], a[48:51], v[160:163]
    buffer_load_dwordx4 a[96:99], v6, s[20:23], s30 offen offset:0 sc1
    v_mfma_f32_16x16x32_bf16 v[164:167], a[0:3], a[36:39], 0
    ds_read_b64_tr_b16 a[18:19], v8 offset:10752
    v_mfma_f32_16x16x32_bf16 v[164:167], a[4:7], a[52:55], v[164:167]
    buffer_load_dwordx4 a[100:103], v6, s[20:23], s30 offen offset:1024 sc1
    v_mfma_f32_16x16x32_bf16 v[168:171], a[0:3], a[40:43], 0
    ds_read_b64_tr_b16 a[20:21], v8 offset:25088
    v_mfma_f32_16x16x32_bf16 v[168:171], a[4:7], a[56:59], v[168:171]
    v_mfma_f32_16x16x32_bf16 v[172:175], a[0:3], a[44:47], 0
    ds_read_b64_tr_b16 a[22:23], v8 offset:27136
    v_mfma_f32_16x16x32_bf16 v[172:175], a[4:7], a[60:63], v[172:175]
    s_waitcnt lgkmcnt(4)
    v_mfma_f32_16x16x32_bf16 v[176:179], a[8:11], a[32:35], 0
    ds_read_b64_tr_b16 a[0:1], v7 offset:12288
    v_mfma_f32_16x16x32_bf16 v[176:179], a[12:15], a[48:51], v[176:179]
    buffer_load_dwordx4 a[104:107], v6, s[20:23], s39 offen offset:0 sc1
    v_mfma_f32_16x16x32_bf16 v[180:183], a[8:11], a[36:39], 0
    ds_read_b64_tr_b16 a[2:3], v7 offset:14336
    v_mfma_f32_16x16x32_bf16 v[180:183], a[12:15], a[52:55], v[180:183]
    buffer_load_dwordx4 a[108:111], v6, s[20:23], s39 offen offset:1024 sc1
    s_add_u32 s30, s30, 4096
    s_add_u32 s39, s39, 4096
    v_mfma_f32_16x16x32_bf16 v[184:187], a[8:11], a[40:43], 0
    ds_read_b64_tr_b16 a[4:5], v7 offset:28672
    s_add_u32 m0, s32, 0x1c000
    v_mfma_f32_16x16x32_bf16 v[184:187], a[12:15], a[56:59], v[184:187]
    buffer_load_dwordx4 v3, s[12:15], s28 offen offset:0 lds
    v_mfma_f32_16x16x32_bf16 v[188:191], a[8:11], a[44:47], 0
    ds_read_b64_tr_b16 a[6:7], v7 offset:30720
    v_mfma_f32_16x16x32_bf16 v[188:191], a[12:15], a[60:63], v[188:191]
    s_waitcnt lgkmcnt(4)
    v_mfma_f32_16x16x32_bf16 v[192:195], a[16:19], a[32:35], 0
    ds_read_b64_tr_b16 a[8:9], v8 offset:12288
    s_add_u32 m0, s32, 0x1cf80
    v_mfma_f32_16x16x32_bf16 v[192:195], a[20:23], a[48:51], v[192:195]
    buffer_load_dwordx4 v3, s[12:15], s28 offen offset:128 lds
    s_add_u32 s28, s28, 0x40000
    v_mfma_f32_16x16x32_bf16 v[196:199], a[16:19], a[36:39], 0
    ds_read_b64_tr_b16 a[10:11], v8 offset:14336
    s_add_u32 m0, s32, 0x1e000
    v_mfma_f32_16x16x32_bf16 v[196:199], a[20:23], a[52:55], v[196:199]
    buffer_load_dwordx4 v4, s[16:19], s29 offen offset:0 lds
    v_mfma_f32_16x16x32_bf16 v[200:203], a[16:19], a[40:43], 0
    ds_read_b64_tr_b16 a[12:13], v8 offset:28672
    v_mfma_f32_16x16x32_bf16 v[200:203], a[20:23], a[56:59], v[200:203]
    v_mfma_f32_16x16x32_bf16 v[204:207], a[16:19], a[44:47], 0
    ds_read_b64_tr_b16 a[14:15], v8 offset:30720
    v_mfma_f32_16x16x32_bf16 v[204:207], a[20:23], a[60:63], v[204:207]
    s_waitcnt lgkmcnt(4)
    v_mfma_f32_16x16x32_bf16 v[208:211], a[0:3], a[32:35], 0
    ds_read_b64_tr_b16 a[16:17], v7 offset:12800
    s_add_u32 m0, s32, 0x1ef80
    v_mfma_f32_16x16x32_bf16 v[208:211], a[4:7], a[48:51], v[208:211]
    buffer_load_dwordx4 v5, s[16:19], s29 offen offset:128 lds
    s_add_u32 s29, s29, 0x38000
    v_mfma_f32_16x16x32_bf16 v[212:215], a[0:3], a[36:39], 0
    ds_read_b64_tr_b16 a[18:19], v7 offset:14848
    v_mfma_f32_16x16x32_bf16 v[212:215], a[4:7], a[52:55], v[212:215]
    buffer_load_dwordx4 a[112:115], v6, s[20:23], s30 offen offset:0 sc1
    v_mfma_f32_16x16x32_bf16 v[216:219], a[0:3], a[40:43], 0
    ds_read_b64_tr_b16 a[20:21], v7 offset:29184
    v_mfma_f32_16x16x32_bf16 v[216:219], a[4:7], a[56:59], v[216:219]
    v_mfma_f32_16x16x32_bf16 v[220:223], a[0:3], a[44:47], 0
    ds_read_b64_tr_b16 a[22:23], v7 offset:31232
    v_mfma_f32_16x16x32_bf16 v[220:223], a[4:7], a[60:63], v[220:223]
    s_waitcnt vmcnt(13)
    s_barrier
    s_waitcnt lgkmcnt(4)
    v_mfma_f32_16x16x32_bf16 v[224:227], a[8:11], a[32:35], 0
    ds_read_b64_tr_b16 a[0:1], v8 offset:12800
    v_mfma_f32_16x16x32_bf16 v[224:227], a[12:15], a[48:51], v[224:227]
    buffer_load_dwordx4 a[116:119], v6, s[20:23], s30 offen offset:1024 sc1
    v_mfma_f32_16x16x32_bf16 v[228:231], a[8:11], a[36:39], 0
    ds_read_b64_tr_b16 a[2:3], v8 offset:14848
    v_mfma_f32_16x16x32_bf16 v[228:231], a[12:15], a[52:55], v[228:231]
    buffer_load_dwordx4 a[120:123], v6, s[20:23], s39 offen offset:0 sc1
    v_mfma_f32_16x16x32_bf16 v[232:235], a[8:11], a[40:43], 0
    ds_read_b64_tr_b16 a[4:5], v8 offset:29184
    v_mfma_f32_16x16x32_bf16 v[232:235], a[12:15], a[56:59], v[232:235]
    buffer_load_dwordx4 a[124:127], v6, s[20:23], s39 offen offset:1024 sc1
    s_add_u32 s30, s30, 4096
    s_add_u32 s39, s39, 4096
    v_mfma_f32_16x16x32_bf16 v[236:239], a[8:11], a[44:47], 0
    ds_read_b64_tr_b16 a[6:7], v8 offset:31232
    v_mfma_f32_16x16x32_bf16 v[236:239], a[12:15], a[60:63], v[236:239]
    s_waitcnt lgkmcnt(4)
    v_mfma_f32_16x16x32_bf16 v[240:243], a[16:19], a[32:35], 0
    ds_read_b64_tr_b16 a[8:9], v7 offset:32768
    v_mfma_f32_16x16x32_bf16 v[240:243], a[20:23], a[48:51], v[240:243]
    ds_read_b64_tr_b16 a[10:11], v7 offset:34816
    v_mfma_f32_16x16x32_bf16 v[244:247], a[16:19], a[36:39], 0
    ds_read_b64_tr_b16 a[12:13], v7 offset:49152
    v_mfma_f32_16x16x32_bf16 v[244:247], a[20:23], a[52:55], v[244:247]
    ds_read_b64_tr_b16 a[14:15], v7 offset:51200
    s_waitcnt lgkmcnt(4)
    v_mfma_f32_16x16x32_bf16 v[248:251], a[0:3], a[32:35], 0
    ds_read_b64_tr_b16 a[16:17], v8 offset:32768
    v_mfma_f32_16x16x32_bf16 v[248:251], a[4:7], a[48:51], v[248:251]
    ds_read_b64_tr_b16 a[18:19], v8 offset:34816
    v_mfma_f32_16x16x32_bf16 v[252:255], a[0:3], a[36:39], 0
    ds_read_b64_tr_b16 a[20:21], v8 offset:49152
    v_mfma_f32_16x16x32_bf16 v[252:255], a[4:7], a[52:55], v[252:255]
    ds_read_b64_tr_b16 a[22:23], v8 offset:51200
    s_waitcnt lgkmcnt(4)
    v_mfma_f32_16x16x32_bf16 v[16:19], a[8:11], a[64:67], v[16:19]
    ds_read_b64_tr_b16 a[0:1], v7 offset:33280
    s_add_u32 m0, s32, 0x20000
    v_mfma_f32_16x16x32_bf16 v[16:19], a[12:15], a[80:83], v[16:19]
    buffer_load_dwordx4 v3, s[12:15], s28 offen offset:0 lds
    v_mfma_f32_16x16x32_bf16 v[20:23], a[8:11], a[68:71], v[20:23]
    ds_read_b64_tr_b16 a[2:3], v7 offset:35328
    v_mfma_f32_16x16x32_bf16 v[20:23], a[12:15], a[84:87], v[20:23]
    v_mfma_f32_16x16x32_bf16 v[24:27], a[8:11], a[72:75], v[24:27]
    ds_read_b64_tr_b16 a[4:5], v7 offset:49664
    v_mfma_f32_16x16x32_bf16 v[24:27], a[12:15], a[88:91], v[24:27]
    v_mfma_f32_16x16x32_bf16 v[28:31], a[8:11], a[76:79], v[28:31]
    ds_read_b64_tr_b16 a[6:7], v7 offset:51712
    v_mfma_f32_16x16x32_bf16 v[28:31], a[12:15], a[92:95], v[28:31]
    s_waitcnt lgkmcnt(4)
    v_mfma_f32_16x16x32_bf16 v[32:35], a[16:19], a[64:67], v[32:35]
    ds_read_b64_tr_b16 a[8:9], v8 offset:33280
    s_add_u32 m0, s32, 0x20f80
    v_mfma_f32_16x16x32_bf16 v[32:35], a[20:23], a[80:83], v[32:35]
    buffer_load_dwordx4 v3, s[12:15], s28 offen offset:128 lds
    s_add_u32 s28, s28, 0x40000
    v_mfma_f32_16x16x32_bf16 v[36:39], a[16:19], a[68:71], v[36:39]
    ds_read_b64_tr_b16 a[10:11], v8 offset:35328
    s_add_u32 m0, s32, 0x22000
    v_mfma_f32_16x16x32_bf16 v[36:39], a[20:23], a[84:87], v[36:39]
    buffer_load_dwordx4 v4, s[16:19], s29 offen offset:0 lds
    v_mfma_f32_16x16x32_bf16 v[40:43], a[16:19], a[72:75], v[40:43]
    ds_read_b64_tr_b16 a[12:13], v8 offset:49664
    v_mfma_f32_16x16x32_bf16 v[40:43], a[20:23], a[88:91], v[40:43]
    v_mfma_f32_16x16x32_bf16 v[44:47], a[16:19], a[76:79], v[44:47]
    ds_read_b64_tr_b16 a[14:15], v8 offset:51712
    v_mfma_f32_16x16x32_bf16 v[44:47], a[20:23], a[92:95], v[44:47]
    s_waitcnt lgkmcnt(4)
    v_mfma_f32_16x16x32_bf16 v[48:51], a[0:3], a[64:67], v[48:51]
    ds_read_b64_tr_b16 a[16:17], v7 offset:36864
    s_add_u32 m0, s32, 0x22f80
    v_mfma_f32_16x16x32_bf16 v[48:51], a[4:7], a[80:83], v[48:51]
    buffer_load_dwordx4 v5, s[16:19], s29 offen offset:128 lds
    s_add_u32 s29, s29, 0x38000
    v_mfma_f32_16x16x32_bf16 v[52:55], a[0:3], a[68:71], v[52:55]
    ds_read_b64_tr_b16 a[18:19], v7 offset:38912
    v_mfma_f32_16x16x32_bf16 v[52:55], a[4:7], a[84:87], v[52:55]
    v_mfma_f32_16x16x32_bf16 v[56:59], a[0:3], a[72:75], v[56:59]
    ds_read_b64_tr_b16 a[20:21], v7 offset:53248
    v_mfma_f32_16x16x32_bf16 v[56:59], a[4:7], a[88:91], v[56:59]
    v_mfma_f32_16x16x32_bf16 v[60:63], a[0:3], a[76:79], v[60:63]
    ds_read_b64_tr_b16 a[22:23], v7 offset:55296
    v_mfma_f32_16x16x32_bf16 v[60:63], a[4:7], a[92:95], v[60:63]
    s_waitcnt lgkmcnt(4)
    v_mfma_f32_16x16x32_bf16 v[64:67], a[8:11], a[64:67], v[64:67]
    ds_read_b64_tr_b16 a[0:1], v8 offset:36864
    v_mfma_f32_16x16x32_bf16 v[64:67], a[12:15], a[80:83], v[64:67]
    buffer_load_dwordx4 a[128:131], v6, s[20:23], s30 offen offset:0 sc1
    v_mfma_f32_16x16x32_bf16 v[68:71], a[8:11], a[68:71], v[68:71]
    ds_read_b64_tr_b16 a[2:3], v8 offset:38912
    v_mfma_f32_16x16x32_bf16 v[68:71], a[12:15], a[84:87], v[68:71]
    buffer_load_dwordx4 a[132:135], v6, s[20:23], s30 offen offset:1024 sc1
    v_mfma_f32_16x16x32_bf16 v[72:75], a[8:11], a[72:75], v[72:75]
    ds_read_b64_tr_b16 a[4:5], v8 offset:53248
    v_mfma_f32_16x16x32_bf16 v[72:75], a[12:15], a[88:91], v[72:75]
    v_mfma_f32_16x16x32_bf16 v[76:79], a[8:11], a[76:79], v[76:79]
    ds_read_b64_tr_b16 a[6:7], v8 offset:55296
    v_mfma_f32_16x16x32_bf16 v[76:79], a[12:15], a[92:95], v[76:79]
    s_waitcnt lgkmcnt(4)
    v_mfma_f32_16x16x32_bf16 v[80:83], a[16:19], a[64:67], v[80:83]
    ds_read_b64_tr_b16 a[8:9], v7 offset:37376
    v_mfma_f32_16x16x32_bf16 v[80:83], a[20:23], a[80:83], v[80:83]
    buffer_load_dwordx4 a[136:139], v6, s[20:23], s39 offen offset:0 sc1
    v_mfma_f32_16x16x32_bf16 v[84:87], a[16:19], a[68:71], v[84:87]
    ds_read_b64_tr_b16 a[10:11], v7 offset:39424
    v_mfma_f32_16x16x32_bf16 v[84:87], a[20:23], a[84:87], v[84:87]
    v_mfma_f32_16x16x32_bf16 v[88:91], a[16:19], a[72:75], v[88:91]
    ds_read_b64_tr_b16 a[12:13], v7 offset:53760
    v_mfma_f32_16x16x32_bf16 v[88:91], a[20:23], a[88:91], v[88:91]
    v_mfma_f32_16x16x32_bf16 v[92:95], a[16:19], a[76:79], v[92:95]
    ds_read_b64_tr_b16 a[14:15], v7 offset:55808
    v_mfma_f32_16x16x32_bf16 v[92:95], a[20:23], a[92:95], v[92:95]
    s_waitcnt lgkmcnt(4)
    v_mfma_f32_16x16x32_bf16 v[96:99], a[0:3], a[64:67], v[96:99]
    ds_read_b64_tr_b16 a[16:17], v8 offset:37376
    v_mfma_f32_16x16x32_bf16 v[96:99], a[4:7], a[80:83], v[96:99]
    buffer_load_dwordx4 a[140:143], v6, s[20:23], s39 offen offset:1024 sc1
    s_add_u32 s30, s30, 4096
    s_add_u32 s39, s39, 4096
    v_mfma_f32_16x16x32_bf16 v[100:103], a[0:3], a[68:71], v[100:103]
    ds_read_b64_tr_b16 a[18:19], v8 offset:39424
    s_add_u32 m0, s32, 0x24000
    v_mfma_f32_16x16x32_bf16 v[100:103], a[4:7], a[84:87], v[100:103]
    buffer_load_dwordx4 v3, s[12:15], s28 offen offset:0 lds
    v_mfma_f32_16x16x32_bf16 v[104:107], a[0:3], a[72:75], v[104:107]
    ds_read_b64_tr_b16 a[20:21], v8 offset:53760
    v_mfma_f32_16x16x32_bf16 v[104:107], a[4:7], a[88:91], v[104:107]
    v_mfma_f32_16x16x32_bf16 v[108:111], a[0:3], a[76:79], v[108:111]
    ds_read_b64_tr_b16 a[22:23], v8 offset:55808
    v_mfma_f32_16x16x32_bf16 v[108:111], a[4:7], a[92:95], v[108:111]
    s_waitcnt lgkmcnt(4)
    v_mfma_f32_16x16x32_bf16 v[112:115], a[8:11], a[64:67], v[112:115]
    ds_read_b64_tr_b16 a[0:1], v7 offset:40960
    s_add_u32 m0, s32, 0x24f80
    v_mfma_f32_16x16x32_bf16 v[112:115], a[12:15], a[80:83], v[112:115]
    buffer_load_dwordx4 v3, s[12:15], s28 offen offset:128 lds
    s_add_u32 s28, s28, 0x40000
    v_mfma_f32_16x16x32_bf16 v[116:119], a[8:11], a[68:71], v[116:119]
    ds_read_b64_tr_b16 a[2:3], v7 offset:43008
    v_mfma_f32_16x16x32_bf16 v[116:119], a[12:15], a[84:87], v[116:119]
    v_mfma_f32_16x16x32_bf16 v[120:123], a[8:11], a[72:75], v[120:123]
    ds_read_b64_tr_b16 a[4:5], v7 offset:57344
    v_mfma_f32_16x16x32_bf16 v[120:123], a[12:15], a[88:91], v[120:123]
    v_mfma_f32_16x16x32_bf16 v[124:127], a[8:11], a[76:79], v[124:127]
    ds_read_b64_tr_b16 a[6:7], v7 offset:59392
    v_mfma_f32_16x16x32_bf16 v[124:127], a[12:15], a[92:95], v[124:127]
    s_waitcnt lgkmcnt(4)
    v_mfma_f32_16x16x32_bf16 v[128:131], a[16:19], a[64:67], v[128:131]
    ds_read_b64_tr_b16 a[8:9], v8 offset:40960
    s_add_u32 m0, s32, 0x26000
    v_mfma_f32_16x16x32_bf16 v[128:131], a[20:23], a[80:83], v[128:131]
    buffer_load_dwordx4 v4, s[16:19], s29 offen offset:0 lds
    v_mfma_f32_16x16x32_bf16 v[132:135], a[16:19], a[68:71], v[132:135]
    ds_read_b64_tr_b16 a[10:11], v8 offset:43008
    s_add_u32 m0, s32, 0x26f80
    v_mfma_f32_16x16x32_bf16 v[132:135], a[20:23], a[84:87], v[132:135]
    buffer_load_dwordx4 v5, s[16:19], s29 offen offset:128 lds
    s_add_u32 s29, s29, 0x38000
    v_mfma_f32_16x16x32_bf16 v[136:139], a[16:19], a[72:75], v[136:139]
    ds_read_b64_tr_b16 a[12:13], v8 offset:57344
    v_mfma_f32_16x16x32_bf16 v[136:139], a[20:23], a[88:91], v[136:139]
    v_mfma_f32_16x16x32_bf16 v[140:143], a[16:19], a[76:79], v[140:143]
    ds_read_b64_tr_b16 a[14:15], v8 offset:59392
    v_mfma_f32_16x16x32_bf16 v[140:143], a[20:23], a[92:95], v[140:143]
    s_waitcnt lgkmcnt(4)
    v_mfma_f32_16x16x32_bf16 v[144:147], a[0:3], a[64:67], v[144:147]
    ds_read_b64_tr_b16 a[16:17], v7 offset:41472
    v_mfma_f32_16x16x32_bf16 v[144:147], a[4:7], a[80:83], v[144:147]
    buffer_load_dwordx4 a[144:147], v6, s[20:23], s30 offen offset:0 sc1
    v_mfma_f32_16x16x32_bf16 v[148:151], a[0:3], a[68:71], v[148:151]
    ds_read_b64_tr_b16 a[18:19], v7 offset:43520
    v_mfma_f32_16x16x32_bf16 v[148:151], a[4:7], a[84:87], v[148:151]
    v_mfma_f32_16x16x32_bf16 v[152:155], a[0:3], a[72:75], v[152:155]
    ds_read_b64_tr_b16 a[20:21], v7 offset:57856
    v_mfma_f32_16x16x32_bf16 v[152:155], a[4:7], a[88:91], v[152:155]
    v_mfma_f32_16x16x32_bf16 v[156:159], a[0:3], a[76:79], v[156:159]
    ds_read_b64_tr_b16 a[22:23], v7 offset:59904
    v_mfma_f32_16x16x32_bf16 v[156:159], a[4:7], a[92:95], v[156:159]
    s_waitcnt lgkmcnt(4)
    v_mfma_f32_16x16x32_bf16 v[160:163], a[8:11], a[64:67], v[160:163]
    ds_read_b64_tr_b16 a[0:1], v8 offset:41472
    v_mfma_f32_16x16x32_bf16 v[160:163], a[12:15], a[80:83], v[160:163]
    buffer_load_dwordx4 a[148:151], v6, s[20:23], s30 offen offset:1024 sc1
    v_mfma_f32_16x16x32_bf16 v[164:167], a[8:11], a[68:71], v[164:167]
    ds_read_b64_tr_b16 a[2:3], v8 offset:43520
    v_mfma_f32_16x16x32_bf16 v[164:167], a[12:15], a[84:87], v[164:167]
    buffer_load_dwordx4 a[152:155], v6, s[20:23], s39 offen offset:0 sc1
    v_mfma_f32_16x16x32_bf16 v[168:171], a[8:11], a[72:75], v[168:171]
    ds_read_b64_tr_b16 a[4:5], v8 offset:57856
    v_mfma_f32_16x16x32_bf16 v[168:171], a[12:15], a[88:91], v[168:171]
    v_mfma_f32_16x16x32_bf16 v[172:175], a[8:11], a[76:79], v[172:175]
    ds_read_b64_tr_b16 a[6:7], v8 offset:59904
    v_mfma_f32_16x16x32_bf16 v[172:175], a[12:15], a[92:95], v[172:175]
    s_waitcnt lgkmcnt(4)
    v_mfma_f32_16x16x32_bf16 v[176:179], a[16:19], a[64:67], v[176:179]
    ds_read_b64_tr_b16 a[8:9], v7 offset:45056
    v_mfma_f32_16x16x32_bf16 v[176:179], a[20:23], a[80:83], v[176:179]
    buffer_load_dwordx4 a[156:159], v6, s[20:23], s39 offen offset:1024 sc1
    s_add_u32 s30, s30, 4096
    s_add_u32 s39, s39, 4096
    v_mfma_f32_16x16x32_bf16 v[180:183], a[16:19], a[68:71], v[180:183]
    ds_read_b64_tr_b16 a[10:11], v7 offset:47104
    v_mfma_f32_16x16x32_bf16 v[180:183], a[20:23], a[84:87], v[180:183]
    v_mfma_f32_16x16x32_bf16 v[184:187], a[16:19], a[72:75], v[184:187]
    ds_read_b64_tr_b16 a[12:13], v7 offset:61440
    v_mfma_f32_16x16x32_bf16 v[184:187], a[20:23], a[88:91], v[184:187]
    v_mfma_f32_16x16x32_bf16 v[188:191], a[16:19], a[76:79], v[188:191]
    ds_read_b64_tr_b16 a[14:15], v7 offset:63488
    v_mfma_f32_16x16x32_bf16 v[188:191], a[20:23], a[92:95], v[188:191]
    s_waitcnt lgkmcnt(4)
    v_mfma_f32_16x16x32_bf16 v[192:195], a[0:3], a[64:67], v[192:195]
    ds_read_b64_tr_b16 a[16:17], v8 offset:45056
    v_mfma_f32_16x16x32_bf16 v[192:195], a[4:7], a[80:83], v[192:195]
    buffer_load_dwordx4 a[224:227], v11, s[12:15], s72 offen offset:0
    v_mfma_f32_16x16x32_bf16 v[196:199], a[0:3], a[68:71], v[196:199]
    ds_read_b64_tr_b16 a[18:19], v8 offset:47104
    v_mfma_f32_16x16x32_bf16 v[196:199], a[4:7], a[84:87], v[196:199]
    buffer_load_dwordx4 a[232:235], v12, s[16:19], s73 offen offset:0
    v_mfma_f32_16x16x32_bf16 v[200:203], a[0:3], a[72:75], v[200:203]
    ds_read_b64_tr_b16 a[20:21], v8 offset:61440
    v_mfma_f32_16x16x32_bf16 v[200:203], a[4:7], a[88:91], v[200:203]
    v_mfma_f32_16x16x32_bf16 v[204:207], a[0:3], a[76:79], v[204:207]
    ds_read_b64_tr_b16 a[22:23], v8 offset:63488
    v_mfma_f32_16x16x32_bf16 v[204:207], a[4:7], a[92:95], v[204:207]
    s_waitcnt vmcnt(18)
    s_barrier
    s_waitcnt lgkmcnt(4)
    v_mfma_f32_16x16x32_bf16 v[208:211], a[8:11], a[64:67], v[208:211]
    ds_read_b64_tr_b16 a[0:1], v7 offset:45568
    v_mfma_f32_16x16x32_bf16 v[208:211], a[12:15], a[80:83], v[208:211]
    buffer_load_dwordx4 a[228:231], v11, s[12:15], s72 offen offset:1024
    v_mfma_f32_16x16x32_bf16 v[212:215], a[8:11], a[68:71], v[212:215]
    ds_read_b64_tr_b16 a[2:3], v7 offset:47616
    v_mfma_f32_16x16x32_bf16 v[212:215], a[12:15], a[84:87], v[212:215]
    v_mfma_f32_16x16x32_bf16 v[216:219], a[8:11], a[72:75], v[216:219]
    ds_read_b64_tr_b16 a[4:5], v7 offset:61952
    v_mfma_f32_16x16x32_bf16 v[216:219], a[12:15], a[88:91], v[216:219]
    v_mfma_f32_16x16x32_bf16 v[220:223], a[8:11], a[76:79], v[220:223]
    ds_read_b64_tr_b16 a[6:7], v7 offset:64000
    v_mfma_f32_16x16x32_bf16 v[220:223], a[12:15], a[92:95], v[220:223]
    s_waitcnt lgkmcnt(4)
    v_mfma_f32_16x16x32_bf16 v[224:227], a[16:19], a[64:67], v[224:227]
    ds_read_b64_tr_b16 a[8:9], v8 offset:45568
    v_mfma_f32_16x16x32_bf16 v[224:227], a[20:23], a[80:83], v[224:227]
    buffer_load_dwordx4 a[236:239], v12, s[16:19], s73 offen offset:896
    s_add_u32 s72, s72, 0x200000
    s_add_u32 s73, s73, 0x1c0000
    v_mfma_f32_16x16x32_bf16 v[228:231], a[16:19], a[68:71], v[228:231]
    ds_read_b64_tr_b16 a[10:11], v8 offset:47616
    v_mfma_f32_16x16x32_bf16 v[228:231], a[20:23], a[84:87], v[228:231]
    s_cmp_eq_u32 s75, 0
    s_cselect_b32 s64, s74, 0x7f000000
    v_mov_b32 v14, 3
    s_mov_b64 exec, 1
    buffer_store_byte v14, off, s[60:63], s64 sc1
    s_mov_b64 exec, -1
    v_mfma_f32_16x16x32_bf16 v[232:235], a[16:19], a[72:75], v[232:235]
    ds_read_b64_tr_b16 a[12:13], v8 offset:61952
    v_mfma_f32_16x16x32_bf16 v[232:235], a[20:23], a[88:91], v[232:235]
    v_mfma_f32_16x16x32_bf16 v[236:239], a[16:19], a[76:79], v[236:239]
    ds_read_b64_tr_b16 a[14:15], v8 offset:64000
    v_mfma_f32_16x16x32_bf16 v[236:239], a[20:23], a[92:95], v[236:239]
    s_waitcnt lgkmcnt(4)
    v_mfma_f32_16x16x32_bf16 v[240:243], a[0:3], a[64:67], v[240:243]
    ds_read_b64_tr_b16 a[16:17], v9 offset:0
    v_mfma_f32_16x16x32_bf16 v[240:243], a[4:7], a[80:83], v[240:243]
    ds_read_b64_tr_b16 a[18:19], v9 offset:2048
    v_mfma_f32_16x16x32_bf16 v[244:247], a[0:3], a[68:71], v[244:247]
    ds_read_b64_tr_b16 a[20:21], v9 offset:16384
    v_mfma_f32_16x16x32_bf16 v[244:247], a[4:7], a[84:87], v[244:247]
    ds_read_b64_tr_b16 a[22:23], v9 offset:18432
    s_waitcnt lgkmcnt(4)
    v_mfma_f32_16x16x32_bf16 v[248:251], a[8:11], a[64:67], v[248:251]
    ds_read_b64_tr_b16 a[0:1], v10 offset:0
    v_mfma_f32_16x16x32_bf16 v[248:251], a[12:15], a[80:83], v[248:251]
    ds_read_b64_tr_b16 a[2:3], v10 offset:2048
    v_mfma_f32_16x16x32_bf16 v[252:255], a[8:11], a[68:71], v[252:255]
    ds_read_b64_tr_b16 a[4:5], v10 offset:16384
    v_mfma_f32_16x16x32_bf16 v[252:255], a[12:15], a[84:87], v[252:255]
    ds_read_b64_tr_b16 a[6:7], v10 offset:18432
    s_waitcnt lgkmcnt(4)
    v_mfma_f32_16x16x32_bf16 v[16:19], a[16:19], a[96:99], v[16:19]
    ds_read_b64_tr_b16 a[8:9], v9 offset:512
    s_add_u32 m0, s32, 0x8000
    v_mfma_f32_16x16x32_bf16 v[16:19], a[20:23], a[112:115], v[16:19]
    buffer_load_dwordx4 v3, s[12:15], s28 offen offset:0 lds
    v_mfma_f32_16x16x32_bf16 v[20:23], a[16:19], a[100:103], v[20:23]
    ds_read_b64_tr_b16 a[10:11], v9 offset:2560
    v_mfma_f32_16x16x32_bf16 v[20:23], a[20:23], a[116:119], v[20:23]
    v_mfma_f32_16x16x32_bf16 v[24:27], a[16:19], a[104:107], v[24:27]
    ds_read_b64_tr_b16 a[12:13], v9 offset:16896
    v_mfma_f32_16x16x32_bf16 v[24:27], a[20:23], a[120:123], v[24:27]
    v_mfma_f32_16x16x32_bf16 v[28:31], a[16:19], a[108:111], v[28:31]
    ds_read_b64_tr_b16 a[14:15], v9 offset:18944
    v_mfma_f32_16x16x32_bf16 v[28:31], a[20:23], a[124:127], v[28:31]
    s_waitcnt lgkmcnt(4)
    v_mfma_f32_16x16x32_bf16 v[32:35], a[0:3], a[96:99], v[32:35]
    ds_read_b64_tr_b16 a[16:17], v10 offset:512
    s_add_u32 m0, s32, 0x8f80
    v_mfma_f32_16x16x32_bf16 v[32:35], a[4:7], a[112:115], v[32:35]
    buffer_load_dwordx4 v3, s[12:15], s28 offen offset:128 lds
    s_add_u32 s28, s28, 0x40000
    v_mfma_f32_16x16x32_bf16 v[36:39], a[0:3], a[100:103], v[36:39]
    ds_read_b64_tr_b16 a[18:19], v10 offset:2560
    v_mfma_f32_16x16x32_bf16 v[36:39], a[4:7], a[116:119], v[36:39]
    v_mfma_f32_16x16x32_bf16 v[40:43], a[0:3], a[104:107], v[40:43]
    ds_read_b64_tr_b16 a[20:21], v10 offset:16896
    v_mfma_f32_16x16x32_bf16 v[40:43], a[4:7], a[120:123], v[40:43]
    v_mfma_f32_16x16x32_bf16 v[44:47], a[0:3], a[108:111], v[44:47]
    ds_read_b64_tr_b16 a[22:23], v10 offset:18944
    v_mfma_f32_16x16x32_bf16 v[44:47], a[4:7], a[124:127], v[44:47]
    s_waitcnt lgkmcnt(4)
    v_mfma_f32_16x16x32_bf16 v[48:51], a[8:11], a[96:99], v[48:51]
    ds_read_b64_tr_b16 a[0:1], v9 offset:4096
    s_add_u32 m0, s32, 0xa000
    v_mfma_f32_16x16x32_bf16 v[48:51], a[12:15], a[112:115], v[48:51]
    buffer_load_dwordx4 v4, s[16:19], s29 offen offset:0 lds
    v_mfma_f32_16x16x32_bf16 v[52:55], a[8:11], a[100:103], v[52:55]
    ds_read_b64_tr_b16 a[2:3], v9 offset:6144
    v_mfma_f32_16x16x32_bf16 v[52:55], a[12:15], a[116:119], v[52:55]
    v_mfma_f32_16x16x32_bf16 v[56:59], a[8:11], a[104:107], v[56:59]
    ds_read_b64_tr_b16 a[4:5], v9 offset:20480
    v_mfma_f32_16x16x32_bf16 v[56:59], a[12:15], a[120:123], v[56:59]
    v_mfma_f32_16x16x32_bf16 v[60:63], a[8:11], a[108:111], v[60:63]
    ds_read_b64_tr_b16 a[6:7], v9 offset:22528
    v_mfma_f32_16x16x32_bf16 v[60:63], a[12:15], a[124:127], v[60:63]
    s_waitcnt lgkmcnt(4)
    v_mfma_f32_16x16x32_bf16 v[64:67], a[16:19], a[96:99], v[64:67]
    ds_read_b64_tr_b16 a[8:9], v10 offset:4096
    s_add_u32 m0, s32, 0xaf80
    v_mfma_f32_16x16x32_bf16 v[64:67], a[20:23], a[112:115], v[64:67]
    buffer_load_dwordx4 v5, s[16:19], s29 offen offset:128 lds
    s_add_u32 s29, s29, 0x38000
    v_mfma_f32_16x16x32_bf16 v[68:71], a[16:19], a[100:103], v[68:71]
    ds_read_b64_tr_b16 a[10:11], v10 offset:6144
    v_mfma_f32_16x16x32_bf16 v[68:71], a[20:23], a[116:119], v[68:71]
    v_mfma_f32_16x16x32_bf16 v[72:75], a[16:19], a[104:107], v[72:75]
    ds_read_b64_tr_b16 a[12:13], v10 offset:20480
    v_mfma_f32_16x16x32_bf16 v[72:75], a[20:23], a[120:123], v[72:75]
    v_mfma_f32_16x16x32_bf16 v[76:79], a[16:19], a[108:111], v[76:79]
    ds_read_b64_tr_b16 a[14:15], v10 offset:22528
    v_mfma_f32_16x16x32_bf16 v[76:79], a[20:23], a[124:127], v[76:79]
    s_waitcnt lgkmcnt(4)
    v_mfma_f32_16x16x32_bf16 v[80:83], a[0:3], a[96:99], v[80:83]
    ds_read_b64_tr_b16 a[16:17], v9 offset:4608
    v_mfma_f32_16x16x32_bf16 v[80:83], a[4:7], a[112:115], v[80:83]
    buffer_load_dwordx4 a[32:35], v6, s[20:23], s30 offen offset:0 sc1
    v_mfma_f32_16x16x32_bf16 v[84:87], a[0:3], a[100:103], v[84:87]
    ds_read_b64_tr_b16 a[18:19], v9 offset:6656
    v_mfma_f32_16x16x32_bf16 v[84:87], a[4:7], a[116:119], v[84:87]
    buffer_load_dwordx4 a[36:39], v6, s[20:23], s30 offen offset:1024 sc1
    v_mfma_f32_16x16x32_bf16 v[88:91], a[0:3], a[104:107], v[88:91]
    ds_read_b64_tr_b16 a[20:21], v9 offset:20992
    v_mfma_f32_16x16x32_bf16 v[88:91], a[4:7], a[120:123], v[88:91]
    v_mfma_f32_16x16x32_bf16 v[92:95], a[0:3], a[108:111], v[92:95]
    ds_read_b64_tr_b16 a[22:23], v9 offset:23040
    v_mfma_f32_16x16x32_bf16 v[92:95], a[4:7], a[124:127], v[92:95]
    s_waitcnt lgkmcnt(4)
    v_mfma_f32_16x16x32_bf16 v[96:99], a[8:11], a[96:99], v[96:99]
    ds_read_b64_tr_b16 a[0:1], v10 offset:4608
    v_mfma_f32_16x16x32_bf16 v[96:99], a[12:15], a[112:115], v[96:99]
    buffer_load_dwordx4 a[40:43], v6, s[20:23], s39 offen offset:0 sc1
    v_mfma_f32_16x16x32_bf16 v[100:103], a[8:11], a[100:103], v[100:103]
    ds_read_b64_tr_b16 a[2:3], v10 offset:6656
    v_mfma_f32_16x16x32_bf16 v[100:103], a[12:15], a[116:119], v[100:103]
    v_mfma_f32_16x16x32_bf16 v[104:107], a[8:11], a[104:107], v[104:107]
    ds_read_b64_tr_b16 a[4:5], v10 offset:20992
    v_mfma_f32_16x16x32_bf16 v[104:107], a[12:15], a[120:123], v[104:107]
    v_mfma_f32_16x16x32_bf16 v[108:111], a[8:11], a[108:111], v[108:111]
    ds_read_b64_tr_b16 a[6:7], v10 offset:23040
    v_mfma_f32_16x16x32_bf16 v[108:111], a[12:15], a[124:127], v[108:111]
    s_waitcnt lgkmcnt(4)
    v_mfma_f32_16x16x32_bf16 v[112:115], a[16:19], a[96:99], v[112:115]
    ds_read_b64_tr_b16 a[8:9], v9 offset:8192
    v_mfma_f32_16x16x32_bf16 v[112:115], a[20:23], a[112:115], v[112:115]
    buffer_load_dwordx4 a[44:47], v6, s[20:23], s39 offen offset:1024 sc1
    s_add_u32 s30, s30, 4096
    s_add_u32 s39, s39, 4096
    v_mfma_f32_16x16x32_bf16 v[116:119], a[16:19], a[100:103], v[116:119]
    ds_read_b64_tr_b16 a[10:11], v9 offset:10240
    v_mfma_f32_16x16x32_bf16 v[116:119], a[20:23], a[116:119], v[116:119]
    v_mfma_f32_16x16x32_bf16 v[120:123], a[16:19], a[104:107], v[120:123]
    ds_read_b64_tr_b16 a[12:13], v9 offset:24576
    v_mfma_f32_16x16x32_bf16 v[120:123], a[20:23], a[120:123], v[120:123]
    v_mfma_f32_16x16x32_bf16 v[124:127], a[16:19], a[108:111], v[124:127]
    ds_read_b64_tr_b16 a[14:15], v9 offset:26624
    v_mfma_f32_16x16x32_bf16 v[124:127], a[20:23], a[124:127], v[124:127]
    s_waitcnt lgkmcnt(4)
    v_mfma_f32_16x16x32_bf16 v[128:131], a[0:3], a[96:99], v[128:131]
    ds_read_b64_tr_b16 a[16:17], v10 offset:8192
    s_add_u32 m0, s32, 0xc000
    v_mfma_f32_16x16x32_bf16 v[128:131], a[4:7], a[112:115], v[128:131]
    buffer_load_dwordx4 v3, s[12:15], s28 offen offset:0 lds
    v_mfma_f32_16x16x32_bf16 v[132:135], a[0:3], a[100:103], v[132:135]
    ds_read_b64_tr_b16 a[18:19], v10 offset:10240
    v_mfma_f32_16x16x32_bf16 v[132:135], a[4:7], a[116:119], v[132:135]
    v_mfma_f32_16x16x32_bf16 v[136:139], a[0:3], a[104:107], v[136:139]
    ds_read_b64_tr_b16 a[20:21], v10 offset:24576
    v_mfma_f32_16x16x32_bf16 v[136:139], a[4:7], a[120:123], v[136:139]
    v_mfma_f32_16x16x32_bf16 v[140:143], a[0:3], a[108:111], v[140:143]
    ds_read_b64_tr_b16 a[22:23], v10 offset:26624
    v_mfma_f32_16x16x32_bf16 v[140:143], a[4:7], a[124:127], v[140:143]
    s_waitcnt lgkmcnt(4)
    v_mfma_f32_16x16x32_bf16 v[144:147], a[8:11], a[96:99], v[144:147]
    ds_read_b64_tr_b16 a[0:1], v9 offset:8704
    s_add_u32 m0, s32, 0xcf80
    v_mfma_f32_16x16x32_bf16 v[144:147], a[12:15], a[112:115], v[144:147]
    buffer_load_dwordx4 v3, s[12:15], s28 offen offset:128 lds
    s_add_u32 s28, s28, 0x40000
    v_mfma_f32_16x16x32_bf16 v[148:151], a[8:11], a[100:103], v[148:151]
    ds_read_b64_tr_b16 a[2:3], v9 offset:10752
    v_mfma_f32_16x16x32_bf16 v[148:151], a[12:15], a[116:119], v[148:151]
    v_mfma_f32_16x16x32_bf16 v[152:155], a[8:11], a[104:107], v[152:155]
    ds_read_b64_tr_b16 a[4:5], v9 offset:25088
    v_mfma_f32_16x16x32_bf16 v[152:155], a[12:15], a[120:123], v[152:155]
    v_mfma_f32_16x16x32_bf16 v[156:159], a[8:11], a[108:111], v[156:159]
    ds_read_b64_tr_b16 a[6:7], v9 offset:27136
    v_mfma_f32_16x16x32_bf16 v[156:159], a[12:15], a[124:127], v[156:159]
    s_waitcnt lgkmcnt(4)
    v_mfma_f32_16x16x32_bf16 v[160:163], a[16:19], a[96:99], v[160:163]
    ds_read_b64_tr_b16 a[8:9], v10 offset:8704
    s_add_u32 m0, s32, 0xe000
    v_mfma_f32_16x16x32_bf16 v[160:163], a[20:23], a[112:115], v[160:163]
    buffer_load_dwordx4 v4, s[16:19], s29 offen offset:0 lds
    v_mfma_f32_16x16x32_bf16 v[164:167], a[16:19], a[100:103], v[164:167]
    ds_read_b64_tr_b16 a[10:11], v10 offset:10752
    s_add_u32 m0, s32, 0xef80
    v_mfma_f32_16x16x32_bf16 v[164:167], a[20:23], a[116:119], v[164:167]
    buffer_load_dwordx4 v5, s[16:19], s29 offen offset:128 lds
    s_add_u32 s29, s29, 0x38000
    v_mfma_f32_16x16x32_bf16 v[168:171], a[16:19], a[104:107], v[168:171]
    ds_read_b64_tr_b16 a[12:13], v10 offset:25088
    v_mfma_f32_16x16x32_bf16 v[168:171], a[20:23], a[120:123], v[168:171]
    v_mfma_f32_16x16x32_bf16 v[172:175], a[16:19], a[108:111], v[172:175]
    ds_read_b64_tr_b16 a[14:15], v10 offset:27136
    v_mfma_f32_16x16x32_bf16 v[172:175], a[20:23], a[124:127], v[172:175]
    s_waitcnt lgkmcnt(4)
    v_mfma_f32_16x16x32_bf16 v[176:179], a[0:3], a[96:99], v[176:179]
    ds_read_b64_tr_b16 a[16:17], v9 offset:12288
    v_mfma_f32_16x16x32_bf16 v[176:179], a[4:7], a[112:115], v[176:179]
    buffer_load_dwordx4 a[48:51], v6, s[20:23], s30 offen offset:0 sc1
    v_mfma_f32_16x16x32_bf16 v[180:183], a[0:3], a[100:103], v[180:183]
    ds_read_b64_tr_b16 a[18:19], v9 offset:14336
    v_mfma_f32_16x16x32_bf16 v[180:183], a[4:7], a[116:119], v[180:183]
    v_mfma_f32_16x16x32_bf16 v[184:187], a[0:3], a[104:107], v[184:187]
    ds_read_b64_tr_b16 a[20:21], v9 offset:28672
    v_mfma_f32_16x16x32_bf16 v[184:187], a[4:7], a[120:123], v[184:187]
    v_mfma_f32_16x16x32_bf16 v[188:191], a[0:3], a[108:111], v[188:191]
    ds_read_b64_tr_b16 a[22:23], v9 offset:30720
    v_mfma_f32_16x16x32_bf16 v[188:191], a[4:7], a[124:127], v[188:191]
    s_waitcnt lgkmcnt(4)
    v_mfma_f32_16x16x32_bf16 v[192:195], a[8:11], a[96:99], v[192:195]
    ds_read_b64_tr_b16 a[0:1], v10 offset:12288
    v_mfma_f32_16x16x32_bf16 v[192:195], a[12:15], a[112:115], v[192:195]
    buffer_load_dwordx4 a[52:55], v6, s[20:23], s30 offen offset:1024 sc1
    v_mfma_f32_16x16x32_bf16 v[196:199], a[8:11], a[100:103], v[196:199]
    ds_read_b64_tr_b16 a[2:3], v10 offset:14336
    v_mfma_f32_16x16x32_bf16 v[196:199], a[12:15], a[116:119], v[196:199]
    v_mfma_f32_16x16x32_bf16 v[200:203], a[8:11], a[104:107], v[200:203]
    ds_read_b64_tr_b16 a[4:5], v10 offset:28672
    v_mfma_f32_16x16x32_bf16 v[200:203], a[12:15], a[120:123], v[200:203]
    v_mfma_f32_16x16x32_bf16 v[204:207], a[8:11], a[108:111], v[204:207]
    ds_read_b64_tr_b16 a[6:7], v10 offset:30720
    v_mfma_f32_16x16x32_bf16 v[204:207], a[12:15], a[124:127], v[204:207]
    s_waitcnt vmcnt(19)
    s_barrier
    s_waitcnt lgkmcnt(4)
    v_mfma_f32_16x16x32_bf16 v[208:211], a[16:19], a[96:99], v[208:211]
    ds_read_b64_tr_b16 a[8:9], v9 offset:12800
    v_mfma_f32_16x16x32_bf16 v[208:211], a[20:23], a[112:115], v[208:211]
    buffer_load_dwordx4 a[56:59], v6, s[20:23], s39 offen offset:0 sc1
    v_mfma_f32_16x16x32_bf16 v[212:215], a[16:19], a[100:103], v[212:215]
    ds_read_b64_tr_b16 a[10:11], v9 offset:14848
    v_mfma_f32_16x16x32_bf16 v[212:215], a[20:23], a[116:119], v[212:215]
    v_mfma_f32_16x16x32_bf16 v[216:219], a[16:19], a[104:107], v[216:219]
    ds_read_b64_tr_b16 a[12:13], v9 offset:29184
    v_mfma_f32_16x16x32_bf16 v[216:219], a[20:23], a[120:123], v[216:219]
    v_mfma_f32_16x16x32_bf16 v[220:223], a[16:19], a[108:111], v[220:223]
    ds_read_b64_tr_b16 a[14:15], v9 offset:31232
    v_mfma_f32_16x16x32_bf16 v[220:223], a[20:23], a[124:127], v[220:223]
    s_waitcnt lgkmcnt(4)
    v_mfma_f32_16x16x32_bf16 v[224:227], a[0:3], a[96:99], v[224:227]
    ds_read_b64_tr_b16 a[16:17], v10 offset:12800
    v_mfma_f32_16x16x32_bf16 v[224:227], a[4:7], a[112:115], v[224:227]
    buffer_load_dwordx4 a[60:63], v6, s[20:23], s39 offen offset:1024 sc1
    s_add_u32 s30, s30, 4096
    s_add_u32 s39, s39, 4096
    v_mfma_f32_16x16x32_bf16 v[228:231], a[0:3], a[100:103], v[228:231]
    ds_read_b64_tr_b16 a[18:19], v10 offset:14848
    v_mfma_f32_16x16x32_bf16 v[228:231], a[4:7], a[116:119], v[228:231]
    s_cmp_eq_u32 s75, 1
    s_cselect_b32 s64, s74, 0x7f000000
    v_mov_b32 v14, 3
    s_mov_b64 exec, 1
    buffer_store_byte v14, off, s[60:63], s64 sc1
    s_mov_b64 exec, -1
    v_mfma_f32_16x16x32_bf16 v[232:235], a[0:3], a[104:107], v[232:235]
    ds_read_b64_tr_b16 a[20:21], v10 offset:29184
    v_mfma_f32_16x16x32_bf16 v[232:235], a[4:7], a[120:123], v[232:235]
    v_mfma_f32_16x16x32_bf16 v[236:239], a[0:3], a[108:111], v[236:239]
    ds_read_b64_tr_b16 a[22:23], v10 offset:31232
    v_mfma_f32_16x16x32_bf16 v[236:239], a[4:7], a[124:127], v[236:239]
    s_waitcnt lgkmcnt(4)
    v_mfma_f32_16x16x32_bf16 v[240:243], a[8:11], a[96:99], v[240:243]
    ds_read_b64_tr_b16 a[0:1], v9 offset:32768
    v_mfma_f32_16x16x32_bf16 v[240:243], a[12:15], a[112:115], v[240:243]
    ds_read_b64_tr_b16 a[2:3], v9 offset:34816
    v_mfma_f32_16x16x32_bf16 v[244:247], a[8:11], a[100:103], v[244:247]
    ds_read_b64_tr_b16 a[4:5], v9 offset:49152
    v_mfma_f32_16x16x32_bf16 v[244:247], a[12:15], a[116:119], v[244:247]
    ds_read_b64_tr_b16 a[6:7], v9 offset:51200
    s_waitcnt lgkmcnt(4)
    v_mfma_f32_16x16x32_bf16 v[248:251], a[16:19], a[96:99], v[248:251]
    ds_read_b64_tr_b16 a[8:9], v10 offset:32768
    v_mfma_f32_16x16x32_bf16 v[248:251], a[20:23], a[112:115], v[248:251]
    ds_read_b64_tr_b16 a[10:11], v10 offset:34816
    v_mfma_f32_16x16x32_bf16 v[252:255], a[16:19], a[100:103], v[252:255]
    ds_read_b64_tr_b16 a[12:13], v10 offset:49152
    v_mfma_f32_16x16x32_bf16 v[252:255], a[20:23], a[116:119], v[252:255]
    ds_read_b64_tr_b16 a[14:15], v10 offset:51200
    s_waitcnt lgkmcnt(4)
    v_mfma_f32_16x16x32_bf16 v[16:19], a[0:3], a[128:131], v[16:19]
    ds_read_b64_tr_b16 a[16:17], v9 offset:33280
    s_add_u32 m0, s32, 0x10000
    v_mfma_f32_16x16x32_bf16 v[16:19], a[4:7], a[144:147], v[16:19]
    buffer_load_dwordx4 v3, s[12:15], s28 offen offset:0 lds
    v_mfma_f32_16x16x32_bf16 v[20:23], a[0:3], a[132:135], v[20:23]
    ds_read_b64_tr_b16 a[18:19], v9 offset:35328
    v_mfma_f32_16x16x32_bf16 v[20:23], a[4:7], a[148:151], v[20:23]
    v_mfma_f32_16x16x32_bf16 v[24:27], a[0:3], a[136:139], v[24:27]
    ds_read_b64_tr_b16 a[20:21], v9 offset:49664
    v_mfma_f32_16x16x32_bf16 v[24:27], a[4:7], a[152:155], v[24:27]
    v_mfma_f32_16x16x32_bf16 v[28:31], a[0:3], a[140:143], v[28:31]
    ds_read_b64_tr_b16 a[22:23], v9 offset:51712
    v_mfma_f32_16x16x32_bf16 v[28:31], a[4:7], a[156:159], v[28:31]
    s_waitcnt lgkmcnt(4)
    v_mfma_f32_16x16x32_bf16 v[32:35], a[8:11], a[128:131], v[32:35]
    ds_read_b64_tr_b16 a[0:1], v10 offset:33280
    s_add_u32 m0, s32, 0x10f80
    v_mfma_f32_16x16x32_bf16 v[32:35], a[12:15], a[144:147], v[32:35]
    buffer_load_dwordx4 v3, s[12:15], s28 offen offset:128 lds
    s_add_u32 s28, s28, 0x40000
    v_mfma_f32_16x16x32_bf16 v[36:39], a[8:11], a[132:135], v[36:39]
    ds_read_b64_tr_b16 a[2:3], v10 offset:35328
    v_mfma_f32_16x16x32_bf16 v[36:39], a[12:15], a[148:151], v[36:39]
    v_mfma_f32_16x16x32_bf16 v[40:43], a[8:11], a[136:139], v[40:43]
    ds_read_b64_tr_b16 a[4:5], v10 offset:49664
    v_mfma_f32_16x16x32_bf16 v[40:43], a[12:15], a[152:155], v[40:43]
    v_mfma_f32_16x16x32_bf16 v[44:47], a[8:11], a[140:143], v[44:47]
    ds_read_b64_tr_b16 a[6:7], v10 offset:51712
    v_mfma_f32_16x16x32_bf16 v[44:47], a[12:15], a[156:159], v[44:47]
    s_waitcnt lgkmcnt(4)
    v_mfma_f32_16x16x32_bf16 v[48:51], a[16:19], a[128:131], v[48:51]
    ds_read_b64_tr_b16 a[8:9], v9 offset:36864
    s_add_u32 m0, s32, 0x12000
    v_mfma_f32_16x16x32_bf16 v[48:51], a[20:23], a[144:147], v[48:51]
    buffer_load_dwordx4 v4, s[16:19], s29 offen offset:0 lds
    v_mfma_f32_16x16x32_bf16 v[52:55], a[16:19], a[132:135], v[52:55]
    ds_read_b64_tr_b16 a[10:11], v9 offset:38912
    v_mfma_f32_16x16x32_bf16 v[52:55], a[20:23], a[148:151], v[52:55]
    v_mfma_f32_16x16x32_bf16 v[56:59], a[16:19], a[136:139], v[56:59]
    ds_read_b64_tr_b16 a[12:13], v9 offset:53248
    v_mfma_f32_16x16x32_bf16 v[56:59], a[20:23], a[152:155], v[56:59]
    v_mfma_f32_16x16x32_bf16 v[60:63], a[16:19], a[140:143], v[60:63]
    ds_read_b64_tr_b16 a[14:15], v9 offset:55296
    v_mfma_f32_16x16x32_bf16 v[60:63], a[20:23], a[156:159], v[60:63]
    s_waitcnt lgkmcnt(4)
    v_mfma_f32_16x16x32_bf16 v[64:67], a[0:3], a[128:131], v[64:67]
    ds_read_b64_tr_b16 a[16:17], v10 offset:36864
    s_add_u32 m0, s32, 0x12f80
    v_mfma_f32_16x16x32_bf16 v[64:67], a[4:7], a[144:147], v[64:67]
    buffer_load_dwordx4 v5, s[16:19], s29 offen offset:128 lds
    s_add_u32 s29, s29, 0x38000
    v_mfma_f32_16x16x32_bf16 v[68:71], a[0:3], a[132:135], v[68:71]
    ds_read_b64_tr_b16 a[18:19], v10 offset:38912
    v_mfma_f32_16x16x32_bf16 v[68:71], a[4:7], a[148:151], v[68:71]
    buffer_load_dwordx4 a[64:67], v6, s[20:23], s30 offen offset:0 sc1
    v_mfma_f32_16x16x32_bf16 v[72:75], a[0:3], a[136:139], v[72:75]
    ds_read_b64_tr_b16 a[20:21], v10 offset:53248
    v_mfma_f32_16x16x32_bf16 v[72:75], a[4:7], a[152:155], v[72:75]
    v_mfma_f32_16x16x32_bf16 v[76:79], a[0:3], a[140:143], v[76:79]
    ds_read_b64_tr_b16 a[22:23], v10 offset:55296
    v_mfma_f32_16x16x32_bf16 v[76:79], a[4:7], a[156:159], v[76:79]
    s_waitcnt lgkmcnt(4)
    v_mfma_f32_16x16x32_bf16 v[80:83], a[8:11], a[128:131], v[80:83]
    ds_read_b64_tr_b16 a[0:1], v9 offset:37376
    v_mfma_f32_16x16x32_bf16 v[80:83], a[12:15], a[144:147], v[80:83]
    buffer_load_dwordx4 a[68:71], v6, s[20:23], s30 offen offset:1024 sc1
    v_mfma_f32_16x16x32_bf16 v[84:87], a[8:11], a[132:135], v[84:87]
    ds_read_b64_tr_b16 a[2:3], v9 offset:39424
    v_mfma_f32_16x16x32_bf16 v[84:87], a[12:15], a[148:151], v[84:87]
    v_mfma_f32_16x16x32_bf16 v[88:91], a[8:11], a[136:139], v[88:91]
    ds_read_b64_tr_b16 a[4:5], v9 offset:53760
    v_mfma_f32_16x16x32_bf16 v[88:91], a[12:15], a[152:155], v[88:91]
    v_mfma_f32_16x16x32_bf16 v[92:95], a[8:11], a[140:143], v[92:95]
    ds_read_b64_tr_b16 a[6:7], v9 offset:55808
    v_mfma_f32_16x16x32_bf16 v[92:95], a[12:15], a[156:159], v[92:95]
    s_waitcnt lgkmcnt(4)
    v_mfma_f32_16x16x32_bf16 v[96:99], a[16:19], a[128:131], v[96:99]
    ds_read_b64_tr_b16 a[8:9], v10 offset:37376
    v_mfma_f32_16x16x32_bf16 v[96:99], a[20:23], a[144:147], v[96:99]
    buffer_load_dwordx4 a[72:75], v6, s[20:23], s39 offen offset:0 sc1
    v_mfma_f32_16x16x32_bf16 v[100:103], a[16:19], a[132:135], v[100:103]
    ds_read_b64_tr_b16 a[10:11], v10 offset:39424
    v_mfma_f32_16x16x32_bf16 v[100:103], a[20:23], a[148:151], v[100:103]
    v_mfma_f32_16x16x32_bf16 v[104:107], a[16:19], a[136:139], v[104:107]
    ds_read_b64_tr_b16 a[12:13], v10 offset:53760
    v_mfma_f32_16x16x32_bf16 v[104:107], a[20:23], a[152:155], v[104:107]
    v_mfma_f32_16x16x32_bf16 v[108:111], a[16:19], a[140:143], v[108:111]
    ds_read_b64_tr_b16 a[14:15], v10 offset:55808
    v_mfma_f32_16x16x32_bf16 v[108:111], a[20:23], a[156:159], v[108:111]
    s_waitcnt lgkmcnt(4)
    v_mfma_f32_16x16x32_bf16 v[112:115], a[0:3], a[128:131], v[112:115]
    ds_read_b64_tr_b16 a[16:17], v9 offset:40960
    v_mfma_f32_16x16x32_bf16 v[112:115], a[4:7], a[144:147], v[112:115]
    buffer_load_dwordx4 a[76:79], v6, s[20:23], s39 offen offset:1024 sc1
    s_add_u32 s30, s30, 4096
    s_add_u32 s39, s39, 4096
    v_mfma_f32_16x16x32_bf16 v[116:119], a[0:3], a[132:135], v[116:119]
    ds_read_b64_tr_b16 a[18:19], v9 offset:43008
    s_add_u32 m0, s32, 0x14000
    v_mfma_f32_16x16x32_bf16 v[116:119], a[4:7], a[148:151], v[116:119]
    buffer_load_dwordx4 v3, s[12:15], s28 offen offset:0 lds
    v_mfma_f32_16x16x32_bf16 v[120:123], a[0:3], a[136:139], v[120:123]
    ds_read_b64_tr_b16 a[20:21], v9 offset:57344
    v_mfma_f32_16x16x32_bf16 v[120:123], a[4:7], a[152:155], v[120:123]
    v_mfma_f32_16x16x32_bf16 v[124:127], a[0:3], a[140:143], v[124:127]
    ds_read_b64_tr_b16 a[22:23], v9 offset:59392
    v_mfma_f32_16x16x32_bf16 v[124:127], a[4:7], a[156:159], v[124:127]
    s_waitcnt lgkmcnt(4)
    v_mfma_f32_16x16x32_bf16 v[128:131], a[8:11], a[128:131], v[128:131]
    ds_read_b64_tr_b16 a[0:1], v10 offset:40960
    s_add_u32 m0, s32, 0x14f80
    v_mfma_f32_16x16x32_bf16 v[128:131], a[12:15], a[144:147], v[128:131]
    buffer_load_dwordx4 v3, s[12:15], s28 offen offset:128 lds
    s_add_u32 s28, s28, 0x40000
    v_mfma_f32_16x16x32_bf16 v[132:135], a[8:11], a[132:135], v[132:135]
    ds_read_b64_tr_b16 a[2:3], v10 offset:43008
    v_mfma_f32_16x16x32_bf16 v[132:135], a[12:15], a[148:151], v[132:135]
    v_mfma_f32_16x16x32_bf16 v[136:139], a[8:11], a[136:139], v[136:139]
    ds_read_b64_tr_b16 a[4:5], v10 offset:57344
    v_mfma_f32_16x16x32_bf16 v[136:139], a[12:15], a[152:155], v[136:139]
    v_mfma_f32_16x16x32_bf16 v[140:143], a[8:11], a[140:143], v[140:143]
    ds_read_b64_tr_b16 a[6:7], v10 offset:59392
    v_mfma_f32_16x16x32_bf16 v[140:143], a[12:15], a[156:159], v[140:143]
    s_waitcnt lgkmcnt(4)
    v_mfma_f32_16x16x32_bf16 v[144:147], a[16:19], a[128:131], v[144:147]
    ds_read_b64_tr_b16 a[8:9], v9 offset:41472
    s_add_u32 m0, s32, 0x16000
    v_mfma_f32_16x16x32_bf16 v[144:147], a[20:23], a[144:147], v[144:147]
    buffer_load_dwordx4 v4, s[16:19], s29 offen offset:0 lds
    v_mfma_f32_16x16x32_bf16 v[148:151], a[16:19], a[132:135], v[148:151]
    ds_read_b64_tr_b16 a[10:11], v9 offset:43520
    v_mfma_f32_16x16x32_bf16 v[148:151], a[20:23], a[148:151], v[148:151]
    v_mfma_f32_16x16x32_bf16 v[152:155], a[16:19], a[136:139], v[152:155]
    ds_read_b64_tr_b16 a[12:13], v9 offset:57856
    v_mfma_f32_16x16x32_bf16 v[152:155], a[20:23], a[152:155], v[152:155]
    v_mfma_f32_16x16x32_bf16 v[156:159], a[16:19], a[140:143], v[156:159]
    ds_read_b64_tr_b16 a[14:15], v9 offset:59904
    v_mfma_f32_16x16x32_bf16 v[156:159], a[20:23], a[156:159], v[156:159]
    s_waitcnt lgkmcnt(4)
    v_mfma_f32_16x16x32_bf16 v[160:163], a[0:3], a[128:131], v[160:163]
    ds_read_b64_tr_b16 a[16:17], v10 offset:41472
    s_add_u32 m0, s32, 0x16f80
    v_mfma_f32_16x16x32_bf16 v[160:163], a[4:7], a[144:147], v[160:163]
    buffer_load_dwordx4 v5, s[16:19], s29 offen offset:128 lds
    s_add_u32 s29, s29, 0x38000
    v_mfma_f32_16x16x32_bf16 v[164:167], a[0:3], a[132:135], v[164:167]
    ds_read_b64_tr_b16 a[18:19], v10 offset:43520
    v_mfma_f32_16x16x32_bf16 v[164:167], a[4:7], a[148:151], v[164:167]
    v_mfma_f32_16x16x32_bf16 v[168:171], a[0:3], a[136:139], v[168:171]
    ds_read_b64_tr_b16 a[20:21], v10 offset:57856
    v_mfma_f32_16x16x32_bf16 v[168:171], a[4:7], a[152:155], v[168:171]
    v_mfma_f32_16x16x32_bf16 v[172:175], a[0:3], a[140:143], v[172:175]
    ds_read_b64_tr_b16 a[22:23], v10 offset:59904
    v_mfma_f32_16x16x32_bf16 v[172:175], a[4:7], a[156:159], v[172:175]
    s_waitcnt lgkmcnt(4)
    v_mfma_f32_16x16x32_bf16 v[176:179], a[8:11], a[128:131], v[176:179]
    ds_read_b64_tr_b16 a[0:1], v9 offset:45056
    v_mfma_f32_16x16x32_bf16 v[176:179], a[12:15], a[144:147], v[176:179]
    buffer_load_dwordx4 a[80:83], v6, s[20:23], s30 offen offset:0 sc1
    v_mfma_f32_16x16x32_bf16 v[180:183], a[8:11], a[132:135], v[180:183]
    ds_read_b64_tr_b16 a[2:3], v9 offset:47104
    v_mfma_f32_16x16x32_bf16 v[180:183], a[12:15], a[148:151], v[180:183]
    buffer_load_dwordx4 a[84:87], v6, s[20:23], s30 offen offset:1024 sc1
    v_mfma_f32_16x16x32_bf16 v[184:187], a[8:11], a[136:139], v[184:187]
    ds_read_b64_tr_b16 a[4:5], v9 offset:61440
    v_mfma_f32_16x16x32_bf16 v[184:187], a[12:15], a[152:155], v[184:187]
    v_mfma_f32_16x16x32_bf16 v[188:191], a[8:11], a[140:143], v[188:191]
    ds_read_b64_tr_b16 a[6:7], v9 offset:63488
    v_mfma_f32_16x16x32_bf16 v[188:191], a[12:15], a[156:159], v[188:191]
    s_waitcnt lgkmcnt(4)
    v_mfma_f32_16x16x32_bf16 v[192:195], a[16:19], a[128:131], v[192:195]
    ds_read_b64_tr_b16 a[8:9], v10 offset:45056
    v_mfma_f32_16x16x32_bf16 v[192:195], a[20:23], a[144:147], v[192:195]
    buffer_load_dwordx4 a[88:91], v6, s[20:23], s39 offen offset:0 sc1
    v_mfma_f32_16x16x32_bf16 v[196:199], a[16:19], a[132:135], v[196:199]
    ds_read_b64_tr_b16 a[10:11], v10 offset:47104
    v_mfma_f32_16x16x32_bf16 v[196:199], a[20:23], a[148:151], v[196:199]
    v_mfma_f32_16x16x32_bf16 v[200:203], a[16:19], a[136:139], v[200:203]
    ds_read_b64_tr_b16 a[12:13], v10 offset:61440
    v_mfma_f32_16x16x32_bf16 v[200:203], a[20:23], a[152:155], v[200:203]
    v_mfma_f32_16x16x32_bf16 v[204:207], a[16:19], a[140:143], v[204:207]
    ds_read_b64_tr_b16 a[14:15], v10 offset:63488
    v_mfma_f32_16x16x32_bf16 v[204:207], a[20:23], a[156:159], v[204:207]
    s_waitcnt vmcnt(16)
    s_barrier
    s_waitcnt lgkmcnt(4)
    v_mfma_f32_16x16x32_bf16 v[208:211], a[0:3], a[128:131], v[208:211]
    ds_read_b64_tr_b16 a[16:17], v9 offset:45568
    v_mfma_f32_16x16x32_bf16 v[208:211], a[4:7], a[144:147], v[208:211]
    buffer_load_dwordx4 a[92:95], v6, s[20:23], s39 offen offset:1024 sc1
    s_add_u32 s30, s30, 4096
    s_add_u32 s39, s39, 4096
    v_mfma_f32_16x16x32_bf16 v[212:215], a[0:3], a[132:135], v[212:215]
    ds_read_b64_tr_b16 a[18:19], v9 offset:47616
    v_mfma_f32_16x16x32_bf16 v[212:215], a[4:7], a[148:151], v[212:215]
    v_mfma_f32_16x16x32_bf16 v[216:219], a[0:3], a[136:139], v[216:219]
    ds_read_b64_tr_b16 a[20:21], v9 offset:61952
    v_mfma_f32_16x16x32_bf16 v[216:219], a[4:7], a[152:155], v[216:219]
    v_mfma_f32_16x16x32_bf16 v[220:223], a[0:3], a[140:143], v[220:223]
    ds_read_b64_tr_b16 a[22:23], v9 offset:64000
    v_mfma_f32_16x16x32_bf16 v[220:223], a[4:7], a[156:159], v[220:223]
    s_waitcnt lgkmcnt(4)
    v_mfma_f32_16x16x32_bf16 v[224:227], a[8:11], a[128:131], v[224:227]
    ds_read_b64_tr_b16 a[0:1], v10 offset:45568
    v_mfma_f32_16x16x32_bf16 v[224:227], a[12:15], a[144:147], v[224:227]
    s_cmp_eq_u32 s75, 2
    s_cselect_b32 s64, s74, 0x7f000000
    v_mov_b32 v14, 3
    s_mov_b64 exec, 1
    buffer_store_byte v14, off, s[60:63], s64 sc1
    s_mov_b64 exec, -1
    v_mfma_f32_16x16x32_bf16 v[228:231], a[8:11], a[132:135], v[228:231]
    ds_read_b64_tr_b16 a[2:3], v10 offset:47616
    v_mfma_f32_16x16x32_bf16 v[228:231], a[12:15], a[148:151], v[228:231]
    s_getpc_b64 s[80:81]
    global_load_dword a255, v0, s[80:81] offset:2048
    v_mfma_f32_16x16x32_bf16 v[232:235], a[8:11], a[136:139], v[232:235]
    ds_read_b64_tr_b16 a[4:5], v10 offset:61952
    v_mfma_f32_16x16x32_bf16 v[232:235], a[12:15], a[152:155], v[232:235]
    v_mfma_f32_16x16x32_bf16 v[236:239], a[8:11], a[140:143], v[236:239]
    ds_read_b64_tr_b16 a[6:7], v10 offset:64000
    v_mfma_f32_16x16x32_bf16 v[236:239], a[12:15], a[156:159], v[236:239]
    s_waitcnt lgkmcnt(4)
    v_mfma_f32_16x16x32_bf16 v[240:243], a[16:19], a[128:131], v[240:243]
    ds_read_b64_tr_b16 a[8:9], v7 offset:0
    v_mfma_f32_16x16x32_bf16 v[240:243], a[20:23], a[144:147], v[240:243]
    ds_read_b64_tr_b16 a[10:11], v7 offset:2048
    v_mfma_f32_16x16x32_bf16 v[244:247], a[16:19], a[132:135], v[244:247]
    ds_read_b64_tr_b16 a[12:13], v7 offset:16384
    v_mfma_f32_16x16x32_bf16 v[244:247], a[20:23], a[148:151], v[244:247]
    ds_read_b64_tr_b16 a[14:15], v7 offset:18432
    s_waitcnt lgkmcnt(4)
    v_mfma_f32_16x16x32_bf16 v[248:251], a[0:3], a[128:131], v[248:251]
    ds_read_b64_tr_b16 a[16:17], v8 offset:0
    v_mfma_f32_16x16x32_bf16 v[248:251], a[4:7], a[144:147], v[248:251]
    ds_read_b64_tr_b16 a[18:19], v8 offset:2048
    v_mfma_f32_16x16x32_bf16 v[252:255], a[0:3], a[132:135], v[252:255]
    ds_read_b64_tr_b16 a[20:21], v8 offset:16384
    v_mfma_f32_16x16x32_bf16 v[252:255], a[4:7], a[148:151], v[252:255]
    ds_read_b64_tr_b16 a[22:23], v8 offset:18432
    s_waitcnt lgkmcnt(4)
    v_mfma_f32_16x16x32_bf16 v[16:19], a[8:11], a[32:35], v[16:19]
    ds_read_b64_tr_b16 a[0:1], v7 offset:512
    s_add_u32 m0, s32, 0x18000
    v_mfma_f32_16x16x32_bf16 v[16:19], a[12:15], a[48:51], v[16:19]
    buffer_load_dwordx4 v3, s[12:15], s28 offen offset:0 lds
    v_mfma_f32_16x16x32_bf16 v[20:23], a[8:11], a[36:39], v[20:23]
    ds_read_b64_tr_b16 a[2:3], v7 offset:2560
    v_mfma_f32_16x16x32_bf16 v[20:23], a[12:15], a[52:55], v[20:23]
    v_mfma_f32_16x16x32_bf16 v[24:27], a[8:11], a[40:43], v[24:27]
    ds_read_b64_tr_b16 a[4:5], v7 offset:16896
    v_mfma_f32_16x16x32_bf16 v[24:27], a[12:15], a[56:59], v[24:27]
    v_mfma_f32_16x16x32_bf16 v[28:31], a[8:11], a[44:47], v[28:31]
    ds_read_b64_tr_b16 a[6:7], v7 offset:18944
    v_mfma_f32_16x16x32_bf16 v[28:31], a[12:15], a[60:63], v[28:31]
    s_waitcnt lgkmcnt(4)
    v_mfma_f32_16x16x32_bf16 v[32:35], a[16:19], a[32:35], v[32:35]
    ds_read_b64_tr_b16 a[8:9], v8 offset:512
    s_add_u32 m0, s32, 0x18f80
    v_mfma_f32_16x16x32_bf16 v[32:35], a[20:23], a[48:51], v[32:35]
    buffer_load_dwordx4 v3, s[12:15], s28 offen offset:128 lds
    s_add_u32 s28, s28, 0x40000
    v_mfma_f32_16x16x32_bf16 v[36:39], a[16:19], a[36:39], v[36:39]
    ds_read_b64_tr_b16 a[10:11], v8 offset:2560
    s_add_u32 m0, s32, 0x1a000
    v_mfma_f32_16x16x32_bf16 v[36:39], a[20:23], a[52:55], v[36:39]
    buffer_load_dwordx4 v4, s[16:19], s29 offen offset:0 lds
    v_mfma_f32_16x16x32_bf16 v[40:43], a[16:19], a[40:43], v[40:43]
    ds_read_b64_tr_b16 a[12:13], v8 offset:16896
    v_mfma_f32_16x16x32_bf16 v[40:43], a[20:23], a[56:59], v[40:43]
    v_mfma_f32_16x16x32_bf16 v[44:47], a[16:19], a[44:47], v[44:47]
    ds_read_b64_tr_b16 a[14:15], v8 offset:18944
    v_mfma_f32_16x16x32_bf16 v[44:47], a[20:23], a[60:63], v[44:47]
    s_waitcnt lgkmcnt(4)
    v_mfma_f32_16x16x32_bf16 v[48:51], a[0:3], a[32:35], v[48:51]
    ds_read_b64_tr_b16 a[16:17], v7 offset:4096
    s_add_u32 m0, s32, 0x1af80
    v_mfma_f32_16x16x32_bf16 v[48:51], a[4:7], a[48:51], v[48:51]
    buffer_load_dwordx4 v5, s[16:19], s29 offen offset:128 lds
    s_add_u32 s29, s29, 0x38000
    v_mfma_f32_16x16x32_bf16 v[52:55], a[0:3], a[36:39], v[52:55]
    ds_read_b64_tr_b16 a[18:19], v7 offset:6144
    v_mfma_f32_16x16x32_bf16 v[52:55], a[4:7], a[52:55], v[52:55]
    v_mfma_f32_16x16x32_bf16 v[56:59], a[0:3], a[40:43], v[56:59]
    ds_read_b64_tr_b16 a[20:21], v7 offset:20480
    v_mfma_f32_16x16x32_bf16 v[56:59], a[4:7], a[56:59], v[56:59]
    v_mfma_f32_16x16x32_bf16 v[60:63], a[0:3], a[44:47], v[60:63]
    ds_read_b64_tr_b16 a[22:23], v7 offset:22528
    v_mfma_f32_16x16x32_bf16 v[60:63], a[4:7], a[60:63], v[60:63]
    s_waitcnt lgkmcnt(4)
    v_mfma_f32_16x16x32_bf16 v[64:67], a[8:11], a[32:35], v[64:67]
    ds_read_b64_tr_b16 a[0:1], v8 offset:4096
    v_mfma_f32_16x16x32_bf16 v[64:67], a[12:15], a[48:51], v[64:67]
    buffer_load_dwordx4 a[96:99], v6, s[20:23], s30 offen offset:0 sc1
    v_mfma_f32_16x16x32_bf16 v[68:71], a[8:11], a[36:39], v[68:71]
    ds_read_b64_tr_b16 a[2:3], v8 offset:6144
    v_mfma_f32_16x16x32_bf16 v[68:71], a[12:15], a[52:55], v[68:71]
    buffer_load_dwordx4 a[100:103], v6, s[20:23], s30 offen offset:1024 sc1
    v_mfma_f32_16x16x32_bf16 v[72:75], a[8:11], a[40:43], v[72:75]
    ds_read_b64_tr_b16 a[4:5], v8 offset:20480
    v_mfma_f32_16x16x32_bf16 v[72:75], a[12:15], a[56:59], v[72:75]
    v_mfma_f32_16x16x32_bf16 v[76:79], a[8:11], a[44:47], v[76:79]
    ds_read_b64_tr_b16 a[6:7], v8 offset:22528
    v_mfma_f32_16x16x32_bf16 v[76:79], a[12:15], a[60:63], v[76:79]
    s_waitcnt lgkmcnt(4)
    v_mfma_f32_16x16x32_bf16 v[80:83], a[16:19], a[32:35], v[80:83]
    ds_read_b64_tr_b16 a[8:9], v7 offset:4608
    v_mfma_f32_16x16x32_bf16 v[80:83], a[20:23], a[48:51], v[80:83]
    buffer_load_dwordx4 a[104:107], v6, s[20:23], s39 offen offset:0 sc1
    v_mfma_f32_16x16x32_bf16 v[84:87], a[16:19], a[36:39], v[84:87]
    ds_read_b64_tr_b16 a[10:11], v7 offset:6656
    v_mfma_f32_16x16x32_bf16 v[84:87], a[20:23], a[52:55], v[84:87]
    v_mfma_f32_16x16x32_bf16 v[88:91], a[16:19], a[40:43], v[88:91]
    ds_read_b64_tr_b16 a[12:13], v7 offset:20992
    v_mfma_f32_16x16x32_bf16 v[88:91], a[20:23], a[56:59], v[88:91]
    v_mfma_f32_16x16x32_bf16 v[92:95], a[16:19], a[44:47], v[92:95]
    ds_read_b64_tr_b16 a[14:15], v7 offset:23040
    v_mfma_f32_16x16x32_bf16 v[92:95], a[20:23], a[60:63], v[92:95]
    s_waitcnt lgkmcnt(4)
    v_mfma_f32_16x16x32_bf16 v[96:99], a[0:3], a[32:35], v[96:99]
    ds_read_b64_tr_b16 a[16:17], v8 offset:4608
    v_mfma_f32_16x16x32_bf16 v[96:99], a[4:7], a[48:51], v[96:99]
    buffer_load_dwordx4 a[108:111], v6, s[20:23], s39 offen offset:1024 sc1
    s_add_u32 s30, s30, 4096
    s_add_u32 s39, s39, 4096
    v_mfma_f32_16x16x32_bf16 v[100:103], a[0:3], a[36:39], v[100:103]
    ds_read_b64_tr_b16 a[18:19], v8 offset:6656
    v_mfma_f32_16x16x32_bf16 v[100:103], a[4:7], a[52:55], v[100:103]
    buffer_load_dwordx4 a[224:227], v11, s[12:15], s72 offen offset:0
    v_mfma_f32_16x16x32_bf16 v[104:107], a[0:3], a[40:43], v[104:107]
    ds_read_b64_tr_b16 a[20:21], v8 offset:20992
    v_mfma_f32_16x16x32_bf16 v[104:107], a[4:7], a[56:59], v[104:107]
    v_mfma_f32_16x16x32_bf16 v[108:111], a[0:3], a[44:47], v[108:111]
    ds_read_b64_tr_b16 a[22:23], v8 offset:23040
    v_mfma_f32_16x16x32_bf16 v[108:111], a[4:7], a[60:63], v[108:111]
    s_waitcnt lgkmcnt(4)
    v_mfma_f32_16x16x32_bf16 v[112:115], a[8:11], a[32:35], v[112:115]
    ds_read_b64_tr_b16 a[0:1], v7 offset:8192
    v_mfma_f32_16x16x32_bf16 v[112:115], a[12:15], a[48:51], v[112:115]
    buffer_load_dwordx4 a[232:235], v12, s[16:19], s73 offen offset:0
    v_mfma_f32_16x16x32_bf16 v[116:119], a[8:11], a[36:39], v[116:119]
    ds_read_b64_tr_b16 a[2:3], v7 offset:10240
    v_mfma_f32_16x16x32_bf16 v[116:119], a[12:15], a[52:55], v[116:119]
    v_mfma_f32_16x16x32_bf16 v[120:123], a[8:11], a[40:43], v[120:123]
    ds_read_b64_tr_b16 a[4:5], v7 offset:24576
    v_mfma_f32_16x16x32_bf16 v[120:123], a[12:15], a[56:59], v[120:123]
    v_mfma_f32_16x16x32_bf16 v[124:127], a[8:11], a[44:47], v[124:127]
    ds_read_b64_tr_b16 a[6:7], v7 offset:26624
    v_mfma_f32_16x16x32_bf16 v[124:127], a[12:15], a[60:63], v[124:127]
    s_waitcnt lgkmcnt(4)
    v_mfma_f32_16x16x32_bf16 v[128:131], a[16:19], a[32:35], v[128:131]
    ds_read_b64_tr_b16 a[8:9], v8 offset:8192
    v_mfma_f32_16x16x32_bf16 v[128:131], a[20:23], a[48:51], v[128:131]
    buffer_load_dwordx4 a[228:231], v11, s[12:15], s72 offen offset:1024
    v_mfma_f32_16x16x32_bf16 v[132:135], a[16:19], a[36:39], v[132:135]
    ds_read_b64_tr_b16 a[10:11], v8 offset:10240
    v_mfma_f32_16x16x32_bf16 v[132:135], a[20:23], a[52:55], v[132:135]
    buffer_load_dwordx4 a[236:239], v12, s[16:19], s73 offen offset:896
    s_add_u32 s72, s72, 0x200000
    s_add_u32 s73, s73, 0x1c0000
    v_mfma_f32_16x16x32_bf16 v[136:139], a[16:19], a[40:43], v[136:139]
    ds_read_b64_tr_b16 a[12:13], v8 offset:24576
    v_mfma_f32_16x16x32_bf16 v[136:139], a[20:23], a[56:59], v[136:139]
    v_mfma_f32_16x16x32_bf16 v[140:143], a[16:19], a[44:47], v[140:143]
    ds_read_b64_tr_b16 a[14:15], v8 offset:26624
    v_mfma_f32_16x16x32_bf16 v[140:143], a[20:23], a[60:63], v[140:143]
    s_waitcnt lgkmcnt(4)
    v_mfma_f32_16x16x32_bf16 v[144:147], a[0:3], a[32:35], v[144:147]
    ds_read_b64_tr_b16 a[16:17], v7 offset:8704
    s_add_u32 m0, s32, 0x1c000
    v_mfma_f32_16x16x32_bf16 v[144:147], a[4:7], a[48:51], v[144:147]
    buffer_load_dwordx4 v3, s[12:15], s28 offen offset:0 lds
    v_mfma_f32_16x16x32_bf16 v[148:151], a[0:3], a[36:39], v[148:151]
    ds_read_b64_tr_b16 a[18:19], v7 offset:10752
    v_mfma_f32_16x16x32_bf16 v[148:151], a[4:7], a[52:55], v[148:151]
    v_mfma_f32_16x16x32_bf16 v[152:155], a[0:3], a[40:43], v[152:155]
    ds_read_b64_tr_b16 a[20:21], v7 offset:25088
    v_mfma_f32_16x16x32_bf16 v[152:155], a[4:7], a[56:59], v[152:155]
    v_mfma_f32_16x16x32_bf16 v[156:159], a[0:3], a[44:47], v[156:159]
    ds_read_b64_tr_b16 a[22:23], v7 offset:27136
    v_mfma_f32_16x16x32_bf16 v[156:159], a[4:7], a[60:63], v[156:159]
    s_waitcnt lgkmcnt(4)
    v_mfma_f32_16x16x32_bf16 v[160:163], a[8:11], a[32:35], v[160:163]
    ds_read_b64_tr_b16 a[0:1], v8 offset:8704
    s_add_u32 m0, s32, 0x1cf80
    v_mfma_f32_16x16x32_bf16 v[160:163], a[12:15], a[48:51], v[160:163]
    buffer_load_dwordx4 v3, s[12:15], s28 offen offset:128 lds
    s_add_u32 s28, s28, 0x40000
    v_mfma_f32_16x16x32_bf16 v[164:167], a[8:11], a[36:39], v[164:167]
    ds_read_b64_tr_b16 a[2:3], v8 offset:10752
    s_add_u32 m0, s32, 0x1e000
    v_mfma_f32_16x16x32_bf16 v[164:167], a[12:15], a[52:55], v[164:167]
    buffer_load_dwordx4 v4, s[16:19], s29 offen offset:0 lds
    v_mfma_f32_16x16x32_bf16 v[168:171], a[8:11], a[40:43], v[168:171]
    ds_read_b64_tr_b16 a[4:5], v8 offset:25088
    v_mfma_f32_16x16x32_bf16 v[168:171], a[12:15], a[56:59], v[168:171]
    v_mfma_f32_16x16x32_bf16 v[172:175], a[8:11], a[44:47], v[172:175]
    ds_read_b64_tr_b16 a[6:7], v8 offset:27136
    v_mfma_f32_16x16x32_bf16 v[172:175], a[12:15], a[60:63], v[172:175]
    s_waitcnt lgkmcnt(4)
    v_mfma_f32_16x16x32_bf16 v[176:179], a[16:19], a[32:35], v[176:179]
    ds_read_b64_tr_b16 a[8:9], v7 offset:12288
    s_add_u32 m0, s32, 0x1ef80
    v_mfma_f32_16x16x32_bf16 v[176:179], a[20:23], a[48:51], v[176:179]
    buffer_load_dwordx4 v5, s[16:19], s29 offen offset:128 lds
    s_add_u32 s29, s29, 0x38000
    v_mfma_f32_16x16x32_bf16 v[180:183], a[16:19], a[36:39], v[180:183]
    ds_read_b64_tr_b16 a[10:11], v7 offset:14336
    v_mfma_f32_16x16x32_bf16 v[180:183], a[20:23], a[52:55], v[180:183]
    v_mfma_f32_16x16x32_bf16 v[184:187], a[16:19], a[40:43], v[184:187]
    ds_read_b64_tr_b16 a[12:13], v7 offset:28672
    v_mfma_f32_16x16x32_bf16 v[184:187], a[20:23], a[56:59], v[184:187]
    v_mfma_f32_16x16x32_bf16 v[188:191], a[16:19], a[44:47], v[188:191]
    ds_read_b64_tr_b16 a[14:15], v7 offset:30720
    v_mfma_f32_16x16x32_bf16 v[188:191], a[20:23], a[60:63], v[188:191]
    s_waitcnt lgkmcnt(4)
    v_mfma_f32_16x16x32_bf16 v[192:195], a[0:3], a[32:35], v[192:195]
    ds_read_b64_tr_b16 a[16:17], v8 offset:12288
    v_mfma_f32_16x16x32_bf16 v[192:195], a[4:7], a[48:51], v[192:195]
    buffer_load_dwordx4 a[112:115], v6, s[20:23], s30 offen offset:0 sc1
    v_mfma_f32_16x16x32_bf16 v[196:199], a[0:3], a[36:39], v[196:199]
    ds_read_b64_tr_b16 a[18:19], v8 offset:14336
    v_mfma_f32_16x16x32_bf16 v[196:199], a[4:7], a[52:55], v[196:199]
    buffer_load_dwordx4 a[116:119], v6, s[20:23], s30 offen offset:1024 sc1
    v_mfma_f32_16x16x32_bf16 v[200:203], a[0:3], a[40:43], v[200:203]
    ds_read_b64_tr_b16 a[20:21], v8 offset:28672
    v_mfma_f32_16x16x32_bf16 v[200:203], a[4:7], a[56:59], v[200:203]
    v_mfma_f32_16x16x32_bf16 v[204:207], a[0:3], a[44:47], v[204:207]
    ds_read_b64_tr_b16 a[22:23], v8 offset:30720
    v_mfma_f32_16x16x32_bf16 v[204:207], a[4:7], a[60:63], v[204:207]
    s_waitcnt vmcnt(20)
    s_barrier
    s_waitcnt lgkmcnt(4)
    v_mfma_f32_16x16x32_bf16 v[208:211], a[8:11], a[32:35], v[208:211]
    ds_read_b64_tr_b16 a[0:1], v7 offset:12800
    v_mfma_f32_16x16x32_bf16 v[208:211], a[12:15], a[48:51], v[208:211]
    buffer_load_dwordx4 a[120:123], v6, s[20:23], s39 offen offset:0 sc1
    v_mfma_f32_16x16x32_bf16 v[212:215], a[8:11], a[36:39], v[212:215]
    ds_read_b64_tr_b16 a[2:3], v7 offset:14848
    v_mfma_f32_16x16x32_bf16 v[212:215], a[12:15], a[52:55], v[212:215]
    v_mfma_f32_16x16x32_bf16 v[216:219], a[8:11], a[40:43], v[216:219]
    ds_read_b64_tr_b16 a[4:5], v7 offset:29184
    v_mfma_f32_16x16x32_bf16 v[216:219], a[12:15], a[56:59], v[216:219]
    v_mfma_f32_16x16x32_bf16 v[220:223], a[8:11], a[44:47], v[220:223]
    ds_read_b64_tr_b16 a[6:7], v7 offset:31232
    v_mfma_f32_16x16x32_bf16 v[220:223], a[12:15], a[60:63], v[220:223]
    s_waitcnt lgkmcnt(4)
    v_mfma_f32_16x16x32_bf16 v[224:227], a[16:19], a[32:35], v[224:227]
    ds_read_b64_tr_b16 a[8:9], v8 offset:12800
    v_mfma_f32_16x16x32_bf16 v[224:227], a[20:23], a[48:51], v[224:227]
    buffer_load_dwordx4 a[124:127], v6, s[20:23], s39 offen offset:1024 sc1
    s_add_u32 s30, s30, 4096
    s_add_u32 s39, s39, 4096
    v_mfma_f32_16x16x32_bf16 v[228:231], a[16:19], a[36:39], v[228:231]
    ds_read_b64_tr_b16 a[10:11], v8 offset:14848
    v_mfma_f32_16x16x32_bf16 v[228:231], a[20:23], a[52:55], v[228:231]
    s_cmp_eq_u32 s75, 3
    s_cselect_b32 s64, s74, 0x7f000000
    v_mov_b32 v14, 3
    s_mov_b64 exec, 1
    buffer_store_byte v14, off, s[60:63], s64 sc1
    s_mov_b64 exec, -1
    v_mfma_f32_16x16x32_bf16 v[232:235], a[16:19], a[40:43], v[232:235]
    ds_read_b64_tr_b16 a[12:13], v8 offset:29184
    v_mfma_f32_16x16x32_bf16 v[232:235], a[20:23], a[56:59], v[232:235]
    v_mfma_f32_16x16x32_bf16 v[236:239], a[16:19], a[44:47], v[236:239]
    ds_read_b64_tr_b16 a[14:15], v8 offset:31232
    v_mfma_f32_16x16x32_bf16 v[236:239], a[20:23], a[60:63], v[236:239]
    s_waitcnt lgkmcnt(4)
    v_mfma_f32_16x16x32_bf16 v[240:243], a[0:3], a[32:35], v[240:243]
    ds_read_b64_tr_b16 a[16:17], v7 offset:32768
    v_mfma_f32_16x16x32_bf16 v[240:243], a[4:7], a[48:51], v[240:243]
    ds_read_b64_tr_b16 a[18:19], v7 offset:34816
    v_mfma_f32_16x16x32_bf16 v[244:247], a[0:3], a[36:39], v[244:247]
    ds_read_b64_tr_b16 a[20:21], v7 offset:49152
    v_mfma_f32_16x16x32_bf16 v[244:247], a[4:7], a[52:55], v[244:247]
    ds_read_b64_tr_b16 a[22:23], v7 offset:51200
    s_waitcnt lgkmcnt(4)
    v_mfma_f32_16x16x32_bf16 v[248:251], a[8:11], a[32:35], v[248:251]
    ds_read_b64_tr_b16 a[0:1], v8 offset:32768
    v_mfma_f32_16x16x32_bf16 v[248:251], a[12:15], a[48:51], v[248:251]
    ds_read_b64_tr_b16 a[2:3], v8 offset:34816
    v_mfma_f32_16x16x32_bf16 v[252:255], a[8:11], a[36:39], v[252:255]
    ds_read_b64_tr_b16 a[4:5], v8 offset:49152
    v_mfma_f32_16x16x32_bf16 v[252:255], a[12:15], a[52:55], v[252:255]
    ds_read_b64_tr_b16 a[6:7], v8 offset:51200
    s_waitcnt lgkmcnt(4)
    v_mfma_f32_16x16x32_bf16 v[16:19], a[16:19], a[64:67], v[16:19]
    ds_read_b64_tr_b16 a[8:9], v7 offset:33280
    s_add_u32 m0, s32, 0x20000
    v_mfma_f32_16x16x32_bf16 v[16:19], a[20:23], a[80:83], v[16:19]
    buffer_load_dwordx4 v3, s[12:15], s28 offen offset:0 lds
    v_mfma_f32_16x16x32_bf16 v[20:23], a[16:19], a[68:71], v[20:23]
    ds_read_b64_tr_b16 a[10:11], v7 offset:35328
    v_mfma_f32_16x16x32_bf16 v[20:23], a[20:23], a[84:87], v[20:23]
    v_mfma_f32_16x16x32_bf16 v[24:27], a[16:19], a[72:75], v[24:27]
    ds_read_b64_tr_b16 a[12:13], v7 offset:49664
    v_mfma_f32_16x16x32_bf16 v[24:27], a[20:23], a[88:91], v[24:27]
    v_mfma_f32_16x16x32_bf16 v[28:31], a[16:19], a[76:79], v[28:31]
    ds_read_b64_tr_b16 a[14:15], v7 offset:51712
    v_mfma_f32_16x16x32_bf16 v[28:31], a[20:23], a[92:95], v[28:31]
    s_waitcnt lgkmcnt(4)
    v_mfma_f32_16x16x32_bf16 v[32:35], a[0:3], a[64:67], v[32:35]
    ds_read_b64_tr_b16 a[16:17], v8 offset:33280
    s_add_u32 m0, s32, 0x20f80
    v_mfma_f32_16x16x32_bf16 v[32:35], a[4:7], a[80:83], v[32:35]
    buffer_load_dwordx4 v3, s[12:15], s28 offen offset:128 lds
    s_add_u32 s28, s28, 0x40000
    v_mfma_f32_16x16x32_bf16 v[36:39], a[0:3], a[68:71], v[36:39]
    ds_read_b64_tr_b16 a[18:19], v8 offset:35328
    v_mfma_f32_16x16x32_bf16 v[36:39], a[4:7], a[84:87], v[36:39]
    v_mfma_f32_16x16x32_bf16 v[40:43], a[0:3], a[72:75], v[40:43]
    ds_read_b64_tr_b16 a[20:21], v8 offset:49664
    v_mfma_f32_16x16x32_bf16 v[40:43], a[4:7], a[88:91], v[40:43]
    v_mfma_f32_16x16x32_bf16 v[44:47], a[0:3], a[76:79], v[44:47]
    ds_read_b64_tr_b16 a[22:23], v8 offset:51712
    v_mfma_f32_16x16x32_bf16 v[44:47], a[4:7], a[92:95], v[44:47]
    s_waitcnt lgkmcnt(4)
    v_mfma_f32_16x16x32_bf16 v[48:51], a[8:11], a[64:67], v[48:51]
    ds_read_b64_tr_b16 a[0:1], v7 offset:36864
    s_add_u32 m0, s32, 0x22000
    v_mfma_f32_16x16x32_bf16 v[48:51], a[12:15], a[80:83], v[48:51]
    buffer_load_dwordx4 v4, s[16:19], s29 offen offset:0 lds
    v_mfma_f32_16x16x32_bf16 v[52:55], a[8:11], a[68:71], v[52:55]
    ds_read_b64_tr_b16 a[2:3], v7 offset:38912
    v_mfma_f32_16x16x32_bf16 v[52:55], a[12:15], a[84:87], v[52:55]
    v_mfma_f32_16x16x32_bf16 v[56:59], a[8:11], a[72:75], v[56:59]
    ds_read_b64_tr_b16 a[4:5], v7 offset:53248
    v_mfma_f32_16x16x32_bf16 v[56:59], a[12:15], a[88:91], v[56:59]
    v_mfma_f32_16x16x32_bf16 v[60:63], a[8:11], a[76:79], v[60:63]
    ds_read_b64_tr_b16 a[6:7], v7 offset:55296
    v_mfma_f32_16x16x32_bf16 v[60:63], a[12:15], a[92:95], v[60:63]
    s_waitcnt lgkmcnt(4)
    v_mfma_f32_16x16x32_bf16 v[64:67], a[16:19], a[64:67], v[64:67]
    ds_read_b64_tr_b16 a[8:9], v8 offset:36864
    s_add_u32 m0, s32, 0x22f80
    v_mfma_f32_16x16x32_bf16 v[64:67], a[20:23], a[80:83], v[64:67]
    buffer_load_dwordx4 v5, s[16:19], s29 offen offset:128 lds
    s_add_u32 s29, s29, 0x38000
    v_mfma_f32_16x16x32_bf16 v[68:71], a[16:19], a[68:71], v[68:71]
    ds_read_b64_tr_b16 a[10:11], v8 offset:38912
    v_mfma_f32_16x16x32_bf16 v[68:71], a[20:23], a[84:87], v[68:71]
    v_mfma_f32_16x16x32_bf16 v[72:75], a[16:19], a[72:75], v[72:75]
    ds_read_b64_tr_b16 a[12:13], v8 offset:53248
    v_mfma_f32_16x16x32_bf16 v[72:75], a[20:23], a[88:91], v[72:75]
    v_mfma_f32_16x16x32_bf16 v[76:79], a[16:19], a[76:79], v[76:79]
    ds_read_b64_tr_b16 a[14:15], v8 offset:55296
    v_mfma_f32_16x16x32_bf16 v[76:79], a[20:23], a[92:95], v[76:79]
    s_waitcnt lgkmcnt(4)
    v_mfma_f32_16x16x32_bf16 v[80:83], a[0:3], a[64:67], v[80:83]
    ds_read_b64_tr_b16 a[16:17], v7 offset:37376
    v_mfma_f32_16x16x32_bf16 v[80:83], a[4:7], a[80:83], v[80:83]
    buffer_load_dwordx4 a[128:131], v6, s[20:23], s30 offen offset:0 sc1
    v_mfma_f32_16x16x32_bf16 v[84:87], a[0:3], a[68:71], v[84:87]
    ds_read_b64_tr_b16 a[18:19], v7 offset:39424
    v_mfma_f32_16x16x32_bf16 v[84:87], a[4:7], a[84:87], v[84:87]
    v_mfma_f32_16x16x32_bf16 v[88:91], a[0:3], a[72:75], v[88:91]
    ds_read_b64_tr_b16 a[20:21], v7 offset:53760
    v_mfma_f32_16x16x32_bf16 v[88:91], a[4:7], a[88:91], v[88:91]
    v_mfma_f32_16x16x32_bf16 v[92:95], a[0:3], a[76:79], v[92:95]
    ds_read_b64_tr_b16 a[22:23], v7 offset:55808
    v_mfma_f32_16x16x32_bf16 v[92:95], a[4:7], a[92:95], v[92:95]
    s_waitcnt lgkmcnt(4)
    v_mfma_f32_16x16x32_bf16 v[96:99], a[8:11], a[64:67], v[96:99]
    ds_read_b64_tr_b16 a[0:1], v8 offset:37376
    v_mfma_f32_16x16x32_bf16 v[96:99], a[12:15], a[80:83], v[96:99]
    buffer_load_dwordx4 a[132:135], v6, s[20:23], s30 offen offset:1024 sc1
    v_mfma_f32_16x16x32_bf16 v[100:103], a[8:11], a[68:71], v[100:103]
    ds_read_b64_tr_b16 a[2:3], v8 offset:39424
    v_mfma_f32_16x16x32_bf16 v[100:103], a[12:15], a[84:87], v[100:103]
    v_mfma_f32_16x16x32_bf16 v[104:107], a[8:11], a[72:75], v[104:107]
    ds_read_b64_tr_b16 a[4:5], v8 offset:53760
    v_mfma_f32_16x16x32_bf16 v[104:107], a[12:15], a[88:91], v[104:107]
    v_mfma_f32_16x16x32_bf16 v[108:111], a[8:11], a[76:79], v[108:111]
    ds_read_b64_tr_b16 a[6:7], v8 offset:55808
    v_mfma_f32_16x16x32_bf16 v[108:111], a[12:15], a[92:95], v[108:111]
    s_waitcnt lgkmcnt(4)
    v_mfma_f32_16x16x32_bf16 v[112:115], a[16:19], a[64:67], v[112:115]
    ds_read_b64_tr_b16 a[8:9], v7 offset:40960
    v_mfma_f32_16x16x32_bf16 v[112:115], a[20:23], a[80:83], v[112:115]
    buffer_load_dwordx4 a[136:139], v6, s[20:23], s39 offen offset:0 sc1
    v_mfma_f32_16x16x32_bf16 v[116:119], a[16:19], a[68:71], v[116:119]
    ds_read_b64_tr_b16 a[10:11], v7 offset:43008
    v_mfma_f32_16x16x32_bf16 v[116:119], a[20:23], a[84:87], v[116:119]
    buffer_load_dwordx4 a[140:143], v6, s[20:23], s39 offen offset:1024 sc1
    s_add_u32 s30, s30, 4096
    s_add_u32 s39, s39, 4096
    v_mfma_f32_16x16x32_bf16 v[120:123], a[16:19], a[72:75], v[120:123]
    ds_read_b64_tr_b16 a[12:13], v7 offset:57344
    v_mfma_f32_16x16x32_bf16 v[120:123], a[20:23], a[88:91], v[120:123]
    v_mfma_f32_16x16x32_bf16 v[124:127], a[16:19], a[76:79], v[124:127]
    ds_read_b64_tr_b16 a[14:15], v7 offset:59392
    v_mfma_f32_16x16x32_bf16 v[124:127], a[20:23], a[92:95], v[124:127]
    s_waitcnt lgkmcnt(4)
    v_mfma_f32_16x16x32_bf16 v[128:131], a[0:3], a[64:67], v[128:131]
    ds_read_b64_tr_b16 a[16:17], v8 offset:40960
    s_add_u32 m0, s32, 0x24000
    v_mfma_f32_16x16x32_bf16 v[128:131], a[4:7], a[80:83], v[128:131]
    buffer_load_dwordx4 v3, s[12:15], s28 offen offset:0 lds
    v_mfma_f32_16x16x32_bf16 v[132:135], a[0:3], a[68:71], v[132:135]
    ds_read_b64_tr_b16 a[18:19], v8 offset:43008
    v_mfma_f32_16x16x32_bf16 v[132:135], a[4:7], a[84:87], v[132:135]
    v_mfma_f32_16x16x32_bf16 v[136:139], a[0:3], a[72:75], v[136:139]
    ds_read_b64_tr_b16 a[20:21], v8 offset:57344
    v_mfma_f32_16x16x32_bf16 v[136:139], a[4:7], a[88:91], v[136:139]
    v_mfma_f32_16x16x32_bf16 v[140:143], a[0:3], a[76:79], v[140:143]
    ds_read_b64_tr_b16 a[22:23], v8 offset:59392
    v_mfma_f32_16x16x32_bf16 v[140:143], a[4:7], a[92:95], v[140:143]
    s_waitcnt lgkmcnt(4)
    v_mfma_f32_16x16x32_bf16 v[144:147], a[8:11], a[64:67], v[144:147]
    ds_read_b64_tr_b16 a[0:1], v7 offset:41472
    s_add_u32 m0, s32, 0x24f80
    v_mfma_f32_16x16x32_bf16 v[144:147], a[12:15], a[80:83], v[144:147]
    buffer_load_dwordx4 v3, s[12:15], s28 offen offset:128 lds
    s_add_u32 s28, s28, 0x40000
    v_mfma_f32_16x16x32_bf16 v[148:151], a[8:11], a[68:71], v[148:151]
    ds_read_b64_tr_b16 a[2:3], v7 offset:43520
    v_mfma_f32_16x16x32_bf16 v[148:151], a[12:15], a[84:87], v[148:151]
    v_mfma_f32_16x16x32_bf16 v[152:155], a[8:11], a[72:75], v[152:155]
    ds_read_b64_tr_b16 a[4:5], v7 offset:57856
    v_mfma_f32_16x16x32_bf16 v[152:155], a[12:15], a[88:91], v[152:155]
    v_mfma_f32_16x16x32_bf16 v[156:159], a[8:11], a[76:79], v[156:159]
    ds_read_b64_tr_b16 a[6:7], v7 offset:59904
    v_mfma_f32_16x16x32_bf16 v[156:159], a[12:15], a[92:95], v[156:159]
    s_waitcnt lgkmcnt(4)
    v_mfma_f32_16x16x32_bf16 v[160:163], a[16:19], a[64:67], v[160:163]
    ds_read_b64_tr_b16 a[8:9], v8 offset:41472
    s_add_u32 m0, s32, 0x26000
    v_mfma_f32_16x16x32_bf16 v[160:163], a[20:23], a[80:83], v[160:163]
    buffer_load_dwordx4 v4, s[16:19], s29 offen offset:0 lds
    v_mfma_f32_16x16x32_bf16 v[164:167], a[16:19], a[68:71], v[164:167]
    ds_read_b64_tr_b16 a[10:11], v8 offset:43520
    v_mfma_f32_16x16x32_bf16 v[164:167], a[20:23], a[84:87], v[164:167]
    v_mfma_f32_16x16x32_bf16 v[168:171], a[16:19], a[72:75], v[168:171]
    ds_read_b64_tr_b16 a[12:13], v8 offset:57856
    v_mfma_f32_16x16x32_bf16 v[168:171], a[20:23], a[88:91], v[168:171]
    v_mfma_f32_16x16x32_bf16 v[172:175], a[16:19], a[76:79], v[172:175]
    ds_read_b64_tr_b16 a[14:15], v8 offset:59904
    v_mfma_f32_16x16x32_bf16 v[172:175], a[20:23], a[92:95], v[172:175]
    s_waitcnt lgkmcnt(4)
    v_mfma_f32_16x16x32_bf16 v[176:179], a[0:3], a[64:67], v[176:179]
    ds_read_b64_tr_b16 a[16:17], v7 offset:45056
    s_add_u32 m0, s32, 0x26f80
    v_mfma_f32_16x16x32_bf16 v[176:179], a[4:7], a[80:83], v[176:179]
    buffer_load_dwordx4 v5, s[16:19], s29 offen offset:128 lds
    s_add_u32 s29, s29, 0x38000
    v_mfma_f32_16x16x32_bf16 v[180:183], a[0:3], a[68:71], v[180:183]
    ds_read_b64_tr_b16 a[18:19], v7 offset:47104
    v_mfma_f32_16x16x32_bf16 v[180:183], a[4:7], a[84:87], v[180:183]
    v_mfma_f32_16x16x32_bf16 v[184:187], a[0:3], a[72:75], v[184:187]
    ds_read_b64_tr_b16 a[20:21], v7 offset:61440
    v_mfma_f32_16x16x32_bf16 v[184:187], a[4:7], a[88:91], v[184:187]
    v_mfma_f32_16x16x32_bf16 v[188:191], a[0:3], a[76:79], v[188:191]
    ds_read_b64_tr_b16 a[22:23], v7 offset:63488
    v_mfma_f32_16x16x32_bf16 v[188:191], a[4:7], a[92:95], v[188:191]
    s_waitcnt lgkmcnt(4)
    v_mfma_f32_16x16x32_bf16 v[192:195], a[8:11], a[64:67], v[192:195]
    ds_read_b64_tr_b16 a[0:1], v8 offset:45056
    v_mfma_f32_16x16x32_bf16 v[192:195], a[12:15], a[80:83], v[192:195]
    buffer_load_dwordx4 a[144:147], v6, s[20:23], s30 offen offset:0 sc1
    v_mfma_f32_16x16x32_bf16 v[196:199], a[8:11], a[68:71], v[196:199]
    ds_read_b64_tr_b16 a[2:3], v8 offset:47104
    v_mfma_f32_16x16x32_bf16 v[196:199], a[12:15], a[84:87], v[196:199]
    v_mfma_f32_16x16x32_bf16 v[200:203], a[8:11], a[72:75], v[200:203]
    ds_read_b64_tr_b16 a[4:5], v8 offset:61440
    v_mfma_f32_16x16x32_bf16 v[200:203], a[12:15], a[88:91], v[200:203]
    v_mfma_f32_16x16x32_bf16 v[204:207], a[8:11], a[76:79], v[204:207]
    ds_read_b64_tr_b16 a[6:7], v8 offset:63488
    v_mfma_f32_16x16x32_bf16 v[204:207], a[12:15], a[92:95], v[204:207]
    s_waitcnt vmcnt(14)
    s_barrier
    s_waitcnt lgkmcnt(4)
    v_mfma_f32_16x16x32_bf16 v[208:211], a[16:19], a[64:67], v[208:211]
    ds_read_b64_tr_b16 a[8:9], v7 offset:45568
    v_mfma_f32_16x16x32_bf16 v[208:211], a[20:23], a[80:83], v[208:211]
    buffer_load_dwordx4 a[148:151], v6, s[20:23], s30 offen offset:1024 sc1
    v_mfma_f32_16x16x32_bf16 v[212:215], a[16:19], a[68:71], v[212:215]
    ds_read_b64_tr_b16 a[10:11], v7 offset:47616
    v_mfma_f32_16x16x32_bf16 v[212:215], a[20:23], a[84:87], v[212:215]
    v_mfma_f32_16x16x32_bf16 v[216:219], a[16:19], a[72:75], v[216:219]
    ds_read_b64_tr_b16 a[12:13], v7 offset:61952
    v_mfma_f32_16x16x32_bf16 v[216:219], a[20:23], a[88:91], v[216:219]
    v_mfma_f32_16x16x32_bf16 v[220:223], a[16:19], a[76:79], v[220:223]
    ds_read_b64_tr_b16 a[14:15], v7 offset:64000
    v_mfma_f32_16x16x32_bf16 v[220:223], a[20:23], a[92:95], v[220:223]
    s_waitcnt lgkmcnt(4)
    v_mfma_f32_16x16x32_bf16 v[224:227], a[0:3], a[64:67], v[224:227]
    ds_read_b64_tr_b16 a[16:17], v8 offset:45568
    v_mfma_f32_16x16x32_bf16 v[224:227], a[4:7], a[80:83], v[224:227]
    buffer_load_dwordx4 a[152:155], v6, s[20:23], s39 offen offset:0 sc1
    v_mfma_f32_16x16x32_bf16 v[228:231], a[0:3], a[68:71], v[228:231]
    ds_read_b64_tr_b16 a[18:19], v8 offset:47616
    v_mfma_f32_16x16x32_bf16 v[228:231], a[4:7], a[84:87], v[228:231]
    buffer_load_dwordx4 a[156:159], v6, s[20:23], s39 offen offset:1024 sc1
    s_add_u32 s30, s30, 4096
    s_add_u32 s39, s39, 4096
    v_mfma_f32_16x16x32_bf16 v[232:235], a[0:3], a[72:75], v[232:235]
    ds_read_b64_tr_b16 a[20:21], v8 offset:61952
    v_mfma_f32_16x16x32_bf16 v[232:235], a[4:7], a[88:91], v[232:235]
    v_mfma_f32_16x16x32_bf16 v[236:239], a[0:3], a[76:79], v[236:239]
    ds_read_b64_tr_b16 a[22:23], v8 offset:64000
    v_mfma_f32_16x16x32_bf16 v[236:239], a[4:7], a[92:95], v[236:239]
    s_waitcnt lgkmcnt(4)
    v_mfma_f32_16x16x32_bf16 v[240:243], a[8:11], a[64:67], v[240:243]
    ds_read_b64_tr_b16 a[0:1], v9 offset:0
    v_mfma_f32_16x16x32_bf16 v[240:243], a[12:15], a[80:83], v[240:243]
    ds_read_b64_tr_b16 a[2:3], v9 offset:2048
    v_mfma_f32_16x16x32_bf16 v[244:247], a[8:11], a[68:71], v[244:247]
    ds_read_b64_tr_b16 a[4:5], v9 offset:16384
    v_mfma_f32_16x16x32_bf16 v[244:247], a[12:15], a[84:87], v[244:247]
    ds_read_b64_tr_b16 a[6:7], v9 offset:18432
    s_waitcnt lgkmcnt(4)
    v_mfma_f32_16x16x32_bf16 v[248:251], a[16:19], a[64:67], v[248:251]
    ds_read_b64_tr_b16 a[8:9], v10 offset:0
    v_mfma_f32_16x16x32_bf16 v[248:251], a[20:23], a[80:83], v[248:251]
    ds_read_b64_tr_b16 a[10:11], v10 offset:2048
    v_mfma_f32_16x16x32_bf16 v[252:255], a[16:19], a[68:71], v[252:255]
    ds_read_b64_tr_b16 a[12:13], v10 offset:16384
    v_mfma_f32_16x16x32_bf16 v[252:255], a[20:23], a[84:87], v[252:255]
    ds_read_b64_tr_b16 a[14:15], v10 offset:18432
    s_waitcnt lgkmcnt(4)
    v_mfma_f32_16x16x32_bf16 v[16:19], a[0:3], a[96:99], v[16:19]
    ds_read_b64_tr_b16 a[16:17], v9 offset:512
    s_add_u32 m0, s32, 0x8000
    v_mfma_f32_16x16x32_bf16 v[16:19], a[4:7], a[112:115], v[16:19]
    buffer_load_dwordx4 v3, s[12:15], s28 offen offset:0 lds
    v_mfma_f32_16x16x32_bf16 v[20:23], a[0:3], a[100:103], v[20:23]
    ds_read_b64_tr_b16 a[18:19], v9 offset:2560
    v_mfma_f32_16x16x32_bf16 v[20:23], a[4:7], a[116:119], v[20:23]
    v_mfma_f32_16x16x32_bf16 v[24:27], a[0:3], a[104:107], v[24:27]
    ds_read_b64_tr_b16 a[20:21], v9 offset:16896
    v_mfma_f32_16x16x32_bf16 v[24:27], a[4:7], a[120:123], v[24:27]
    v_mfma_f32_16x16x32_bf16 v[28:31], a[0:3], a[108:111], v[28:31]
    ds_read_b64_tr_b16 a[22:23], v9 offset:18944
    v_mfma_f32_16x16x32_bf16 v[28:31], a[4:7], a[124:127], v[28:31]
    s_waitcnt lgkmcnt(4)
    v_mfma_f32_16x16x32_bf16 v[32:35], a[8:11], a[96:99], v[32:35]
    ds_read_b64_tr_b16 a[0:1], v10 offset:512
    s_add_u32 m0, s32, 0x8f80
    v_mfma_f32_16x16x32_bf16 v[32:35], a[12:15], a[112:115], v[32:35]
    buffer_load_dwordx4 v3, s[12:15], s28 offen offset:128 lds
    s_add_u32 s28, s28, 0x40000
    v_mfma_f32_16x16x32_bf16 v[36:39], a[8:11], a[100:103], v[36:39]
    ds_read_b64_tr_b16 a[2:3], v10 offset:2560
    v_mfma_f32_16x16x32_bf16 v[36:39], a[12:15], a[116:119], v[36:39]
    v_mfma_f32_16x16x32_bf16 v[40:43], a[8:11], a[104:107], v[40:43]
    ds_read_b64_tr_b16 a[4:5], v10 offset:16896
    v_mfma_f32_16x16x32_bf16 v[40:43], a[12:15], a[120:123], v[40:43]
    v_mfma_f32_16x16x32_bf16 v[44:47], a[8:11], a[108:111], v[44:47]
    ds_read_b64_tr_b16 a[6:7], v10 offset:18944
    v_mfma_f32_16x16x32_bf16 v[44:47], a[12:15], a[124:127], v[44:47]
    s_waitcnt lgkmcnt(4)
    v_mfma_f32_16x16x32_bf16 v[48:51], a[16:19], a[96:99], v[48:51]
    ds_read_b64_tr_b16 a[8:9], v9 offset:4096
    s_add_u32 m0, s32, 0xa000
    v_mfma_f32_16x16x32_bf16 v[48:51], a[20:23], a[112:115], v[48:51]
    buffer_load_dwordx4 v4, s[16:19], s29 offen offset:0 lds
    v_mfma_f32_16x16x32_bf16 v[52:55], a[16:19], a[100:103], v[52:55]
    ds_read_b64_tr_b16 a[10:11], v9 offset:6144
    v_mfma_f32_16x16x32_bf16 v[52:55], a[20:23], a[116:119], v[52:55]
    v_mfma_f32_16x16x32_bf16 v[56:59], a[16:19], a[104:107], v[56:59]
    ds_read_b64_tr_b16 a[12:13], v9 offset:20480
    v_mfma_f32_16x16x32_bf16 v[56:59], a[20:23], a[120:123], v[56:59]
    v_mfma_f32_16x16x32_bf16 v[60:63], a[16:19], a[108:111], v[60:63]
    ds_read_b64_tr_b16 a[14:15], v9 offset:22528
    v_mfma_f32_16x16x32_bf16 v[60:63], a[20:23], a[124:127], v[60:63]
    s_waitcnt lgkmcnt(4)
    v_mfma_f32_16x16x32_bf16 v[64:67], a[0:3], a[96:99], v[64:67]
    ds_read_b64_tr_b16 a[16:17], v10 offset:4096
    s_add_u32 m0, s32, 0xaf80
    v_mfma_f32_16x16x32_bf16 v[64:67], a[4:7], a[112:115], v[64:67]
    buffer_load_dwordx4 v5, s[16:19], s29 offen offset:128 lds
    s_add_u32 s29, s29, 0x38000
    v_mfma_f32_16x16x32_bf16 v[68:71], a[0:3], a[100:103], v[68:71]
    ds_read_b64_tr_b16 a[18:19], v10 offset:6144
    v_mfma_f32_16x16x32_bf16 v[68:71], a[4:7], a[116:119], v[68:71]
    v_mfma_f32_16x16x32_bf16 v[72:75], a[0:3], a[104:107], v[72:75]
    ds_read_b64_tr_b16 a[20:21], v10 offset:20480
    v_mfma_f32_16x16x32_bf16 v[72:75], a[4:7], a[120:123], v[72:75]
    v_mfma_f32_16x16x32_bf16 v[76:79], a[0:3], a[108:111], v[76:79]
    ds_read_b64_tr_b16 a[22:23], v10 offset:22528
    v_mfma_f32_16x16x32_bf16 v[76:79], a[4:7], a[124:127], v[76:79]
    s_waitcnt lgkmcnt(4)
    v_mfma_f32_16x16x32_bf16 v[80:83], a[8:11], a[96:99], v[80:83]
    ds_read_b64_tr_b16 a[0:1], v9 offset:4608
    v_mfma_f32_16x16x32_bf16 v[80:83], a[12:15], a[112:115], v[80:83]
    buffer_load_dwordx4 a[32:35], v6, s[20:23], s30 offen offset:0 sc1
    v_mfma_f32_16x16x32_bf16 v[84:87], a[8:11], a[100:103], v[84:87]
    ds_read_b64_tr_b16 a[2:3], v9 offset:6656
    v_mfma_f32_16x16x32_bf16 v[84:87], a[12:15], a[116:119], v[84:87]
    v_mfma_f32_16x16x32_bf16 v[88:91], a[8:11], a[104:107], v[88:91]
    ds_read_b64_tr_b16 a[4:5], v9 offset:20992
    v_mfma_f32_16x16x32_bf16 v[88:91], a[12:15], a[120:123], v[88:91]
    v_mfma_f32_16x16x32_bf16 v[92:95], a[8:11], a[108:111], v[92:95]
    ds_read_b64_tr_b16 a[6:7], v9 offset:23040
    v_mfma_f32_16x16x32_bf16 v[92:95], a[12:15], a[124:127], v[92:95]
    s_waitcnt lgkmcnt(4)
    v_mfma_f32_16x16x32_bf16 v[96:99], a[16:19], a[96:99], v[96:99]
    ds_read_b64_tr_b16 a[8:9], v10 offset:4608
    v_mfma_f32_16x16x32_bf16 v[96:99], a[20:23], a[112:115], v[96:99]
    buffer_load_dwordx4 a[36:39], v6, s[20:23], s30 offen offset:1024 sc1
    v_mfma_f32_16x16x32_bf16 v[100:103], a[16:19], a[100:103], v[100:103]
    ds_read_b64_tr_b16 a[10:11], v10 offset:6656
    v_mfma_f32_16x16x32_bf16 v[100:103], a[20:23], a[116:119], v[100:103]
    v_mfma_f32_16x16x32_bf16 v[104:107], a[16:19], a[104:107], v[104:107]
    ds_read_b64_tr_b16 a[12:13], v10 offset:20992
    v_mfma_f32_16x16x32_bf16 v[104:107], a[20:23], a[120:123], v[104:107]
    v_mfma_f32_16x16x32_bf16 v[108:111], a[16:19], a[108:111], v[108:111]
    ds_read_b64_tr_b16 a[14:15], v10 offset:23040
    v_mfma_f32_16x16x32_bf16 v[108:111], a[20:23], a[124:127], v[108:111]
    s_waitcnt lgkmcnt(4)
    v_mfma_f32_16x16x32_bf16 v[112:115], a[0:3], a[96:99], v[112:115]
    ds_read_b64_tr_b16 a[16:17], v9 offset:8192
    v_mfma_f32_16x16x32_bf16 v[112:115], a[4:7], a[112:115], v[112:115]
    buffer_load_dwordx4 a[40:43], v6, s[20:23], s39 offen offset:0 sc1
    v_mfma_f32_16x16x32_bf16 v[116:119], a[0:3], a[100:103], v[116:119]
    ds_read_b64_tr_b16 a[18:19], v9 offset:10240
    v_mfma_f32_16x16x32_bf16 v[116:119], a[4:7], a[116:119], v[116:119]
    buffer_load_dwordx4 a[44:47], v6, s[20:23], s39 offen offset:1024 sc1
    s_add_u32 s30, s30, 4096
    s_add_u32 s39, s39, 4096
    v_mfma_f32_16x16x32_bf16 v[120:123], a[0:3], a[104:107], v[120:123]
    ds_read_b64_tr_b16 a[20:21], v9 offset:24576
    v_mfma_f32_16x16x32_bf16 v[120:123], a[4:7], a[120:123], v[120:123]
    v_mfma_f32_16x16x32_bf16 v[124:127], a[0:3], a[108:111], v[124:127]
    ds_read_b64_tr_b16 a[22:23], v9 offset:26624
    v_mfma_f32_16x16x32_bf16 v[124:127], a[4:7], a[124:127], v[124:127]
    s_waitcnt lgkmcnt(4)
    v_mfma_f32_16x16x32_bf16 v[128:131], a[8:11], a[96:99], v[128:131]
    ds_read_b64_tr_b16 a[0:1], v10 offset:8192
    s_add_u32 m0, s32, 0xc000
    v_mfma_f32_16x16x32_bf16 v[128:131], a[12:15], a[112:115], v[128:131]
    buffer_load_dwordx4 v3, s[12:15], s28 offen offset:0 lds
    v_mfma_f32_16x16x32_bf16 v[132:135], a[8:11], a[100:103], v[132:135]
    ds_read_b64_tr_b16 a[2:3], v10 offset:10240
    v_mfma_f32_16x16x32_bf16 v[132:135], a[12:15], a[116:119], v[132:135]
    v_mfma_f32_16x16x32_bf16 v[136:139], a[8:11], a[104:107], v[136:139]
    ds_read_b64_tr_b16 a[4:5], v10 offset:24576
    v_mfma_f32_16x16x32_bf16 v[136:139], a[12:15], a[120:123], v[136:139]
    v_mfma_f32_16x16x32_bf16 v[140:143], a[8:11], a[108:111], v[140:143]
    ds_read_b64_tr_b16 a[6:7], v10 offset:26624
    v_mfma_f32_16x16x32_bf16 v[140:143], a[12:15], a[124:127], v[140:143]
    s_waitcnt lgkmcnt(4)
    v_mfma_f32_16x16x32_bf16 v[144:147], a[16:19], a[96:99], v[144:147]
    ds_read_b64_tr_b16 a[8:9], v9 offset:8704
    s_add_u32 m0, s32, 0xcf80
    v_mfma_f32_16x16x32_bf16 v[144:147], a[20:23], a[112:115], v[144:147]
    buffer_load_dwordx4 v3, s[12:15], s28 offen offset:128 lds
    s_add_u32 s28, s28, 0x40000
    v_mfma_f32_16x16x32_bf16 v[148:151], a[16:19], a[100:103], v[148:151]
    ds_read_b64_tr_b16 a[10:11], v9 offset:10752
    v_mfma_f32_16x16x32_bf16 v[148:151], a[20:23], a[116:119], v[148:151]
    v_mfma_f32_16x16x32_bf16 v[152:155], a[16:19], a[104:107], v[152:155]
    ds_read_b64_tr_b16 a[12:13], v9 offset:25088
    v_mfma_f32_16x16x32_bf16 v[152:155], a[20:23], a[120:123], v[152:155]
    v_mfma_f32_16x16x32_bf16 v[156:159], a[16:19], a[108:111], v[156:159]
    ds_read_b64_tr_b16 a[14:15], v9 offset:27136
    v_mfma_f32_16x16x32_bf16 v[156:159], a[20:23], a[124:127], v[156:159]
    s_waitcnt lgkmcnt(4)
    v_mfma_f32_16x16x32_bf16 v[160:163], a[0:3], a[96:99], v[160:163]
    ds_read_b64_tr_b16 a[16:17], v10 offset:8704
    s_add_u32 m0, s32, 0xe000
    v_mfma_f32_16x16x32_bf16 v[160:163], a[4:7], a[112:115], v[160:163]
    buffer_load_dwordx4 v4, s[16:19], s29 offen offset:0 lds
    v_mfma_f32_16x16x32_bf16 v[164:167], a[0:3], a[100:103], v[164:167]
    ds_read_b64_tr_b16 a[18:19], v10 offset:10752
    v_mfma_f32_16x16x32_bf16 v[164:167], a[4:7], a[116:119], v[164:167]
    v_mfma_f32_16x16x32_bf16 v[168:171], a[0:3], a[104:107], v[168:171]
    ds_read_b64_tr_b16 a[20:21], v10 offset:25088
    v_mfma_f32_16x16x32_bf16 v[168:171], a[4:7], a[120:123], v[168:171]
    v_mfma_f32_16x16x32_bf16 v[172:175], a[0:3], a[108:111], v[172:175]
    ds_read_b64_tr_b16 a[22:23], v10 offset:27136
    v_mfma_f32_16x16x32_bf16 v[172:175], a[4:7], a[124:127], v[172:175]
    s_waitcnt lgkmcnt(4)
    v_mfma_f32_16x16x32_bf16 v[176:179], a[8:11], a[96:99], v[176:179]
    ds_read_b64_tr_b16 a[0:1], v9 offset:12288
    s_add_u32 m0, s32, 0xef80
    v_mfma_f32_16x16x32_bf16 v[176:179], a[12:15], a[112:115], v[176:179]
    buffer_load_dwordx4 v5, s[16:19], s29 offen offset:128 lds
    s_add_u32 s29, s29, 0x38000
    v_mfma_f32_16x16x32_bf16 v[180:183], a[8:11], a[100:103], v[180:183]
    ds_read_b64_tr_b16 a[2:3], v9 offset:14336
    v_mfma_f32_16x16x32_bf16 v[180:183], a[12:15], a[116:119], v[180:183]
    v_mfma_f32_16x16x32_bf16 v[184:187], a[8:11], a[104:107], v[184:187]
    ds_read_b64_tr_b16 a[4:5], v9 offset:28672
    v_mfma_f32_16x16x32_bf16 v[184:187], a[12:15], a[120:123], v[184:187]
    v_mfma_f32_16x16x32_bf16 v[188:191], a[8:11], a[108:111], v[188:191]
    ds_read_b64_tr_b16 a[6:7], v9 offset:30720
    v_mfma_f32_16x16x32_bf16 v[188:191], a[12:15], a[124:127], v[188:191]
    s_waitcnt lgkmcnt(4)
    v_mfma_f32_16x16x32_bf16 v[192:195], a[16:19], a[96:99], v[192:195]
    ds_read_b64_tr_b16 a[8:9], v10 offset:12288
    v_mfma_f32_16x16x32_bf16 v[192:195], a[20:23], a[112:115], v[192:195]
    buffer_load_dwordx4 a[48:51], v6, s[20:23], s30 offen offset:0 sc1
    v_mfma_f32_16x16x32_bf16 v[196:199], a[16:19], a[100:103], v[196:199]
    ds_read_b64_tr_b16 a[10:11], v10 offset:14336
    v_mfma_f32_16x16x32_bf16 v[196:199], a[20:23], a[116:119], v[196:199]
    v_mfma_f32_16x16x32_bf16 v[200:203], a[16:19], a[104:107], v[200:203]
    ds_read_b64_tr_b16 a[12:13], v10 offset:28672
    v_mfma_f32_16x16x32_bf16 v[200:203], a[20:23], a[120:123], v[200:203]
    v_mfma_f32_16x16x32_bf16 v[204:207], a[16:19], a[108:111], v[204:207]
    ds_read_b64_tr_b16 a[14:15], v10 offset:30720
    v_mfma_f32_16x16x32_bf16 v[204:207], a[20:23], a[124:127], v[204:207]
    s_waitcnt vmcnt(13)
    s_barrier
    s_waitcnt lgkmcnt(4)
    v_mfma_f32_16x16x32_bf16 v[208:211], a[0:3], a[96:99], v[208:211]
    ds_read_b64_tr_b16 a[16:17], v9 offset:12800
    v_mfma_f32_16x16x32_bf16 v[208:211], a[4:7], a[112:115], v[208:211]
    buffer_load_dwordx4 a[52:55], v6, s[20:23], s30 offen offset:1024 sc1
    v_mfma_f32_16x16x32_bf16 v[212:215], a[0:3], a[100:103], v[212:215]
    ds_read_b64_tr_b16 a[18:19], v9 offset:14848
    v_mfma_f32_16x16x32_bf16 v[212:215], a[4:7], a[116:119], v[212:215]
    v_mfma_f32_16x16x32_bf16 v[216:219], a[0:3], a[104:107], v[216:219]
    ds_read_b64_tr_b16 a[20:21], v9 offset:29184
    v_mfma_f32_16x16x32_bf16 v[216:219], a[4:7], a[120:123], v[216:219]
    v_mfma_f32_16x16x32_bf16 v[220:223], a[0:3], a[108:111], v[220:223]
    ds_read_b64_tr_b16 a[22:23], v9 offset:31232
    v_mfma_f32_16x16x32_bf16 v[220:223], a[4:7], a[124:127], v[220:223]
    s_waitcnt lgkmcnt(4)
    v_mfma_f32_16x16x32_bf16 v[224:227], a[8:11], a[96:99], v[224:227]
    ds_read_b64_tr_b16 a[0:1], v10 offset:12800
    v_mfma_f32_16x16x32_bf16 v[224:227], a[12:15], a[112:115], v[224:227]
    buffer_load_dwordx4 a[56:59], v6, s[20:23], s39 offen offset:0 sc1
    v_mfma_f32_16x16x32_bf16 v[228:231], a[8:11], a[100:103], v[228:231]
    ds_read_b64_tr_b16 a[2:3], v10 offset:14848
    v_mfma_f32_16x16x32_bf16 v[228:231], a[12:15], a[116:119], v[228:231]
    buffer_load_dwordx4 a[60:63], v6, s[20:23], s39 offen offset:1024 sc1
    s_add_u32 s30, s30, 4096
    s_add_u32 s39, s39, 4096
    v_mfma_f32_16x16x32_bf16 v[232:235], a[8:11], a[104:107], v[232:235]
    ds_read_b64_tr_b16 a[4:5], v10 offset:29184
    v_mfma_f32_16x16x32_bf16 v[232:235], a[12:15], a[120:123], v[232:235]
    v_mfma_f32_16x16x32_bf16 v[236:239], a[8:11], a[108:111], v[236:239]
    ds_read_b64_tr_b16 a[6:7], v10 offset:31232
    v_mfma_f32_16x16x32_bf16 v[236:239], a[12:15], a[124:127], v[236:239]
    s_waitcnt lgkmcnt(4)
    v_mfma_f32_16x16x32_bf16 v[240:243], a[16:19], a[96:99], v[240:243]
    ds_read_b64_tr_b16 a[8:9], v9 offset:32768
    v_mfma_f32_16x16x32_bf16 v[240:243], a[20:23], a[112:115], v[240:243]
    ds_read_b64_tr_b16 a[10:11], v9 offset:34816
    v_mfma_f32_16x16x32_bf16 v[244:247], a[16:19], a[100:103], v[244:247]
    ds_read_b64_tr_b16 a[12:13], v9 offset:49152
    v_mfma_f32_16x16x32_bf16 v[244:247], a[20:23], a[116:119], v[244:247]
    ds_read_b64_tr_b16 a[14:15], v9 offset:51200
    s_waitcnt lgkmcnt(4)
    v_mfma_f32_16x16x32_bf16 v[248:251], a[0:3], a[96:99], v[248:251]
    ds_read_b64_tr_b16 a[16:17], v10 offset:32768
    v_mfma_f32_16x16x32_bf16 v[248:251], a[4:7], a[112:115], v[248:251]
    ds_read_b64_tr_b16 a[18:19], v10 offset:34816
    v_mfma_f32_16x16x32_bf16 v[252:255], a[0:3], a[100:103], v[252:255]
    ds_read_b64_tr_b16 a[20:21], v10 offset:49152
    v_mfma_f32_16x16x32_bf16 v[252:255], a[4:7], a[116:119], v[252:255]
    ds_read_b64_tr_b16 a[22:23], v10 offset:51200
    s_waitcnt lgkmcnt(4)
    v_mfma_f32_16x16x32_bf16 v[16:19], a[8:11], a[128:131], v[16:19]
    ds_read_b64_tr_b16 a[0:1], v9 offset:33280
    v_mfma_f32_16x16x32_bf16 v[16:19], a[12:15], a[144:147], v[16:19]
    buffer_load_dword v14, v13, s[60:63], s65 offen sc1
    v_mfma_f32_16x16x32_bf16 v[20:23], a[8:11], a[132:135], v[20:23]
    ds_read_b64_tr_b16 a[2:3], v9 offset:35328
    v_mfma_f32_16x16x32_bf16 v[20:23], a[12:15], a[148:151], v[20:23]
    v_mfma_f32_16x16x32_bf16 v[24:27], a[8:11], a[136:139], v[24:27]
    ds_read_b64_tr_b16 a[4:5], v9 offset:49664
    v_mfma_f32_16x16x32_bf16 v[24:27], a[12:15], a[152:155], v[24:27]
    v_mfma_f32_16x16x32_bf16 v[28:31], a[8:11], a[140:143], v[28:31]
    ds_read_b64_tr_b16 a[6:7], v9 offset:51712
    v_mfma_f32_16x16x32_bf16 v[28:31], a[12:15], a[156:159], v[28:31]
    s_waitcnt lgkmcnt(4)
    v_mfma_f32_16x16x32_bf16 v[32:35], a[16:19], a[128:131], v[32:35]
    ds_read_b64_tr_b16 a[8:9], v10 offset:33280
    s_add_u32 m0, s32, 0x10000
    v_mfma_f32_16x16x32_bf16 v[32:35], a[20:23], a[144:147], v[32:35]
    buffer_load_dwordx4 v3, s[12:15], s28 offen offset:0 lds
    v_mfma_f32_16x16x32_bf16 v[36:39], a[16:19], a[132:135], v[36:39]
    ds_read_b64_tr_b16 a[10:11], v10 offset:35328
    s_add_u32 m0, s32, 0x10f80
    v_mfma_f32_16x16x32_bf16 v[36:39], a[20:23], a[148:151], v[36:39]
    buffer_load_dwordx4 v3, s[12:15], s28 offen offset:128 lds
    s_add_u32 s28, s28, 0x40000
    v_mfma_f32_16x16x32_bf16 v[40:43], a[16:19], a[136:139], v[40:43]
    ds_read_b64_tr_b16 a[12:13], v10 offset:49664
    v_mfma_f32_16x16x32_bf16 v[40:43], a[20:23], a[152:155], v[40:43]
    v_mfma_f32_16x16x32_bf16 v[44:47], a[16:19], a[140:143], v[44:47]
    ds_read_b64_tr_b16 a[14:15], v10 offset:51712
    v_mfma_f32_16x16x32_bf16 v[44:47], a[20:23], a[156:159], v[44:47]
    s_waitcnt lgkmcnt(4)
    v_mfma_f32_16x16x32_bf16 v[48:51], a[0:3], a[128:131], v[48:51]
    ds_read_b64_tr_b16 a[16:17], v9 offset:36864
    s_add_u32 m0, s32, 0x12000
    v_mfma_f32_16x16x32_bf16 v[48:51], a[4:7], a[144:147], v[48:51]
    buffer_load_dwordx4 v4, s[16:19], s29 offen offset:0 lds
    v_mfma_f32_16x16x32_bf16 v[52:55], a[0:3], a[132:135], v[52:55]
    ds_read_b64_tr_b16 a[18:19], v9 offset:38912
    v_mfma_f32_16x16x32_bf16 v[52:55], a[4:7], a[148:151], v[52:55]
    v_mfma_f32_16x16x32_bf16 v[56:59], a[0:3], a[136:139], v[56:59]
    ds_read_b64_tr_b16 a[20:21], v9 offset:53248
    v_mfma_f32_16x16x32_bf16 v[56:59], a[4:7], a[152:155], v[56:59]
    v_mfma_f32_16x16x32_bf16 v[60:63], a[0:3], a[140:143], v[60:63]
    ds_read_b64_tr_b16 a[22:23], v9 offset:55296
    v_mfma_f32_16x16x32_bf16 v[60:63], a[4:7], a[156:159], v[60:63]
    s_waitcnt lgkmcnt(4)
    v_mfma_f32_16x16x32_bf16 v[64:67], a[8:11], a[128:131], v[64:67]
    ds_read_b64_tr_b16 a[0:1], v10 offset:36864
    s_add_u32 m0, s32, 0x12f80
    v_mfma_f32_16x16x32_bf16 v[64:67], a[12:15], a[144:147], v[64:67]
    buffer_load_dwordx4 v5, s[16:19], s29 offen offset:128 lds
    s_add_u32 s29, s29, 0x38000
    v_mfma_f32_16x16x32_bf16 v[68:71], a[8:11], a[132:135], v[68:71]
    ds_read_b64_tr_b16 a[2:3], v10 offset:38912
    v_mfma_f32_16x16x32_bf16 v[68:71], a[12:15], a[148:151], v[68:71]
    buffer_load_dwordx4 a[64:67], v6, s[20:23], s30 offen offset:0 sc1
    v_mfma_f32_16x16x32_bf16 v[72:75], a[8:11], a[136:139], v[72:75]
    ds_read_b64_tr_b16 a[4:5], v10 offset:53248
    v_mfma_f32_16x16x32_bf16 v[72:75], a[12:15], a[152:155], v[72:75]
    v_mfma_f32_16x16x32_bf16 v[76:79], a[8:11], a[140:143], v[76:79]
    ds_read_b64_tr_b16 a[6:7], v10 offset:55296
    v_mfma_f32_16x16x32_bf16 v[76:79], a[12:15], a[156:159], v[76:79]
    s_waitcnt lgkmcnt(4)
    v_mfma_f32_16x16x32_bf16 v[80:83], a[16:19], a[128:131], v[80:83]
    ds_read_b64_tr_b16 a[8:9], v9 offset:37376
    v_mfma_f32_16x16x32_bf16 v[80:83], a[20:23], a[144:147], v[80:83]
    buffer_load_dwordx4 a[68:71], v6, s[20:23], s30 offen offset:1024 sc1
    v_mfma_f32_16x16x32_bf16 v[84:87], a[16:19], a[132:135], v[84:87]
    ds_read_b64_tr_b16 a[10:11], v9 offset:39424
    v_mfma_f32_16x16x32_bf16 v[84:87], a[20:23], a[148:151], v[84:87]
    v_mfma_f32_16x16x32_bf16 v[88:91], a[16:19], a[136:139], v[88:91]
    ds_read_b64_tr_b16 a[12:13], v9 offset:53760
    v_mfma_f32_16x16x32_bf16 v[88:91], a[20:23], a[152:155], v[88:91]
    v_mfma_f32_16x16x32_bf16 v[92:95], a[16:19], a[140:143], v[92:95]
    ds_read_b64_tr_b16 a[14:15], v9 offset:55808
    v_mfma_f32_16x16x32_bf16 v[92:95], a[20:23], a[156:159], v[92:95]
    s_waitcnt lgkmcnt(4)
    v_mfma_f32_16x16x32_bf16 v[96:99], a[0:3], a[128:131], v[96:99]
    ds_read_b64_tr_b16 a[16:17], v10 offset:37376
    v_mfma_f32_16x16x32_bf16 v[96:99], a[4:7], a[144:147], v[96:99]
    buffer_load_dwordx4 a[72:75], v6, s[20:23], s39 offen offset:0 sc1
    v_mfma_f32_16x16x32_bf16 v[100:103], a[0:3], a[132:135], v[100:103]
    ds_read_b64_tr_b16 a[18:19], v10 offset:39424
    v_mfma_f32_16x16x32_bf16 v[100:103], a[4:7], a[148:151], v[100:103]
    buffer_load_dwordx4 a[76:79], v6, s[20:23], s39 offen offset:1024 sc1
    s_add_u32 s30, s30, 4096
    s_add_u32 s39, s39, 4096
    v_mfma_f32_16x16x32_bf16 v[104:107], a[0:3], a[136:139], v[104:107]
    ds_read_b64_tr_b16 a[20:21], v10 offset:53760
    v_mfma_f32_16x16x32_bf16 v[104:107], a[4:7], a[152:155], v[104:107]
    v_mfma_f32_16x16x32_bf16 v[108:111], a[0:3], a[140:143], v[108:111]
    ds_read_b64_tr_b16 a[22:23], v10 offset:55808
    v_mfma_f32_16x16x32_bf16 v[108:111], a[4:7], a[156:159], v[108:111]
    s_waitcnt lgkmcnt(4)
    v_mfma_f32_16x16x32_bf16 v[112:115], a[8:11], a[128:131], v[112:115]
    ds_read_b64_tr_b16 a[0:1], v9 offset:40960
    v_mfma_f32_16x16x32_bf16 v[112:115], a[12:15], a[144:147], v[112:115]
    buffer_load_dwordx4 a[224:227], v11, s[12:15], s72 offen offset:0
    v_mfma_f32_16x16x32_bf16 v[116:119], a[8:11], a[132:135], v[116:119]
    ds_read_b64_tr_b16 a[2:3], v9 offset:43008
    v_mfma_f32_16x16x32_bf16 v[116:119], a[12:15], a[148:151], v[116:119]
    buffer_load_dwordx4 a[232:235], v12, s[16:19], s73 offen offset:0
    v_mfma_f32_16x16x32_bf16 v[120:123], a[8:11], a[136:139], v[120:123]
    ds_read_b64_tr_b16 a[4:5], v9 offset:57344
    v_mfma_f32_16x16x32_bf16 v[120:123], a[12:15], a[152:155], v[120:123]
    v_mfma_f32_16x16x32_bf16 v[124:127], a[8:11], a[140:143], v[124:127]
    ds_read_b64_tr_b16 a[6:7], v9 offset:59392
    v_mfma_f32_16x16x32_bf16 v[124:127], a[12:15], a[156:159], v[124:127]
    s_waitcnt lgkmcnt(4)
    v_mfma_f32_16x16x32_bf16 v[128:131], a[16:19], a[128:131], v[128:131]
    ds_read_b64_tr_b16 a[8:9], v10 offset:40960
    v_mfma_f32_16x16x32_bf16 v[128:131], a[20:23], a[144:147], v[128:131]
    buffer_load_dwordx4 a[228:231], v11, s[12:15], s72 offen offset:1024
    v_mfma_f32_16x16x32_bf16 v[132:135], a[16:19], a[132:135], v[132:135]
    ds_read_b64_tr_b16 a[10:11], v10 offset:43008
    v_mfma_f32_16x16x32_bf16 v[132:135], a[20:23], a[148:151], v[132:135]
    v_mfma_f32_16x16x32_bf16 v[136:139], a[16:19], a[136:139], v[136:139]
    ds_read_b64_tr_b16 a[12:13], v10 offset:57344
    v_mfma_f32_16x16x32_bf16 v[136:139], a[20:23], a[152:155], v[136:139]
    v_mfma_f32_16x16x32_bf16 v[140:143], a[16:19], a[140:143], v[140:143]
    ds_read_b64_tr_b16 a[14:15], v10 offset:59392
    v_mfma_f32_16x16x32_bf16 v[140:143], a[20:23], a[156:159], v[140:143]
    s_waitcnt lgkmcnt(4)
    v_mfma_f32_16x16x32_bf16 v[144:147], a[0:3], a[128:131], v[144:147]
    ds_read_b64_tr_b16 a[16:17], v9 offset:41472
    v_mfma_f32_16x16x32_bf16 v[144:147], a[4:7], a[144:147], v[144:147]
    buffer_load_dwordx4 a[236:239], v12, s[16:19], s73 offen offset:896
    s_add_u32 s72, s72, 0x200000
    s_add_u32 s73, s73, 0x1c0000
    v_mfma_f32_16x16x32_bf16 v[148:151], a[0:3], a[132:135], v[148:151]
    ds_read_b64_tr_b16 a[18:19], v9 offset:43520
    s_add_u32 m0, s32, 0x14000
    v_mfma_f32_16x16x32_bf16 v[148:151], a[4:7], a[148:151], v[148:151]
    buffer_load_dwordx4 v3, s[12:15], s28 offen offset:0 lds
    v_mfma_f32_16x16x32_bf16 v[152:155], a[0:3], a[136:139], v[152:155]
    ds_read_b64_tr_b16 a[20:21], v9 offset:57856
    v_mfma_f32_16x16x32_bf16 v[152:155], a[4:7], a[152:155], v[152:155]
    v_mfma_f32_16x16x32_bf16 v[156:159], a[0:3], a[140:143], v[156:159]
    ds_read_b64_tr_b16 a[22:23], v9 offset:59904
    v_mfma_f32_16x16x32_bf16 v[156:159], a[4:7], a[156:159], v[156:159]
    s_waitcnt lgkmcnt(4)
    v_mfma_f32_16x16x32_bf16 v[160:163], a[8:11], a[128:131], v[160:163]
    ds_read_b64_tr_b16 a[0:1], v10 offset:41472
    s_add_u32 m0, s32, 0x14f80
    v_mfma_f32_16x16x32_bf16 v[160:163], a[12:15], a[144:147], v[160:163]
    buffer_load_dwordx4 v3, s[12:15], s28 offen offset:128 lds
    s_add_u32 s28, s28, 0x40000
    v_mfma_f32_16x16x32_bf16 v[164:167], a[8:11], a[132:135], v[164:167]
    ds_read_b64_tr_b16 a[2:3], v10 offset:43520
    v_mfma_f32_16x16x32_bf16 v[164:167], a[12:15], a[148:151], v[164:167]
    v_mfma_f32_16x16x32_bf16 v[168:171], a[8:11], a[136:139], v[168:171]
    ds_read_b64_tr_b16 a[4:5], v10 offset:57856
    v_mfma_f32_16x16x32_bf16 v[168:171], a[12:15], a[152:155], v[168:171]
    v_mfma_f32_16x16x32_bf16 v[172:175], a[8:11], a[140:143], v[172:175]
    ds_read_b64_tr_b16 a[6:7], v10 offset:59904
    v_mfma_f32_16x16x32_bf16 v[172:175], a[12:15], a[156:159], v[172:175]
    s_waitcnt lgkmcnt(4)
    v_mfma_f32_16x16x32_bf16 v[176:179], a[16:19], a[128:131], v[176:179]
    ds_read_b64_tr_b16 a[8:9], v9 offset:45056
    s_add_u32 m0, s32, 0x16000
    v_mfma_f32_16x16x32_bf16 v[176:179], a[20:23], a[144:147], v[176:179]
    buffer_load_dwordx4 v4, s[16:19], s29 offen offset:0 lds
    v_mfma_f32_16x16x32_bf16 v[180:183], a[16:19], a[132:135], v[180:183]
    ds_read_b64_tr_b16 a[10:11], v9 offset:47104
    s_add_u32 m0, s32, 0x16f80
    v_mfma_f32_16x16x32_bf16 v[180:183], a[20:23], a[148:151], v[180:183]
    buffer_load_dwordx4 v5, s[16:19], s29 offen offset:128 lds
    s_add_u32 s29, s29, 0x38000
    v_mfma_f32_16x16x32_bf16 v[184:187], a[16:19], a[136:139], v[184:187]
    ds_read_b64_tr_b16 a[12:13], v9 offset:61440
    v_mfma_f32_16x16x32_bf16 v[184:187], a[20:23], a[152:155], v[184:187]
    v_mfma_f32_16x16x32_bf16 v[188:191], a[16:19], a[140:143], v[188:191]
    ds_read_b64_tr_b16 a[14:15], v9 offset:63488
    v_mfma_f32_16x16x32_bf16 v[188:191], a[20:23], a[156:159], v[188:191]
    s_waitcnt lgkmcnt(4)
    v_mfma_f32_16x16x32_bf16 v[192:195], a[0:3], a[128:131], v[192:195]
    ds_read_b64_tr_b16 a[16:17], v10 offset:45056
    v_mfma_f32_16x16x32_bf16 v[192:195], a[4:7], a[144:147], v[192:195]
    buffer_load_dwordx4 a[80:83], v6, s[20:23], s30 offen offset:0 sc1
    v_mfma_f32_16x16x32_bf16 v[196:199], a[0:3], a[132:135], v[196:199]
    ds_read_b64_tr_b16 a[18:19], v10 offset:47104
    v_mfma_f32_16x16x32_bf16 v[196:199], a[4:7], a[148:151], v[196:199]
    v_mfma_f32_16x16x32_bf16 v[200:203], a[0:3], a[136:139], v[200:203]
    ds_read_b64_tr_b16 a[20:21], v10 offset:61440
    v_mfma_f32_16x16x32_bf16 v[200:203], a[4:7], a[152:155], v[200:203]
    v_mfma_f32_16x16x32_bf16 v[204:207], a[0:3], a[140:143], v[204:207]
    ds_read_b64_tr_b16 a[22:23], v10 offset:63488
    v_mfma_f32_16x16x32_bf16 v[204:207], a[4:7], a[156:159], v[204:207]
    s_waitcnt vmcnt(18)
    s_barrier
    s_waitcnt lgkmcnt(4)
    v_mfma_f32_16x16x32_bf16 v[208:211], a[8:11], a[128:131], v[208:211]
    ds_read_b64_tr_b16 a[0:1], v9 offset:45568
    v_mfma_f32_16x16x32_bf16 v[208:211], a[12:15], a[144:147], v[208:211]
    buffer_load_dwordx4 a[84:87], v6, s[20:23], s30 offen offset:1024 sc1
    v_mfma_f32_16x16x32_bf16 v[212:215], a[8:11], a[132:135], v[212:215]
    ds_read_b64_tr_b16 a[2:3], v9 offset:47616
    v_mfma_f32_16x16x32_bf16 v[212:215], a[12:15], a[148:151], v[212:215]
    buffer_load_dwordx4 a[88:91], v6, s[20:23], s39 offen offset:0 sc1
    v_mfma_f32_16x16x32_bf16 v[216:219], a[8:11], a[136:139], v[216:219]
    ds_read_b64_tr_b16 a[4:5], v9 offset:61952
    v_mfma_f32_16x16x32_bf16 v[216:219], a[12:15], a[152:155], v[216:219]
    v_mfma_f32_16x16x32_bf16 v[220:223], a[8:11], a[140:143], v[220:223]
    ds_read_b64_tr_b16 a[6:7], v9 offset:64000
    v_mfma_f32_16x16x32_bf16 v[220:223], a[12:15], a[156:159], v[220:223]
    s_waitcnt lgkmcnt(4)
    v_mfma_f32_16x16x32_bf16 v[224:227], a[16:19], a[128:131], v[224:227]
    ds_read_b64_tr_b16 a[8:9], v10 offset:45568
    v_mfma_f32_16x16x32_bf16 v[224:227], a[20:23], a[144:147], v[224:227]
    buffer_load_dwordx4 a[92:95], v6, s[20:23], s39 offen offset:1024 sc1
    s_add_u32 s30, s30, 4096
    s_add_u32 s39, s39, 4096
    v_mfma_f32_16x16x32_bf16 v[228:231], a[16:19], a[132:135], v[228:231]
    ds_read_b64_tr_b16 a[10:11], v10 offset:47616
    v_mfma_f32_16x16x32_bf16 v[228:231], a[20:23], a[148:151], v[228:231]
    s_getpc_b64 s[80:81]
    global_load_dword a255, v0, s[80:81] offset:2048
    v_mfma_f32_16x16x32_bf16 v[232:235], a[16:19], a[136:139], v[232:235]
    ds_read_b64_tr_b16 a[12:13], v10 offset:61952
    v_mfma_f32_16x16x32_bf16 v[232:235], a[20:23], a[152:155], v[232:235]
    v_mfma_f32_16x16x32_bf16 v[236:239], a[16:19], a[140:143], v[236:239]
    ds_read_b64_tr_b16 a[14:15], v10 offset:64000
    v_mfma_f32_16x16x32_bf16 v[236:239], a[20:23], a[156:159], v[236:239]
    s_waitcnt lgkmcnt(4)
    v_mfma_f32_16x16x32_bf16 v[240:243], a[0:3], a[128:131], v[240:243]
    ds_read_b64_tr_b16 a[16:17], v7 offset:0
    v_mfma_f32_16x16x32_bf16 v[240:243], a[4:7], a[144:147], v[240:243]
    ds_read_b64_tr_b16 a[18:19], v7 offset:2048
    v_mfma_f32_16x16x32_bf16 v[244:247], a[0:3], a[132:135], v[244:247]
    ds_read_b64_tr_b16 a[20:21], v7 offset:16384
    v_mfma_f32_16x16x32_bf16 v[244:247], a[4:7], a[148:151], v[244:247]
    ds_read_b64_tr_b16 a[22:23], v7 offset:18432
    s_waitcnt lgkmcnt(4)
    v_mfma_f32_16x16x32_bf16 v[248:251], a[8:11], a[128:131], v[248:251]
    ds_read_b64_tr_b16 a[0:1], v8 offset:0
    v_mfma_f32_16x16x32_bf16 v[248:251], a[12:15], a[144:147], v[248:251]
    ds_read_b64_tr_b16 a[2:3], v8 offset:2048
    v_mfma_f32_16x16x32_bf16 v[252:255], a[8:11], a[132:135], v[252:255]
    ds_read_b64_tr_b16 a[4:5], v8 offset:16384
    v_mfma_f32_16x16x32_bf16 v[252:255], a[12:15], a[148:151], v[252:255]
    ds_read_b64_tr_b16 a[6:7], v8 offset:18432
    s_waitcnt lgkmcnt(4)
    v_mfma_f32_16x16x32_bf16 v[16:19], a[16:19], a[32:35], v[16:19]
    ds_read_b64_tr_b16 a[8:9], v7 offset:512
    s_add_u32 m0, s32, 0x18000
    v_mfma_f32_16x16x32_bf16 v[16:19], a[20:23], a[48:51], v[16:19]
    buffer_load_dwordx4 v3, s[12:15], s28 offen offset:0 lds
    v_mfma_f32_16x16x32_bf16 v[20:23], a[16:19], a[36:39], v[20:23]
    ds_read_b64_tr_b16 a[10:11], v7 offset:2560
    v_mfma_f32_16x16x32_bf16 v[20:23], a[20:23], a[52:55], v[20:23]
    v_mfma_f32_16x16x32_bf16 v[24:27], a[16:19], a[40:43], v[24:27]
    ds_read_b64_tr_b16 a[12:13], v7 offset:16896
    v_mfma_f32_16x16x32_bf16 v[24:27], a[20:23], a[56:59], v[24:27]
    v_mfma_f32_16x16x32_bf16 v[28:31], a[16:19], a[44:47], v[28:31]
    ds_read_b64_tr_b16 a[14:15], v7 offset:18944
    v_mfma_f32_16x16x32_bf16 v[28:31], a[20:23], a[60:63], v[28:31]
    s_waitcnt lgkmcnt(4)
    v_mfma_f32_16x16x32_bf16 v[32:35], a[0:3], a[32:35], v[32:35]
    ds_read_b64_tr_b16 a[16:17], v8 offset:512
    s_add_u32 m0, s32, 0x18f80
    v_mfma_f32_16x16x32_bf16 v[32:35], a[4:7], a[48:51], v[32:35]
    buffer_load_dwordx4 v3, s[12:15], s28 offen offset:128 lds
    s_add_u32 s28, s28, 0x40000
    v_mfma_f32_16x16x32_bf16 v[36:39], a[0:3], a[36:39], v[36:39]
    ds_read_b64_tr_b16 a[18:19], v8 offset:2560
    v_mfma_f32_16x16x32_bf16 v[36:39], a[4:7], a[52:55], v[36:39]
    v_mfma_f32_16x16x32_bf16 v[40:43], a[0:3], a[40:43], v[40:43]
    ds_read_b64_tr_b16 a[20:21], v8 offset:16896
    v_mfma_f32_16x16x32_bf16 v[40:43], a[4:7], a[56:59], v[40:43]
    v_mfma_f32_16x16x32_bf16 v[44:47], a[0:3], a[44:47], v[44:47]
    ds_read_b64_tr_b16 a[22:23], v8 offset:18944
    v_mfma_f32_16x16x32_bf16 v[44:47], a[4:7], a[60:63], v[44:47]
    s_waitcnt lgkmcnt(4)
    v_mfma_f32_16x16x32_bf16 v[48:51], a[8:11], a[32:35], v[48:51]
    ds_read_b64_tr_b16 a[0:1], v7 offset:4096
    s_add_u32 m0, s32, 0x1a000
    v_mfma_f32_16x16x32_bf16 v[48:51], a[12:15], a[48:51], v[48:51]
    buffer_load_dwordx4 v4, s[16:19], s29 offen offset:0 lds
    v_mfma_f32_16x16x32_bf16 v[52:55], a[8:11], a[36:39], v[52:55]
    ds_read_b64_tr_b16 a[2:3], v7 offset:6144
    v_mfma_f32_16x16x32_bf16 v[52:55], a[12:15], a[52:55], v[52:55]
    v_mfma_f32_16x16x32_bf16 v[56:59], a[8:11], a[40:43], v[56:59]
    ds_read_b64_tr_b16 a[4:5], v7 offset:20480
    v_mfma_f32_16x16x32_bf16 v[56:59], a[12:15], a[56:59], v[56:59]
    v_mfma_f32_16x16x32_bf16 v[60:63], a[8:11], a[44:47], v[60:63]
    ds_read_b64_tr_b16 a[6:7], v7 offset:22528
    v_mfma_f32_16x16x32_bf16 v[60:63], a[12:15], a[60:63], v[60:63]
    s_waitcnt lgkmcnt(4)
    v_mfma_f32_16x16x32_bf16 v[64:67], a[16:19], a[32:35], v[64:67]
    ds_read_b64_tr_b16 a[8:9], v8 offset:4096
    s_add_u32 m0, s32, 0x1af80
    v_mfma_f32_16x16x32_bf16 v[64:67], a[20:23], a[48:51], v[64:67]
    buffer_load_dwordx4 v5, s[16:19], s29 offen offset:128 lds
    s_add_u32 s29, s29, 0x38000
    v_mfma_f32_16x16x32_bf16 v[68:71], a[16:19], a[36:39], v[68:71]
    ds_read_b64_tr_b16 a[10:11], v8 offset:6144
    v_mfma_f32_16x16x32_bf16 v[68:71], a[20:23], a[52:55], v[68:71]
    v_mfma_f32_16x16x32_bf16 v[72:75], a[16:19], a[40:43], v[72:75]
    ds_read_b64_tr_b16 a[12:13], v8 offset:20480
    v_mfma_f32_16x16x32_bf16 v[72:75], a[20:23], a[56:59], v[72:75]
    v_mfma_f32_16x16x32_bf16 v[76:79], a[16:19], a[44:47], v[76:79]
    ds_read_b64_tr_b16 a[14:15], v8 offset:22528
    v_mfma_f32_16x16x32_bf16 v[76:79], a[20:23], a[60:63], v[76:79]
    s_waitcnt lgkmcnt(4)
    v_mfma_f32_16x16x32_bf16 v[80:83], a[0:3], a[32:35], v[80:83]
    ds_read_b64_tr_b16 a[16:17], v7 offset:4608
    v_mfma_f32_16x16x32_bf16 v[80:83], a[4:7], a[48:51], v[80:83]
    buffer_load_dwordx4 a[96:99], v6, s[20:23], s30 offen offset:0 sc1
    v_mfma_f32_16x16x32_bf16 v[84:87], a[0:3], a[36:39], v[84:87]
    ds_read_b64_tr_b16 a[18:19], v7 offset:6656
    v_mfma_f32_16x16x32_bf16 v[84:87], a[4:7], a[52:55], v[84:87]
    v_mfma_f32_16x16x32_bf16 v[88:91], a[0:3], a[40:43], v[88:91]
    ds_read_b64_tr_b16 a[20:21], v7 offset:20992
    v_mfma_f32_16x16x32_bf16 v[88:91], a[4:7], a[56:59], v[88:91]
    v_mfma_f32_16x16x32_bf16 v[92:95], a[0:3], a[44:47], v[92:95]
    ds_read_b64_tr_b16 a[22:23], v7 offset:23040
    v_mfma_f32_16x16x32_bf16 v[92:95], a[4:7], a[60:63], v[92:95]
    s_waitcnt lgkmcnt(4)
    v_mfma_f32_16x16x32_bf16 v[96:99], a[8:11], a[32:35], v[96:99]
    ds_read_b64_tr_b16 a[0:1], v8 offset:4608
    v_mfma_f32_16x16x32_bf16 v[96:99], a[12:15], a[48:51], v[96:99]
    buffer_load_dwordx4 a[100:103], v6, s[20:23], s30 offen offset:1024 sc1
    v_mfma_f32_16x16x32_bf16 v[100:103], a[8:11], a[36:39], v[100:103]
    ds_read_b64_tr_b16 a[2:3], v8 offset:6656
    v_mfma_f32_16x16x32_bf16 v[100:103], a[12:15], a[52:55], v[100:103]
    v_mfma_f32_16x16x32_bf16 v[104:107], a[8:11], a[40:43], v[104:107]
    ds_read_b64_tr_b16 a[4:5], v8 offset:20992
    v_mfma_f32_16x16x32_bf16 v[104:107], a[12:15], a[56:59], v[104:107]
    v_mfma_f32_16x16x32_bf16 v[108:111], a[8:11], a[44:47], v[108:111]
    ds_read_b64_tr_b16 a[6:7], v8 offset:23040
    v_mfma_f32_16x16x32_bf16 v[108:111], a[12:15], a[60:63], v[108:111]
    s_waitcnt lgkmcnt(4)
    v_mfma_f32_16x16x32_bf16 v[112:115], a[16:19], a[32:35], v[112:115]
    ds_read_b64_tr_b16 a[8:9], v7 offset:8192
    v_mfma_f32_16x16x32_bf16 v[112:115], a[20:23], a[48:51], v[112:115]
    buffer_load_dwordx4 a[104:107], v6, s[20:23], s39 offen offset:0 sc1
    v_mfma_f32_16x16x32_bf16 v[116:119], a[16:19], a[36:39], v[116:119]
    ds_read_b64_tr_b16 a[10:11], v7 offset:10240
    v_mfma_f32_16x16x32_bf16 v[116:119], a[20:23], a[52:55], v[116:119]
    buffer_load_dwordx4 a[108:111], v6, s[20:23], s39 offen offset:1024 sc1
    s_add_u32 s30, s30, 4096
    s_add_u32 s39, s39, 4096
    v_mfma_f32_16x16x32_bf16 v[120:123], a[16:19], a[40:43], v[120:123]
    ds_read_b64_tr_b16 a[12:13], v7 offset:24576
    v_mfma_f32_16x16x32_bf16 v[120:123], a[20:23], a[56:59], v[120:123]
    v_mfma_f32_16x16x32_bf16 v[124:127], a[16:19], a[44:47], v[124:127]
    ds_read_b64_tr_b16 a[14:15], v7 offset:26624
    v_mfma_f32_16x16x32_bf16 v[124:127], a[20:23], a[60:63], v[124:127]
    s_waitcnt lgkmcnt(4)
    v_mfma_f32_16x16x32_bf16 v[128:131], a[0:3], a[32:35], v[128:131]
    ds_read_b64_tr_b16 a[16:17], v8 offset:8192
    s_add_u32 m0, s32, 0x1c000
    v_mfma_f32_16x16x32_bf16 v[128:131], a[4:7], a[48:51], v[128:131]
    buffer_load_dwordx4 v3, s[12:15], s28 offen offset:0 lds
    v_mfma_f32_16x16x32_bf16 v[132:135], a[0:3], a[36:39], v[132:135]
    ds_read_b64_tr_b16 a[18:19], v8 offset:10240
    v_mfma_f32_16x16x32_bf16 v[132:135], a[4:7], a[52:55], v[132:135]
    v_mfma_f32_16x16x32_bf16 v[136:139], a[0:3], a[40:43], v[136:139]
    ds_read_b64_tr_b16 a[20:21], v8 offset:24576
    v_mfma_f32_16x16x32_bf16 v[136:139], a[4:7], a[56:59], v[136:139]
    v_mfma_f32_16x16x32_bf16 v[140:143], a[0:3], a[44:47], v[140:143]
    ds_read_b64_tr_b16 a[22:23], v8 offset:26624
    v_mfma_f32_16x16x32_bf16 v[140:143], a[4:7], a[60:63], v[140:143]
    s_waitcnt lgkmcnt(4)
    v_mfma_f32_16x16x32_bf16 v[144:147], a[8:11], a[32:35], v[144:147]
    ds_read_b64_tr_b16 a[0:1], v7 offset:8704
    s_add_u32 m0, s32, 0x1cf80
    v_mfma_f32_16x16x32_bf16 v[144:147], a[12:15], a[48:51], v[144:147]
    buffer_load_dwordx4 v3, s[12:15], s28 offen offset:128 lds
    s_add_u32 s28, s28, 0x40000
    v_mfma_f32_16x16x32_bf16 v[148:151], a[8:11], a[36:39], v[148:151]
    ds_read_b64_tr_b16 a[2:3], v7 offset:10752
    v_mfma_f32_16x16x32_bf16 v[148:151], a[12:15], a[52:55], v[148:151]
    v_mfma_f32_16x16x32_bf16 v[152:155], a[8:11], a[40:43], v[152:155]
    ds_read_b64_tr_b16 a[4:5], v7 offset:25088
    v_mfma_f32_16x16x32_bf16 v[152:155], a[12:15], a[56:59], v[152:155]
    v_mfma_f32_16x16x32_bf16 v[156:159], a[8:11], a[44:47], v[156:159]
    ds_read_b64_tr_b16 a[6:7], v7 offset:27136
    v_mfma_f32_16x16x32_bf16 v[156:159], a[12:15], a[60:63], v[156:159]
    s_waitcnt lgkmcnt(4)
    v_mfma_f32_16x16x32_bf16 v[160:163], a[16:19], a[32:35], v[160:163]
    ds_read_b64_tr_b16 a[8:9], v8 offset:8704
    s_add_u32 m0, s32, 0x1e000
    v_mfma_f32_16x16x32_bf16 v[160:163], a[20:23], a[48:51], v[160:163]
    buffer_load_dwordx4 v4, s[16:19], s29 offen offset:0 lds
    v_mfma_f32_16x16x32_bf16 v[164:167], a[16:19], a[36:39], v[164:167]
    ds_read_b64_tr_b16 a[10:11], v8 offset:10752
    v_mfma_f32_16x16x32_bf16 v[164:167], a[20:23], a[52:55], v[164:167]
    v_mfma_f32_16x16x32_bf16 v[168:171], a[16:19], a[40:43], v[168:171]
    ds_read_b64_tr_b16 a[12:13], v8 offset:25088
    v_mfma_f32_16x16x32_bf16 v[168:171], a[20:23], a[56:59], v[168:171]
    v_mfma_f32_16x16x32_bf16 v[172:175], a[16:19], a[44:47], v[172:175]
    ds_read_b64_tr_b16 a[14:15], v8 offset:27136
    v_mfma_f32_16x16x32_bf16 v[172:175], a[20:23], a[60:63], v[172:175]
    s_waitcnt lgkmcnt(4)
    v_mfma_f32_16x16x32_bf16 v[176:179], a[0:3], a[32:35], v[176:179]
    ds_read_b64_tr_b16 a[16:17], v7 offset:12288
    s_add_u32 m0, s32, 0x1ef80
    v_mfma_f32_16x16x32_bf16 v[176:179], a[4:7], a[48:51], v[176:179]
    buffer_load_dwordx4 v5, s[16:19], s29 offen offset:128 lds
    s_add_u32 s29, s29, 0x38000
    v_mfma_f32_16x16x32_bf16 v[180:183], a[0:3], a[36:39], v[180:183]
    ds_read_b64_tr_b16 a[18:19], v7 offset:14336
    v_mfma_f32_16x16x32_bf16 v[180:183], a[4:7], a[52:55], v[180:183]
    v_mfma_f32_16x16x32_bf16 v[184:187], a[0:3], a[40:43], v[184:187]
    ds_read_b64_tr_b16 a[20:21], v7 offset:28672
    v_mfma_f32_16x16x32_bf16 v[184:187], a[4:7], a[56:59], v[184:187]
    v_mfma_f32_16x16x32_bf16 v[188:191], a[0:3], a[44:47], v[188:191]
    ds_read_b64_tr_b16 a[22:23], v7 offset:30720
    v_mfma_f32_16x16x32_bf16 v[188:191], a[4:7], a[60:63], v[188:191]
    s_waitcnt lgkmcnt(4)
    v_mfma_f32_16x16x32_bf16 v[192:195], a[8:11], a[32:35], v[192:195]
    ds_read_b64_tr_b16 a[0:1], v8 offset:12288
    v_mfma_f32_16x16x32_bf16 v[192:195], a[12:15], a[48:51], v[192:195]
    buffer_load_dwordx4 a[112:115], v6, s[20:23], s30 offen offset:0 sc1
    v_mfma_f32_16x16x32_bf16 v[196:199], a[8:11], a[36:39], v[196:199]
    ds_read_b64_tr_b16 a[2:3], v8 offset:14336
    v_mfma_f32_16x16x32_bf16 v[196:199], a[12:15], a[52:55], v[196:199]
    v_mfma_f32_16x16x32_bf16 v[200:203], a[8:11], a[40:43], v[200:203]
    ds_read_b64_tr_b16 a[4:5], v8 offset:28672
    v_mfma_f32_16x16x32_bf16 v[200:203], a[12:15], a[56:59], v[200:203]
    v_mfma_f32_16x16x32_bf16 v[204:207], a[8:11], a[44:47], v[204:207]
    ds_read_b64_tr_b16 a[6:7], v8 offset:30720
    v_mfma_f32_16x16x32_bf16 v[204:207], a[12:15], a[60:63], v[204:207]
    s_waitcnt vmcnt(14)
    s_barrier
    s_waitcnt lgkmcnt(4)
    v_mfma_f32_16x16x32_bf16 v[208:211], a[16:19], a[32:35], v[208:211]
    ds_read_b64_tr_b16 a[8:9], v7 offset:12800
    v_mfma_f32_16x16x32_bf16 v[208:211], a[20:23], a[48:51], v[208:211]
    buffer_load_dwordx4 a[116:119], v6, s[20:23], s30 offen offset:1024 sc1
    v_mfma_f32_16x16x32_bf16 v[212:215], a[16:19], a[36:39], v[212:215]
    ds_read_b64_tr_b16 a[10:11], v7 offset:14848
    v_mfma_f32_16x16x32_bf16 v[212:215], a[20:23], a[52:55], v[212:215]
    v_mfma_f32_16x16x32_bf16 v[216:219], a[16:19], a[40:43], v[216:219]
    ds_read_b64_tr_b16 a[12:13], v7 offset:29184
    v_mfma_f32_16x16x32_bf16 v[216:219], a[20:23], a[56:59], v[216:219]
    v_mfma_f32_16x16x32_bf16 v[220:223], a[16:19], a[44:47], v[220:223]
    ds_read_b64_tr_b16 a[14:15], v7 offset:31232
    v_mfma_f32_16x16x32_bf16 v[220:223], a[20:23], a[60:63], v[220:223]
    s_waitcnt lgkmcnt(4)
    v_mfma_f32_16x16x32_bf16 v[224:227], a[0:3], a[32:35], v[224:227]
    ds_read_b64_tr_b16 a[16:17], v8 offset:12800
    v_mfma_f32_16x16x32_bf16 v[224:227], a[4:7], a[48:51], v[224:227]
    buffer_load_dwordx4 a[120:123], v6, s[20:23], s39 offen offset:0 sc1
    v_mfma_f32_16x16x32_bf16 v[228:231], a[0:3], a[36:39], v[228:231]
    ds_read_b64_tr_b16 a[18:19], v8 offset:14848
    v_mfma_f32_16x16x32_bf16 v[228:231], a[4:7], a[52:55], v[228:231]
    buffer_load_dwordx4 a[124:127], v6, s[20:23], s39 offen offset:1024 sc1
    s_add_u32 s30, s30, 4096
    s_add_u32 s39, s39, 4096
    v_mfma_f32_16x16x32_bf16 v[232:235], a[0:3], a[40:43], v[232:235]
    ds_read_b64_tr_b16 a[20:21], v8 offset:29184
    v_mfma_f32_16x16x32_bf16 v[232:235], a[4:7], a[56:59], v[232:235]
    v_mfma_f32_16x16x32_bf16 v[236:239], a[0:3], a[44:47], v[236:239]
    ds_read_b64_tr_b16 a[22:23], v8 offset:31232
    v_mfma_f32_16x16x32_bf16 v[236:239], a[4:7], a[60:63], v[236:239]
    s_waitcnt lgkmcnt(4)
    v_mfma_f32_16x16x32_bf16 v[240:243], a[8:11], a[32:35], v[240:243]
    ds_read_b64_tr_b16 a[0:1], v7 offset:32768
    v_mfma_f32_16x16x32_bf16 v[240:243], a[12:15], a[48:51], v[240:243]
    ds_read_b64_tr_b16 a[2:3], v7 offset:34816
    v_mfma_f32_16x16x32_bf16 v[244:247], a[8:11], a[36:39], v[244:247]
    ds_read_b64_tr_b16 a[4:5], v7 offset:49152
    v_mfma_f32_16x16x32_bf16 v[244:247], a[12:15], a[52:55], v[244:247]
    ds_read_b64_tr_b16 a[6:7], v7 offset:51200
    s_waitcnt lgkmcnt(4)
    v_mfma_f32_16x16x32_bf16 v[248:251], a[16:19], a[32:35], v[248:251]
    ds_read_b64_tr_b16 a[8:9], v8 offset:32768
    v_mfma_f32_16x16x32_bf16 v[248:251], a[20:23], a[48:51], v[248:251]
    ds_read_b64_tr_b16 a[10:11], v8 offset:34816
    v_mfma_f32_16x16x32_bf16 v[252:255], a[16:19], a[36:39], v[252:255]
    ds_read_b64_tr_b16 a[12:13], v8 offset:49152
    v_mfma_f32_16x16x32_bf16 v[252:255], a[20:23], a[52:55], v[252:255]
    ds_read_b64_tr_b16 a[14:15], v8 offset:51200
    s_waitcnt vmcnt(17)
    s_mov_b32 s64, 0x100000
L_m_dw:
    v_cmp_ne_u32 vcc, s47, v14
    s_nop 4
    s_cbranch_vccz L_m_dok
    buffer_load_dword v14, v13, s[60:63], s65 offen sc1
    s_waitcnt vmcnt(0)
    s_sub_u32 s64, s64, 1
    s_cmp_lg_u32 s64, 0
    s_cbranch_scc1 L_m_dw
L_m_dok:
    s_waitcnt lgkmcnt(4)
    v_mfma_f32_16x16x32_bf16 v[16:19], a[0:3], a[64:67], v[16:19]
    ds_read_b64_tr_b16 a[16:17], v7 offset:33280
    s_add_u32 m0, s32, 0x20000
    v_mfma_f32_16x16x32_bf16 v[16:19], a[4:7], a[80:83], v[16:19]
    buffer_load_dwordx4 v3, s[12:15], s28 offen offset:0 lds
    v_mfma_f32_16x16x32_bf16 v[20:23], a[0:3], a[68:71], v[20:23]
    ds_read_b64_tr_b16 a[18:19], v7 offset:35328
    v_mfma_f32_16x16x32_bf16 v[20:23], a[4:7], a[84:87], v[20:23]
    v_mfma_f32_16x16x32_bf16 v[24:27], a[0:3], a[72:75], v[24:27]
    ds_read_b64_tr_b16 a[20:21], v7 offset:49664
    v_mfma_f32_16x16x32_bf16 v[24:27], a[4:7], a[88:91], v[24:27]
    v_mfma_f32_16x16x32_bf16 v[28:31], a[0:3], a[76:79], v[28:31]
    ds_read_b64_tr_b16 a[22:23], v7 offset:51712
    v_mfma_f32_16x16x32_bf16 v[28:31], a[4:7], a[92:95], v[28:31]
    s_waitcnt lgkmcnt(4)
    v_mfma_f32_16x16x32_bf16 v[32:35], a[8:11], a[64:67], v[32:35]
    ds_read_b64_tr_b16 a[0:1], v8 offset:33280
    s_add_u32 m0, s32, 0x20f80
    v_mfma_f32_16x16x32_bf16 v[32:35], a[12:15], a[80:83], v[32:35]
    buffer_load_dwordx4 v3, s[12:15], s28 offen offset:128 lds
    s_add_u32 s28, s28, 0x40000
    v_mfma_f32_16x16x32_bf16 v[36:39], a[8:11], a[68:71], v[36:39]
    ds_read_b64_tr_b16 a[2:3], v8 offset:35328
    v_mfma_f32_16x16x32_bf16 v[36:39], a[12:15], a[84:87], v[36:39]
    v_mfma_f32_16x16x32_bf16 v[40:43], a[8:11], a[72:75], v[40:43]
    ds_read_b64_tr_b16 a[4:5], v8 offset:49664
    v_mfma_f32_16x16x32_bf16 v[40:43], a[12:15], a[88:91], v[40:43]
    v_mfma_f32_16x16x32_bf16 v[44:47], a[8:11], a[76:79], v[44:47]
    ds_read_b64_tr_b16 a[6:7], v8 offset:51712
    v_mfma_f32_16x16x32_bf16 v[44:47], a[12:15], a[92:95], v[44:47]
    s_waitcnt lgkmcnt(4)
    v_mfma_f32_16x16x32_bf16 v[48:51], a[16:19], a[64:67], v[48:51]
    ds_read_b64_tr_b16 a[8:9], v7 offset:36864
    s_add_u32 m0, s32, 0x22000
    v_mfma_f32_16x16x32_bf16 v[48:51], a[20:23], a[80:83], v[48:51]
    buffer_load_dwordx4 v4, s[16:19], s29 offen offset:0 lds
    v_mfma_f32_16x16x32_bf16 v[52:55], a[16:19], a[68:71], v[52:55]
    ds_read_b64_tr_b16 a[10:11], v7 offset:38912
    v_mfma_f32_16x16x32_bf16 v[52:55], a[20:23], a[84:87], v[52:55]
    v_mfma_f32_16x16x32_bf16 v[56:59], a[16:19], a[72:75], v[56:59]
    ds_read_b64_tr_b16 a[12:13], v7 offset:53248
    v_mfma_f32_16x16x32_bf16 v[56:59], a[20:23], a[88:91], v[56:59]
    v_mfma_f32_16x16x32_bf16 v[60:63], a[16:19], a[76:79], v[60:63]
    ds_read_b64_tr_b16 a[14:15], v7 offset:55296
    v_mfma_f32_16x16x32_bf16 v[60:63], a[20:23], a[92:95], v[60:63]
    s_waitcnt lgkmcnt(4)
    v_mfma_f32_16x16x32_bf16 v[64:67], a[0:3], a[64:67], v[64:67]
    ds_read_b64_tr_b16 a[16:17], v8 offset:36864
    s_add_u32 m0, s32, 0x22f80
    v_mfma_f32_16x16x32_bf16 v[64:67], a[4:7], a[80:83], v[64:67]
    buffer_load_dwordx4 v5, s[16:19], s29 offen offset:128 lds
    s_add_u32 s29, s29, 0x38000
    v_mfma_f32_16x16x32_bf16 v[68:71], a[0:3], a[68:71], v[68:71]
    ds_read_b64_tr_b16 a[18:19], v8 offset:38912
    v_mfma_f32_16x16x32_bf16 v[68:71], a[4:7], a[84:87], v[68:71]
    v_mfma_f32_16x16x32_bf16 v[72:75], a[0:3], a[72:75], v[72:75]
    ds_read_b64_tr_b16 a[20:21], v8 offset:53248
    v_mfma_f32_16x16x32_bf16 v[72:75], a[4:7], a[88:91], v[72:75]
    v_mfma_f32_16x16x32_bf16 v[76:79], a[0:3], a[76:79], v[76:79]
    ds_read_b64_tr_b16 a[22:23], v8 offset:55296
    v_mfma_f32_16x16x32_bf16 v[76:79], a[4:7], a[92:95], v[76:79]
    s_waitcnt lgkmcnt(4)
    v_mfma_f32_16x16x32_bf16 v[80:83], a[8:11], a[64:67], v[80:83]
    ds_read_b64_tr_b16 a[0:1], v7 offset:37376
    v_mfma_f32_16x16x32_bf16 v[80:83], a[12:15], a[80:83], v[80:83]
    buffer_load_dwordx4 a[128:131], v6, s[20:23], s30 offen offset:0 sc1
    v_mfma_f32_16x16x32_bf16 v[84:87], a[8:11], a[68:71], v[84:87]
    ds_read_b64_tr_b16 a[2:3], v7 offset:39424
    v_mfma_f32_16x16x32_bf16 v[84:87], a[12:15], a[84:87], v[84:87]
    v_mfma_f32_16x16x32_bf16 v[88:91], a[8:11], a[72:75], v[88:91]
    ds_read_b64_tr_b16 a[4:5], v7 offset:53760
    v_mfma_f32_16x16x32_bf16 v[88:91], a[12:15], a[88:91], v[88:91]
    v_mfma_f32_16x16x32_bf16 v[92:95], a[8:11], a[76:79], v[92:95]
    ds_read_b64_tr_b16 a[6:7], v7 offset:55808
    v_mfma_f32_16x16x32_bf16 v[92:95], a[12:15], a[92:95], v[92:95]
    s_waitcnt lgkmcnt(4)
    v_mfma_f32_16x16x32_bf16 v[96:99], a[16:19], a[64:67], v[96:99]
    ds_read_b64_tr_b16 a[8:9], v8 offset:37376
    v_mfma_f32_16x16x32_bf16 v[96:99], a[20:23], a[80:83], v[96:99]
    buffer_load_dwordx4 a[132:135], v6, s[20:23], s30 offen offset:1024 sc1
    v_mfma_f32_16x16x32_bf16 v[100:103], a[16:19], a[68:71], v[100:103]
    ds_read_b64_tr_b16 a[10:11], v8 offset:39424
    v_mfma_f32_16x16x32_bf16 v[100:103], a[20:23], a[84:87], v[100:103]
    v_mfma_f32_16x16x32_bf16 v[104:107], a[16:19], a[72:75], v[104:107]
    ds_read_b64_tr_b16 a[12:13], v8 offset:53760
    v_mfma_f32_16x16x32_bf16 v[104:107], a[20:23], a[88:91], v[104:107]
    v_mfma_f32_16x16x32_bf16 v[108:111], a[16:19], a[76:79], v[108:111]
    ds_read_b64_tr_b16 a[14:15], v8 offset:55808
    v_mfma_f32_16x16x32_bf16 v[108:111], a[20:23], a[92:95], v[108:111]
    s_waitcnt lgkmcnt(4)
    v_mfma_f32_16x16x32_bf16 v[112:115], a[0:3], a[64:67], v[112:115]
    ds_read_b64_tr_b16 a[16:17], v7 offset:40960
    v_mfma_f32_16x16x32_bf16 v[112:115], a[4:7], a[80:83], v[112:115]
    buffer_load_dwordx4 a[136:139], v6, s[20:23], s39 offen offset:0 sc1
    v_mfma_f32_16x16x32_bf16 v[116:119], a[0:3], a[68:71], v[116:119]
    ds_read_b64_tr_b16 a[18:19], v7 offset:43008
    v_mfma_f32_16x16x32_bf16 v[116:119], a[4:7], a[84:87], v[116:119]
    buffer_load_dwordx4 a[140:143], v6, s[20:23], s39 offen offset:1024 sc1
    s_add_u32 s30, s30, 4096
    s_add_u32 s39, s39, 4096
    v_mfma_f32_16x16x32_bf16 v[120:123], a[0:3], a[72:75], v[120:123]
    ds_read_b64_tr_b16 a[20:21], v7 offset:57344
    v_mfma_f32_16x16x32_bf16 v[120:123], a[4:7], a[88:91], v[120:123]
    v_mfma_f32_16x16x32_bf16 v[124:127], a[0:3], a[76:79], v[124:127]
    ds_read_b64_tr_b16 a[22:23], v7 offset:59392
    v_mfma_f32_16x16x32_bf16 v[124:127], a[4:7], a[92:95], v[124:127]
    s_waitcnt lgkmcnt(4)
    v_mfma_f32_16x16x32_bf16 v[128:131], a[8:11], a[64:67], v[128:131]
    ds_read_b64_tr_b16 a[0:1], v8 offset:40960
    s_add_u32 m0, s32, 0x24000
    v_mfma_f32_16x16x32_bf16 v[128:131], a[12:15], a[80:83], v[128:131]
    buffer_load_dwordx4 v3, s[12:15], s28 offen offset:0 lds
    v_mfma_f32_16x16x32_bf16 v[132:135], a[8:11], a[68:71], v[132:135]
    ds_read_b64_tr_b16 a[2:3], v8 offset:43008
    v_mfma_f32_16x16x32_bf16 v[132:135], a[12:15], a[84:87], v[132:135]
    v_mfma_f32_16x16x32_bf16 v[136:139], a[8:11], a[72:75], v[136:139]
    ds_read_b64_tr_b16 a[4:5], v8 offset:57344
    v_mfma_f32_16x16x32_bf16 v[136:139], a[12:15], a[88:91], v[136:139]
    v_mfma_f32_16x16x32_bf16 v[140:143], a[8:11], a[76:79], v[140:143]
    ds_read_b64_tr_b16 a[6:7], v8 offset:59392
    v_mfma_f32_16x16x32_bf16 v[140:143], a[12:15], a[92:95], v[140:143]
    s_waitcnt lgkmcnt(4)
    v_mfma_f32_16x16x32_bf16 v[144:147], a[16:19], a[64:67], v[144:147]
    ds_read_b64_tr_b16 a[8:9], v7 offset:41472
    s_add_u32 m0, s32, 0x24f80
    v_mfma_f32_16x16x32_bf16 v[144:147], a[20:23], a[80:83], v[144:147]
    buffer_load_dwordx4 v3, s[12:15], s28 offen offset:128 lds
    s_add_u32 s28, s28, 0x40000
    v_mfma_f32_16x16x32_bf16 v[148:151], a[16:19], a[68:71], v[148:151]
    ds_read_b64_tr_b16 a[10:11], v7 offset:43520
    v_mfma_f32_16x16x32_bf16 v[148:151], a[20:23], a[84:87], v[148:151]
    v_mfma_f32_16x16x32_bf16 v[152:155], a[16:19], a[72:75], v[152:155]
    ds_read_b64_tr_b16 a[12:13], v7 offset:57856
    v_mfma_f32_16x16x32_bf16 v[152:155], a[20:23], a[88:91], v[152:155]
    v_mfma_f32_16x16x32_bf16 v[156:159], a[16:19], a[76:79], v[156:159]
    ds_read_b64_tr_b16 a[14:15], v7 offset:59904
    v_mfma_f32_16x16x32_bf16 v[156:159], a[20:23], a[92:95], v[156:159]
    s_waitcnt lgkmcnt(4)
    v_mfma_f32_16x16x32_bf16 v[160:163], a[0:3], a[64:67], v[160:163]
    ds_read_b64_tr_b16 a[16:17], v8 offset:41472
    s_add_u32 m0, s32, 0x26000
    v_mfma_f32_16x16x32_bf16 v[160:163], a[4:7], a[80:83], v[160:163]
    buffer_load_dwordx4 v4, s[16:19], s29 offen offset:0 lds
    v_mfma_f32_16x16x32_bf16 v[164:167], a[0:3], a[68:71], v[164:167]
    ds_read_b64_tr_b16 a[18:19], v8 offset:43520
    v_mfma_f32_16x16x32_bf16 v[164:167], a[4:7], a[84:87], v[164:167]
    v_mfma_f32_16x16x32_bf16 v[168:171], a[0:3], a[72:75], v[168:171]
    ds_read_b64_tr_b16 a[20:21], v8 offset:57856
    v_mfma_f32_16x16x32_bf16 v[168:171], a[4:7], a[88:91], v[168:171]
    v_mfma_f32_16x16x32_bf16 v[172:175], a[0:3], a[76:79], v[172:175]
    ds_read_b64_tr_b16 a[22:23], v8 offset:59904
    v_mfma_f32_16x16x32_bf16 v[172:175], a[4:7], a[92:95], v[172:175]
    s_waitcnt lgkmcnt(4)
    v_mfma_f32_16x16x32_bf16 v[176:179], a[8:11], a[64:67], v[176:179]
    ds_read_b64_tr_b16 a[0:1], v7 offset:45056
    s_add_u32 m0, s32, 0x26f80
    v_mfma_f32_16x16x32_bf16 v[176:179], a[12:15], a[80:83], v[176:179]
    buffer_load_dwordx4 v5, s[16:19], s29 offen offset:128 lds
    s_add_u32 s29, s29, 0x38000
    v_mfma_f32_16x16x32_bf16 v[180:183], a[8:11], a[68:71], v[180:183]
    ds_read_b64_tr_b16 a[2:3], v7 offset:47104
    v_mfma_f32_16x16x32_bf16 v[180:183], a[12:15], a[84:87], v[180:183]
    v_mfma_f32_16x16x32_bf16 v[184:187], a[8:11], a[72:75], v[184:187]
    ds_read_b64_tr_b16 a[4:5], v7 offset:61440
    v_mfma_f32_16x16x32_bf16 v[184:187], a[12:15], a[88:91], v[184:187]
    v_mfma_f32_16x16x32_bf16 v[188:191], a[8:11], a[76:79], v[188:191]
    ds_read_b64_tr_b16 a[6:7], v7 offset:63488
    v_mfma_f32_16x16x32_bf16 v[188:191], a[12:15], a[92:95], v[188:191]
    s_waitcnt lgkmcnt(4)
    v_mfma_f32_16x16x32_bf16 v[192:195], a[16:19], a[64:67], v[192:195]
    ds_read_b64_tr_b16 a[8:9], v8 offset:45056
    v_mfma_f32_16x16x32_bf16 v[192:195], a[20:23], a[80:83], v[192:195]
    buffer_load_dwordx4 a[144:147], v6, s[20:23], s30 offen offset:0 sc1
    v_mfma_f32_16x16x32_bf16 v[196:199], a[16:19], a[68:71], v[196:199]
    ds_read_b64_tr_b16 a[10:11], v8 offset:47104
    v_mfma_f32_16x16x32_bf16 v[196:199], a[20:23], a[84:87], v[196:199]
    v_mfma_f32_16x16x32_bf16 v[200:203], a[16:19], a[72:75], v[200:203]
    ds_read_b64_tr_b16 a[12:13], v8 offset:61440
    v_mfma_f32_16x16x32_bf16 v[200:203], a[20:23], a[88:91], v[200:203]
    v_mfma_f32_16x16x32_bf16 v[204:207], a[16:19], a[76:79], v[204:207]
    ds_read_b64_tr_b16 a[14:15], v8 offset:63488
    v_mfma_f32_16x16x32_bf16 v[204:207], a[20:23], a[92:95], v[204:207]
    s_waitcnt vmcnt(13)
    s_barrier
    s_waitcnt lgkmcnt(4)
    v_mfma_f32_16x16x32_bf16 v[208:211], a[0:3], a[64:67], v[208:211]
    ds_read_b64_tr_b16 a[16:17], v7 offset:45568
    v_mfma_f32_16x16x32_bf16 v[208:211], a[4:7], a[80:83], v[208:211]
    buffer_load_dwordx4 a[148:151], v6, s[20:23], s30 offen offset:1024 sc1
    v_mfma_f32_16x16x32_bf16 v[212:215], a[0:3], a[68:71], v[212:215]
    ds_read_b64_tr_b16 a[18:19], v7 offset:47616
    v_mfma_f32_16x16x32_bf16 v[212:215], a[4:7], a[84:87], v[212:215]
    v_mfma_f32_16x16x32_bf16 v[216:219], a[0:3], a[72:75], v[216:219]
    ds_read_b64_tr_b16 a[20:21], v7 offset:61952
    v_mfma_f32_16x16x32_bf16 v[216:219], a[4:7], a[88:91], v[216:219]
    v_mfma_f32_16x16x32_bf16 v[220:223], a[0:3], a[76:79], v[220:223]
    ds_read_b64_tr_b16 a[22:23], v7 offset:64000
    v_mfma_f32_16x16x32_bf16 v[220:223], a[4:7], a[92:95], v[220:223]
    s_waitcnt lgkmcnt(4)
    v_mfma_f32_16x16x32_bf16 v[224:227], a[8:11], a[64:67], v[224:227]
    ds_read_b64_tr_b16 a[0:1], v8 offset:45568
    v_mfma_f32_16x16x32_bf16 v[224:227], a[12:15], a[80:83], v[224:227]
    buffer_load_dwordx4 a[152:155], v6, s[20:23], s39 offen offset:0 sc1
    v_mfma_f32_16x16x32_bf16 v[228:231], a[8:11], a[68:71], v[228:231]
    ds_read_b64_tr_b16 a[2:3], v8 offset:47616
    v_mfma_f32_16x16x32_bf16 v[228:231], a[12:15], a[84:87], v[228:231]
    buffer_load_dwordx4 a[156:159], v6, s[20:23], s39 offen offset:1024 sc1
    s_add_u32 s30, s30, 4096
    s_add_u32 s39, s39, 4096
    v_mfma_f32_16x16x32_bf16 v[232:235], a[8:11], a[72:75], v[232:235]
    ds_read_b64_tr_b16 a[4:5], v8 offset:61952
    v_mfma_f32_16x16x32_bf16 v[232:235], a[12:15], a[88:91], v[232:235]
    v_mfma_f32_16x16x32_bf16 v[236:239], a[8:11], a[76:79], v[236:239]
    ds_read_b64_tr_b16 a[6:7], v8 offset:64000
    v_mfma_f32_16x16x32_bf16 v[236:239], a[12:15], a[92:95], v[236:239]
    s_waitcnt lgkmcnt(4)
    v_mfma_f32_16x16x32_bf16 v[240:243], a[16:19], a[64:67], v[240:243]
    ds_read_b64_tr_b16 a[8:9], v9 offset:0
    v_mfma_f32_16x16x32_bf16 v[240:243], a[20:23], a[80:83], v[240:243]
    ds_read_b64_tr_b16 a[10:11], v9 offset:2048
    v_mfma_f32_16x16x32_bf16 v[244:247], a[16:19], a[68:71], v[244:247]
    ds_read_b64_tr_b16 a[12:13], v9 offset:16384
    v_mfma_f32_16x16x32_bf16 v[244:247], a[20:23], a[84:87], v[244:247]
    ds_read_b64_tr_b16 a[14:15], v9 offset:18432
    s_waitcnt lgkmcnt(4)
    v_mfma_f32_16x16x32_bf16 v[248:251], a[0:3], a[64:67], v[248:251]
    ds_read_b64_tr_b16 a[16:17], v10 offset:0
    v_mfma_f32_16x16x32_bf16 v[248:251], a[4:7], a[80:83], v[248:251]
    ds_read_b64_tr_b16 a[18:19], v10 offset:2048
    v_mfma_f32_16x16x32_bf16 v[252:255], a[0:3], a[68:71], v[252:255]
    ds_read_b64_tr_b16 a[20:21], v10 offset:16384
    v_mfma_f32_16x16x32_bf16 v[252:255], a[4:7], a[84:87], v[252:255]
    ds_read_b64_tr_b16 a[22:23], v10 offset:18432
    s_waitcnt lgkmcnt(4)
    v_mfma_f32_16x16x32_bf16 v[16:19], a[8:11], a[96:99], v[16:19]
    ds_read_b64_tr_b16 a[0:1], v9 offset:512
    s_add_u32 m0, s32, 0x8000
    v_mfma_f32_16x16x32_bf16 v[16:19], a[12:15], a[112:115], v[16:19]
    buffer_load_dwordx4 v3, s[12:15], s28 offen offset:0 lds
    v_mfma_f32_16x16x32_bf16 v[20:23], a[8:11], a[100:103], v[20:23]
    ds_read_b64_tr_b16 a[2:3], v9 offset:2560
    v_mfma_f32_16x16x32_bf16 v[20:23], a[12:15], a[116:119], v[20:23]
    v_mfma_f32_16x16x32_bf16 v[24:27], a[8:11], a[104:107], v[24:27]
    ds_read_b64_tr_b16 a[4:5], v9 offset:16896
    v_mfma_f32_16x16x32_bf16 v[24:27], a[12:15], a[120:123], v[24:27]
    v_mfma_f32_16x16x32_bf16 v[28:31], a[8:11], a[108:111], v[28:31]
    ds_read_b64_tr_b16 a[6:7], v9 offset:18944
    v_mfma_f32_16x16x32_bf16 v[28:31], a[12:15], a[124:127], v[28:31]
    s_waitcnt lgkmcnt(4)
    v_mfma_f32_16x16x32_bf16 v[32:35], a[16:19], a[96:99], v[32:35]
    ds_read_b64_tr_b16 a[8:9], v10 offset:512
    s_add_u32 m0, s32, 0x8f80
    v_mfma_f32_16x16x32_bf16 v[32:35], a[20:23], a[112:115], v[32:35]
    buffer_load_dwordx4 v3, s[12:15], s28 offen offset:128 lds
    s_add_u32 s28, s28, 0x40000
    v_mfma_f32_16x16x32_bf16 v[36:39], a[16:19], a[100:103], v[36:39]
    ds_read_b64_tr_b16 a[10:11], v10 offset:2560
    s_add_u32 m0, s32, 0xa000
    v_mfma_f32_16x16x32_bf16 v[36:39], a[20:23], a[116:119], v[36:39]
    buffer_load_dwordx4 v4, s[16:19], s29 offen offset:0 lds
    v_mfma_f32_16x16x32_bf16 v[40:43], a[16:19], a[104:107], v[40:43]
    ds_read_b64_tr_b16 a[12:13], v10 offset:16896
    v_mfma_f32_16x16x32_bf16 v[40:43], a[20:23], a[120:123], v[40:43]
    v_mfma_f32_16x16x32_bf16 v[44:47], a[16:19], a[108:111], v[44:47]
    ds_read_b64_tr_b16 a[14:15], v10 offset:18944
    v_mfma_f32_16x16x32_bf16 v[44:47], a[20:23], a[124:127], v[44:47]
    s_waitcnt lgkmcnt(4)
    v_mfma_f32_16x16x32_bf16 v[48:51], a[0:3], a[96:99], v[48:51]
    ds_read_b64_tr_b16 a[16:17], v9 offset:4096
    s_add_u32 m0, s32, 0xaf80
    v_mfma_f32_16x16x32_bf16 v[48:51], a[4:7], a[112:115], v[48:51]
    buffer_load_dwordx4 v5, s[16:19], s29 offen offset:128 lds
    s_add_u32 s29, s29, 0x38000
    v_mfma_f32_16x16x32_bf16 v[52:55], a[0:3], a[100:103], v[52:55]
    ds_read_b64_tr_b16 a[18:19], v9 offset:6144
    v_mfma_f32_16x16x32_bf16 v[52:55], a[4:7], a[116:119], v[52:55]
    buffer_load_dwordx4 a[32:35], v6, s[20:23], s30 offen offset:0 sc1
    v_mfma_f32_16x16x32_bf16 v[56:59], a[0:3], a[104:107], v[56:59]
    ds_read_b64_tr_b16 a[20:21], v9 offset:20480
    v_mfma_f32_16x16x32_bf16 v[56:59], a[4:7], a[120:123], v[56:59]
    v_mfma_f32_16x16x32_bf16 v[60:63], a[0:3], a[108:111], v[60:63]
    ds_read_b64_tr_b16 a[22:23], v9 offset:22528
    v_mfma_f32_16x16x32_bf16 v[60:63], a[4:7], a[124:127], v[60:63]
    s_waitcnt lgkmcnt(4)
    v_mfma_f32_16x16x32_bf16 v[64:67], a[8:11], a[96:99], v[64:67]
    ds_read_b64_tr_b16 a[0:1], v10 offset:4096
    v_mfma_f32_16x16x32_bf16 v[64:67], a[12:15], a[112:115], v[64:67]
    buffer_load_dwordx4 a[36:39], v6, s[20:23], s30 offen offset:1024 sc1
    v_mfma_f32_16x16x32_bf16 v[68:71], a[8:11], a[100:103], v[68:71]
    ds_read_b64_tr_b16 a[2:3], v10 offset:6144
    v_mfma_f32_16x16x32_bf16 v[68:71], a[12:15], a[116:119], v[68:71]
    buffer_load_dwordx4 a[40:43], v6, s[20:23], s39 offen offset:0 sc1
    v_mfma_f32_16x16x32_bf16 v[72:75], a[8:11], a[104:107], v[72:75]
    ds_read_b64_tr_b16 a[4:5], v10 offset:20480
    v_mfma_f32_16x16x32_bf16 v[72:75], a[12:15], a[120:123], v[72:75]
    v_mfma_f32_16x16x32_bf16 v[76:79], a[8:11], a[108:111], v[76:79]
    ds_read_b64_tr_b16 a[6:7], v10 offset:22528
    v_mfma_f32_16x16x32_bf16 v[76:79], a[12:15], a[124:127], v[76:79]
    s_waitcnt lgkmcnt(4)
    v_mfma_f32_16x16x32_bf16 v[80:83], a[16:19], a[96:99], v[80:83]
    ds_read_b64_tr_b16 a[8:9], v9 offset:4608
    v_mfma_f32_16x16x32_bf16 v[80:83], a[20:23], a[112:115], v[80:83]
    buffer_load_dwordx4 a[44:47], v6, s[20:23], s39 offen offset:1024 sc1
    s_add_u32 s30, s30, 4096
    s_add_u32 s39, s39, 4096
    v_mfma_f32_16x16x32_bf16 v[84:87], a[16:19], a[100:103], v[84:87]
    ds_read_b64_tr_b16 a[10:11], v9 offset:6656
    s_add_u32 m0, s32, 0xc000
    v_mfma_f32_16x16x32_bf16 v[84:87], a[20:23], a[116:119], v[84:87]
    buffer_load_dwordx4 v3, s[12:15], s28 offen offset:0 lds
    v_mfma_f32_16x16x32_bf16 v[88:91], a[16:19], a[104:107], v[88:91]
    ds_read_b64_tr_b16 a[12:13], v9 offset:20992
    v_mfma_f32_16x16x32_bf16 v[88:91], a[20:23], a[120:123], v[88:91]
    v_mfma_f32_16x16x32_bf16 v[92:95], a[16:19], a[108:111], v[92:95]
    ds_read_b64_tr_b16 a[14:15], v9 offset:23040
    v_mfma_f32_16x16x32_bf16 v[92:95], a[20:23], a[124:127], v[92:95]
    s_waitcnt lgkmcnt(4)
    v_mfma_f32_16x16x32_bf16 v[96:99], a[0:3], a[96:99], v[96:99]
    ds_read_b64_tr_b16 a[16:17], v10 offset:4608
    s_add_u32 m0, s32, 0xcf80
    v_mfma_f32_16x16x32_bf16 v[96:99], a[4:7], a[112:115], v[96:99]
    buffer_load_dwordx4 v3, s[12:15], s28 offen offset:128 lds
    s_add_u32 s28, s28, 0x40000
    v_mfma_f32_16x16x32_bf16 v[100:103], a[0:3], a[100:103], v[100:103]
    ds_read_b64_tr_b16 a[18:19], v10 offset:6656
    s_add_u32 m0, s32, 0xe000
    v_mfma_f32_16x16x32_bf16 v[100:103], a[4:7], a[116:119], v[100:103]
    buffer_load_dwordx4 v4, s[16:19], s29 offen offset:0 lds
    v_mfma_f32_16x16x32_bf16 v[104:107], a[0:3], a[104:107], v[104:107]
    ds_read_b64_tr_b16 a[20:21], v10 offset:20992
    v_mfma_f32_16x16x32_bf16 v[104:107], a[4:7], a[120:123], v[104:107]
    v_mfma_f32_16x16x32_bf16 v[108:111], a[0:3], a[108:111], v[108:111]
    ds_read_b64_tr_b16 a[22:23], v10 offset:23040
    v_mfma_f32_16x16x32_bf16 v[108:111], a[4:7], a[124:127], v[108:111]
    s_waitcnt lgkmcnt(4)
    v_mfma_f32_16x16x32_bf16 v[112:115], a[8:11], a[96:99], v[112:115]
    ds_read_b64_tr_b16 a[0:1], v9 offset:8192
    s_add_u32 m0, s32, 0xef80
    v_mfma_f32_16x16x32_bf16 v[112:115], a[12:15], a[112:115], v[112:115]
    buffer_load_dwordx4 v5, s[16:19], s29 offen offset:128 lds
    s_add_u32 s29, s29, 0x38000
    v_mfma_f32_16x16x32_bf16 v[116:119], a[8:11], a[100:103], v[116:119]
    ds_read_b64_tr_b16 a[2:3], v9 offset:10240
    v_mfma_f32_16x16x32_bf16 v[116:119], a[12:15], a[116:119], v[116:119]
    buffer_load_dwordx4 a[48:51], v6, s[20:23], s30 offen offset:0 sc1
    v_mfma_f32_16x16x32_bf16 v[120:123], a[8:11], a[104:107], v[120:123]
    ds_read_b64_tr_b16 a[4:5], v9 offset:24576
    v_mfma_f32_16x16x32_bf16 v[120:123], a[12:15], a[120:123], v[120:123]
    v_mfma_f32_16x16x32_bf16 v[124:127], a[8:11], a[108:111], v[124:127]
    ds_read_b64_tr_b16 a[6:7], v9 offset:26624
    v_mfma_f32_16x16x32_bf16 v[124:127], a[12:15], a[124:127], v[124:127]
    s_waitcnt lgkmcnt(4)
    v_mfma_f32_16x16x32_bf16 v[128:131], a[16:19], a[96:99], v[128:131]
    ds_read_b64_tr_b16 a[8:9], v10 offset:8192
    v_mfma_f32_16x16x32_bf16 v[128:131], a[20:23], a[112:115], v[128:131]
    buffer_load_dwordx4 a[52:55], v6, s[20:23], s30 offen offset:1024 sc1
    v_mfma_f32_16x16x32_bf16 v[132:135], a[16:19], a[100:103], v[132:135]
    ds_read_b64_tr_b16 a[10:11], v10 offset:10240
    v_mfma_f32_16x16x32_bf16 v[132:135], a[20:23], a[116:119], v[132:135]
    v_mfma_f32_16x16x32_bf16 v[136:139], a[16:19], a[104:107], v[136:139]
    ds_read_b64_tr_b16 a[12:13], v10 offset:24576
    v_mfma_f32_16x16x32_bf16 v[136:139], a[20:23], a[120:123], v[136:139]
    v_mfma_f32_16x16x32_bf16 v[140:143], a[16:19], a[108:111], v[140:143]
    ds_read_b64_tr_b16 a[14:15], v10 offset:26624
    v_mfma_f32_16x16x32_bf16 v[140:143], a[20:23], a[124:127], v[140:143]
    s_waitcnt lgkmcnt(4)
    v_mfma_f32_16x16x32_bf16 v[144:147], a[0:3], a[96:99], v[144:147]
    ds_read_b64_tr_b16 a[16:17], v9 offset:8704
    v_mfma_f32_16x16x32_bf16 v[144:147], a[4:7], a[112:115], v[144:147]
    buffer_load_dwordx4 a[56:59], v6, s[20:23], s39 offen offset:0 sc1
    v_mfma_f32_16x16x32_bf16 v[148:151], a[0:3], a[100:103], v[148:151]
    ds_read_b64_tr_b16 a[18:19], v9 offset:10752
    v_mfma_f32_16x16x32_bf16 v[148:151], a[4:7], a[116:119], v[148:151]
    buffer_load_dwordx4 a[60:63], v6, s[20:23], s39 offen offset:1024 sc1
    s_add_u32 s30, s30, 4096
    s_add_u32 s39, s39, 4096
    v_mfma_f32_16x16x32_bf16 v[152:155], a[0:3], a[104:107], v[152:155]
    ds_read_b64_tr_b16 a[20:21], v9 offset:25088
    v_mfma_f32_16x16x32_bf16 v[152:155], a[4:7], a[120:123], v[152:155]
    v_mfma_f32_16x16x32_bf16 v[156:159], a[0:3], a[108:111], v[156:159]
    ds_read_b64_tr_b16 a[22:23], v9 offset:27136
    v_mfma_f32_16x16x32_bf16 v[156:159], a[4:7], a[124:127], v[156:159]
    s_waitcnt lgkmcnt(4)
    v_mfma_f32_16x16x32_bf16 v[160:163], a[8:11], a[96:99], v[160:163]
    ds_read_b64_tr_b16 a[0:1], v10 offset:8704
    s_add_u32 m0, s32, 0x0
    v_mfma_f32_16x16x32_bf16 v[160:163], a[12:15], a[112:115], v[160:163]
    buffer_load_dwordx4 v6, s[20:23], s31 offen sc1 lds
    s_add_u32 s31, s31, 4096
    v_mfma_f32_16x16x32_bf16 v[164:167], a[8:11], a[100:103], v[164:167]
    ds_read_b64_tr_b16 a[2:3], v10 offset:10752
    s_add_u32 m0, s32, 0x1000
    v_mfma_f32_16x16x32_bf16 v[164:167], a[12:15], a[116:119], v[164:167]
    buffer_load_dwordx4 v6, s[20:23], s31 offen sc1 lds
    s_add_u32 s31, s31, 4096
    v_mfma_f32_16x16x32_bf16 v[168:171], a[8:11], a[104:107], v[168:171]
    ds_read_b64_tr_b16 a[4:5], v10 offset:25088
    v_mfma_f32_16x16x32_bf16 v[168:171], a[12:15], a[120:123], v[168:171]
    v_mfma_f32_16x16x32_bf16 v[172:175], a[8:11], a[108:111], v[172:175]
    ds_read_b64_tr_b16 a[6:7], v10 offset:27136
    v_mfma_f32_16x16x32_bf16 v[172:175], a[12:15], a[124:127], v[172:175]
    s_waitcnt lgkmcnt(4)
    v_mfma_f32_16x16x32_bf16 v[176:179], a[16:19], a[96:99], v[176:179]
    ds_read_b64_tr_b16 a[8:9], v9 offset:12288
    s_add_u32 m0, s32, 0x2000
    v_mfma_f32_16x16x32_bf16 v[176:179], a[20:23], a[112:115], v[176:179]
    buffer_load_dwordx4 v6, s[20:23], s31 offen sc1 lds
    s_add_u32 s31, s31, 4096
    v_mfma_f32_16x16x32_bf16 v[180:183], a[16:19], a[100:103], v[180:183]
    ds_read_b64_tr_b16 a[10:11], v9 offset:14336
    s_add_u32 m0, s32, 0x3000
    v_mfma_f32_16x16x32_bf16 v[180:183], a[20:23], a[116:119], v[180:183]
    buffer_load_dwordx4 v6, s[20:23], s31 offen sc1 lds
    s_add_u32 s31, s31, 4096
    v_mfma_f32_16x16x32_bf16 v[184:187], a[16:19], a[104:107], v[184:187]
    ds_read_b64_tr_b16 a[12:13], v9 offset:28672
    v_mfma_f32_16x16x32_bf16 v[184:187], a[20:23], a[120:123], v[184:187]
    v_mfma_f32_16x16x32_bf16 v[188:191], a[16:19], a[108:111], v[188:191]
    ds_read_b64_tr_b16 a[14:15], v9 offset:30720
    v_mfma_f32_16x16x32_bf16 v[188:191], a[20:23], a[124:127], v[188:191]
    s_waitcnt lgkmcnt(4)
    v_mfma_f32_16x16x32_bf16 v[192:195], a[0:3], a[96:99], v[192:195]
    ds_read_b64_tr_b16 a[16:17], v10 offset:12288
    s_add_u32 m0, s32, 0x4000
    v_mfma_f32_16x16x32_bf16 v[192:195], a[4:7], a[112:115], v[192:195]
    buffer_load_dwordx4 v6, s[20:23], s31 offen sc1 lds
    s_add_u32 s31, s31, 4096
    v_mfma_f32_16x16x32_bf16 v[196:199], a[0:3], a[100:103], v[196:199]
    ds_read_b64_tr_b16 a[18:19], v10 offset:14336
    s_add_u32 m0, s32, 0x5000
    v_mfma_f32_16x16x32_bf16 v[196:199], a[4:7], a[116:119], v[196:199]
    buffer_load_dwordx4 v6, s[20:23], s31 offen sc1 lds
    s_add_u32 s31, s31, 4096
    v_mfma_f32_16x16x32_bf16 v[200:203], a[0:3], a[104:107], v[200:203]
    ds_read_b64_tr_b16 a[20:21], v10 offset:28672
    v_mfma_f32_16x16x32_bf16 v[200:203], a[4:7], a[120:123], v[200:203]
    v_mfma_f32_16x16x32_bf16 v[204:207], a[0:3], a[108:111], v[204:207]
    ds_read_b64_tr_b16 a[22:23], v10 offset:30720
    v_mfma_f32_16x16x32_bf16 v[204:207], a[4:7], a[124:127], v[204:207]
    s_waitcnt vmcnt(22)
    s_barrier
    s_waitcnt lgkmcnt(4)
    v_mfma_f32_16x16x32_bf16 v[208:211], a[8:11], a[96:99], v[208:211]
    ds_read_b64_tr_b16 a[0:1], v9 offset:12800
    s_add_u32 m0, s32, 0x6000
    v_mfma_f32_16x16x32_bf16 v[208:211], a[12:15], a[112:115], v[208:211]
    buffer_load_dwordx4 v6, s[20:23], s31 offen sc1 lds
    s_add_u32 s31, s31, 4096
    v_mfma_f32_16x16x32_bf16 v[212:215], a[8:11], a[100:103], v[212:215]
    ds_read_b64_tr_b16 a[2:3], v9 offset:14848
    s_add_u32 m0, s32, 0x7000
    v_mfma_f32_16x16x32_bf16 v[212:215], a[12:15], a[116:119], v[212:215]
    buffer_load_dwordx4 v6, s[20:23], s31 offen sc1 lds
    s_add_u32 s31, s31, 4096
    v_mfma_f32_16x16x32_bf16 v[216:219], a[8:11], a[104:107], v[216:219]
    ds_read_b64_tr_b16 a[4:5], v9 offset:29184
    v_mfma_f32_16x16x32_bf16 v[216:219], a[12:15], a[120:123], v[216:219]
    v_mfma_f32_16x16x32_bf16 v[220:223], a[8:11], a[108:111], v[220:223]
    ds_read_b64_tr_b16 a[6:7], v9 offset:31232
    v_mfma_f32_16x16x32_bf16 v[220:223], a[12:15], a[124:127], v[220:223]
    s_waitcnt lgkmcnt(4)
    v_mfma_f32_16x16x32_bf16 v[224:227], a[16:19], a[96:99], v[224:227]
    ds_read_b64_tr_b16 a[8:9], v10 offset:12800
    v_mfma_f32_16x16x32_bf16 v[224:227], a[20:23], a[112:115], v[224:227]
    v_lshrrev_b32 v14, 3, v1
    v_lshlrev_b32 v14, 11, v14
    v_and_b32 v13, 0x70, v6
    v_add_u32 v14, v14, v13
    buffer_load_dwordx4 a[240:243], v14, s[52:55], s38 offen
    v_mfma_f32_16x16x32_bf16 v[228:231], a[16:19], a[100:103], v[228:231]
    ds_read_b64_tr_b16 a[10:11], v10 offset:14848
    v_mfma_f32_16x16x32_bf16 v[228:231], a[20:23], a[116:119], v[228:231]
    buffer_load_dwordx4 a[244:247], v14, s[56:59], s38 offen
    v_mfma_f32_16x16x32_bf16 v[232:235], a[16:19], a[104:107], v[232:235]
    ds_read_b64_tr_b16 a[12:13], v10 offset:29184
    v_mfma_f32_16x16x32_bf16 v[232:235], a[20:23], a[120:123], v[232:235]
    v_mfma_f32_16x16x32_bf16 v[236:239], a[16:19], a[108:111], v[236:239]
    ds_read_b64_tr_b16 a[14:15], v10 offset:31232
    v_mfma_f32_16x16x32_bf16 v[236:239], a[20:23], a[124:127], v[236:239]
    s_waitcnt lgkmcnt(4)
    v_mfma_f32_16x16x32_bf16 v[240:243], a[0:3], a[96:99], v[240:243]
    ds_read_b64_tr_b16 a[16:17], v9 offset:32768
    v_mfma_f32_16x16x32_bf16 v[240:243], a[4:7], a[112:115], v[240:243]
    ds_read_b64_tr_b16 a[18:19], v9 offset:34816
    v_mfma_f32_16x16x32_bf16 v[244:247], a[0:3], a[100:103], v[244:247]
    ds_read_b64_tr_b16 a[20:21], v9 offset:49152
    v_mfma_f32_16x16x32_bf16 v[244:247], a[4:7], a[116:119], v[244:247]
    ds_read_b64_tr_b16 a[22:23], v9 offset:51200
    s_waitcnt lgkmcnt(4)
    v_mfma_f32_16x16x32_bf16 v[248:251], a[8:11], a[96:99], v[248:251]
    ds_read_b64_tr_b16 a[0:1], v10 offset:32768
    v_mfma_f32_16x16x32_bf16 v[248:251], a[12:15], a[112:115], v[248:251]
    ds_read_b64_tr_b16 a[2:3], v10 offset:34816
    v_mfma_f32_16x16x32_bf16 v[252:255], a[8:11], a[100:103], v[252:255]
    ds_read_b64_tr_b16 a[4:5], v10 offset:49152
    v_mfma_f32_16x16x32_bf16 v[252:255], a[12:15], a[116:119], v[252:255]
    ds_read_b64_tr_b16 a[6:7], v10 offset:51200
    s_waitcnt lgkmcnt(4)
    v_mfma_f32_16x16x32_bf16 v[16:19], a[16:19], a[128:131], v[16:19]
    ds_read_b64_tr_b16 a[8:9], v9 offset:33280
    s_add_u32 m0, s32, 0x10000
    v_mfma_f32_16x16x32_bf16 v[16:19], a[20:23], a[144:147], v[16:19]
    buffer_load_dwordx4 v3, s[12:15], s28 offen offset:0 lds
    v_mfma_f32_16x16x32_bf16 v[20:23], a[16:19], a[132:135], v[20:23]
    ds_read_b64_tr_b16 a[10:11], v9 offset:35328
    v_mfma_f32_16x16x32_bf16 v[20:23], a[20:23], a[148:151], v[20:23]
    v_mfma_f32_16x16x32_bf16 v[24:27], a[16:19], a[136:139], v[24:27]
    ds_read_b64_tr_b16 a[12:13], v9 offset:49664
    v_mfma_f32_16x16x32_bf16 v[24:27], a[20:23], a[152:155], v[24:27]
    v_mfma_f32_16x16x32_bf16 v[28:31], a[16:19], a[140:143], v[28:31]
    ds_read_b64_tr_b16 a[14:15], v9 offset:51712
    v_mfma_f32_16x16x32_bf16 v[28:31], a[20:23], a[156:159], v[28:31]
    s_waitcnt lgkmcnt(4)
    v_mfma_f32_16x16x32_bf16 v[32:35], a[0:3], a[128:131], v[32:35]
    ds_read_b64_tr_b16 a[16:17], v10 offset:33280
    s_add_u32 m0, s32, 0x10f80
    v_mfma_f32_16x16x32_bf16 v[32:35], a[4:7], a[144:147], v[32:35]
    buffer_load_dwordx4 v3, s[12:15], s28 offen offset:128 lds
    s_add_u32 s28, s28, 0x40000
    v_mfma_f32_16x16x32_bf16 v[36:39], a[0:3], a[132:135], v[36:39]
    ds_read_b64_tr_b16 a[18:19], v10 offset:35328
    v_mfma_f32_16x16x32_bf16 v[36:39], a[4:7], a[148:151], v[36:39]
    v_mfma_f32_16x16x32_bf16 v[40:43], a[0:3], a[136:139], v[40:43]
    ds_read_b64_tr_b16 a[20:21], v10 offset:49664
    v_mfma_f32_16x16x32_bf16 v[40:43], a[4:7], a[152:155], v[40:43]
    v_mfma_f32_16x16x32_bf16 v[44:47], a[0:3], a[140:143], v[44:47]
    ds_read_b64_tr_b16 a[22:23], v10 offset:51712
    v_mfma_f32_16x16x32_bf16 v[44:47], a[4:7], a[156:159], v[44:47]
    s_waitcnt lgkmcnt(4)
    v_mfma_f32_16x16x32_bf16 v[48:51], a[8:11], a[128:131], v[48:51]
    ds_read_b64_tr_b16 a[0:1], v9 offset:36864
    s_add_u32 m0, s32, 0x12000
    v_mfma_f32_16x16x32_bf16 v[48:51], a[12:15], a[144:147], v[48:51]
    buffer_load_dwordx4 v4, s[16:19], s29 offen offset:0 lds
    v_mfma_f32_16x16x32_bf16 v[52:55], a[8:11], a[132:135], v[52:55]
    ds_read_b64_tr_b16 a[2:3], v9 offset:38912
    v_mfma_f32_16x16x32_bf16 v[52:55], a[12:15], a[148:151], v[52:55]
    v_mfma_f32_16x16x32_bf16 v[56:59], a[8:11], a[136:139], v[56:59]
    ds_read_b64_tr_b16 a[4:5], v9 offset:53248
    v_mfma_f32_16x16x32_bf16 v[56:59], a[12:15], a[152:155], v[56:59]
    v_mfma_f32_16x16x32_bf16 v[60:63], a[8:11], a[140:143], v[60:63]
    ds_read_b64_tr_b16 a[6:7], v9 offset:55296
    v_mfma_f32_16x16x32_bf16 v[60:63], a[12:15], a[156:159], v[60:63]
    s_waitcnt lgkmcnt(4)
    v_mfma_f32_16x16x32_bf16 v[64:67], a[16:19], a[128:131], v[64:67]
    ds_read_b64_tr_b16 a[8:9], v10 offset:36864
    s_add_u32 m0, s32, 0x12f80
    v_mfma_f32_16x16x32_bf16 v[64:67], a[20:23], a[144:147], v[64:67]
    buffer_load_dwordx4 v5, s[16:19], s29 offen offset:128 lds
    s_add_u32 s29, s29, 0x38000
    v_mfma_f32_16x16x32_bf16 v[68:71], a[16:19], a[132:135], v[68:71]
    ds_read_b64_tr_b16 a[10:11], v10 offset:38912
    v_mfma_f32_16x16x32_bf16 v[68:71], a[20:23], a[148:151], v[68:71]
    v_mfma_f32_16x16x32_bf16 v[72:75], a[16:19], a[136:139], v[72:75]
    ds_read_b64_tr_b16 a[12:13], v10 offset:53248
    v_mfma_f32_16x16x32_bf16 v[72:75], a[20:23], a[152:155], v[72:75]
    v_mfma_f32_16x16x32_bf16 v[76:79], a[16:19], a[140:143], v[76:79]
    ds_read_b64_tr_b16 a[14:15], v10 offset:55296
    v_mfma_f32_16x16x32_bf16 v[76:79], a[20:23], a[156:159], v[76:79]
    s_waitcnt lgkmcnt(4)
    v_mfma_f32_16x16x32_bf16 v[80:83], a[0:3], a[128:131], v[80:83]
    ds_read_b64_tr_b16 a[16:17], v9 offset:37376
    v_mfma_f32_16x16x32_bf16 v[80:83], a[4:7], a[144:147], v[80:83]
    buffer_load_dwordx4 a[64:67], v6, s[20:23], s30 offen offset:0 sc1
    v_mfma_f32_16x16x32_bf16 v[84:87], a[0:3], a[132:135], v[84:87]
    ds_read_b64_tr_b16 a[18:19], v9 offset:39424
    v_mfma_f32_16x16x32_bf16 v[84:87], a[4:7], a[148:151], v[84:87]
    buffer_load_dwordx4 a[68:71], v6, s[20:23], s30 offen offset:1024 sc1
    v_mfma_f32_16x16x32_bf16 v[88:91], a[0:3], a[136:139], v[88:91]
    ds_read_b64_tr_b16 a[20:21], v9 offset:53760
    v_mfma_f32_16x16x32_bf16 v[88:91], a[4:7], a[152:155], v[88:91]
    v_mfma_f32_16x16x32_bf16 v[92:95], a[0:3], a[140:143], v[92:95]
    ds_read_b64_tr_b16 a[22:23], v9 offset:55808
    v_mfma_f32_16x16x32_bf16 v[92:95], a[4:7], a[156:159], v[92:95]
    s_waitcnt lgkmcnt(4)
    v_mfma_f32_16x16x32_bf16 v[96:99], a[8:11], a[128:131], v[96:99]
    ds_read_b64_tr_b16 a[0:1], v10 offset:37376
    v_mfma_f32_16x16x32_bf16 v[96:99], a[12:15], a[144:147], v[96:99]
    buffer_load_dwordx4 a[72:75], v6, s[20:23], s39 offen offset:0 sc1
    v_mfma_f32_16x16x32_bf16 v[100:103], a[8:11], a[132:135], v[100:103]
    ds_read_b64_tr_b16 a[2:3], v10 offset:39424
    v_mfma_f32_16x16x32_bf16 v[100:103], a[12:15], a[148:151], v[100:103]
    v_mfma_f32_16x16x32_bf16 v[104:107], a[8:11], a[136:139], v[104:107]
    ds_read_b64_tr_b16 a[4:5], v10 offset:53760
    v_mfma_f32_16x16x32_bf16 v[104:107], a[12:15], a[152:155], v[104:107]
    v_mfma_f32_16x16x32_bf16 v[108:111], a[8:11], a[140:143], v[108:111]
    ds_read_b64_tr_b16 a[6:7], v10 offset:55808
    v_mfma_f32_16x16x32_bf16 v[108:111], a[12:15], a[156:159], v[108:111]
    s_waitcnt lgkmcnt(4)
    v_mfma_f32_16x16x32_bf16 v[112:115], a[16:19], a[128:131], v[112:115]
    ds_read_b64_tr_b16 a[8:9], v9 offset:40960
    v_mfma_f32_16x16x32_bf16 v[112:115], a[20:23], a[144:147], v[112:115]
    buffer_load_dwordx4 a[76:79], v6, s[20:23], s39 offen offset:1024 sc1
    s_add_u32 s30, s30, 4096
    s_add_u32 s39, s39, 4096
    v_mfma_f32_16x16x32_bf16 v[116:119], a[16:19], a[132:135], v[116:119]
    ds_read_b64_tr_b16 a[10:11], v9 offset:43008
    v_mfma_f32_16x16x32_bf16 v[116:119], a[20:23], a[148:151], v[116:119]
    v_mfma_f32_16x16x32_bf16 v[120:123], a[16:19], a[136:139], v[120:123]
    ds_read_b64_tr_b16 a[12:13], v9 offset:57344
    v_mfma_f32_16x16x32_bf16 v[120:123], a[20:23], a[152:155], v[120:123]
    v_mfma_f32_16x16x32_bf16 v[124:127], a[16:19], a[140:143], v[124:127]
    ds_read_b64_tr_b16 a[14:15], v9 offset:59392
    v_mfma_f32_16x16x32_bf16 v[124:127], a[20:23], a[156:159], v[124:127]
    s_waitcnt lgkmcnt(4)
    v_mfma_f32_16x16x32_bf16 v[128:131], a[0:3], a[128:131], v[128:131]
    ds_read_b64_tr_b16 a[16:17], v10 offset:40960
    s_add_u32 m0, s32, 0x14000
    v_mfma_f32_16x16x32_bf16 v[128:131], a[4:7], a[144:147], v[128:131]
    buffer_load_dwordx4 v3, s[12:15], s28 offen offset:0 lds
    v_mfma_f32_16x16x32_bf16 v[132:135], a[0:3], a[132:135], v[132:135]
    ds_read_b64_tr_b16 a[18:19], v10 offset:43008
    v_mfma_f32_16x16x32_bf16 v[132:135], a[4:7], a[148:151], v[132:135]
    v_mfma_f32_16x16x32_bf16 v[136:139], a[0:3], a[136:139], v[136:139]
    ds_read_b64_tr_b16 a[20:21], v10 offset:57344
    v_mfma_f32_16x16x32_bf16 v[136:139], a[4:7], a[152:155], v[136:139]
    v_mfma_f32_16x16x32_bf16 v[140:143], a[0:3], a[140:143], v[140:143]
    ds_read_b64_tr_b16 a[22:23], v10 offset:59392
    v_mfma_f32_16x16x32_bf16 v[140:143], a[4:7], a[156:159], v[140:143]
    s_waitcnt lgkmcnt(4)
    v_mfma_f32_16x16x32_bf16 v[144:147], a[8:11], a[128:131], v[144:147]
    ds_read_b64_tr_b16 a[0:1], v9 offset:41472
    s_add_u32 m0, s32, 0x14f80
    v_mfma_f32_16x16x32_bf16 v[144:147], a[12:15], a[144:147], v[144:147]
    buffer_load_dwordx4 v3, s[12:15], s28 offen offset:128 lds
    s_add_u32 s28, s28, 0x40000
    v_mfma_f32_16x16x32_bf16 v[148:151], a[8:11], a[132:135], v[148:151]
    ds_read_b64_tr_b16 a[2:3], v9 offset:43520
    v_mfma_f32_16x16x32_bf16 v[148:151], a[12:15], a[148:151], v[148:151]
    v_mfma_f32_16x16x32_bf16 v[152:155], a[8:11], a[136:139], v[152:155]
    ds_read_b64_tr_b16 a[4:5], v9 offset:57856
    v_mfma_f32_16x16x32_bf16 v[152:155], a[12:15], a[152:155], v[152:155]
    v_mfma_f32_16x16x32_bf16 v[156:159], a[8:11], a[140:143], v[156:159]
    ds_read_b64_tr_b16 a[6:7], v9 offset:59904
    v_mfma_f32_16x16x32_bf16 v[156:159], a[12:15], a[156:159], v[156:159]
    s_waitcnt lgkmcnt(4)
    v_mfma_f32_16x16x32_bf16 v[160:163], a[16:19], a[128:131], v[160:163]
    ds_read_b64_tr_b16 a[8:9], v10 offset:41472
    s_add_u32 m0, s32, 0x16000
    v_mfma_f32_16x16x32_bf16 v[160:163], a[20:23], a[144:147], v[160:163]
    buffer_load_dwordx4 v4, s[16:19], s29 offen offset:0 lds
    v_mfma_f32_16x16x32_bf16 v[164:167], a[16:19], a[132:135], v[164:167]
    ds_read_b64_tr_b16 a[10:11], v10 offset:43520
    s_add_u32 m0, s32, 0x16f80
    v_mfma_f32_16x16x32_bf16 v[164:167], a[20:23], a[148:151], v[164:167]
    buffer_load_dwordx4 v5, s[16:19], s29 offen offset:128 lds
    s_add_u32 s29, s29, 0x38000
    v_mfma_f32_16x16x32_bf16 v[168:171], a[16:19], a[136:139], v[168:171]
    ds_read_b64_tr_b16 a[12:13], v10 offset:57856
    v_mfma_f32_16x16x32_bf16 v[168:171], a[20:23], a[152:155], v[168:171]
    v_mfma_f32_16x16x32_bf16 v[172:175], a[16:19], a[140:143], v[172:175]
    ds_read_b64_tr_b16 a[14:15], v10 offset:59904
    v_mfma_f32_16x16x32_bf16 v[172:175], a[20:23], a[156:159], v[172:175]
    s_waitcnt lgkmcnt(4)
    v_mfma_f32_16x16x32_bf16 v[176:179], a[0:3], a[128:131], v[176:179]
    ds_read_b64_tr_b16 a[16:17], v9 offset:45056
    v_mfma_f32_16x16x32_bf16 v[176:179], a[4:7], a[144:147], v[176:179]
    buffer_load_dwordx4 a[80:83], v6, s[20:23], s30 offen offset:0 sc1
    v_mfma_f32_16x16x32_bf16 v[180:183], a[0:3], a[132:135], v[180:183]
    ds_read_b64_tr_b16 a[18:19], v9 offset:47104
    v_mfma_f32_16x16x32_bf16 v[180:183], a[4:7], a[148:151], v[180:183]
    v_mfma_f32_16x16x32_bf16 v[184:187], a[0:3], a[136:139], v[184:187]
    ds_read_b64_tr_b16 a[20:21], v9 offset:61440
    v_mfma_f32_16x16x32_bf16 v[184:187], a[4:7], a[152:155], v[184:187]
    v_mfma_f32_16x16x32_bf16 v[188:191], a[0:3], a[140:143], v[188:191]
    ds_read_b64_tr_b16 a[22:23], v9 offset:63488
    v_mfma_f32_16x16x32_bf16 v[188:191], a[4:7], a[156:159], v[188:191]
    s_waitcnt lgkmcnt(4)
    v_mfma_f32_16x16x32_bf16 v[192:195], a[8:11], a[128:131], v[192:195]
    ds_read_b64_tr_b16 a[0:1], v10 offset:45056
    v_mfma_f32_16x16x32_bf16 v[192:195], a[12:15], a[144:147], v[192:195]
    buffer_load_dwordx4 a[84:87], v6, s[20:23], s30 offen offset:1024 sc1
    v_mfma_f32_16x16x32_bf16 v[196:199], a[8:11], a[132:135], v[196:199]
    ds_read_b64_tr_b16 a[2:3], v10 offset:47104
    v_mfma_f32_16x16x32_bf16 v[196:199], a[12:15], a[148:151], v[196:199]
    v_mfma_f32_16x16x32_bf16 v[200:203], a[8:11], a[136:139], v[200:203]
    ds_read_b64_tr_b16 a[4:5], v10 offset:61440
    v_mfma_f32_16x16x32_bf16 v[200:203], a[12:15], a[152:155], v[200:203]
    v_mfma_f32_16x16x32_bf16 v[204:207], a[8:11], a[140:143], v[204:207]
    ds_read_b64_tr_b16 a[6:7], v10 offset:63488
    v_mfma_f32_16x16x32_bf16 v[204:207], a[12:15], a[156:159], v[204:207]
    s_waitcnt vmcnt(24)
    s_barrier
    s_waitcnt lgkmcnt(4)
    v_mfma_f32_16x16x32_bf16 v[208:211], a[16:19], a[128:131], v[208:211]
    ds_read_b64_tr_b16 a[8:9], v9 offset:45568
    v_mfma_f32_16x16x32_bf16 v[208:211], a[20:23], a[144:147], v[208:211]
    buffer_load_dwordx4 a[88:91], v6, s[20:23], s39 offen offset:0 sc1
    v_mfma_f32_16x16x32_bf16 v[212:215], a[16:19], a[132:135], v[212:215]
    ds_read_b64_tr_b16 a[10:11], v9 offset:47616
    v_mfma_f32_16x16x32_bf16 v[212:215], a[20:23], a[148:151], v[212:215]
    v_mfma_f32_16x16x32_bf16 v[216:219], a[16:19], a[136:139], v[216:219]
    ds_read_b64_tr_b16 a[12:13], v9 offset:61952
    v_mfma_f32_16x16x32_bf16 v[216:219], a[20:23], a[152:155], v[216:219]
    v_mfma_f32_16x16x32_bf16 v[220:223], a[16:19], a[140:143], v[220:223]
    ds_read_b64_tr_b16 a[14:15], v9 offset:64000
    v_mfma_f32_16x16x32_bf16 v[220:223], a[20:23], a[156:159], v[220:223]
    s_waitcnt lgkmcnt(4)
    v_mfma_f32_16x16x32_bf16 v[224:227], a[0:3], a[128:131], v[224:227]
    ds_read_b64_tr_b16 a[16:17], v10 offset:45568
    v_mfma_f32_16x16x32_bf16 v[224:227], a[4:7], a[144:147], v[224:227]
    buffer_load_dwordx4 a[92:95], v6, s[20:23], s39 offen offset:1024 sc1
    s_add_u32 s30, s30, 4096
    s_add_u32 s39, s39, 4096
    v_mfma_f32_16x16x32_bf16 v[228:231], a[0:3], a[132:135], v[228:231]
    ds_read_b64_tr_b16 a[18:19], v10 offset:47616
    v_mfma_f32_16x16x32_bf16 v[228:231], a[4:7], a[148:151], v[228:231]
    s_getpc_b64 s[80:81]
    global_load_dword a255, v0, s[80:81] offset:2048
    v_mfma_f32_16x16x32_bf16 v[232:235], a[0:3], a[136:139], v[232:235]
    ds_read_b64_tr_b16 a[20:21], v10 offset:61952
    v_mfma_f32_16x16x32_bf16 v[232:235], a[4:7], a[152:155], v[232:235]
    v_mfma_f32_16x16x32_bf16 v[236:239], a[0:3], a[140:143], v[236:239]
    ds_read_b64_tr_b16 a[22:23], v10 offset:64000
    v_mfma_f32_16x16x32_bf16 v[236:239], a[4:7], a[156:159], v[236:239]
    s_waitcnt lgkmcnt(4)
    v_mfma_f32_16x16x32_bf16 v[240:243], a[8:11], a[128:131], v[240:243]
    ds_read_b64_tr_b16 a[0:1], v7 offset:0
    v_mfma_f32_16x16x32_bf16 v[240:243], a[12:15], a[144:147], v[240:243]
    ds_read_b64_tr_b16 a[2:3], v7 offset:2048
    v_mfma_f32_16x16x32_bf16 v[244:247], a[8:11], a[132:135], v[244:247]
    ds_read_b64_tr_b16 a[4:5], v7 offset:16384
    v_mfma_f32_16x16x32_bf16 v[244:247], a[12:15], a[148:151], v[244:247]
    ds_read_b64_tr_b16 a[6:7], v7 offset:18432
    s_waitcnt lgkmcnt(4)
    v_mfma_f32_16x16x32_bf16 v[248:251], a[16:19], a[128:131], v[248:251]
    ds_read_b64_tr_b16 a[8:9], v8 offset:0
    v_mfma_f32_16x16x32_bf16 v[248:251], a[20:23], a[144:147], v[248:251]
    ds_read_b64_tr_b16 a[10:11], v8 offset:2048
    v_mfma_f32_16x16x32_bf16 v[252:255], a[16:19], a[132:135], v[252:255]
    ds_read_b64_tr_b16 a[12:13], v8 offset:16384
    v_mfma_f32_16x16x32_bf16 v[252:255], a[20:23], a[148:151], v[252:255]
    ds_read_b64_tr_b16 a[14:15], v8 offset:18432
    s_waitcnt lgkmcnt(4)
    v_mfma_f32_16x16x32_bf16 v[16:19], a[0:3], a[32:35], v[16:19]
    ds_read_b64_tr_b16 a[16:17], v7 offset:512
    s_add_u32 m0, s32, 0x18000
    v_mfma_f32_16x16x32_bf16 v[16:19], a[4:7], a[48:51], v[16:19]
    buffer_load_dwordx4 v3, s[12:15], s28 offen offset:0 lds
    v_mfma_f32_16x16x32_bf16 v[20:23], a[0:3], a[36:39], v[20:23]
    ds_read_b64_tr_b16 a[18:19], v7 offset:2560
    v_mfma_f32_16x16x32_bf16 v[20:23], a[4:7], a[52:55], v[20:23]
    v_mfma_f32_16x16x32_bf16 v[24:27], a[0:3], a[40:43], v[24:27]
    ds_read_b64_tr_b16 a[20:21], v7 offset:16896
    v_mfma_f32_16x16x32_bf16 v[24:27], a[4:7], a[56:59], v[24:27]
    v_mfma_f32_16x16x32_bf16 v[28:31], a[0:3], a[44:47], v[28:31]
    ds_read_b64_tr_b16 a[22:23], v7 offset:18944
    v_mfma_f32_16x16x32_bf16 v[28:31], a[4:7], a[60:63], v[28:31]
    s_waitcnt lgkmcnt(4)
    v_mfma_f32_16x16x32_bf16 v[32:35], a[8:11], a[32:35], v[32:35]
    ds_read_b64_tr_b16 a[0:1], v8 offset:512
    s_add_u32 m0, s32, 0x18f80
    v_mfma_f32_16x16x32_bf16 v[32:35], a[12:15], a[48:51], v[32:35]
    buffer_load_dwordx4 v3, s[12:15], s28 offen offset:128 lds
    s_add_u32 s28, s28, 0x40000
    v_mfma_f32_16x16x32_bf16 v[36:39], a[8:11], a[36:39], v[36:39]
    ds_read_b64_tr_b16 a[2:3], v8 offset:2560
    v_mfma_f32_16x16x32_bf16 v[36:39], a[12:15], a[52:55], v[36:39]
    v_mfma_f32_16x16x32_bf16 v[40:43], a[8:11], a[40:43], v[40:43]
    ds_read_b64_tr_b16 a[4:5], v8 offset:16896
    v_mfma_f32_16x16x32_bf16 v[40:43], a[12:15], a[56:59], v[40:43]
    v_mfma_f32_16x16x32_bf16 v[44:47], a[8:11], a[44:47], v[44:47]
    ds_read_b64_tr_b16 a[6:7], v8 offset:18944
    v_mfma_f32_16x16x32_bf16 v[44:47], a[12:15], a[60:63], v[44:47]
    s_waitcnt lgkmcnt(4)
    v_mfma_f32_16x16x32_bf16 v[48:51], a[16:19], a[32:35], v[48:51]
    ds_read_b64_tr_b16 a[8:9], v7 offset:4096
    s_add_u32 m0, s32, 0x1a000
    v_mfma_f32_16x16x32_bf16 v[48:51], a[20:23], a[48:51], v[48:51]
    buffer_load_dwordx4 v4, s[16:19], s29 offen offset:0 lds
    v_mfma_f32_16x16x32_bf16 v[52:55], a[16:19], a[36:39], v[52:55]
    ds_read_b64_tr_b16 a[10:11], v7 offset:6144
    v_mfma_f32_16x16x32_bf16 v[52:55], a[20:23], a[52:55], v[52:55]
    v_mfma_f32_16x16x32_bf16 v[56:59], a[16:19], a[40:43], v[56:59]
    ds_read_b64_tr_b16 a[12:13], v7 offset:20480
    v_mfma_f32_16x16x32_bf16 v[56:59], a[20:23], a[56:59], v[56:59]
    v_mfma_f32_16x16x32_bf16 v[60:63], a[16:19], a[44:47], v[60:63]
    ds_read_b64_tr_b16 a[14:15], v7 offset:22528
    v_mfma_f32_16x16x32_bf16 v[60:63], a[20:23], a[60:63], v[60:63]
    s_waitcnt lgkmcnt(4)
    v_mfma_f32_16x16x32_bf16 v[64:67], a[0:3], a[32:35], v[64:67]
    ds_read_b64_tr_b16 a[16:17], v8 offset:4096
    s_add_u32 m0, s32, 0x1af80
    v_mfma_f32_16x16x32_bf16 v[64:67], a[4:7], a[48:51], v[64:67]
    buffer_load_dwordx4 v5, s[16:19], s29 offen offset:128 lds
    s_add_u32 s29, s29, 0x38000
    v_mfma_f32_16x16x32_bf16 v[68:71], a[0:3], a[36:39], v[68:71]
    ds_read_b64_tr_b16 a[18:19], v8 offset:6144
    v_mfma_f32_16x16x32_bf16 v[68:71], a[4:7], a[52:55], v[68:71]
    v_mfma_f32_16x16x32_bf16 v[72:75], a[0:3], a[40:43], v[72:75]
    ds_read_b64_tr_b16 a[20:21], v8 offset:20480
    v_mfma_f32_16x16x32_bf16 v[72:75], a[4:7], a[56:59], v[72:75]
    v_mfma_f32_16x16x32_bf16 v[76:79], a[0:3], a[44:47], v[76:79]
    ds_read_b64_tr_b16 a[22:23], v8 offset:22528
    v_mfma_f32_16x16x32_bf16 v[76:79], a[4:7], a[60:63], v[76:79]
    s_waitcnt lgkmcnt(4)
    v_mfma_f32_16x16x32_bf16 v[80:83], a[8:11], a[32:35], v[80:83]
    ds_read_b64_tr_b16 a[0:1], v7 offset:4608
    v_mfma_f32_16x16x32_bf16 v[80:83], a[12:15], a[48:51], v[80:83]
    buffer_load_dwordx4 a[96:99], v6, s[20:23], s30 offen offset:0 sc1
    v_mfma_f32_16x16x32_bf16 v[84:87], a[8:11], a[36:39], v[84:87]
    ds_read_b64_tr_b16 a[2:3], v7 offset:6656
    v_mfma_f32_16x16x32_bf16 v[84:87], a[12:15], a[52:55], v[84:87]
    v_mfma_f32_16x16x32_bf16 v[88:91], a[8:11], a[40:43], v[88:91]
    ds_read_b64_tr_b16 a[4:5], v7 offset:20992
    v_mfma_f32_16x16x32_bf16 v[88:91], a[12:15], a[56:59], v[88:91]
    v_mfma_f32_16x16x32_bf16 v[92:95], a[8:11], a[44:47], v[92:95]
    ds_read_b64_tr_b16 a[6:7], v7 offset:23040
    v_mfma_f32_16x16x32_bf16 v[92:95], a[12:15], a[60:63], v[92:95]
    s_waitcnt lgkmcnt(4)
    v_mfma_f32_16x16x32_bf16 v[96:99], a[16:19], a[32:35], v[96:99]
    ds_read_b64_tr_b16 a[8:9], v8 offset:4608
    v_mfma_f32_16x16x32_bf16 v[96:99], a[20:23], a[48:51], v[96:99]
    buffer_load_dwordx4 a[100:103], v6, s[20:23], s30 offen offset:1024 sc1
    v_mfma_f32_16x16x32_bf16 v[100:103], a[16:19], a[36:39], v[100:103]
    ds_read_b64_tr_b16 a[10:11], v8 offset:6656
    v_mfma_f32_16x16x32_bf16 v[100:103], a[20:23], a[52:55], v[100:103]
    v_mfma_f32_16x16x32_bf16 v[104:107], a[16:19], a[40:43], v[104:107]
    ds_read_b64_tr_b16 a[12:13], v8 offset:20992
    v_mfma_f32_16x16x32_bf16 v[104:107], a[20:23], a[56:59], v[104:107]
    v_mfma_f32_16x16x32_bf16 v[108:111], a[16:19], a[44:47], v[108:111]
    ds_read_b64_tr_b16 a[14:15], v8 offset:23040
    v_mfma_f32_16x16x32_bf16 v[108:111], a[20:23], a[60:63], v[108:111]
    s_waitcnt lgkmcnt(4)
    v_mfma_f32_16x16x32_bf16 v[112:115], a[0:3], a[32:35], v[112:115]
    ds_read_b64_tr_b16 a[16:17], v7 offset:8192
    v_mfma_f32_16x16x32_bf16 v[112:115], a[4:7], a[48:51], v[112:115]
    buffer_load_dwordx4 a[104:107], v6, s[20:23], s39 offen offset:0 sc1
    v_mfma_f32_16x16x32_bf16 v[116:119], a[0:3], a[36:39], v[116:119]
    ds_read_b64_tr_b16 a[18:19], v7 offset:10240
    v_mfma_f32_16x16x32_bf16 v[116:119], a[4:7], a[52:55], v[116:119]
    buffer_load_dwordx4 a[108:111], v6, s[20:23], s39 offen offset:1024 sc1
    s_add_u32 s30, s30, 4096
    s_add_u32 s39, s39, 4096
    v_mfma_f32_16x16x32_bf16 v[120:123], a[0:3], a[40:43], v[120:123]
    ds_read_b64_tr_b16 a[20:21], v7 offset:24576
    v_mfma_f32_16x16x32_bf16 v[120:123], a[4:7], a[56:59], v[120:123]
    v_mfma_f32_16x16x32_bf16 v[124:127], a[0:3], a[44:47], v[124:127]
    ds_read_b64_tr_b16 a[22:23], v7 offset:26624
    v_mfma_f32_16x16x32_bf16 v[124:127], a[4:7], a[60:63], v[124:127]
    s_waitcnt lgkmcnt(4)
    v_mfma_f32_16x16x32_bf16 v[128:131], a[8:11], a[32:35], v[128:131]
    ds_read_b64_tr_b16 a[0:1], v8 offset:8192
    s_add_u32 m0, s32, 0x1c000
    v_mfma_f32_16x16x32_bf16 v[128:131], a[12:15], a[48:51], v[128:131]
    buffer_load_dwordx4 v3, s[12:15], s28 offen offset:0 lds
    v_mfma_f32_16x16x32_bf16 v[132:135], a[8:11], a[36:39], v[132:135]
    ds_read_b64_tr_b16 a[2:3], v8 offset:10240
    v_mfma_f32_16x16x32_bf16 v[132:135], a[12:15], a[52:55], v[132:135]
    v_mfma_f32_16x16x32_bf16 v[136:139], a[8:11], a[40:43], v[136:139]
    ds_read_b64_tr_b16 a[4:5], v8 offset:24576
    v_mfma_f32_16x16x32_bf16 v[136:139], a[12:15], a[56:59], v[136:139]
    v_mfma_f32_16x16x32_bf16 v[140:143], a[8:11], a[44:47], v[140:143]
    ds_read_b64_tr_b16 a[6:7], v8 offset:26624
    v_mfma_f32_16x16x32_bf16 v[140:143], a[12:15], a[60:63], v[140:143]
    s_waitcnt lgkmcnt(4)
    v_mfma_f32_16x16x32_bf16 v[144:147], a[16:19], a[32:35], v[144:147]
    ds_read_b64_tr_b16 a[8:9], v7 offset:8704
    s_add_u32 m0, s32, 0x1cf80
    v_mfma_f32_16x16x32_bf16 v[144:147], a[20:23], a[48:51], v[144:147]
    buffer_load_dwordx4 v3, s[12:15], s28 offen offset:128 lds
    s_add_u32 s28, s28, 0x40000
    v_mfma_f32_16x16x32_bf16 v[148:151], a[16:19], a[36:39], v[148:151]
    ds_read_b64_tr_b16 a[10:11], v7 offset:10752
    v_mfma_f32_16x16x32_bf16 v[148:151], a[20:23], a[52:55], v[148:151]
    v_mfma_f32_16x16x32_bf16 v[152:155], a[16:19], a[40:43], v[152:155]
    ds_read_b64_tr_b16 a[12:13], v7 offset:25088
    v_mfma_f32_16x16x32_bf16 v[152:155], a[20:23], a[56:59], v[152:155]
    v_mfma_f32_16x16x32_bf16 v[156:159], a[16:19], a[44:47], v[156:159]
    ds_read_b64_tr_b16 a[14:15], v7 offset:27136
    v_mfma_f32_16x16x32_bf16 v[156:159], a[20:23], a[60:63], v[156:159]
    s_waitcnt lgkmcnt(4)
    v_mfma_f32_16x16x32_bf16 v[160:163], a[0:3], a[32:35], v[160:163]
    ds_read_b64_tr_b16 a[16:17], v8 offset:8704
    s_add_u32 m0, s32, 0x1e000
    v_mfma_f32_16x16x32_bf16 v[160:163], a[4:7], a[48:51], v[160:163]
    buffer_load_dwordx4 v4, s[16:19], s29 offen offset:0 lds
    v_mfma_f32_16x16x32_bf16 v[164:167], a[0:3], a[36:39], v[164:167]
    ds_read_b64_tr_b16 a[18:19], v8 offset:10752
    v_mfma_f32_16x16x32_bf16 v[164:167], a[4:7], a[52:55], v[164:167]
    v_mfma_f32_16x16x32_bf16 v[168:171], a[0:3], a[40:43], v[168:171]
    ds_read_b64_tr_b16 a[20:21], v8 offset:25088
    v_mfma_f32_16x16x32_bf16 v[168:171], a[4:7], a[56:59], v[168:171]
    v_mfma_f32_16x16x32_bf16 v[172:175], a[0:3], a[44:47], v[172:175]
    ds_read_b64_tr_b16 a[22:23], v8 offset:27136
    v_mfma_f32_16x16x32_bf16 v[172:175], a[4:7], a[60:63], v[172:175]
    s_waitcnt lgkmcnt(4)
    v_mfma_f32_16x16x32_bf16 v[176:179], a[8:11], a[32:35], v[176:179]
    ds_read_b64_tr_b16 a[0:1], v7 offset:12288
    s_add_u32 m0, s32, 0x1ef80
    v_mfma_f32_16x16x32_bf16 v[176:179], a[12:15], a[48:51], v[176:179]
    buffer_load_dwordx4 v5, s[16:19], s29 offen offset:128 lds
    s_add_u32 s29, s29, 0x38000
    v_mfma_f32_16x16x32_bf16 v[180:183], a[8:11], a[36:39], v[180:183]
    ds_read_b64_tr_b16 a[2:3], v7 offset:14336
    v_mfma_f32_16x16x32_bf16 v[180:183], a[12:15], a[52:55], v[180:183]
    v_mfma_f32_16x16x32_bf16 v[184:187], a[8:11], a[40:43], v[184:187]
    ds_read_b64_tr_b16 a[4:5], v7 offset:28672
    v_mfma_f32_16x16x32_bf16 v[184:187], a[12:15], a[56:59], v[184:187]
    v_mfma_f32_16x16x32_bf16 v[188:191], a[8:11], a[44:47], v[188:191]
    ds_read_b64_tr_b16 a[6:7], v7 offset:30720
    v_mfma_f32_16x16x32_bf16 v[188:191], a[12:15], a[60:63], v[188:191]
    s_waitcnt lgkmcnt(4)
    v_mfma_f32_16x16x32_bf16 v[192:195], a[16:19], a[32:35], v[192:195]
    ds_read_b64_tr_b16 a[8:9], v8 offset:12288
    v_mfma_f32_16x16x32_bf16 v[192:195], a[20:23], a[48:51], v[192:195]
    buffer_load_dwordx4 a[112:115], v6, s[20:23], s30 offen offset:0 sc1
    v_mfma_f32_16x16x32_bf16 v[196:199], a[16:19], a[36:39], v[196:199]
    ds_read_b64_tr_b16 a[10:11], v8 offset:14336
    v_mfma_f32_16x16x32_bf16 v[196:199], a[20:23], a[52:55], v[196:199]
    v_mfma_f32_16x16x32_bf16 v[200:203], a[16:19], a[40:43], v[200:203]
    ds_read_b64_tr_b16 a[12:13], v8 offset:28672
    v_mfma_f32_16x16x32_bf16 v[200:203], a[20:23], a[56:59], v[200:203]
    v_mfma_f32_16x16x32_bf16 v[204:207], a[16:19], a[44:47], v[204:207]
    ds_read_b64_tr_b16 a[14:15], v8 offset:30720
    v_mfma_f32_16x16x32_bf16 v[204:207], a[20:23], a[60:63], v[204:207]
    s_waitcnt vmcnt(14)
    s_barrier
    s_waitcnt lgkmcnt(4)
    v_mfma_f32_16x16x32_bf16 v[208:211], a[0:3], a[32:35], v[208:211]
    ds_read_b64_tr_b16 a[16:17], v7 offset:12800
    v_mfma_f32_16x16x32_bf16 v[208:211], a[4:7], a[48:51], v[208:211]
    buffer_load_dwordx4 a[116:119], v6, s[20:23], s30 offen offset:1024 sc1
    v_mfma_f32_16x16x32_bf16 v[212:215], a[0:3], a[36:39], v[212:215]
    ds_read_b64_tr_b16 a[18:19], v7 offset:14848
    v_mfma_f32_16x16x32_bf16 v[212:215], a[4:7], a[52:55], v[212:215]
    v_mfma_f32_16x16x32_bf16 v[216:219], a[0:3], a[40:43], v[216:219]
    ds_read_b64_tr_b16 a[20:21], v7 offset:29184
    v_mfma_f32_16x16x32_bf16 v[216:219], a[4:7], a[56:59], v[216:219]
    v_mfma_f32_16x16x32_bf16 v[220:223], a[0:3], a[44:47], v[220:223]
    ds_read_b64_tr_b16 a[22:23], v7 offset:31232
    v_mfma_f32_16x16x32_bf16 v[220:223], a[4:7], a[60:63], v[220:223]
    s_waitcnt lgkmcnt(4)
    v_mfma_f32_16x16x32_bf16 v[224:227], a[8:11], a[32:35], v[224:227]
    ds_read_b64_tr_b16 a[0:1], v8 offset:12800
    v_mfma_f32_16x16x32_bf16 v[224:227], a[12:15], a[48:51], v[224:227]
    buffer_load_dwordx4 a[120:123], v6, s[20:23], s39 offen offset:0 sc1
    v_mfma_f32_16x16x32_bf16 v[228:231], a[8:11], a[36:39], v[228:231]
    ds_read_b64_tr_b16 a[2:3], v8 offset:14848
    v_mfma_f32_16x16x32_bf16 v[228:231], a[12:15], a[52:55], v[228:231]
    buffer_load_dwordx4 a[124:127], v6, s[20:23], s39 offen offset:1024 sc1
    s_add_u32 s30, s30, 4096
    s_add_u32 s39, s39, 4096
    v_mfma_f32_16x16x32_bf16 v[232:235], a[8:11], a[40:43], v[232:235]
    ds_read_b64_tr_b16 a[4:5], v8 offset:29184
    v_mfma_f32_16x16x32_bf16 v[232:235], a[12:15], a[56:59], v[232:235]
    v_mfma_f32_16x16x32_bf16 v[236:239], a[8:11], a[44:47], v[236:239]
    ds_read_b64_tr_b16 a[6:7], v8 offset:31232
    v_mfma_f32_16x16x32_bf16 v[236:239], a[12:15], a[60:63], v[236:239]
    s_waitcnt lgkmcnt(4)
    v_mfma_f32_16x16x32_bf16 v[240:243], a[16:19], a[32:35], v[240:243]
    ds_read_b64_tr_b16 a[8:9], v7 offset:32768
    v_mfma_f32_16x16x32_bf16 v[240:243], a[20:23], a[48:51], v[240:243]
    ds_read_b64_tr_b16 a[10:11], v7 offset:34816
    v_mfma_f32_16x16x32_bf16 v[244:247], a[16:19], a[36:39], v[244:247]
    ds_read_b64_tr_b16 a[12:13], v7 offset:49152
    v_mfma_f32_16x16x32_bf16 v[244:247], a[20:23], a[52:55], v[244:247]
    ds_read_b64_tr_b16 a[14:15], v7 offset:51200
    s_waitcnt lgkmcnt(4)
    v_mfma_f32_16x16x32_bf16 v[248:251], a[0:3], a[32:35], v[248:251]
    ds_read_b64_tr_b16 a[16:17], v8 offset:32768
    v_mfma_f32_16x16x32_bf16 v[248:251], a[4:7], a[48:51], v[248:251]
    ds_read_b64_tr_b16 a[18:19], v8 offset:34816
    v_mfma_f32_16x16x32_bf16 v[252:255], a[0:3], a[36:39], v[252:255]
    ds_read_b64_tr_b16 a[20:21], v8 offset:49152
    v_mfma_f32_16x16x32_bf16 v[252:255], a[4:7], a[52:55], v[252:255]
    ds_read_b64_tr_b16 a[22:23], v8 offset:51200
    s_waitcnt lgkmcnt(4)
    v_mfma_f32_16x16x32_bf16 v[16:19], a[8:11], a[64:67], v[16:19]
    ds_read_b64_tr_b16 a[0:1], v7 offset:33280
    v_mfma_f32_16x16x32_bf16 v[16:19], a[12:15], a[80:83], v[16:19]
    buffer_store_dwordx4 a[240:243], v6, s[20:23], s46 offen sc1
    s_add_u32 s46, s46, 0x100000
    v_mfma_f32_16x16x32_bf16 v[20:23], a[8:11], a[68:71], v[20:23]
    ds_read_b64_tr_b16 a[2:3], v7 offset:35328
    v_mfma_f32_16x16x32_bf16 v[20:23], a[12:15], a[84:87], v[20:23]
    v_mfma_f32_16x16x32_bf16 v[24:27], a[8:11], a[72:75], v[24:27]
    ds_read_b64_tr_b16 a[4:5], v7 offset:49664
    v_mfma_f32_16x16x32_bf16 v[24:27], a[12:15], a[88:91], v[24:27]
    v_mfma_f32_16x16x32_bf16 v[28:31], a[8:11], a[76:79], v[28:31]
    ds_read_b64_tr_b16 a[6:7], v7 offset:51712
    v_mfma_f32_16x16x32_bf16 v[28:31], a[12:15], a[92:95], v[28:31]
    s_waitcnt lgkmcnt(4)
    v_mfma_f32_16x16x32_bf16 v[32:35], a[16:19], a[64:67], v[32:35]
    ds_read_b64_tr_b16 a[8:9], v8 offset:33280
    v_mfma_f32_16x16x32_bf16 v[32:35], a[20:23], a[80:83], v[32:35]
    buffer_store_dwordx4 a[244:247], v6, s[20:23], s46 offen sc1
    v_mfma_f32_16x16x32_bf16 v[36:39], a[16:19], a[68:71], v[36:39]
    ds_read_b64_tr_b16 a[10:11], v8 offset:35328
    v_mfma_f32_16x16x32_bf16 v[36:39], a[20:23], a[84:87], v[36:39]
    v_mfma_f32_16x16x32_bf16 v[40:43], a[16:19], a[72:75], v[40:43]
    ds_read_b64_tr_b16 a[12:13], v8 offset:49664
    v_mfma_f32_16x16x32_bf16 v[40:43], a[20:23], a[88:91], v[40:43]
    v_mfma_f32_16x16x32_bf16 v[44:47], a[16:19], a[76:79], v[44:47]
    ds_read_b64_tr_b16 a[14:15], v8 offset:51712
    v_mfma_f32_16x16x32_bf16 v[44:47], a[20:23], a[92:95], v[44:47]
    s_waitcnt lgkmcnt(4)
    v_mfma_f32_16x16x32_bf16 v[48:51], a[0:3], a[64:67], v[48:51]
    ds_read_b64_tr_b16 a[16:17], v7 offset:36864
    s_add_u32 m0, s32, 0x20000
    v_mfma_f32_16x16x32_bf16 v[48:51], a[4:7], a[80:83], v[48:51]
    buffer_load_dwordx4 v3, s[12:15], s28 offen offset:0 lds
    v_mfma_f32_16x16x32_bf16 v[52:55], a[0:3], a[68:71], v[52:55]
    ds_read_b64_tr_b16 a[18:19], v7 offset:38912
    v_mfma_f32_16x16x32_bf16 v[52:55], a[4:7], a[84:87], v[52:55]
    v_mfma_f32_16x16x32_bf16 v[56:59], a[0:3], a[72:75], v[56:59]
    ds_read_b64_tr_b16 a[20:21], v7 offset:53248
    v_mfma_f32_16x16x32_bf16 v[56:59], a[4:7], a[88:91], v[56:59]
    v_mfma_f32_16x16x32_bf16 v[60:63], a[0:3], a[76:79], v[60:63]
    ds_read_b64_tr_b16 a[22:23], v7 offset:55296
    v_mfma_f32_16x16x32_bf16 v[60:63], a[4:7], a[92:95], v[60:63]
    s_waitcnt lgkmcnt(4)
    v_mfma_f32_16x16x32_bf16 v[64:67], a[8:11], a[64:67], v[64:67]
    ds_read_b64_tr_b16 a[0:1], v8 offset:36864
    s_add_u32 m0, s32, 0x20f80
    v_mfma_f32_16x16x32_bf16 v[64:67], a[12:15], a[80:83], v[64:67]
    buffer_load_dwordx4 v3, s[12:15], s28 offen offset:128 lds
    s_add_u32 s28, s28, 0x40000
    v_mfma_f32_16x16x32_bf16 v[68:71], a[8:11], a[68:71], v[68:71]
    ds_read_b64_tr_b16 a[2:3], v8 offset:38912
    s_add_u32 m0, s32, 0x22000
    v_mfma_f32_16x16x32_bf16 v[68:71], a[12:15], a[84:87], v[68:71]
    buffer_load_dwordx4 v4, s[16:19], s29 offen offset:0 lds
    v_mfma_f32_16x16x32_bf16 v[72:75], a[8:11], a[72:75], v[72:75]
    ds_read_b64_tr_b16 a[4:5], v8 offset:53248
    v_mfma_f32_16x16x32_bf16 v[72:75], a[12:15], a[88:91], v[72:75]
    v_mfma_f32_16x16x32_bf16 v[76:79], a[8:11], a[76:79], v[76:79]
    ds_read_b64_tr_b16 a[6:7], v8 offset:55296
    v_mfma_f32_16x16x32_bf16 v[76:79], a[12:15], a[92:95], v[76:79]
    s_waitcnt lgkmcnt(4)
    v_mfma_f32_16x16x32_bf16 v[80:83], a[16:19], a[64:67], v[80:83]
    ds_read_b64_tr_b16 a[8:9], v7 offset:37376
    s_add_u32 m0, s32, 0x22f80
    v_mfma_f32_16x16x32_bf16 v[80:83], a[20:23], a[80:83], v[80:83]
    buffer_load_dwordx4 v5, s[16:19], s29 offen offset:128 lds
    s_add_u32 s29, s29, 0x38000
    v_mfma_f32_16x16x32_bf16 v[84:87], a[16:19], a[68:71], v[84:87]
    ds_read_b64_tr_b16 a[10:11], v7 offset:39424
    v_mfma_f32_16x16x32_bf16 v[84:87], a[20:23], a[84:87], v[84:87]
    v_mfma_f32_16x16x32_bf16 v[88:91], a[16:19], a[72:75], v[88:91]
    ds_read_b64_tr_b16 a[12:13], v7 offset:53760
    v_mfma_f32_16x16x32_bf16 v[88:91], a[20:23], a[88:91], v[88:91]
    v_mfma_f32_16x16x32_bf16 v[92:95], a[16:19], a[76:79], v[92:95]
    ds_read_b64_tr_b16 a[14:15], v7 offset:55808
    v_mfma_f32_16x16x32_bf16 v[92:95], a[20:23], a[92:95], v[92:95]
    s_waitcnt lgkmcnt(4)
    v_mfma_f32_16x16x32_bf16 v[96:99], a[0:3], a[64:67], v[96:99]
    ds_read_b64_tr_b16 a[16:17], v8 offset:37376
    v_mfma_f32_16x16x32_bf16 v[96:99], a[4:7], a[80:83], v[96:99]
    buffer_load_dwordx4 a[128:131], v6, s[20:23], s30 offen offset:0 sc1
    v_mfma_f32_16x16x32_bf16 v[100:103], a[0:3], a[68:71], v[100:103]
    ds_read_b64_tr_b16 a[18:19], v8 offset:39424
    v_mfma_f32_16x16x32_bf16 v[100:103], a[4:7], a[84:87], v[100:103]
    v_mfma_f32_16x16x32_bf16 v[104:107], a[0:3], a[72:75], v[104:107]
    ds_read_b64_tr_b16 a[20:21], v8 offset:53760
    v_mfma_f32_16x16x32_bf16 v[104:107], a[4:7], a[88:91], v[104:107]
    v_mfma_f32_16x16x32_bf16 v[108:111], a[0:3], a[76:79], v[108:111]
    ds_read_b64_tr_b16 a[22:23], v8 offset:55808
    v_mfma_f32_16x16x32_bf16 v[108:111], a[4:7], a[92:95], v[108:111]
    s_waitcnt lgkmcnt(4)
    v_mfma_f32_16x16x32_bf16 v[112:115], a[8:11], a[64:67], v[112:115]
    ds_read_b64_tr_b16 a[0:1], v7 offset:40960
    v_mfma_f32_16x16x32_bf16 v[112:115], a[12:15], a[80:83], v[112:115]
    buffer_load_dwordx4 a[132:135], v6, s[20:23], s30 offen offset:1024 sc1
    v_mfma_f32_16x16x32_bf16 v[116:119], a[8:11], a[68:71], v[116:119]
    ds_read_b64_tr_b16 a[2:3], v7 offset:43008
    v_mfma_f32_16x16x32_bf16 v[116:119], a[12:15], a[84:87], v[116:119]
    buffer_load_dwordx4 a[136:139], v6, s[20:23], s39 offen offset:0 sc1
    v_mfma_f32_16x16x32_bf16 v[120:123], a[8:11], a[72:75], v[120:123]
    ds_read_b64_tr_b16 a[4:5], v7 offset:57344
    v_mfma_f32_16x16x32_bf16 v[120:123], a[12:15], a[88:91], v[120:123]
    v_mfma_f32_16x16x32_bf16 v[124:127], a[8:11], a[76:79], v[124:127]
    ds_read_b64_tr_b16 a[6:7], v7 offset:59392
    v_mfma_f32_16x16x32_bf16 v[124:127], a[12:15], a[92:95], v[124:127]
    s_waitcnt lgkmcnt(4)
    v_mfma_f32_16x16x32_bf16 v[128:131], a[16:19], a[64:67], v[128:131]
    ds_read_b64_tr_b16 a[8:9], v8 offset:40960
    v_mfma_f32_16x16x32_bf16 v[128:131], a[20:23], a[80:83], v[128:131]
    buffer_load_dwordx4 a[140:143], v6, s[20:23], s39 offen offset:1024 sc1
    s_add_u32 s30, s30, 4096
    s_add_u32 s39, s39, 4096
    v_mfma_f32_16x16x32_bf16 v[132:135], a[16:19], a[68:71], v[132:135]
    ds_read_b64_tr_b16 a[10:11], v8 offset:43008
    v_mfma_f32_16x16x32_bf16 v[132:135], a[20:23], a[84:87], v[132:135]
    v_mfma_f32_16x16x32_bf16 v[136:139], a[16:19], a[72:75], v[136:139]
    ds_read_b64_tr_b16 a[12:13], v8 offset:57344
    v_mfma_f32_16x16x32_bf16 v[136:139], a[20:23], a[88:91], v[136:139]
    v_mfma_f32_16x16x32_bf16 v[140:143], a[16:19], a[76:79], v[140:143]
    ds_read_b64_tr_b16 a[14:15], v8 offset:59392
    v_mfma_f32_16x16x32_bf16 v[140:143], a[20:23], a[92:95], v[140:143]
    s_waitcnt lgkmcnt(4)
    v_mfma_f32_16x16x32_bf16 v[144:147], a[0:3], a[64:67], v[144:147]
    ds_read_b64_tr_b16 a[16:17], v7 offset:41472
    s_add_u32 m0, s32, 0x24000
    v_mfma_f32_16x16x32_bf16 v[144:147], a[4:7], a[80:83], v[144:147]
    buffer_load_dwordx4 v3, s[12:15], s28 offen offset:0 lds
    v_mfma_f32_16x16x32_bf16 v[148:151], a[0:3], a[68:71], v[148:151]
    ds_read_b64_tr_b16 a[18:19], v7 offset:43520
    v_mfma_f32_16x16x32_bf16 v[148:151], a[4:7], a[84:87], v[148:151]
    v_mfma_f32_16x16x32_bf16 v[152:155], a[0:3], a[72:75], v[152:155]
    ds_read_b64_tr_b16 a[20:21], v7 offset:57856
    v_mfma_f32_16x16x32_bf16 v[152:155], a[4:7], a[88:91], v[152:155]
    v_mfma_f32_16x16x32_bf16 v[156:159], a[0:3], a[76:79], v[156:159]
    ds_read_b64_tr_b16 a[22:23], v7 offset:59904
    v_mfma_f32_16x16x32_bf16 v[156:159], a[4:7], a[92:95], v[156:159]
    s_waitcnt lgkmcnt(4)
    v_mfma_f32_16x16x32_bf16 v[160:163], a[8:11], a[64:67], v[160:163]
    ds_read_b64_tr_b16 a[0:1], v8 offset:41472
    s_add_u32 m0, s32, 0x24f80
    v_mfma_f32_16x16x32_bf16 v[160:163], a[12:15], a[80:83], v[160:163]
    buffer_load_dwordx4 v3, s[12:15], s28 offen offset:128 lds
    s_add_u32 s28, s28, 0x40000
    v_mfma_f32_16x16x32_bf16 v[164:167], a[8:11], a[68:71], v[164:167]
    ds_read_b64_tr_b16 a[2:3], v8 offset:43520
    v_mfma_f32_16x16x32_bf16 v[164:167], a[12:15], a[84:87], v[164:167]
    v_mfma_f32_16x16x32_bf16 v[168:171], a[8:11], a[72:75], v[168:171]
    ds_read_b64_tr_b16 a[4:5], v8 offset:57856
    v_mfma_f32_16x16x32_bf16 v[168:171], a[12:15], a[88:91], v[168:171]
    v_mfma_f32_16x16x32_bf16 v[172:175], a[8:11], a[76:79], v[172:175]
    ds_read_b64_tr_b16 a[6:7], v8 offset:59904
    v_mfma_f32_16x16x32_bf16 v[172:175], a[12:15], a[92:95], v[172:175]
    s_waitcnt lgkmcnt(4)
    v_mfma_f32_16x16x32_bf16 v[176:179], a[16:19], a[64:67], v[176:179]
    ds_read_b64_tr_b16 a[8:9], v7 offset:45056
    s_add_u32 m0, s32, 0x26000
    v_mfma_f32_16x16x32_bf16 v[176:179], a[20:23], a[80:83], v[176:179]
    buffer_load_dwordx4 v4, s[16:19], s29 offen offset:0 lds
    v_mfma_f32_16x16x32_bf16 v[180:183], a[16:19], a[68:71], v[180:183]
    ds_read_b64_tr_b16 a[10:11], v7 offset:47104
    s_add_u32 m0, s32, 0x26f80
    v_mfma_f32_16x16x32_bf16 v[180:183], a[20:23], a[84:87], v[180:183]
    buffer_load_dwordx4 v5, s[16:19], s29 offen offset:128 lds
    s_add_u32 s29, s29, 0x38000
    v_mfma_f32_16x16x32_bf16 v[184:187], a[16:19], a[72:75], v[184:187]
    ds_read_b64_tr_b16 a[12:13], v7 offset:61440
    v_mfma_f32_16x16x32_bf16 v[184:187], a[20:23], a[88:91], v[184:187]
    v_mfma_f32_16x16x32_bf16 v[188:191], a[16:19], a[76:79], v[188:191]
    ds_read_b64_tr_b16 a[14:15], v7 offset:63488
    v_mfma_f32_16x16x32_bf16 v[188:191], a[20:23], a[92:95], v[188:191]
    s_waitcnt lgkmcnt(4)
    v_mfma_f32_16x16x32_bf16 v[192:195], a[0:3], a[64:67], v[192:195]
    ds_read_b64_tr_b16 a[16:17], v8 offset:45056
    v_mfma_f32_16x16x32_bf16 v[192:195], a[4:7], a[80:83], v[192:195]
    buffer_load_dwordx4 a[144:147], v6, s[20:23], s30 offen offset:0 sc1
    v_mfma_f32_16x16x32_bf16 v[196:199], a[0:3], a[68:71], v[196:199]
    ds_read_b64_tr_b16 a[18:19], v8 offset:47104
    v_mfma_f32_16x16x32_bf16 v[196:199], a[4:7], a[84:87], v[196:199]
    v_mfma_f32_16x16x32_bf16 v[200:203], a[0:3], a[72:75], v[200:203]
    ds_read_b64_tr_b16 a[20:21], v8 offset:61440
    v_mfma_f32_16x16x32_bf16 v[200:203], a[4:7], a[88:91], v[200:203]
    v_mfma_f32_16x16x32_bf16 v[204:207], a[0:3], a[76:79], v[204:207]
    ds_read_b64_tr_b16 a[22:23], v8 offset:63488
    v_mfma_f32_16x16x32_bf16 v[204:207], a[4:7], a[92:95], v[204:207]
    s_waitcnt vmcnt(15)
    s_barrier
    s_waitcnt lgkmcnt(4)
    v_mfma_f32_16x16x32_bf16 v[208:211], a[8:11], a[64:67], v[208:211]
    ds_read_b64_tr_b16 a[0:1], v7 offset:45568
    v_mfma_f32_16x16x32_bf16 v[208:211], a[12:15], a[80:83], v[208:211]
    buffer_load_dwordx4 a[148:151], v6, s[20:23], s30 offen offset:1024 sc1
    v_mfma_f32_16x16x32_bf16 v[212:215], a[8:11], a[68:71], v[212:215]
    ds_read_b64_tr_b16 a[2:3], v7 offset:47616
    v_mfma_f32_16x16x32_bf16 v[212:215], a[12:15], a[84:87], v[212:215]
    v_mfma_f32_16x16x32_bf16 v[216:219], a[8:11], a[72:75], v[216:219]
    ds_read_b64_tr_b16 a[4:5], v7 offset:61952
    v_mfma_f32_16x16x32_bf16 v[216:219], a[12:15], a[88:91], v[216:219]
    v_mfma_f32_16x16x32_bf16 v[220:223], a[8:11], a[76:79], v[220:223]
    ds_read_b64_tr_b16 a[6:7], v7 offset:64000
    v_mfma_f32_16x16x32_bf16 v[220:223], a[12:15], a[92:95], v[220:223]
    s_waitcnt lgkmcnt(4)
    v_mfma_f32_16x16x32_bf16 v[224:227], a[16:19], a[64:67], v[224:227]
    ds_read_b64_tr_b16 a[8:9], v8 offset:45568
    v_mfma_f32_16x16x32_bf16 v[224:227], a[20:23], a[80:83], v[224:227]
    buffer_load_dwordx4 a[152:155], v6, s[20:23], s39 offen offset:0 sc1
    v_mfma_f32_16x16x32_bf16 v[228:231], a[16:19], a[68:71], v[228:231]
    ds_read_b64_tr_b16 a[10:11], v8 offset:47616
    v_mfma_f32_16x16x32_bf16 v[228:231], a[20:23], a[84:87], v[228:231]
    buffer_load_dwordx4 a[156:159], v6, s[20:23], s39 offen offset:1024 sc1
    s_add_u32 s30, s30, 4096
    s_add_u32 s39, s39, 4096
    v_mfma_f32_16x16x32_bf16 v[232:235], a[16:19], a[72:75], v[232:235]
    ds_read_b64_tr_b16 a[12:13], v8 offset:61952
    v_mfma_f32_16x16x32_bf16 v[232:235], a[20:23], a[88:91], v[232:235]
    v_mfma_f32_16x16x32_bf16 v[236:239], a[16:19], a[76:79], v[236:239]
    ds_read_b64_tr_b16 a[14:15], v8 offset:64000
    v_mfma_f32_16x16x32_bf16 v[236:239], a[20:23], a[92:95], v[236:239]
    s_waitcnt lgkmcnt(4)
    v_mfma_f32_16x16x32_bf16 v[240:243], a[0:3], a[64:67], v[240:243]
    ds_read_b64_tr_b16 a[16:17], v9 offset:0
    v_mfma_f32_16x16x32_bf16 v[240:243], a[4:7], a[80:83], v[240:243]
    ds_read_b64_tr_b16 a[18:19], v9 offset:2048
    v_mfma_f32_16x16x32_bf16 v[244:247], a[0:3], a[68:71], v[244:247]
    ds_read_b64_tr_b16 a[20:21], v9 offset:16384
    v_mfma_f32_16x16x32_bf16 v[244:247], a[4:7], a[84:87], v[244:247]
    ds_read_b64_tr_b16 a[22:23], v9 offset:18432
    s_waitcnt lgkmcnt(4)
    v_mfma_f32_16x16x32_bf16 v[248:251], a[8:11], a[64:67], v[248:251]
    ds_read_b64_tr_b16 a[0:1], v10 offset:0
    v_mfma_f32_16x16x32_bf16 v[248:251], a[12:15], a[80:83], v[248:251]
    ds_read_b64_tr_b16 a[2:3], v10 offset:2048
    v_mfma_f32_16x16x32_bf16 v[252:255], a[8:11], a[68:71], v[252:255]
    ds_read_b64_tr_b16 a[4:5], v10 offset:16384
    v_mfma_f32_16x16x32_bf16 v[252:255], a[12:15], a[84:87], v[252:255]
    ds_read_b64_tr_b16 a[6:7], v10 offset:18432
    s_waitcnt lgkmcnt(4)
    v_mfma_f32_16x16x32_bf16 v[16:19], a[16:19], a[96:99], v[16:19]
    ds_read_b64_tr_b16 a[8:9], v9 offset:512
    v_mfma_f32_16x16x32_bf16 v[16:19], a[20:23], a[112:115], v[16:19]
    v_mfma_f32_16x16x32_bf16 v[20:23], a[16:19], a[100:103], v[20:23]
    ds_read_b64_tr_b16 a[10:11], v9 offset:2560
    v_mfma_f32_16x16x32_bf16 v[20:23], a[20:23], a[116:119], v[20:23]
    v_mfma_f32_16x16x32_bf16 v[24:27], a[16:19], a[104:107], v[24:27]
    ds_read_b64_tr_b16 a[12:13], v9 offset:16896
    v_mfma_f32_16x16x32_bf16 v[24:27], a[20:23], a[120:123], v[24:27]
    v_mfma_f32_16x16x32_bf16 v[28:31], a[16:19], a[108:111], v[28:31]
    ds_read_b64_tr_b16 a[14:15], v9 offset:18944
    v_mfma_f32_16x16x32_bf16 v[28:31], a[20:23], a[124:127], v[28:31]
    s_waitcnt lgkmcnt(4)
    v_mfma_f32_16x16x32_bf16 v[32:35], a[0:3], a[96:99], v[32:35]
    ds_read_b64_tr_b16 a[16:17], v10 offset:512
    s_add_u32 m0, s32, 0x8000
    v_mfma_f32_16x16x32_bf16 v[32:35], a[4:7], a[112:115], v[32:35]
    buffer_load_dwordx4 v6, s[20:23], s31 offen sc1 lds
    s_add_u32 s31, s31, 4096
    v_mfma_f32_16x16x32_bf16 v[36:39], a[0:3], a[100:103], v[36:39]
    ds_read_b64_tr_b16 a[18:19], v10 offset:2560
    v_mfma_f32_16x16x32_bf16 v[36:39], a[4:7], a[116:119], v[36:39]
    v_mfma_f32_16x16x32_bf16 v[40:43], a[0:3], a[104:107], v[40:43]
    ds_read_b64_tr_b16 a[20:21], v10 offset:16896
    v_mfma_f32_16x16x32_bf16 v[40:43], a[4:7], a[120:123], v[40:43]
    v_mfma_f32_16x16x32_bf16 v[44:47], a[0:3], a[108:111], v[44:47]
    ds_read_b64_tr_b16 a[22:23], v10 offset:18944
    v_mfma_f32_16x16x32_bf16 v[44:47], a[4:7], a[124:127], v[44:47]
    s_waitcnt lgkmcnt(4)
    v_mfma_f32_16x16x32_bf16 v[48:51], a[8:11], a[96:99], v[48:51]
    ds_read_b64_tr_b16 a[0:1], v9 offset:4096
    v_mfma_f32_16x16x32_bf16 v[48:51], a[12:15], a[112:115], v[48:51]
    v_mfma_f32_16x16x32_bf16 v[52:55], a[8:11], a[100:103], v[52:55]
    ds_read_b64_tr_b16 a[2:3], v9 offset:6144
    v_mfma_f32_16x16x32_bf16 v[52:55], a[12:15], a[116:119], v[52:55]
    v_mfma_f32_16x16x32_bf16 v[56:59], a[8:11], a[104:107], v[56:59]
    ds_read_b64_tr_b16 a[4:5], v9 offset:20480
    v_mfma_f32_16x16x32_bf16 v[56:59], a[12:15], a[120:123], v[56:59]
    v_mfma_f32_16x16x32_bf16 v[60:63], a[8:11], a[108:111], v[60:63]
    ds_read_b64_tr_b16 a[6:7], v9 offset:22528
    v_mfma_f32_16x16x32_bf16 v[60:63], a[12:15], a[124:127], v[60:63]
    s_waitcnt lgkmcnt(4)
    v_mfma_f32_16x16x32_bf16 v[64:67], a[16:19], a[96:99], v[64:67]
    ds_read_b64_tr_b16 a[8:9], v10 offset:4096
    s_add_u32 m0, s32, 0x9000
    v_mfma_f32_16x16x32_bf16 v[64:67], a[20:23], a[112:115], v[64:67]
    buffer_load_dwordx4 v6, s[20:23], s31 offen sc1 lds
    s_add_u32 s31, s31, 4096
    v_mfma_f32_16x16x32_bf16 v[68:71], a[16:19], a[100:103], v[68:71]
    ds_read_b64_tr_b16 a[10:11], v10 offset:6144
    v_mfma_f32_16x16x32_bf16 v[68:71], a[20:23], a[116:119], v[68:71]
    v_mfma_f32_16x16x32_bf16 v[72:75], a[16:19], a[104:107], v[72:75]
    ds_read_b64_tr_b16 a[12:13], v10 offset:20480
    v_mfma_f32_16x16x32_bf16 v[72:75], a[20:23], a[120:123], v[72:75]
    v_mfma_f32_16x16x32_bf16 v[76:79], a[16:19], a[108:111], v[76:79]
    ds_read_b64_tr_b16 a[14:15], v10 offset:22528
    v_mfma_f32_16x16x32_bf16 v[76:79], a[20:23], a[124:127], v[76:79]
    s_waitcnt lgkmcnt(4)
    v_mfma_f32_16x16x32_bf16 v[80:83], a[0:3], a[96:99], v[80:83]
    ds_read_b64_tr_b16 a[16:17], v9 offset:4608
    v_mfma_f32_16x16x32_bf16 v[80:83], a[4:7], a[112:115], v[80:83]
    v_mfma_f32_16x16x32_bf16 v[84:87], a[0:3], a[100:103], v[84:87]
    ds_read_b64_tr_b16 a[18:19], v9 offset:6656
    v_mfma_f32_16x16x32_bf16 v[84:87], a[4:7], a[116:119], v[84:87]
    v_mfma_f32_16x16x32_bf16 v[88:91], a[0:3], a[104:107], v[88:91]
    ds_read_b64_tr_b16 a[20:21], v9 offset:20992
    v_mfma_f32_16x16x32_bf16 v[88:91], a[4:7], a[120:123], v[88:91]
    v_mfma_f32_16x16x32_bf16 v[92:95], a[0:3], a[108:111], v[92:95]
    ds_read_b64_tr_b16 a[22:23], v9 offset:23040
    v_mfma_f32_16x16x32_bf16 v[92:95], a[4:7], a[124:127], v[92:95]
    s_waitcnt lgkmcnt(4)
    v_mfma_f32_16x16x32_bf16 v[96:99], a[8:11], a[96:99], v[96:99]
    ds_read_b64_tr_b16 a[0:1], v10 offset:4608
    s_add_u32 m0, s32, 0xa000
    v_mfma_f32_16x16x32_bf16 v[96:99], a[12:15], a[112:115], v[96:99]
    buffer_load_dwordx4 v6, s[20:23], s31 offen sc1 lds
    s_add_u32 s31, s31, 4096
    v_mfma_f32_16x16x32_bf16 v[100:103], a[8:11], a[100:103], v[100:103]
    ds_read_b64_tr_b16 a[2:3], v10 offset:6656
    v_mfma_f32_16x16x32_bf16 v[100:103], a[12:15], a[116:119], v[100:103]
    v_mfma_f32_16x16x32_bf16 v[104:107], a[8:11], a[104:107], v[104:107]
    ds_read_b64_tr_b16 a[4:5], v10 offset:20992
    v_mfma_f32_16x16x32_bf16 v[104:107], a[12:15], a[120:123], v[104:107]
    v_mfma_f32_16x16x32_bf16 v[108:111], a[8:11], a[108:111], v[108:111]
    ds_read_b64_tr_b16 a[6:7], v10 offset:23040
    v_mfma_f32_16x16x32_bf16 v[108:111], a[12:15], a[124:127], v[108:111]
    s_waitcnt lgkmcnt(4)
    v_mfma_f32_16x16x32_bf16 v[112:115], a[16:19], a[96:99], v[112:115]
    ds_read_b64_tr_b16 a[8:9], v9 offset:8192
    s_add_u32 m0, s32, 0xb000
    v_mfma_f32_16x16x32_bf16 v[112:115], a[20:23], a[112:115], v[112:115]
    buffer_load_dwordx4 v6, s[20:23], s31 offen sc1 lds
    s_add_u32 s31, s31, 4096
    v_mfma_f32_16x16x32_bf16 v[116:119], a[16:19], a[100:103], v[116:119]
    ds_read_b64_tr_b16 a[10:11], v9 offset:10240
    v_mfma_f32_16x16x32_bf16 v[116:119], a[20:23], a[116:119], v[116:119]
    v_mfma_f32_16x16x32_bf16 v[120:123], a[16:19], a[104:107], v[120:123]
    ds_read_b64_tr_b16 a[12:13], v9 offset:24576
    v_mfma_f32_16x16x32_bf16 v[120:123], a[20:23], a[120:123], v[120:123]
    v_mfma_f32_16x16x32_bf16 v[124:127], a[16:19], a[108:111], v[124:127]
    ds_read_b64_tr_b16 a[14:15], v9 offset:26624
    v_mfma_f32_16x16x32_bf16 v[124:127], a[20:23], a[124:127], v[124:127]
    s_waitcnt lgkmcnt(4)
    v_mfma_f32_16x16x32_bf16 v[128:131], a[0:3], a[96:99], v[128:131]
    ds_read_b64_tr_b16 a[16:17], v10 offset:8192
    v_mfma_f32_16x16x32_bf16 v[128:131], a[4:7], a[112:115], v[128:131]
    v_mfma_f32_16x16x32_bf16 v[132:135], a[0:3], a[100:103], v[132:135]
    ds_read_b64_tr_b16 a[18:19], v10 offset:10240
    v_mfma_f32_16x16x32_bf16 v[132:135], a[4:7], a[116:119], v[132:135]
    v_mfma_f32_16x16x32_bf16 v[136:139], a[0:3], a[104:107], v[136:139]
    ds_read_b64_tr_b16 a[20:21], v10 offset:24576
    v_mfma_f32_16x16x32_bf16 v[136:139], a[4:7], a[120:123], v[136:139]
    v_mfma_f32_16x16x32_bf16 v[140:143], a[0:3], a[108:111], v[140:143]
    ds_read_b64_tr_b16 a[22:23], v10 offset:26624
    v_mfma_f32_16x16x32_bf16 v[140:143], a[4:7], a[124:127], v[140:143]
    s_waitcnt lgkmcnt(4)
    v_mfma_f32_16x16x32_bf16 v[144:147], a[8:11], a[96:99], v[144:147]
    ds_read_b64_tr_b16 a[0:1], v9 offset:8704
    s_add_u32 m0, s32, 0xc000
    v_mfma_f32_16x16x32_bf16 v[144:147], a[12:15], a[112:115], v[144:147]
    buffer_load_dwordx4 v6, s[20:23], s31 offen sc1 lds
    s_add_u32 s31, s31, 4096
    v_mfma_f32_16x16x32_bf16 v[148:151], a[8:11], a[100:103], v[148:151]
    ds_read_b64_tr_b16 a[2:3], v9 offset:10752
    v_mfma_f32_16x16x32_bf16 v[148:151], a[12:15], a[116:119], v[148:151]
    v_mfma_f32_16x16x32_bf16 v[152:155], a[8:11], a[104:107], v[152:155]
    ds_read_b64_tr_b16 a[4:5], v9 offset:25088
    v_mfma_f32_16x16x32_bf16 v[152:155], a[12:15], a[120:123], v[152:155]
    v_mfma_f32_16x16x32_bf16 v[156:159], a[8:11], a[108:111], v[156:159]
    ds_read_b64_tr_b16 a[6:7], v9 offset:27136
    v_mfma_f32_16x16x32_bf16 v[156:159], a[12:15], a[124:127], v[156:159]
    s_waitcnt lgkmcnt(4)
    v_mfma_f32_16x16x32_bf16 v[160:163], a[16:19], a[96:99], v[160:163]
    ds_read_b64_tr_b16 a[8:9], v10 offset:8704
    v_mfma_f32_16x16x32_bf16 v[160:163], a[20:23], a[112:115], v[160:163]
    v_mfma_f32_16x16x32_bf16 v[164:167], a[16:19], a[100:103], v[164:167]
    ds_read_b64_tr_b16 a[10:11], v10 offset:10752
    v_mfma_f32_16x16x32_bf16 v[164:167], a[20:23], a[116:119], v[164:167]
    v_mfma_f32_16x16x32_bf16 v[168:171], a[16:19], a[104:107], v[168:171]
    ds_read_b64_tr_b16 a[12:13], v10 offset:25088
    v_mfma_f32_16x16x32_bf16 v[168:171], a[20:23], a[120:123], v[168:171]
    v_mfma_f32_16x16x32_bf16 v[172:175], a[16:19], a[108:111], v[172:175]
    ds_read_b64_tr_b16 a[14:15], v10 offset:27136
    v_mfma_f32_16x16x32_bf16 v[172:175], a[20:23], a[124:127], v[172:175]
    s_waitcnt lgkmcnt(4)
    v_mfma_f32_16x16x32_bf16 v[176:179], a[0:3], a[96:99], v[176:179]
    ds_read_b64_tr_b16 a[16:17], v9 offset:12288
    s_add_u32 m0, s32, 0xd000
    v_mfma_f32_16x16x32_bf16 v[176:179], a[4:7], a[112:115], v[176:179]
    buffer_load_dwordx4 v6, s[20:23], s31 offen sc1 lds
    s_add_u32 s31, s31, 4096
    v_mfma_f32_16x16x32_bf16 v[180:183], a[0:3], a[100:103], v[180:183]
    ds_read_b64_tr_b16 a[18:19], v9 offset:14336
    v_mfma_f32_16x16x32_bf16 v[180:183], a[4:7], a[116:119], v[180:183]
    v_mfma_f32_16x16x32_bf16 v[184:187], a[0:3], a[104:107], v[184:187]
    ds_read_b64_tr_b16 a[20:21], v9 offset:28672
    v_mfma_f32_16x16x32_bf16 v[184:187], a[4:7], a[120:123], v[184:187]
    v_mfma_f32_16x16x32_bf16 v[188:191], a[0:3], a[108:111], v[188:191]
    ds_read_b64_tr_b16 a[22:23], v9 offset:30720
    v_mfma_f32_16x16x32_bf16 v[188:191], a[4:7], a[124:127], v[188:191]
    s_waitcnt lgkmcnt(4)
    v_mfma_f32_16x16x32_bf16 v[192:195], a[8:11], a[96:99], v[192:195]
    ds_read_b64_tr_b16 a[0:1], v10 offset:12288
    v_mfma_f32_16x16x32_bf16 v[192:195], a[12:15], a[112:115], v[192:195]
    v_mfma_f32_16x16x32_bf16 v[196:199], a[8:11], a[100:103], v[196:199]
    ds_read_b64_tr_b16 a[2:3], v10 offset:14336
    v_mfma_f32_16x16x32_bf16 v[196:199], a[12:15], a[116:119], v[196:199]
    v_mfma_f32_16x16x32_bf16 v[200:203], a[8:11], a[104:107], v[200:203]
    ds_read_b64_tr_b16 a[4:5], v10 offset:28672
    v_mfma_f32_16x16x32_bf16 v[200:203], a[12:15], a[120:123], v[200:203]
    v_mfma_f32_16x16x32_bf16 v[204:207], a[8:11], a[108:111], v[204:207]
    ds_read_b64_tr_b16 a[6:7], v10 offset:30720
    v_mfma_f32_16x16x32_bf16 v[204:207], a[12:15], a[124:127], v[204:207]
    s_waitcnt vmcnt(6)
    s_barrier
    s_waitcnt lgkmcnt(4)
    v_mfma_f32_16x16x32_bf16 v[208:211], a[16:19], a[96:99], v[208:211]
    ds_read_b64_tr_b16 a[8:9], v9 offset:12800
    s_add_u32 m0, s32, 0xe000
    v_mfma_f32_16x16x32_bf16 v[208:211], a[20:23], a[112:115], v[208:211]
    buffer_load_dwordx4 v6, s[20:23], s31 offen sc1 lds
    s_add_u32 s31, s31, 4096
    v_mfma_f32_16x16x32_bf16 v[212:215], a[16:19], a[100:103], v[212:215]
    ds_read_b64_tr_b16 a[10:11], v9 offset:14848
    v_mfma_f32_16x16x32_bf16 v[212:215], a[20:23], a[116:119], v[212:215]
    v_mfma_f32_16x16x32_bf16 v[216:219], a[16:19], a[104:107], v[216:219]
    ds_read_b64_tr_b16 a[12:13], v9 offset:29184
    v_mfma_f32_16x16x32_bf16 v[216:219], a[20:23], a[120:123], v[216:219]
    v_mfma_f32_16x16x32_bf16 v[220:223], a[16:19], a[108:111], v[220:223]
    ds_read_b64_tr_b16 a[14:15], v9 offset:31232
    v_mfma_f32_16x16x32_bf16 v[220:223], a[20:23], a[124:127], v[220:223]
    s_waitcnt lgkmcnt(4)
    v_mfma_f32_16x16x32_bf16 v[224:227], a[0:3], a[96:99], v[224:227]
    ds_read_b64_tr_b16 a[16:17], v10 offset:12800
    s_add_u32 m0, s32, 0xf000
    v_mfma_f32_16x16x32_bf16 v[224:227], a[4:7], a[112:115], v[224:227]
    buffer_load_dwordx4 v6, s[20:23], s31 offen sc1 lds
    s_add_u32 s31, s31, 4096
    v_mfma_f32_16x16x32_bf16 v[228:231], a[0:3], a[100:103], v[228:231]
    ds_read_b64_tr_b16 a[18:19], v10 offset:14848
    v_mfma_f32_16x16x32_bf16 v[228:231], a[4:7], a[116:119], v[228:231]
    v_mfma_f32_16x16x32_bf16 v[232:235], a[0:3], a[104:107], v[232:235]
    ds_read_b64_tr_b16 a[20:21], v10 offset:29184
    v_mfma_f32_16x16x32_bf16 v[232:235], a[4:7], a[120:123], v[232:235]
    v_mfma_f32_16x16x32_bf16 v[236:239], a[0:3], a[108:111], v[236:239]
    ds_read_b64_tr_b16 a[22:23], v10 offset:31232
    v_mfma_f32_16x16x32_bf16 v[236:239], a[4:7], a[124:127], v[236:239]
    s_waitcnt lgkmcnt(4)
    v_mfma_f32_16x16x32_bf16 v[240:243], a[8:11], a[96:99], v[240:243]
    ds_read_b64_tr_b16 a[0:1], v9 offset:32768
    v_mfma_f32_16x16x32_bf16 v[240:243], a[12:15], a[112:115], v[240:243]
    ds_read_b64_tr_b16 a[2:3], v9 offset:34816
    v_mfma_f32_16x16x32_bf16 v[244:247], a[8:11], a[100:103], v[244:247]
    ds_read_b64_tr_b16 a[4:5], v9 offset:49152
    v_mfma_f32_16x16x32_bf16 v[244:247], a[12:15], a[116:119], v[244:247]
    ds_read_b64_tr_b16 a[6:7], v9 offset:51200
    s_waitcnt lgkmcnt(4)
    v_mfma_f32_16x16x32_bf16 v[248:251], a[16:19], a[96:99], v[248:251]
    ds_read_b64_tr_b16 a[8:9], v10 offset:32768
    v_mfma_f32_16x16x32_bf16 v[248:251], a[20:23], a[112:115], v[248:251]
    ds_read_b64_tr_b16 a[10:11], v10 offset:34816
    v_mfma_f32_16x16x32_bf16 v[252:255], a[16:19], a[100:103], v[252:255]
    ds_read_b64_tr_b16 a[12:13], v10 offset:49152
    v_mfma_f32_16x16x32_bf16 v[252:255], a[20:23], a[116:119], v[252:255]
    ds_read_b64_tr_b16 a[14:15], v10 offset:51200
    s_waitcnt lgkmcnt(4)
    v_mfma_f32_16x16x32_bf16 v[16:19], a[0:3], a[128:131], v[16:19]
    ds_read_b64_tr_b16 a[16:17], v9 offset:33280
    v_mfma_f32_16x16x32_bf16 v[16:19], a[4:7], a[144:147], v[16:19]
    v_mfma_f32_16x16x32_bf16 v[20:23], a[0:3], a[132:135], v[20:23]
    ds_read_b64_tr_b16 a[18:19], v9 offset:35328
    v_mfma_f32_16x16x32_bf16 v[20:23], a[4:7], a[148:151], v[20:23]
    v_mfma_f32_16x16x32_bf16 v[24:27], a[0:3], a[136:139], v[24:27]
    ds_read_b64_tr_b16 a[20:21], v9 offset:49664
    v_mfma_f32_16x16x32_bf16 v[24:27], a[4:7], a[152:155], v[24:27]
    v_mfma_f32_16x16x32_bf16 v[28:31], a[0:3], a[140:143], v[28:31]
    ds_read_b64_tr_b16 a[22:23], v9 offset:51712
    v_mfma_f32_16x16x32_bf16 v[28:31], a[4:7], a[156:159], v[28:31]
    s_waitcnt lgkmcnt(4)
    v_mfma_f32_16x16x32_bf16 v[32:35], a[8:11], a[128:131], v[32:35]
    ds_read_b64_tr_b16 a[0:1], v10 offset:33280
    s_add_u32 m0, s32, 0x10000
    v_mfma_f32_16x16x32_bf16 v[32:35], a[12:15], a[144:147], v[32:35]
    buffer_load_dwordx4 v6, s[20:23], s31 offen sc1 lds
    s_add_u32 s31, s31, 4096
    v_mfma_f32_16x16x32_bf16 v[36:39], a[8:11], a[132:135], v[36:39]
    ds_read_b64_tr_b16 a[2:3], v10 offset:35328
    v_mfma_f32_16x16x32_bf16 v[36:39], a[12:15], a[148:151], v[36:39]
    v_mfma_f32_16x16x32_bf16 v[40:43], a[8:11], a[136:139], v[40:43]
    ds_read_b64_tr_b16 a[4:5], v10 offset:49664
    v_mfma_f32_16x16x32_bf16 v[40:43], a[12:15], a[152:155], v[40:43]
    v_mfma_f32_16x16x32_bf16 v[44:47], a[8:11], a[140:143], v[44:47]
    ds_read_b64_tr_b16 a[6:7], v10 offset:51712
    v_mfma_f32_16x16x32_bf16 v[44:47], a[12:15], a[156:159], v[44:47]
    s_waitcnt lgkmcnt(4)
    v_mfma_f32_16x16x32_bf16 v[48:51], a[16:19], a[128:131], v[48:51]
    ds_read_b64_tr_b16 a[8:9], v9 offset:36864
    s_add_u32 m0, s32, 0x11000
    v_mfma_f32_16x16x32_bf16 v[48:51], a[20:23], a[144:147], v[48:51]
    buffer_load_dwordx4 v6, s[20:23], s31 offen sc1 lds
    s_add_u32 s31, s31, 4096
    v_mfma_f32_16x16x32_bf16 v[52:55], a[16:19], a[132:135], v[52:55]
    ds_read_b64_tr_b16 a[10:11], v9 offset:38912
    v_mfma_f32_16x16x32_bf16 v[52:55], a[20:23], a[148:151], v[52:55]
    v_mfma_f32_16x16x32_bf16 v[56:59], a[16:19], a[136:139], v[56:59]
    ds_read_b64_tr_b16 a[12:13], v9 offset:53248
    v_mfma_f32_16x16x32_bf16 v[56:59], a[20:23], a[152:155], v[56:59]
    v_mfma_f32_16x16x32_bf16 v[60:63], a[16:19], a[140:143], v[60:63]
    ds_read_b64_tr_b16 a[14:15], v9 offset:55296
    v_mfma_f32_16x16x32_bf16 v[60:63], a[20:23], a[156:159], v[60:63]
    s_waitcnt lgkmcnt(4)
    v_mfma_f32_16x16x32_bf16 v[64:67], a[0:3], a[128:131], v[64:67]
    ds_read_b64_tr_b16 a[16:17], v10 offset:36864
    v_mfma_f32_16x16x32_bf16 v[64:67], a[4:7], a[144:147], v[64:67]
    v_mfma_f32_16x16x32_bf16 v[68:71], a[0:3], a[132:135], v[68:71]
    ds_read_b64_tr_b16 a[18:19], v10 offset:38912
    v_mfma_f32_16x16x32_bf16 v[68:71], a[4:7], a[148:151], v[68:71]
    v_mfma_f32_16x16x32_bf16 v[72:75], a[0:3], a[136:139], v[72:75]
    ds_read_b64_tr_b16 a[20:21], v10 offset:53248
    v_mfma_f32_16x16x32_bf16 v[72:75], a[4:7], a[152:155], v[72:75]
    v_mfma_f32_16x16x32_bf16 v[76:79], a[0:3], a[140:143], v[76:79]
    ds_read_b64_tr_b16 a[22:23], v10 offset:55296
    v_mfma_f32_16x16x32_bf16 v[76:79], a[4:7], a[156:159], v[76:79]
    s_waitcnt lgkmcnt(4)
    v_mfma_f32_16x16x32_bf16 v[80:83], a[8:11], a[128:131], v[80:83]
    ds_read_b64_tr_b16 a[0:1], v9 offset:37376
    s_add_u32 m0, s32, 0x12000
    v_mfma_f32_16x16x32_bf16 v[80:83], a[12:15], a[144:147], v[80:83]
    buffer_load_dwordx4 v6, s[20:23], s31 offen sc1 lds
    s_add_u32 s31, s31, 4096
    v_mfma_f32_16x16x32_bf16 v[84:87], a[8:11], a[132:135], v[84:87]
    ds_read_b64_tr_b16 a[2:3], v9 offset:39424
    v_mfma_f32_16x16x32_bf16 v[84:87], a[12:15], a[148:151], v[84:87]
    v_mfma_f32_16x16x32_bf16 v[88:91], a[8:11], a[136:139], v[88:91]
    ds_read_b64_tr_b16 a[4:5], v9 offset:53760
    v_mfma_f32_16x16x32_bf16 v[88:91], a[12:15], a[152:155], v[88:91]
    v_mfma_f32_16x16x32_bf16 v[92:95], a[8:11], a[140:143], v[92:95]
    ds_read_b64_tr_b16 a[6:7], v9 offset:55808
    v_mfma_f32_16x16x32_bf16 v[92:95], a[12:15], a[156:159], v[92:95]
    s_waitcnt lgkmcnt(4)
    v_mfma_f32_16x16x32_bf16 v[96:99], a[16:19], a[128:131], v[96:99]
    ds_read_b64_tr_b16 a[8:9], v10 offset:37376
    s_add_u32 m0, s32, 0x13000
    v_mfma_f32_16x16x32_bf16 v[96:99], a[20:23], a[144:147], v[96:99]
    buffer_load_dwordx4 v6, s[20:23], s31 offen sc1 lds
    s_add_u32 s31, s31, 4096
    v_mfma_f32_16x16x32_bf16 v[100:103], a[16:19], a[132:135], v[100:103]
    ds_read_b64_tr_b16 a[10:11], v10 offset:39424
    v_mfma_f32_16x16x32_bf16 v[100:103], a[20:23], a[148:151], v[100:103]
    v_mfma_f32_16x16x32_bf16 v[104:107], a[16:19], a[136:139], v[104:107]
    ds_read_b64_tr_b16 a[12:13], v10 offset:53760
    v_mfma_f32_16x16x32_bf16 v[104:107], a[20:23], a[152:155], v[104:107]
    v_mfma_f32_16x16x32_bf16 v[108:111], a[16:19], a[140:143], v[108:111]
    ds_read_b64_tr_b16 a[14:15], v10 offset:55808
    v_mfma_f32_16x16x32_bf16 v[108:111], a[20:23], a[156:159], v[108:111]
    s_waitcnt lgkmcnt(4)
    v_mfma_f32_16x16x32_bf16 v[112:115], a[0:3], a[128:131], v[112:115]
    ds_read_b64_tr_b16 a[16:17], v9 offset:40960
    s_add_u32 m0, s32, 0x14000
    v_mfma_f32_16x16x32_bf16 v[112:115], a[4:7], a[144:147], v[112:115]
    buffer_load_dwordx4 v6, s[20:23], s31 offen sc1 lds
    s_add_u32 s31, s31, 4096
    v_mfma_f32_16x16x32_bf16 v[116:119], a[0:3], a[132:135], v[116:119]
    ds_read_b64_tr_b16 a[18:19], v9 offset:43008
    v_mfma_f32_16x16x32_bf16 v[116:119], a[4:7], a[148:151], v[116:119]
    v_mfma_f32_16x16x32_bf16 v[120:123], a[0:3], a[136:139], v[120:123]
    ds_read_b64_tr_b16 a[20:21], v9 offset:57344
    v_mfma_f32_16x16x32_bf16 v[120:123], a[4:7], a[152:155], v[120:123]
    v_mfma_f32_16x16x32_bf16 v[124:127], a[0:3], a[140:143], v[124:127]
    ds_read_b64_tr_b16 a[22:23], v9 offset:59392
    v_mfma_f32_16x16x32_bf16 v[124:127], a[4:7], a[156:159], v[124:127]
    s_waitcnt lgkmcnt(4)
    v_mfma_f32_16x16x32_bf16 v[128:131], a[8:11], a[128:131], v[128:131]
    ds_read_b64_tr_b16 a[0:1], v10 offset:40960
    v_mfma_f32_16x16x32_bf16 v[128:131], a[12:15], a[144:147], v[128:131]
    v_mfma_f32_16x16x32_bf16 v[132:135], a[8:11], a[132:135], v[132:135]
    ds_read_b64_tr_b16 a[2:3], v10 offset:43008
    v_mfma_f32_16x16x32_bf16 v[132:135], a[12:15], a[148:151], v[132:135]
    v_mfma_f32_16x16x32_bf16 v[136:139], a[8:11], a[136:139], v[136:139]
    ds_read_b64_tr_b16 a[4:5], v10 offset:57344
    v_mfma_f32_16x16x32_bf16 v[136:139], a[12:15], a[152:155], v[136:139]
    v_mfma_f32_16x16x32_bf16 v[140:143], a[8:11], a[140:143], v[140:143]
    ds_read_b64_tr_b16 a[6:7], v10 offset:59392
    v_mfma_f32_16x16x32_bf16 v[140:143], a[12:15], a[156:159], v[140:143]
    s_waitcnt lgkmcnt(4)
    v_mfma_f32_16x16x32_bf16 v[144:147], a[16:19], a[128:131], v[144:147]
    ds_read_b64_tr_b16 a[8:9], v9 offset:41472
    s_add_u32 m0, s32, 0x15000
    v_mfma_f32_16x16x32_bf16 v[144:147], a[20:23], a[144:147], v[144:147]
    buffer_load_dwordx4 v6, s[20:23], s31 offen sc1 lds
    s_add_u32 s31, s31, 4096
    v_mfma_f32_16x16x32_bf16 v[148:151], a[16:19], a[132:135], v[148:151]
    ds_read_b64_tr_b16 a[10:11], v9 offset:43520
    v_mfma_f32_16x16x32_bf16 v[148:151], a[20:23], a[148:151], v[148:151]
    v_mfma_f32_16x16x32_bf16 v[152:155], a[16:19], a[136:139], v[152:155]
    ds_read_b64_tr_b16 a[12:13], v9 offset:57856
    v_mfma_f32_16x16x32_bf16 v[152:155], a[20:23], a[152:155], v[152:155]
    v_mfma_f32_16x16x32_bf16 v[156:159], a[16:19], a[140:143], v[156:159]
    ds_read_b64_tr_b16 a[14:15], v9 offset:59904
    v_mfma_f32_16x16x32_bf16 v[156:159], a[20:23], a[156:159], v[156:159]
    s_waitcnt lgkmcnt(4)
    v_mfma_f32_16x16x32_bf16 v[160:163], a[0:3], a[128:131], v[160:163]
    ds_read_b64_tr_b16 a[16:17], v10 offset:41472
    s_add_u32 m0, s32, 0x16000
    v_mfma_f32_16x16x32_bf16 v[160:163], a[4:7], a[144:147], v[160:163]
    buffer_load_dwordx4 v6, s[20:23], s31 offen sc1 lds
    s_add_u32 s31, s31, 4096
    v_mfma_f32_16x16x32_bf16 v[164:167], a[0:3], a[132:135], v[164:167]
    ds_read_b64_tr_b16 a[18:19], v10 offset:43520
    v_mfma_f32_16x16x32_bf16 v[164:167], a[4:7], a[148:151], v[164:167]
    v_mfma_f32_16x16x32_bf16 v[168:171], a[0:3], a[136:139], v[168:171]
    ds_read_b64_tr_b16 a[20:21], v10 offset:57856
    v_mfma_f32_16x16x32_bf16 v[168:171], a[4:7], a[152:155], v[168:171]
    v_mfma_f32_16x16x32_bf16 v[172:175], a[0:3], a[140:143], v[172:175]
    ds_read_b64_tr_b16 a[22:23], v10 offset:59904
    v_mfma_f32_16x16x32_bf16 v[172:175], a[4:7], a[156:159], v[172:175]
    s_waitcnt lgkmcnt(4)
    v_mfma_f32_16x16x32_bf16 v[176:179], a[8:11], a[128:131], v[176:179]
    ds_read_b64_tr_b16 a[0:1], v9 offset:45056
    v_mfma_f32_16x16x32_bf16 v[176:179], a[12:15], a[144:147], v[176:179]
    v_mfma_f32_16x16x32_bf16 v[180:183], a[8:11], a[132:135], v[180:183]
    ds_read_b64_tr_b16 a[2:3], v9 offset:47104
    v_mfma_f32_16x16x32_bf16 v[180:183], a[12:15], a[148:151], v[180:183]
    v_mfma_f32_16x16x32_bf16 v[184:187], a[8:11], a[136:139], v[184:187]
    ds_read_b64_tr_b16 a[4:5], v9 offset:61440
    v_mfma_f32_16x16x32_bf16 v[184:187], a[12:15], a[152:155], v[184:187]
    v_mfma_f32_16x16x32_bf16 v[188:191], a[8:11], a[140:143], v[188:191]
    ds_read_b64_tr_b16 a[6:7], v9 offset:63488
    v_mfma_f32_16x16x32_bf16 v[188:191], a[12:15], a[156:159], v[188:191]
    s_waitcnt lgkmcnt(4)
    v_mfma_f32_16x16x32_bf16 v[192:195], a[16:19], a[128:131], v[192:195]
    ds_read_b64_tr_b16 a[8:9], v10 offset:45056
    s_add_u32 m0, s32, 0x17000
    v_mfma_f32_16x16x32_bf16 v[192:195], a[20:23], a[144:147], v[192:195]
    buffer_load_dwordx4 v6, s[20:23], s31 offen sc1 lds
    s_add_u32 s31, s31, 4096
    v_mfma_f32_16x16x32_bf16 v[196:199], a[16:19], a[132:135], v[196:199]
    ds_read_b64_tr_b16 a[10:11], v10 offset:47104
    v_mfma_f32_16x16x32_bf16 v[196:199], a[20:23], a[148:151], v[196:199]
    v_mfma_f32_16x16x32_bf16 v[200:203], a[16:19], a[136:139], v[200:203]
    ds_read_b64_tr_b16 a[12:13], v10 offset:61440
    v_mfma_f32_16x16x32_bf16 v[200:203], a[20:23], a[152:155], v[200:203]
    v_mfma_f32_16x16x32_bf16 v[204:207], a[16:19], a[140:143], v[204:207]
    ds_read_b64_tr_b16 a[14:15], v10 offset:63488
    v_mfma_f32_16x16x32_bf16 v[204:207], a[20:23], a[156:159], v[204:207]
    s_waitcnt lgkmcnt(4)
    v_mfma_f32_16x16x32_bf16 v[208:211], a[0:3], a[128:131], v[208:211]
    ds_read_b64_tr_b16 a[16:17], v9 offset:45568
    v_mfma_f32_16x16x32_bf16 v[208:211], a[4:7], a[144:147], v[208:211]
    v_mov_b32 v14, 1
    s_mov_b64 exec, 1
    buffer_store_short v14, off, s[20:23], s3 sc1
    s_mov_b64 exec, -1
    v_mfma_f32_16x16x32_bf16 v[212:215], a[0:3], a[132:135], v[212:215]
    ds_read_b64_tr_b16 a[18:19], v9 offset:47616
    v_mfma_f32_16x16x32_bf16 v[212:215], a[4:7], a[148:151], v[212:215]
    v_mfma_f32_16x16x32_bf16 v[216:219], a[0:3], a[136:139], v[216:219]
    ds_read_b64_tr_b16 a[20:21], v9 offset:61952
    v_mfma_f32_16x16x32_bf16 v[216:219], a[4:7], a[152:155], v[216:219]
    v_mfma_f32_16x16x32_bf16 v[220:223], a[0:3], a[140:143], v[220:223]
    ds_read_b64_tr_b16 a[22:23], v9 offset:64000
    v_mfma_f32_16x16x32_bf16 v[220:223], a[4:7], a[156:159], v[220:223]
    s_waitcnt lgkmcnt(4)
    v_mfma_f32_16x16x32_bf16 v[224:227], a[8:11], a[128:131], v[224:227]
    ds_read_b64_tr_b16 a[0:1], v10 offset:45568
    v_mfma_f32_16x16x32_bf16 v[224:227], a[12:15], a[144:147], v[224:227]
    s_getpc_b64 s[80:81]
    global_load_dword a255, v0, s[80:81] offset:2048
    v_mfma_f32_16x16x32_bf16 v[228:231], a[8:11], a[132:135], v[228:231]
    ds_read_b64_tr_b16 a[2:3], v10 offset:47616
    v_mfma_f32_16x16x32_bf16 v[228:231], a[12:15], a[148:151], v[228:231]
    v_mfma_f32_16x16x32_bf16 v[232:235], a[8:11], a[136:139], v[232:235]
    ds_read_b64_tr_b16 a[4:5], v10 offset:61952
    v_mfma_f32_16x16x32_bf16 v[232:235], a[12:15], a[152:155], v[232:235]
    v_mfma_f32_16x16x32_bf16 v[236:239], a[8:11], a[140:143], v[236:239]
    ds_read_b64_tr_b16 a[6:7], v10 offset:64000
    v_mfma_f32_16x16x32_bf16 v[236:239], a[12:15], a[156:159], v[236:239]
    s_waitcnt lgkmcnt(4)
    v_mfma_f32_16x16x32_bf16 v[240:243], a[16:19], a[128:131], v[240:243]
    v_mfma_f32_16x16x32_bf16 v[240:243], a[20:23], a[144:147], v[240:243]
    v_mfma_f32_16x16x32_bf16 v[244:247], a[16:19], a[132:135], v[244:247]
    v_mfma_f32_16x16x32_bf16 v[244:247], a[20:23], a[148:151], v[244:247]
    s_waitcnt lgkmcnt(0)
    v_mfma_f32_16x16x32_bf16 v[248:251], a[0:3], a[128:131], v[248:251]
    v_mfma_f32_16x16x32_bf16 v[248:251], a[4:7], a[144:147], v[248:251]
    v_mfma_f32_16x16x32_bf16 v[252:255], a[0:3], a[132:135], v[252:255]
    v_mfma_f32_16x16x32_bf16 v[252:255], a[4:7], a[148:151], v[252:255]
    s_mov_b32 s28, s44
    s_mov_b32 s29, s45
    s_mov_b32 s50, 0xffff0000
    s_mov_b32 s70, 0xbfb8aa3b
    s_mov_b32 s71, 0xbfb8aa3b
    s_lshl_b32 s52, s35, 3
    s_lshl_b32 s53, s34, 1
    s_add_u32 s52, s52, s53
    s_add_u32 s42, s52, s49
    s_xor_b32 s59, s42, 1
    s_mul_i32 s54, s43, 7
    s_lshl_b32 s54, s54, 11
    s_add_u32 s54, s54, 0x1900000
    s_mul_i32 s53, s42, 229376
    s_add_u32 s53, s53, s54
    s_add_u32 s43, s53, 6144
    s_mul_i32 s55, s59, 229376
    s_add_u32 s55, s55, s54
    s_lshl_b32 s54, s49, 13
    s_add_u32 s53, s53, s54
    s_add_u32 s55, s55, s54
    s_add_u32 s54, s53, 4096
    s_add_u32 s56, s55, 4096
    s_lshl_b32 s44, s52, 6
    s_add_u32 s44, s44, 0x3010000
    s_lshl_b32 s45, s33, 2
    s_add_u32 s45, s45, s44
    s_add_u32 s45, s45, 4096
    s_xor_b32 s37, s33, 16
    s_lshl_b32 s33, s37, 2
    s_add_u32 s44, s44, s33
    v_lshrrev_b32 v5, 3, v1
    v_cmp_eq_u32 vcc, 3, v5
    v_mov_b32 v5, 0x4000080
    s_nop 1
    v_cndmask_b32 v5, 0, v5, vcc
    v_add_u32 v4, v6, v5
    s_cmp_eq_u32 s51, 0
    s_cbranch_scc0 L_m_skip_h
    v_pk_mul_f32 v[8:9], v[144:145], s[70:71]
    v_pk_mul_f32 v[10:11], v[146:147], s[70:71]
    v_pk_mul_f32 v[12:13], v[160:161], s[70:71]
    v_pk_mul_f32 v[14:15], v[162:163], s[70:71]
    v_exp_f32 v8, v8
    v_exp_f32 v9, v9
    v_exp_f32 v10, v10
    v_exp_f32 v11, v11
    v_exp_f32 v12, v12
    v_exp_f32 v13, v13
    v_exp_f32 v14, v14
    v_exp_f32 v15, v15
    v_pk_add_f32 v[8:9], v[8:9], 1.0 op_sel_hi:[1,0]
    v_pk_add_f32 v[10:11], v[10:11], 1.0 op_sel_hi:[1,0]
    v_pk_add_f32 v[12:13], v[12:13], 1.0 op_sel_hi:[1,0]
    v_pk_add_f32 v[14:15], v[14:15], 1.0 op_sel_hi:[1,0]
    v_rcp_f32 v8, v8
    v_rcp_f32 v9, v9
    v_rcp_f32 v10, v10
    v_rcp_f32 v11, v11
    v_rcp_f32 v12, v12
    v_rcp_f32 v13, v13
    v_rcp_f32 v14, v14
    v_rcp_f32 v15, v15
    v_pk_mul_f32 v[8:9], v[8:9], v[144:145]
    v_pk_mul_f32 v[10:11], v[10:11], v[146:147]
    v_pk_mul_f32 v[12:13], v[12:13], v[160:161]
    v_pk_mul_f32 v[14:15], v[14:15], v[162:163]
    v_cvt_pk_bf16_f32 v144, v8, v9
    v_cvt_pk_bf16_f32 v145, v10, v11
    v_cvt_pk_bf16_f32 v146, v12, v13
    v_cvt_pk_bf16_f32 v147, v14, v15
    buffer_store_dwordx4 v[144:147], v4, s[20:23], s53 offen offset:0 sc1
    v_pk_mul_f32 v[8:9], v[148:149], s[70:71]
    v_pk_mul_f32 v[10:11], v[150:151], s[70:71]
    v_pk_mul_f32 v[12:13], v[164:165], s[70:71]
    v_pk_mul_f32 v[14:15], v[166:167], s[70:71]
    v_exp_f32 v8, v8
    v_exp_f32 v9, v9
    v_exp_f32 v10, v10
    v_exp_f32 v11, v11
    v_exp_f32 v12, v12
    v_exp_f32 v13, v13
    v_exp_f32 v14, v14
    v_exp_f32 v15, v15
    v_pk_add_f32 v[8:9], v[8:9], 1.0 op_sel_hi:[1,0]
    v_pk_add_f32 v[10:11], v[10:11], 1.0 op_sel_hi:[1,0]
    v_pk_add_f32 v[12:13], v[12:13], 1.0 op_sel_hi:[1,0]
    v_pk_add_f32 v[14:15], v[14:15], 1.0 op_sel_hi:[1,0]
    v_rcp_f32 v8, v8
    v_rcp_f32 v9, v9
    v_rcp_f32 v10, v10
    v_rcp_f32 v11, v11
    v_rcp_f32 v12, v12
    v_rcp_f32 v13, v13
    v_rcp_f32 v14, v14
    v_rcp_f32 v15, v15
    v_pk_mul_f32 v[8:9], v[8:9], v[148:149]
    v_pk_mul_f32 v[10:11], v[10:11], v[150:151]
    v_pk_mul_f32 v[12:13], v[12:13], v[164:165]
    v_pk_mul_f32 v[14:15], v[14:15], v[166:167]
    v_cvt_pk_bf16_f32 v148, v8, v9
    v_cvt_pk_bf16_f32 v149, v10, v11
    v_cvt_pk_bf16_f32 v150, v12, v13
    v_cvt_pk_bf16_f32 v151, v14, v15
    buffer_store_dwordx4 v[148:151], v4, s[20:23], s53 offen offset:1024 sc1
    v_pk_mul_f32 v[8:9], v[152:153], s[70:71]
    v_pk_mul_f32 v[10:11], v[154:155], s[70:71]
    v_pk_mul_f32 v[12:13], v[168:169], s[70:71]
    v_pk_mul_f32 v[14:15], v[170:171], s[70:71]
    v_exp_f32 v8, v8
    v_exp_f32 v9, v9
    v_exp_f32 v10, v10
    v_exp_f32 v11, v11
    v_exp_f32 v12, v12
    v_exp_f32 v13, v13
    v_exp_f32 v14, v14
    v_exp_f32 v15, v15
    v_pk_add_f32 v[8:9], v[8:9], 1.0 op_sel_hi:[1,0]
    v_pk_add_f32 v[10:11], v[10:11], 1.0 op_sel_hi:[1,0]
    v_pk_add_f32 v[12:13], v[12:13], 1.0 op_sel_hi:[1,0]
    v_pk_add_f32 v[14:15], v[14:15], 1.0 op_sel_hi:[1,0]
    v_rcp_f32 v8, v8
    v_rcp_f32 v9, v9
    v_rcp_f32 v10, v10
    v_rcp_f32 v11, v11
    v_rcp_f32 v12, v12
    v_rcp_f32 v13, v13
    v_rcp_f32 v14, v14
    v_rcp_f32 v15, v15
    v_pk_mul_f32 v[8:9], v[8:9], v[152:153]
    v_pk_mul_f32 v[10:11], v[10:11], v[154:155]
    v_pk_mul_f32 v[12:13], v[12:13], v[168:169]
    v_pk_mul_f32 v[14:15], v[14:15], v[170:171]
    v_cvt_pk_bf16_f32 v152, v8, v9
    v_cvt_pk_bf16_f32 v153, v10, v11
    v_cvt_pk_bf16_f32 v154, v12, v13
    v_cvt_pk_bf16_f32 v155, v14, v15
    buffer_store_dwordx4 v[152:155], v4, s[20:23], s55 offen offset:0 sc1
    v_pk_mul_f32 v[8:9], v[156:157], s[70:71]
    v_pk_mul_f32 v[10:11], v[158:159], s[70:71]
    v_pk_mul_f32 v[12:13], v[172:173], s[70:71]
    v_pk_mul_f32 v[14:15], v[174:175], s[70:71]
    v_exp_f32 v8, v8
    v_exp_f32 v9, v9
    v_exp_f32 v10, v10
    v_exp_f32 v11, v11
    v_exp_f32 v12, v12
    v_exp_f32 v13, v13
    v_exp_f32 v14, v14
    v_exp_f32 v15, v15
    v_pk_add_f32 v[8:9], v[8:9], 1.0 op_sel_hi:[1,0]
    v_pk_add_f32 v[10:11], v[10:11], 1.0 op_sel_hi:[1,0]
    v_pk_add_f32 v[12:13], v[12:13], 1.0 op_sel_hi:[1,0]
    v_pk_add_f32 v[14:15], v[14:15], 1.0 op_sel_hi:[1,0]
    v_rcp_f32 v8, v8
    v_rcp_f32 v9, v9
    v_rcp_f32 v10, v10
    v_rcp_f32 v11, v11
    v_rcp_f32 v12, v12
    v_rcp_f32 v13, v13
    v_rcp_f32 v14, v14
    v_rcp_f32 v15, v15
    v_pk_mul_f32 v[8:9], v[8:9], v[156:157]
    v_pk_mul_f32 v[10:11], v[10:11], v[158:159]
    v_pk_mul_f32 v[12:13], v[12:13], v[172:173]
    v_pk_mul_f32 v[14:15], v[14:15], v[174:175]
    v_cvt_pk_bf16_f32 v156, v8, v9
    v_cvt_pk_bf16_f32 v157, v10, v11
    v_cvt_pk_bf16_f32 v158, v12, v13
    v_cvt_pk_bf16_f32 v159, v14, v15
    buffer_store_dwordx4 v[156:159], v4, s[20:23], s55 offen offset:1024 sc1
    v_pk_mul_f32 v[8:9], v[176:177], s[70:71]
    v_pk_mul_f32 v[10:11], v[178:179], s[70:71]
    v_pk_mul_f32 v[12:13], v[192:193], s[70:71]
    v_pk_mul_f32 v[14:15], v[194:195], s[70:71]
    v_exp_f32 v8, v8
    v_exp_f32 v9, v9
    v_exp_f32 v10, v10
    v_exp_f32 v11, v11
    v_exp_f32 v12, v12
    v_exp_f32 v13, v13
    v_exp_f32 v14, v14
    v_exp_f32 v15, v15
    v_pk_add_f32 v[8:9], v[8:9], 1.0 op_sel_hi:[1,0]
    v_pk_add_f32 v[10:11], v[10:11], 1.0 op_sel_hi:[1,0]
    v_pk_add_f32 v[12:13], v[12:13], 1.0 op_sel_hi:[1,0]
    v_pk_add_f32 v[14:15], v[14:15], 1.0 op_sel_hi:[1,0]
    v_rcp_f32 v8, v8
    v_rcp_f32 v9, v9
    v_rcp_f32 v10, v10
    v_rcp_f32 v11, v11
    v_rcp_f32 v12, v12
    v_rcp_f32 v13, v13
    v_rcp_f32 v14, v14
    v_rcp_f32 v15, v15
    v_pk_mul_f32 v[8:9], v[8:9], v[176:177]
    v_pk_mul_f32 v[10:11], v[10:11], v[178:179]
    v_pk_mul_f32 v[12:13], v[12:13], v[192:193]
    v_pk_mul_f32 v[14:15], v[14:15], v[194:195]
    v_cvt_pk_bf16_f32 v176, v8, v9
    v_cvt_pk_bf16_f32 v177, v10, v11
    v_cvt_pk_bf16_f32 v178, v12, v13
    v_cvt_pk_bf16_f32 v179, v14, v15
    buffer_store_dwordx4 v[176:179], v4, s[20:23], s53 offen offset:2048 sc1
    v_pk_mul_f32 v[8:9], v[180:181], s[70:71]
    v_pk_mul_f32 v[10:11], v[182:183], s[70:71]
    v_pk_mul_f32 v[12:13], v[196:197], s[70:71]
    v_pk_mul_f32 v[14:15], v[198:199], s[70:71]
    v_exp_f32 v8, v8
    v_exp_f32 v9, v9
    v_exp_f32 v10, v10
    v_exp_f32 v11, v11
    v_exp_f32 v12, v12
    v_exp_f32 v13, v13
    v_exp_f32 v14, v14
    v_exp_f32 v15, v15
    v_pk_add_f32 v[8:9], v[8:9], 1.0 op_sel_hi:[1,0]
    v_pk_add_f32 v[10:11], v[10:11], 1.0 op_sel_hi:[1,0]
    v_pk_add_f32 v[12:13], v[12:13], 1.0 op_sel_hi:[1,0]
    v_pk_add_f32 v[14:15], v[14:15], 1.0 op_sel_hi:[1,0]
    v_rcp_f32 v8, v8
    v_rcp_f32 v9, v9
    v_rcp_f32 v10, v10
    v_rcp_f32 v11, v11
    v_rcp_f32 v12, v12
    v_rcp_f32 v13, v13
    v_rcp_f32 v14, v14
    v_rcp_f32 v15, v15
    v_pk_mul_f32 v[8:9], v[8:9], v[180:181]
    v_pk_mul_f32 v[10:11], v[10:11], v[182:183]
    v_pk_mul_f32 v[12:13], v[12:13], v[196:197]
    v_pk_mul_f32 v[14:15], v[14:15], v[198:199]
    v_cvt_pk_bf16_f32 v180, v8, v9
    v_cvt_pk_bf16_f32 v181, v10, v11
    v_cvt_pk_bf16_f32 v182, v12, v13
    v_cvt_pk_bf16_f32 v183, v14, v15
    buffer_store_dwordx4 v[180:183], v4, s[20:23], s53 offen offset:3072 sc1
    v_pk_mul_f32 v[8:9], v[184:185], s[70:71]
    v_pk_mul_f32 v[10:11], v[186:187], s[70:71]
    v_pk_mul_f32 v[12:13], v[200:201], s[70:71]
    v_pk_mul_f32 v[14:15], v[202:203], s[70:71]
    v_exp_f32 v8, v8
    v_exp_f32 v9, v9
    v_exp_f32 v10, v10
    v_exp_f32 v11, v11
    v_exp_f32 v12, v12
    v_exp_f32 v13, v13
    v_exp_f32 v14, v14
    v_exp_f32 v15, v15
    v_pk_add_f32 v[8:9], v[8:9], 1.0 op_sel_hi:[1,0]
    v_pk_add_f32 v[10:11], v[10:11], 1.0 op_sel_hi:[1,0]
    v_pk_add_f32 v[12:13], v[12:13], 1.0 op_sel_hi:[1,0]
    v_pk_add_f32 v[14:15], v[14:15], 1.0 op_sel_hi:[1,0]
    v_rcp_f32 v8, v8
    v_rcp_f32 v9, v9
    v_rcp_f32 v10, v10
    v_rcp_f32 v11, v11
    v_rcp_f32 v12, v12
    v_rcp_f32 v13, v13
    v_rcp_f32 v14, v14
    v_rcp_f32 v15, v15
    v_pk_mul_f32 v[8:9], v[8:9], v[184:185]
    v_pk_mul_f32 v[10:11], v[10:11], v[186:187]
    v_pk_mul_f32 v[12:13], v[12:13], v[200:201]
    v_pk_mul_f32 v[14:15], v[14:15], v[202:203]
    v_cvt_pk_bf16_f32 v184, v8, v9
    v_cvt_pk_bf16_f32 v185, v10, v11
    v_cvt_pk_bf16_f32 v186, v12, v13
    v_cvt_pk_bf16_f32 v187, v14, v15
    buffer_store_dwordx4 v[184:187], v4, s[20:23], s55 offen offset:2048 sc1
    v_pk_mul_f32 v[8:9], v[188:189], s[70:71]
    v_pk_mul_f32 v[10:11], v[190:191], s[70:71]
    v_pk_mul_f32 v[12:13], v[204:205], s[70:71]
    v_pk_mul_f32 v[14:15], v[206:207], s[70:71]
    v_exp_f32 v8, v8
    v_exp_f32 v9, v9
    v_exp_f32 v10, v10
    v_exp_f32 v11, v11
    v_exp_f32 v12, v12
    v_exp_f32 v13, v13
    v_exp_f32 v14, v14
    v_exp_f32 v15, v15
    v_pk_add_f32 v[8:9], v[8:9], 1.0 op_sel_hi:[1,0]
    v_pk_add_f32 v[10:11], v[10:11], 1.0 op_sel_hi:[1,0]
    v_pk_add_f32 v[12:13], v[12:13], 1.0 op_sel_hi:[1,0]
    v_pk_add_f32 v[14:15], v[14:15], 1.0 op_sel_hi:[1,0]
    v_rcp_f32 v8, v8
    v_rcp_f32 v9, v9
    v_rcp_f32 v10, v10
    v_rcp_f32 v11, v11
    v_rcp_f32 v12, v12
    v_rcp_f32 v13, v13
    v_rcp_f32 v14, v14
    v_rcp_f32 v15, v15
    v_pk_mul_f32 v[8:9], v[8:9], v[188:189]
    v_pk_mul_f32 v[10:11], v[10:11], v[190:191]
    v_pk_mul_f32 v[12:13], v[12:13], v[204:205]
    v_pk_mul_f32 v[14:15], v[14:15], v[206:207]
    v_cvt_pk_bf16_f32 v188, v8, v9
    v_cvt_pk_bf16_f32 v189, v10, v11
    v_cvt_pk_bf16_f32 v190, v12, v13
    v_cvt_pk_bf16_f32 v191, v14, v15
    buffer_store_dwordx4 v[188:191], v4, s[20:23], s55 offen offset:3072 sc1
    v_pk_mul_f32 v[8:9], v[208:209], s[70:71]
    v_pk_mul_f32 v[10:11], v[210:211], s[70:71]
    v_pk_mul_f32 v[12:13], v[224:225], s[70:71]
    v_pk_mul_f32 v[14:15], v[226:227], s[70:71]
    v_exp_f32 v8, v8
    v_exp_f32 v9, v9
    v_exp_f32 v10, v10
    v_exp_f32 v11, v11
    v_exp_f32 v12, v12
    v_exp_f32 v13, v13
    v_exp_f32 v14, v14
    v_exp_f32 v15, v15
    v_pk_add_f32 v[8:9], v[8:9], 1.0 op_sel_hi:[1,0]
    v_pk_add_f32 v[10:11], v[10:11], 1.0 op_sel_hi:[1,0]
    v_pk_add_f32 v[12:13], v[12:13], 1.0 op_sel_hi:[1,0]
    v_pk_add_f32 v[14:15], v[14:15], 1.0 op_sel_hi:[1,0]
    v_rcp_f32 v8, v8
    v_rcp_f32 v9, v9
    v_rcp_f32 v10, v10
    v_rcp_f32 v11, v11
    v_rcp_f32 v12, v12
    v_rcp_f32 v13, v13
    v_rcp_f32 v14, v14
    v_rcp_f32 v15, v15
    v_pk_mul_f32 v[8:9], v[8:9], v[208:209]
    v_pk_mul_f32 v[10:11], v[10:11], v[210:211]
    v_pk_mul_f32 v[12:13], v[12:13], v[224:225]
    v_pk_mul_f32 v[14:15], v[14:15], v[226:227]
    v_cvt_pk_bf16_f32 v208, v8, v9
    v_cvt_pk_bf16_f32 v209, v10, v11
    v_cvt_pk_bf16_f32 v210, v12, v13
    v_cvt_pk_bf16_f32 v211, v14, v15
    buffer_store_dwordx4 v[208:211], v4, s[20:23], s54 offen offset:0 sc1
    v_pk_mul_f32 v[8:9], v[212:213], s[70:71]
    v_pk_mul_f32 v[10:11], v[214:215], s[70:71]
    v_pk_mul_f32 v[12:13], v[228:229], s[70:71]
    v_pk_mul_f32 v[14:15], v[230:231], s[70:71]
    v_exp_f32 v8, v8
    v_exp_f32 v9, v9
    v_exp_f32 v10, v10
    v_exp_f32 v11, v11
    v_exp_f32 v12, v12
    v_exp_f32 v13, v13
    v_exp_f32 v14, v14
    v_exp_f32 v15, v15
    v_pk_add_f32 v[8:9], v[8:9], 1.0 op_sel_hi:[1,0]
    v_pk_add_f32 v[10:11], v[10:11], 1.0 op_sel_hi:[1,0]
    v_pk_add_f32 v[12:13], v[12:13], 1.0 op_sel_hi:[1,0]
    v_pk_add_f32 v[14:15], v[14:15], 1.0 op_sel_hi:[1,0]
    v_rcp_f32 v8, v8
    v_rcp_f32 v9, v9
    v_rcp_f32 v10, v10
    v_rcp_f32 v11, v11
    v_rcp_f32 v12, v12
    v_rcp_f32 v13, v13
    v_rcp_f32 v14, v14
    v_rcp_f32 v15, v15
    v_pk_mul_f32 v[8:9], v[8:9], v[212:213]
    v_pk_mul_f32 v[10:11], v[10:11], v[214:215]
    v_pk_mul_f32 v[12:13], v[12:13], v[228:229]
    v_pk_mul_f32 v[14:15], v[14:15], v[230:231]
    v_cvt_pk_bf16_f32 v212, v8, v9
    v_cvt_pk_bf16_f32 v213, v10, v11
    v_cvt_pk_bf16_f32 v214, v12, v13
    v_cvt_pk_bf16_f32 v215, v14, v15
    buffer_store_dwordx4 v[212:215], v4, s[20:23], s54 offen offset:1024 sc1
    v_pk_mul_f32 v[8:9], v[216:217], s[70:71]
    v_pk_mul_f32 v[10:11], v[218:219], s[70:71]
    v_pk_mul_f32 v[12:13], v[232:233], s[70:71]
    v_pk_mul_f32 v[14:15], v[234:235], s[70:71]
    v_exp_f32 v8, v8
    v_exp_f32 v9, v9
    v_exp_f32 v10, v10
    v_exp_f32 v11, v11
    v_exp_f32 v12, v12
    v_exp_f32 v13, v13
    v_exp_f32 v14, v14
    v_exp_f32 v15, v15
    v_pk_add_f32 v[8:9], v[8:9], 1.0 op_sel_hi:[1,0]
    v_pk_add_f32 v[10:11], v[10:11], 1.0 op_sel_hi:[1,0]
    v_pk_add_f32 v[12:13], v[12:13], 1.0 op_sel_hi:[1,0]
    v_pk_add_f32 v[14:15], v[14:15], 1.0 op_sel_hi:[1,0]
    v_rcp_f32 v8, v8
    v_rcp_f32 v9, v9
    v_rcp_f32 v10, v10
    v_rcp_f32 v11, v11
    v_rcp_f32 v12, v12
    v_rcp_f32 v13, v13
    v_rcp_f32 v14, v14
    v_rcp_f32 v15, v15
    v_pk_mul_f32 v[8:9], v[8:9], v[216:217]
    v_pk_mul_f32 v[10:11], v[10:11], v[218:219]
    v_pk_mul_f32 v[12:13], v[12:13], v[232:233]
    v_pk_mul_f32 v[14:15], v[14:15], v[234:235]
    v_cvt_pk_bf16_f32 v216, v8, v9
    v_cvt_pk_bf16_f32 v217, v10, v11
    v_cvt_pk_bf16_f32 v218, v12, v13
    v_cvt_pk_bf16_f32 v219, v14, v15
    buffer_store_dwordx4 v[216:219], v4, s[20:23], s56 offen offset:0 sc1
    v_pk_mul_f32 v[8:9], v[220:221], s[70:71]
    v_pk_mul_f32 v[10:11], v[222:223], s[70:71]
    v_pk_mul_f32 v[12:13], v[236:237], s[70:71]
    v_pk_mul_f32 v[14:15], v[238:239], s[70:71]
    v_exp_f32 v8, v8
    v_exp_f32 v9, v9
    v_exp_f32 v10, v10
    v_exp_f32 v11, v11
    v_exp_f32 v12, v12
    v_exp_f32 v13, v13
    v_exp_f32 v14, v14
    v_exp_f32 v15, v15
    v_pk_add_f32 v[8:9], v[8:9], 1.0 op_sel_hi:[1,0]
    v_pk_add_f32 v[10:11], v[10:11], 1.0 op_sel_hi:[1,0]
    v_pk_add_f32 v[12:13], v[12:13], 1.0 op_sel_hi:[1,0]
    v_pk_add_f32 v[14:15], v[14:15], 1.0 op_sel_hi:[1,0]
    v_rcp_f32 v8, v8
    v_rcp_f32 v9, v9
    v_rcp_f32 v10, v10
    v_rcp_f32 v11, v11
    v_rcp_f32 v12, v12
    v_rcp_f32 v13, v13
    v_rcp_f32 v14, v14
    v_rcp_f32 v15, v15
    v_pk_mul_f32 v[8:9], v[8:9], v[220:221]
    v_pk_mul_f32 v[10:11], v[10:11], v[222:223]
    v_pk_mul_f32 v[12:13], v[12:13], v[236:237]
    v_pk_mul_f32 v[14:15], v[14:15], v[238:239]
    v_cvt_pk_bf16_f32 v220, v8, v9
    v_cvt_pk_bf16_f32 v221, v10, v11
    v_cvt_pk_bf16_f32 v222, v12, v13
    v_cvt_pk_bf16_f32 v223, v14, v15
    buffer_store_dwordx4 v[220:223], v4, s[20:23], s56 offen offset:1024 sc1
    v_pk_mul_f32 v[8:9], v[240:241], s[70:71]
    v_pk_mul_f32 v[10:11], v[242:243], s[70:71]
    v_pk_mul_f32 v[12:13], v[248:249], s[70:71]
    v_pk_mul_f32 v[14:15], v[250:251], s[70:71]
    v_exp_f32 v8, v8
    v_exp_f32 v9, v9
    v_exp_f32 v10, v10
    v_exp_f32 v11, v11
    v_exp_f32 v12, v12
    v_exp_f32 v13, v13
    v_exp_f32 v14, v14
    v_exp_f32 v15, v15
    v_pk_add_f32 v[8:9], v[8:9], 1.0 op_sel_hi:[1,0]
    v_pk_add_f32 v[10:11], v[10:11], 1.0 op_sel_hi:[1,0]
    v_pk_add_f32 v[12:13], v[12:13], 1.0 op_sel_hi:[1,0]
    v_pk_add_f32 v[14:15], v[14:15], 1.0 op_sel_hi:[1,0]
    v_rcp_f32 v8, v8
    v_rcp_f32 v9, v9
    v_rcp_f32 v10, v10
    v_rcp_f32 v11, v11
    v_rcp_f32 v12, v12
    v_rcp_f32 v13, v13
    v_rcp_f32 v14, v14
    v_rcp_f32 v15, v15
    v_pk_mul_f32 v[8:9], v[8:9], v[240:241]
    v_pk_mul_f32 v[10:11], v[10:11], v[242:243]
    v_pk_mul_f32 v[12:13], v[12:13], v[248:249]
    v_pk_mul_f32 v[14:15], v[14:15], v[250:251]
    v_cvt_pk_bf16_f32 v240, v8, v9
    v_cvt_pk_bf16_f32 v241, v10, v11
    v_cvt_pk_bf16_f32 v242, v12, v13
    v_cvt_pk_bf16_f32 v243, v14, v15
    buffer_store_dwordx4 v[240:243], v4, s[20:23], s43 offen offset:0 sc1
    v_pk_mul_f32 v[8:9], v[244:245], s[70:71]
    v_pk_mul_f32 v[10:11], v[246:247], s[70:71]
    v_pk_mul_f32 v[12:13], v[252:253], s[70:71]
    v_pk_mul_f32 v[14:15], v[254:255], s[70:71]
    v_exp_f32 v8, v8
    v_exp_f32 v9, v9
    v_exp_f32 v10, v10
    v_exp_f32 v11, v11
    v_exp_f32 v12, v12
    v_exp_f32 v13, v13
    v_exp_f32 v14, v14
    v_exp_f32 v15, v15
    v_pk_add_f32 v[8:9], v[8:9], 1.0 op_sel_hi:[1,0]
    v_pk_add_f32 v[10:11], v[10:11], 1.0 op_sel_hi:[1,0]
    v_pk_add_f32 v[12:13], v[12:13], 1.0 op_sel_hi:[1,0]
    v_pk_add_f32 v[14:15], v[14:15], 1.0 op_sel_hi:[1,0]
    v_rcp_f32 v8, v8
    v_rcp_f32 v9, v9
    v_rcp_f32 v10, v10
    v_rcp_f32 v11, v11
    v_rcp_f32 v12, v12
    v_rcp_f32 v13, v13
    v_rcp_f32 v14, v14
    v_rcp_f32 v15, v15
    v_pk_mul_f32 v[8:9], v[8:9], v[244:245]
    v_pk_mul_f32 v[10:11], v[10:11], v[246:247]
    v_pk_mul_f32 v[12:13], v[12:13], v[252:253]
    v_pk_mul_f32 v[14:15], v[14:15], v[254:255]
    v_cvt_pk_bf16_f32 v244, v8, v9
    v_cvt_pk_bf16_f32 v245, v10, v11
    v_cvt_pk_bf16_f32 v246, v12, v13
    v_cvt_pk_bf16_f32 v247, v14, v15
    buffer_store_dwordx4 v[244:247], v4, s[20:23], s43 offen offset:1024 sc1
L_m_skip_h:
    s_mov_b32 s64, 0x3e0293ee
    s_mov_b32 s65, 0x3e0293ee
    v_pk_mul_f32 v[16:17], v[16:17], s[64:65]
    v_pk_mul_f32 v[18:19], v[18:19], s[64:65]
    v_pk_mul_f32 v[20:21], v[20:21], s[64:65]
    v_pk_mul_f32 v[22:23], v[22:23], s[64:65]
    v_pk_mul_f32 v[24:25], v[24:25], s[64:65]
    v_pk_mul_f32 v[26:27], v[26:27], s[64:65]
    v_pk_mul_f32 v[28:29], v[28:29], s[64:65]
    v_pk_mul_f32 v[30:31], v[30:31], s[64:65]
    v_cvt_pk_bf16_f32 v16, v16, v17
    v_cvt_pk_bf16_f32 v18, v18, v19
    v_cvt_pk_bf16_f32 v20, v20, v21
    v_cvt_pk_bf16_f32 v22, v22, v23
    v_cvt_pk_bf16_f32 v24, v24, v25
    v_cvt_pk_bf16_f32 v26, v26, v27
    v_cvt_pk_bf16_f32 v28, v28, v29
    v_cvt_pk_bf16_f32 v30, v30, v31
    v_accvgpr_write_b32 a160, v16
    v_accvgpr_write_b32 a161, v18
    v_accvgpr_write_b32 a176, v20
    v_accvgpr_write_b32 a177, v22
    v_accvgpr_write_b32 a192, v24
    v_accvgpr_write_b32 a193, v26
    v_accvgpr_write_b32 a208, v28
    v_accvgpr_write_b32 a209, v30
    v_pk_mul_f32 v[32:33], v[32:33], s[64:65]
    v_pk_mul_f32 v[34:35], v[34:35], s[64:65]
    v_pk_mul_f32 v[36:37], v[36:37], s[64:65]
    v_pk_mul_f32 v[38:39], v[38:39], s[64:65]
    v_pk_mul_f32 v[40:41], v[40:41], s[64:65]
    v_pk_mul_f32 v[42:43], v[42:43], s[64:65]
    v_pk_mul_f32 v[44:45], v[44:45], s[64:65]
    v_pk_mul_f32 v[46:47], v[46:47], s[64:65]
    v_cvt_pk_bf16_f32 v32, v32, v33
    v_cvt_pk_bf16_f32 v34, v34, v35
    v_cvt_pk_bf16_f32 v36, v36, v37
    v_cvt_pk_bf16_f32 v38, v38, v39
    v_cvt_pk_bf16_f32 v40, v40, v41
    v_cvt_pk_bf16_f32 v42, v42, v43
    v_cvt_pk_bf16_f32 v44, v44, v45
    v_cvt_pk_bf16_f32 v46, v46, v47
    v_accvgpr_write_b32 a162, v32
    v_accvgpr_write_b32 a163, v34
    v_accvgpr_write_b32 a178, v36
    v_accvgpr_write_b32 a179, v38
    v_accvgpr_write_b32 a194, v40
    v_accvgpr_write_b32 a195, v42
    v_accvgpr_write_b32 a210, v44
    v_accvgpr_write_b32 a211, v46
    v_pk_mul_f32 v[48:49], v[48:49], s[64:65]
    v_pk_mul_f32 v[50:51], v[50:51], s[64:65]
    v_pk_mul_f32 v[52:53], v[52:53], s[64:65]
    v_pk_mul_f32 v[54:55], v[54:55], s[64:65]
    v_pk_mul_f32 v[56:57], v[56:57], s[64:65]
    v_pk_mul_f32 v[58:59], v[58:59], s[64:65]
    v_pk_mul_f32 v[60:61], v[60:61], s[64:65]
    v_pk_mul_f32 v[62:63], v[62:63], s[64:65]
    v_cvt_pk_bf16_f32 v48, v48, v49
    v_cvt_pk_bf16_f32 v50, v50, v51
    v_cvt_pk_bf16_f32 v52, v52, v53
    v_cvt_pk_bf16_f32 v54, v54, v55
    v_cvt_pk_bf16_f32 v56, v56, v57
    v_cvt_pk_bf16_f32 v58, v58, v59
    v_cvt_pk_bf16_f32 v60, v60, v61
    v_cvt_pk_bf16_f32 v62, v62, v63
    v_accvgpr_write_b32 a164, v48
    v_accvgpr_write_b32 a165, v50
    v_accvgpr_write_b32 a180, v52
    v_accvgpr_write_b32 a181, v54
    v_accvgpr_write_b32 a196, v56
    v_accvgpr_write_b32 a197, v58
    v_accvgpr_write_b32 a212, v60
    v_accvgpr_write_b32 a213, v62
    v_pk_mul_f32 v[64:65], v[64:65], s[64:65]
    v_pk_mul_f32 v[66:67], v[66:67], s[64:65]
    v_pk_mul_f32 v[68:69], v[68:69], s[64:65]
    v_pk_mul_f32 v[70:71], v[70:71], s[64:65]
    v_pk_mul_f32 v[72:73], v[72:73], s[64:65]
    v_pk_mul_f32 v[74:75], v[74:75], s[64:65]
    v_pk_mul_f32 v[76:77], v[76:77], s[64:65]
    v_pk_mul_f32 v[78:79], v[78:79], s[64:65]
    v_cvt_pk_bf16_f32 v64, v64, v65
    v_cvt_pk_bf16_f32 v66, v66, v67
    v_cvt_pk_bf16_f32 v68, v68, v69
    v_cvt_pk_bf16_f32 v70, v70, v71
    v_cvt_pk_bf16_f32 v72, v72, v73
    v_cvt_pk_bf16_f32 v74, v74, v75
    v_cvt_pk_bf16_f32 v76, v76, v77
    v_cvt_pk_bf16_f32 v78, v78, v79
    v_accvgpr_write_b32 a166, v64
    v_accvgpr_write_b32 a167, v66
    v_accvgpr_write_b32 a182, v68
    v_accvgpr_write_b32 a183, v70
    v_accvgpr_write_b32 a198, v72
    v_accvgpr_write_b32 a199, v74
    v_accvgpr_write_b32 a214, v76
    v_accvgpr_write_b32 a215, v78
    v_pk_mul_f32 v[80:81], v[80:81], s[64:65]
    v_pk_mul_f32 v[82:83], v[82:83], s[64:65]
    v_pk_mul_f32 v[84:85], v[84:85], s[64:65]
    v_pk_mul_f32 v[86:87], v[86:87], s[64:65]
    v_pk_mul_f32 v[88:89], v[88:89], s[64:65]
    v_pk_mul_f32 v[90:91], v[90:91], s[64:65]
    v_pk_mul_f32 v[92:93], v[92:93], s[64:65]
    v_pk_mul_f32 v[94:95], v[94:95], s[64:65]
    v_cvt_pk_bf16_f32 v80, v80, v81
    v_cvt_pk_bf16_f32 v82, v82, v83
    v_cvt_pk_bf16_f32 v84, v84, v85
    v_cvt_pk_bf16_f32 v86, v86, v87
    v_cvt_pk_bf16_f32 v88, v88, v89
    v_cvt_pk_bf16_f32 v90, v90, v91
    v_cvt_pk_bf16_f32 v92, v92, v93
    v_cvt_pk_bf16_f32 v94, v94, v95
    v_accvgpr_write_b32 a168, v80
    v_accvgpr_write_b32 a169, v82
    v_accvgpr_write_b32 a184, v84
    v_accvgpr_write_b32 a185, v86
    v_accvgpr_write_b32 a200, v88
    v_accvgpr_write_b32 a201, v90
    v_accvgpr_write_b32 a216, v92
    v_accvgpr_write_b32 a217, v94
    v_pk_mul_f32 v[96:97], v[96:97], s[64:65]
    v_pk_mul_f32 v[98:99], v[98:99], s[64:65]
    v_pk_mul_f32 v[100:101], v[100:101], s[64:65]
    v_pk_mul_f32 v[102:103], v[102:103], s[64:65]
    v_pk_mul_f32 v[104:105], v[104:105], s[64:65]
    v_pk_mul_f32 v[106:107], v[106:107], s[64:65]
    v_pk_mul_f32 v[108:109], v[108:109], s[64:65]
    v_pk_mul_f32 v[110:111], v[110:111], s[64:65]
    v_cvt_pk_bf16_f32 v96, v96, v97
    v_cvt_pk_bf16_f32 v98, v98, v99
    v_cvt_pk_bf16_f32 v100, v100, v101
    v_cvt_pk_bf16_f32 v102, v102, v103
    v_cvt_pk_bf16_f32 v104, v104, v105
    v_cvt_pk_bf16_f32 v106, v106, v107
    v_cvt_pk_bf16_f32 v108, v108, v109
    v_cvt_pk_bf16_f32 v110, v110, v111
    v_accvgpr_write_b32 a170, v96
    v_accvgpr_write_b32 a171, v98
    v_accvgpr_write_b32 a186, v100
    v_accvgpr_write_b32 a187, v102
    v_accvgpr_write_b32 a202, v104
    v_accvgpr_write_b32 a203, v106
    v_accvgpr_write_b32 a218, v108
    v_accvgpr_write_b32 a219, v110
    v_pk_mul_f32 v[112:113], v[112:113], s[64:65]
    v_pk_mul_f32 v[114:115], v[114:115], s[64:65]
    v_pk_mul_f32 v[116:117], v[116:117], s[64:65]
    v_pk_mul_f32 v[118:119], v[118:119], s[64:65]
    v_pk_mul_f32 v[120:121], v[120:121], s[64:65]
    v_pk_mul_f32 v[122:123], v[122:123], s[64:65]
    v_pk_mul_f32 v[124:125], v[124:125], s[64:65]
    v_pk_mul_f32 v[126:127], v[126:127], s[64:65]
    v_cvt_pk_bf16_f32 v112, v112, v113
    v_cvt_pk_bf16_f32 v114, v114, v115
    v_cvt_pk_bf16_f32 v116, v116, v117
    v_cvt_pk_bf16_f32 v118, v118, v119
    v_cvt_pk_bf16_f32 v120, v120, v121
    v_cvt_pk_bf16_f32 v122, v122, v123
    v_cvt_pk_bf16_f32 v124, v124, v125
    v_cvt_pk_bf16_f32 v126, v126, v127
    v_accvgpr_write_b32 a172, v112
    v_accvgpr_write_b32 a173, v114
    v_accvgpr_write_b32 a188, v116
    v_accvgpr_write_b32 a189, v118
    v_accvgpr_write_b32 a204, v120
    v_accvgpr_write_b32 a205, v122
    v_accvgpr_write_b32 a220, v124
    v_accvgpr_write_b32 a221, v126
    v_pk_mul_f32 v[128:129], v[128:129], s[64:65]
    v_pk_mul_f32 v[130:131], v[130:131], s[64:65]
    v_pk_mul_f32 v[132:133], v[132:133], s[64:65]
    v_pk_mul_f32 v[134:135], v[134:135], s[64:65]
    v_pk_mul_f32 v[136:137], v[136:137], s[64:65]
    v_pk_mul_f32 v[138:139], v[138:139], s[64:65]
    v_pk_mul_f32 v[140:141], v[140:141], s[64:65]
    v_pk_mul_f32 v[142:143], v[142:143], s[64:65]
    v_cvt_pk_bf16_f32 v128, v128, v129
    v_cvt_pk_bf16_f32 v130, v130, v131
    v_cvt_pk_bf16_f32 v132, v132, v133
    v_cvt_pk_bf16_f32 v134, v134, v135
    v_cvt_pk_bf16_f32 v136, v136, v137
    v_cvt_pk_bf16_f32 v138, v138, v139
    v_cvt_pk_bf16_f32 v140, v140, v141
    v_cvt_pk_bf16_f32 v142, v142, v143
    v_accvgpr_write_b32 a174, v128
    v_accvgpr_write_b32 a175, v130
    v_accvgpr_write_b32 a190, v132
    v_accvgpr_write_b32 a191, v134
    v_accvgpr_write_b32 a206, v136
    v_accvgpr_write_b32 a207, v138
    v_accvgpr_write_b32 a222, v140
    v_accvgpr_write_b32 a223, v142
    v_add_u32 v7, 0x10000, v6
    v_add_u32 v8, 0x20000, v6
    v_mov_b32 v10, 0x3f803f80
    v_mov_b32 v11, 0x3f803f80
    v_mov_b32 v12, 0x3f803f80
    v_mov_b32 v13, 0x3f803f80
    s_mov_b32 s12, s66
    s_and_b32 s13, s67, 0xffff
    s_mov_b32 s14, 0x800000
    s_mov_b32 s15, 0x00020000
    s_mov_b32 s16, s68
    s_and_b32 s17, s69, 0xffff
    s_mov_b32 s18, 0x700000
    s_mov_b32 s19, 0x00020000
    v_lshl_add_u32 v14, v2, 11, v6
    v_mul_u32_u24 v15, 1792, v2
    v_add_u32 v15, v15, v6
    s_lshr_b32 s78, s40, 1
    s_lshl_b32 s78, s78, 2
    s_and_b32 s79, s41, 3
    s_add_u32 s78, s78, s79
    s_and_b32 s79, s36, 1
    s_lshl_b32 s79, s79, 2
    s_bfe_u32 s41, s41, 0x20002
    s_add_u32 s79, s79, s41
    s_lshl_b32 s40, s78, 2
    s_add_u32 s40, s40, s34
    s_lshl_b32 s41, s78, 3
    s_add_u32 s41, s41, s79
    s_lshl_b32 s41, s41, 2
    s_add_u32 s41, s41, s34
    s_lshl_b32 s75, s79, 8
    s_cmp_eq_u32 s51, 0
    s_cselect_b32 s35, 8, 7
    s_cselect_b32 s4, 8, 25
    s_cselect_b32 s24, s12, s16
    s_cselect_b32 s25, s13, s17
    s_cselect_b32 s26, s14, s18
    s_cselect_b32 s46, s44, s45
    s_cselect_b32 s74, s36, 0
    s_cselect_b32 s7, 0x100000, 0
    s_mov_b32 s27, 0x00020000
    s_lshl_b32 s4, s4, 20
    s_lshl_b32 s5, s35, 15
    s_add_u32 s5, s5, 0
    s_mul_i32 s6, s40, s5
    s_add_u32 s4, s4, s6
    s_lshl_b32 s72, s74, 21
    s_add_u32 s72, s72, s7
    s_add_u32 s72, s72, s75
    s_add_u32 s73, s72, 0x10000
    s_lshl_b32 s5, s74, 15
    s_add_u32 s5, s5, s4
    s_mov_b32 s65, 0
    s_lshl_b32 s6, s36, 2
    s_lshl_b32 s6, 15, s6
    s_cmp_eq_u32 s51, 0
    s_cselect_b32 s30, 0x7f000000, s4
    s_lshr_b32 s47, s40, 1
    s_lshl_b32 s47, s47, 7
    s_lshl_b32 s7, s51, 12
    s_add_u32 s47, s47, s7
    s_add_u32 s47, s47, 0x3010000
    s_cmp_eq_u32 s51, 0
    s_cselect_b32 s38, 0, 0xffff
    s_cselect_b32 s39, 0xffff, 0
    v_lshrrev_b32 v16, 5, v1
    v_bfe_u32 v5, v1, 2, 3
    v_bfe_u32 v9, v1, 1, 1
    v_lshrrev_b32 v3, 2, v5
    v_xor_b32 v9, v9, v3
    v_lshl_add_u32 v3, v2, 3, v5
    v_lshlrev_b32 v3, 11, v3
    v_lshl_add_u32 v3, v16, 6, v3
    v_lshl_add_u32 v3, v9, 5, v3
    v_and_b32 v9, 1, v1
    v_lshl_add_u32 v3, v9, 4, v3
    s_mov_b32 s66, s10
    s_mov_b32 s67, s11
    s_and_b32 s78, s75, 0x300
    s_lshl_b32 s79, s51, 20
    s_add_u32 s79, s79, 0x3600000
    s_and_b32 s52, s75, 0x400
    s_lshl_b32 s52, s52, 9
    s_add_u32 s79, s79, s52
    s_cmp_eq_u32 s78, 0x100
    s_cselect_b32 s8, s20, s24
    s_cselect_b32 s9, s21, s25
    s_cselect_b32 s10, s22, s26
    s_cselect_b32 s49, 4, 0
    s_cselect_b32 s52, s79, s75
    s_cselect_b32 s78, -1, 0
    s_mov_b32 s11, 0x00020000
    s_lshr_b32 s3, 0x10000, s49
    s_cmp_eq_u32 s34, 3
    s_cselect_b32 s57, s78, 0
    s_and_b32 s58, s75, 0x400
    s_lshr_b32 s58, s58, 2
    s_add_u32 s58, s58, 0x3016000
    s_cmp_lg_u32 s57, 0
    s_cselect_b32 s58, s58, 0x7f000000
    s_and_b32 s57, s57, 0x00010001
    v_and_b32 v5, 0x7ff, v3
    v_lshrrev_b32 v9, 4, v3
    v_and_b32 v9, 0xffffff80, v9
    v_add_u32 v9, v9, v5
    v_add_u32 v2, 128, v3
    v_mov_b32 v5, s78
    v_bfi_b32 v2, v5, v9, v2
    s_sub_u32 s68, s72, s75
    s_lshr_b32 s68, s68, s49
    s_add_u32 s68, s68, s52
    s_add_u32 s69, s68, s3
    v_and_b32 v5, 31, v1
    v_lshlrev_b32 v5, 2, v5
    ds_read_b128 a[0:3], v6 offset:0
    ds_read_b128 a[4:7], v6 offset:1024
    ds_read_b128 a[8:11], v6 offset:2048
    ds_read_b128 a[12:15], v6 offset:3072
    s_waitcnt lgkmcnt(2)
    v_mfma_f32_16x16x32_bf16 v[32:35], a[0:3], a[160:163], 0
    ds_read_b128 a[16:19], v6 offset:4096
    v_mfma_f32_16x16x32_bf16 v[32:35], a[4:7], a[164:167], v[32:35]
    v_mfma_f32_16x16x32_bf16 v[40:43], a[0:3], a[176:179], 0
    v_mfma_f32_16x16x32_bf16 v[40:43], a[4:7], a[180:183], v[40:43]
    v_mfma_f32_16x16x32_bf16 v[48:51], a[0:3], a[192:195], 0
    ds_read_b128 a[20:23], v6 offset:5120
    v_mfma_f32_16x16x32_bf16 v[48:51], a[4:7], a[196:199], v[48:51]
    v_mfma_f32_16x16x32_bf16 v[56:59], a[0:3], a[208:211], 0
    v_mfma_f32_16x16x32_bf16 v[56:59], a[4:7], a[212:215], v[56:59]
    s_waitcnt lgkmcnt(2)
    v_mfma_f32_16x16x32_bf16 v[32:35], a[8:11], a[168:171], v[32:35]
    ds_read_b128 a[24:27], v6 offset:6144
    v_mfma_f32_16x16x32_bf16 v[32:35], a[12:15], a[172:175], v[32:35]
    v_mfma_f32_16x16x32_bf16 v[40:43], a[8:11], a[184:187], v[40:43]
    v_mfma_f32_16x16x32_bf16 v[40:43], a[12:15], a[188:191], v[40:43]
    v_mfma_f32_16x16x32_bf16 v[48:51], a[8:11], a[200:203], v[48:51]
    ds_read_b128 a[28:31], v6 offset:7168
    v_mfma_f32_16x16x32_bf16 v[48:51], a[12:15], a[204:207], v[48:51]
    v_mfma_f32_16x16x32_bf16 v[56:59], a[8:11], a[216:219], v[56:59]
    v_mfma_f32_16x16x32_bf16 v[56:59], a[12:15], a[220:223], v[56:59]
    s_waitcnt lgkmcnt(2)
    v_mfma_f32_16x16x32_bf16 v[36:39], a[16:19], a[160:163], 0
    ds_read_b128 a[0:3], v6 offset:16384
    v_mfma_f32_16x16x32_bf16 v[36:39], a[20:23], a[164:167], v[36:39]
    v_mfma_f32_16x16x32_bf16 v[44:47], a[16:19], a[176:179], 0
    v_mfma_f32_16x16x32_bf16 v[44:47], a[20:23], a[180:183], v[44:47]
    v_mfma_f32_16x16x32_bf16 v[52:55], a[16:19], a[192:195], 0
    ds_read_b128 a[4:7], v6 offset:17408
    v_mfma_f32_16x16x32_bf16 v[52:55], a[20:23], a[196:199], v[52:55]
    v_mfma_f32_16x16x32_bf16 v[60:63], a[16:19], a[208:211], 0
    v_mfma_f32_16x16x32_bf16 v[60:63], a[20:23], a[212:215], v[60:63]
    s_waitcnt lgkmcnt(2)
    v_mfma_f32_16x16x32_bf16 v[36:39], a[24:27], a[168:171], v[36:39]
    ds_read_b128 a[8:11], v6 offset:18432
    v_mfma_f32_16x16x32_bf16 v[36:39], a[28:31], a[172:175], v[36:39]
    v_mfma_f32_16x16x32_bf16 v[44:47], a[24:27], a[184:187], v[44:47]
    v_mfma_f32_16x16x32_bf16 v[44:47], a[28:31], a[188:191], v[44:47]
    v_mfma_f32_16x16x32_bf16 v[52:55], a[24:27], a[200:203], v[52:55]
    ds_read_b128 a[12:15], v6 offset:19456
    v_mfma_f32_16x16x32_bf16 v[52:55], a[28:31], a[204:207], v[52:55]
    v_mfma_f32_16x16x32_bf16 v[60:63], a[24:27], a[216:219], v[60:63]
    v_mfma_f32_16x16x32_bf16 v[60:63], a[28:31], a[220:223], v[60:63]
    s_nop 7
    v_max3_f32 v20, v32, v33, v34
    v_max3_f32 v20, v20, v35, v36
    v_max3_f32 v20, v20, v37, v38
    v_max_f32 v20, v20, v39
    v_max3_f32 v21, v40, v41, v42
    v_max3_f32 v21, v21, v43, v44
    v_max3_f32 v21, v21, v45, v46
    v_max_f32 v21, v21, v47
    v_max3_f32 v22, v48, v49, v50
    v_max3_f32 v22, v22, v51, v52
    v_max3_f32 v22, v22, v53, v54
    v_max_f32 v22, v22, v55
    v_max3_f32 v23, v56, v57, v58
    v_max3_f32 v23, v23, v59, v60
    v_max3_f32 v23, v23, v61, v62
    v_max_f32 v23, v23, v63
    v_mov_b32 v16, v20
    v_mov_b32 v17, v21
    v_mov_b32 v18, v22
    v_mov_b32 v19, v23
    s_nop 1
    v_permlane16_swap_b32 v20, v16
    v_permlane16_swap_b32 v21, v17
    v_permlane16_swap_b32 v22, v18
    v_permlane16_swap_b32 v23, v19
    s_nop 1
    v_max_f32 v20, v20, v16
    v_max_f32 v21, v21, v17
    v_max_f32 v22, v22, v18
    v_max_f32 v23, v23, v19
    v_mov_b32 v16, v20
    v_mov_b32 v17, v21
    v_mov_b32 v18, v22
    v_mov_b32 v19, v23
    s_nop 1
    v_permlane32_swap_b32 v20, v16
    v_permlane32_swap_b32 v21, v17
    v_permlane32_swap_b32 v22, v18
    v_permlane32_swap_b32 v23, v19
    s_nop 1
    v_max_f32 v20, v20, v16
    v_max_f32 v21, v21, v17
    v_max_f32 v22, v22, v18
    v_max_f32 v23, v23, v19
    v_sub_f32 v128, 0, v20
    v_sub_f32 v129, 0, v20
    v_sub_f32 v130, 0, v20
    v_sub_f32 v131, 0, v20
    v_sub_f32 v132, 0, v21
    v_sub_f32 v133, 0, v21
    v_sub_f32 v134, 0, v21
    v_sub_f32 v135, 0, v21
    v_sub_f32 v136, 0, v22
    v_sub_f32 v137, 0, v22
    v_sub_f32 v138, 0, v22
    v_sub_f32 v139, 0, v22
    v_sub_f32 v140, 0, v23
    v_sub_f32 v141, 0, v23
    v_sub_f32 v142, 0, v23
    v_sub_f32 v143, 0, v23
    v_pk_add_f32 v[32:33], v[32:33], v[128:129]
    v_pk_add_f32 v[34:35], v[34:35], v[128:129]
    v_pk_add_f32 v[40:41], v[40:41], v[132:133]
    v_pk_add_f32 v[42:43], v[42:43], v[132:133]
    v_pk_add_f32 v[48:49], v[48:49], v[136:137]
    v_pk_add_f32 v[50:51], v[50:51], v[136:137]
    v_pk_add_f32 v[56:57], v[56:57], v[140:141]
    v_pk_add_f32 v[58:59], v[58:59], v[140:141]
    v_pk_add_f32 v[36:37], v[36:37], v[128:129]
    v_pk_add_f32 v[38:39], v[38:39], v[128:129]
    v_pk_add_f32 v[44:45], v[44:45], v[132:133]
    v_pk_add_f32 v[46:47], v[46:47], v[132:133]
    v_pk_add_f32 v[52:53], v[52:53], v[136:137]
    v_pk_add_f32 v[54:55], v[54:55], v[136:137]
    v_pk_add_f32 v[60:61], v[60:61], v[140:141]
    v_pk_add_f32 v[62:63], v[62:63], v[140:141]
    v_exp_f32 v32, v32
    v_exp_f32 v33, v33
    v_exp_f32 v34, v34
    v_exp_f32 v35, v35
    v_exp_f32 v40, v40
    v_exp_f32 v41, v41
    v_exp_f32 v42, v42
    v_exp_f32 v43, v43
    v_exp_f32 v48, v48
    v_exp_f32 v49, v49
    v_exp_f32 v50, v50
    v_exp_f32 v51, v51
    v_exp_f32 v56, v56
    v_exp_f32 v57, v57
    v_exp_f32 v58, v58
    v_exp_f32 v59, v59
    v_exp_f32 v36, v36
    v_exp_f32 v37, v37
    v_exp_f32 v38, v38
    s_nop 0
    v_cvt_pk_bf16_f32 v96, v32, v33
    v_cvt_pk_bf16_f32 v97, v34, v35
    v_cvt_pk_bf16_f32 v100, v40, v41
    v_cvt_pk_bf16_f32 v101, v42, v43
    v_cvt_pk_bf16_f32 v104, v48, v49
    v_cvt_pk_bf16_f32 v105, v50, v51
    v_cvt_pk_bf16_f32 v108, v56, v57
    v_cvt_pk_bf16_f32 v109, v58, v59
    v_cvt_pk_bf16_f32 v98, v36, v37
    s_waitcnt lgkmcnt(2)
    s_waitcnt vmcnt(0)
    s_barrier
    s_cmp_eq_u32 s51, 0
    s_cbranch_scc0 L_m_nohflag
    v_mov_b32 v9, 1
    s_mov_b64 exec, 1
    buffer_store_dword v9, off, s[20:23], s45 sc1
    s_mov_b64 exec, -1
L_m_nohflag:
    v_mfma_f32_16x16x32_bf16 v[64:67], a[0:3], a[160:163], v[128:131]
    v_exp_f32 v39, v39
    v_mfma_f32_16x16x32_bf16 v[64:67], a[4:7], a[164:167], v[64:67]
    ds_read_b128 a[16:19], v6 offset:20480
    v_cvt_pk_bf16_f32 v99, v38, v39
    v_mfma_f32_16x16x32_bf16 v[72:75], a[0:3], a[176:179], v[132:135]
    v_exp_f32 v44, v44
    v_mfma_f32_16x16x32_bf16 v[72:75], a[4:7], a[180:183], v[72:75]
    buffer_load_dwordx4 a[224:227], v14, s[12:15], s28 offen offset:0
    v_mfma_f32_16x16x32_bf16 v[80:83], a[0:3], a[192:195], v[136:139]
    v_exp_f32 v45, v45
    v_mfma_f32_16x16x32_bf16 v[80:83], a[4:7], a[196:199], v[80:83]
    ds_read_b128 a[20:23], v6 offset:21504
    v_cvt_pk_bf16_f32 v102, v44, v45
    v_mfma_f32_16x16x32_bf16 v[88:91], a[0:3], a[208:211], v[140:143]
    v_exp_f32 v46, v46
    v_mfma_f32_16x16x32_bf16 v[88:91], a[4:7], a[212:215], v[88:91]
    s_waitcnt lgkmcnt(2)
    v_mfma_f32_16x16x32_bf16 v[64:67], a[8:11], a[168:171], v[64:67]
    v_exp_f32 v47, v47
    v_mfma_f32_16x16x32_bf16 v[64:67], a[12:15], a[172:175], v[64:67]
    ds_read_b128 a[24:27], v6 offset:22528
    v_cvt_pk_bf16_f32 v103, v46, v47
    v_mfma_f32_16x16x32_bf16 v[72:75], a[8:11], a[184:187], v[72:75]
    v_exp_f32 v52, v52
    v_mfma_f32_16x16x32_bf16 v[72:75], a[12:15], a[188:191], v[72:75]
    buffer_load_dwordx4 a[228:231], v15, s[16:19], s29 offen offset:0
    v_mfma_f32_16x16x32_bf16 v[80:83], a[8:11], a[200:203], v[80:83]
    v_exp_f32 v53, v53
    v_mfma_f32_16x16x32_bf16 v[80:83], a[12:15], a[204:207], v[80:83]
    ds_read_b128 a[28:31], v6 offset:23552
    v_cvt_pk_bf16_f32 v106, v52, v53
    v_mfma_f32_16x16x32_bf16 v[88:91], a[8:11], a[216:219], v[88:91]
    v_exp_f32 v54, v54
    v_mfma_f32_16x16x32_bf16 v[88:91], a[12:15], a[220:223], v[88:91]
    s_waitcnt lgkmcnt(2)
    v_mfma_f32_16x16x32_bf16 v[68:71], a[16:19], a[160:163], v[128:131]
    v_exp_f32 v55, v55
    v_mfma_f32_16x16x32_bf16 v[68:71], a[20:23], a[164:167], v[68:71]
    ds_read_b128 a[0:3], v6 offset:8192
    v_cvt_pk_bf16_f32 v107, v54, v55
    v_mfma_f32_16x16x32_bf16 v[76:79], a[16:19], a[176:179], v[132:135]
    v_exp_f32 v60, v60
    v_mfma_f32_16x16x32_bf16 v[76:79], a[20:23], a[180:183], v[76:79]
    buffer_load_dwordx4 a[232:235], v14, s[12:15], s28 offen offset:1024
    v_mfma_f32_16x16x32_bf16 v[84:87], a[16:19], a[192:195], v[136:139]
    v_exp_f32 v61, v61
    v_mfma_f32_16x16x32_bf16 v[84:87], a[20:23], a[196:199], v[84:87]
    ds_read_b128 a[4:7], v6 offset:9216
    v_cvt_pk_bf16_f32 v110, v60, v61
    v_mfma_f32_16x16x32_bf16 v[92:95], a[16:19], a[208:211], v[140:143]
    v_exp_f32 v62, v62
    v_mfma_f32_16x16x32_bf16 v[92:95], a[20:23], a[212:215], v[92:95]
    s_waitcnt lgkmcnt(2)
    v_mfma_f32_16x16x32_bf16 v[68:71], a[24:27], a[168:171], v[68:71]
    v_exp_f32 v63, v63
    v_mfma_f32_16x16x32_bf16 v[68:71], a[28:31], a[172:175], v[68:71]
    ds_read_b128 a[8:11], v6 offset:10240
    v_cvt_pk_bf16_f32 v111, v62, v63
    v_mfma_f32_16x16x32_bf16 v[76:79], a[24:27], a[184:187], v[76:79]
    v_exp_f32 v64, v64
    v_mfma_f32_16x16x32_bf16 v[76:79], a[28:31], a[188:191], v[76:79]
    buffer_load_dwordx4 a[236:239], v15, s[16:19], s29 offen offset:896
    s_add_u32 s28, s28, 0x400000
    s_add_u32 s29, s29, 0x1c0000
    v_mfma_f32_16x16x32_bf16 v[84:87], a[24:27], a[200:203], v[84:87]
    v_exp_f32 v65, v65
    v_mfma_f32_16x16x32_bf16 v[84:87], a[28:31], a[204:207], v[84:87]
    ds_read_b128 a[12:15], v6 offset:11264
    v_cvt_pk_bf16_f32 v112, v64, v65
    v_mfma_f32_16x16x32_bf16 v[92:95], a[24:27], a[216:219], v[92:95]
    v_exp_f32 v66, v66
    v_mfma_f32_16x16x32_bf16 v[92:95], a[28:31], a[220:223], v[92:95]
    s_waitcnt lgkmcnt(2)
    v_mfma_f32_16x16x32_bf16 a[32:35], a[0:3], v[96:99], 0
    v_exp_f32 v67, v67
    v_mfma_f32_16x16x32_bf16 a[36:39], a[0:3], v[100:103], 0
    ds_read_b128 a[16:19], v6 offset:12288
    v_cvt_pk_bf16_f32 v113, v66, v67
    v_mfma_f32_16x16x32_bf16 a[40:43], a[0:3], v[104:107], 0
    v_exp_f32 v72, v72
    v_mfma_f32_16x16x32_bf16 a[44:47], a[0:3], v[108:111], 0
    s_getpc_b64 s[80:81]
    global_load_dword a255, v0, s[80:81] offset:2048
    v_mfma_f32_16x16x32_bf16 a[48:51], a[4:7], v[96:99], 0
    v_exp_f32 v73, v73
    v_mfma_f32_16x16x32_bf16 a[52:55], a[4:7], v[100:103], 0
    ds_read_b128 a[20:23], v6 offset:13312
    v_cvt_pk_bf16_f32 v116, v72, v73
    v_mfma_f32_16x16x32_bf16 a[56:59], a[4:7], v[104:107], 0
    v_exp_f32 v74, v74
    v_mfma_f32_16x16x32_bf16 a[60:63], a[4:7], v[108:111], 0
    s_waitcnt lgkmcnt(2)
    v_mfma_f32_16x16x32_bf16 a[64:67], a[8:11], v[96:99], 0
    v_exp_f32 v75, v75
    v_mfma_f32_16x16x32_bf16 a[68:71], a[8:11], v[100:103], 0
    ds_read_b128 a[24:27], v6 offset:14336
    v_cvt_pk_bf16_f32 v117, v74, v75
    v_mfma_f32_16x16x32_bf16 a[72:75], a[8:11], v[104:107], 0
    v_exp_f32 v80, v80
    v_mfma_f32_16x16x32_bf16 a[76:79], a[8:11], v[108:111], 0
    v_mfma_f32_16x16x32_bf16 a[80:83], a[12:15], v[96:99], 0
    v_exp_f32 v81, v81
    v_mfma_f32_16x16x32_bf16 a[84:87], a[12:15], v[100:103], 0
    ds_read_b128 a[28:31], v6 offset:15360
    v_cvt_pk_bf16_f32 v120, v80, v81
    v_mfma_f32_16x16x32_bf16 a[88:91], a[12:15], v[104:107], 0
    v_exp_f32 v82, v82
    v_mfma_f32_16x16x32_bf16 a[92:95], a[12:15], v[108:111], 0
    s_waitcnt lgkmcnt(2)
    v_mfma_f32_16x16x32_bf16 a[96:99], a[16:19], v[96:99], 0
    v_exp_f32 v83, v83
    v_mfma_f32_16x16x32_bf16 a[100:103], a[16:19], v[100:103], 0
    ds_read_b128 a[0:3], v6 offset:32768
    v_cvt_pk_bf16_f32 v121, v82, v83
    v_mfma_f32_16x16x32_bf16 a[104:107], a[16:19], v[104:107], 0
    v_exp_f32 v88, v88
    v_mfma_f32_16x16x32_bf16 a[108:111], a[16:19], v[108:111], 0
    v_mfma_f32_16x16x32_bf16 a[112:115], a[20:23], v[96:99], 0
    v_exp_f32 v89, v89
    v_mfma_f32_16x16x32_bf16 a[116:119], a[20:23], v[100:103], 0
    ds_read_b128 a[4:7], v6 offset:33792
    v_cvt_pk_bf16_f32 v124, v88, v89
    v_mfma_f32_16x16x32_bf16 a[120:123], a[20:23], v[104:107], 0
    v_exp_f32 v90, v90
    v_mfma_f32_16x16x32_bf16 a[124:127], a[20:23], v[108:111], 0
    s_waitcnt lgkmcnt(2)
    v_mfma_f32_16x16x32_bf16 a[128:131], a[24:27], v[96:99], 0
    v_exp_f32 v91, v91
    v_mfma_f32_16x16x32_bf16 a[132:135], a[24:27], v[100:103], 0
    ds_read_b128 a[8:11], v6 offset:34816
    v_cvt_pk_bf16_f32 v125, v90, v91
    v_mfma_f32_16x16x32_bf16 a[136:139], a[24:27], v[104:107], 0
    v_exp_f32 v68, v68
    v_mfma_f32_16x16x32_bf16 a[140:143], a[24:27], v[108:111], 0
    v_mfma_f32_16x16x32_bf16 a[144:147], a[28:31], v[96:99], 0
    v_exp_f32 v69, v69
    v_mfma_f32_16x16x32_bf16 a[148:151], a[28:31], v[100:103], 0
    ds_read_b128 a[12:15], v6 offset:35840
    v_cvt_pk_bf16_f32 v114, v68, v69
    v_mfma_f32_16x16x32_bf16 a[152:155], a[28:31], v[104:107], 0
    v_exp_f32 v70, v70
    v_mfma_f32_16x16x32_bf16 a[156:159], a[28:31], v[108:111], 0
    s_waitcnt lgkmcnt(2)
    v_mfma_f32_16x16x32_bf16 v[16:19], v[10:13], v[96:99], 0
    v_exp_f32 v71, v71
    v_mfma_f32_16x16x32_bf16 v[20:23], v[10:13], v[100:103], 0
    v_cvt_pk_bf16_f32 v115, v70, v71
    v_mfma_f32_16x16x32_bf16 v[24:27], v[10:13], v[104:107], 0
    v_exp_f32 v76, v76
    v_mfma_f32_16x16x32_bf16 v[28:31], v[10:13], v[108:111], 0
    v_mfma_f32_16x16x32_bf16 v[32:35], a[0:3], a[160:163], v[128:131]
    v_exp_f32 v77, v77
    v_mfma_f32_16x16x32_bf16 v[32:35], a[4:7], a[164:167], v[32:35]
    ds_read_b128 a[16:19], v6 offset:36864
    v_cvt_pk_bf16_f32 v118, v76, v77
    v_mfma_f32_16x16x32_bf16 v[40:43], a[0:3], a[176:179], v[132:135]
    v_exp_f32 v78, v78
    v_mfma_f32_16x16x32_bf16 v[40:43], a[4:7], a[180:183], v[40:43]
    s_add_u32 m0, s32, 0x18000
    v_mfma_f32_16x16x32_bf16 v[48:51], a[0:3], a[192:195], v[136:139]
    v_exp_f32 v79, v79
    v_mfma_f32_16x16x32_bf16 v[48:51], a[4:7], a[196:199], v[48:51]
    ds_read_b128 a[20:23], v6 offset:37888
    v_cvt_pk_bf16_f32 v119, v78, v79
    v_mfma_f32_16x16x32_bf16 v[56:59], a[0:3], a[208:211], v[140:143]
    v_exp_f32 v84, v84
    v_mfma_f32_16x16x32_bf16 v[56:59], a[4:7], a[212:215], v[56:59]
    s_waitcnt lgkmcnt(2)
    v_mfma_f32_16x16x32_bf16 v[32:35], a[8:11], a[168:171], v[32:35]
    v_exp_f32 v85, v85
    v_mfma_f32_16x16x32_bf16 v[32:35], a[12:15], a[172:175], v[32:35]
    ds_read_b128 a[24:27], v6 offset:38912
    v_cvt_pk_bf16_f32 v122, v84, v85
    v_mfma_f32_16x16x32_bf16 v[40:43], a[8:11], a[184:187], v[40:43]
    v_exp_f32 v86, v86
    v_mfma_f32_16x16x32_bf16 v[40:43], a[12:15], a[188:191], v[40:43]
    buffer_load_dwordx4 v6, s[20:23], s31 offen sc1 lds
    s_add_u32 s31, s31, 4096
    s_add_u32 m0, s32, 0x19000
    v_mfma_f32_16x16x32_bf16 v[48:51], a[8:11], a[200:203], v[48:51]
    v_exp_f32 v87, v87
    v_mfma_f32_16x16x32_bf16 v[48:51], a[12:15], a[204:207], v[48:51]
    ds_read_b128 a[28:31], v6 offset:39936
    v_cvt_pk_bf16_f32 v123, v86, v87
    v_mfma_f32_16x16x32_bf16 v[56:59], a[8:11], a[216:219], v[56:59]
    v_exp_f32 v92, v92
    v_mfma_f32_16x16x32_bf16 v[56:59], a[12:15], a[220:223], v[56:59]
    s_waitcnt lgkmcnt(2)
    v_mfma_f32_16x16x32_bf16 v[36:39], a[16:19], a[160:163], v[128:131]
    v_exp_f32 v93, v93
    v_mfma_f32_16x16x32_bf16 v[36:39], a[20:23], a[164:167], v[36:39]
    ds_read_b128 a[0:3], v6 offset:24576
    v_cvt_pk_bf16_f32 v126, v92, v93
    v_mfma_f32_16x16x32_bf16 v[44:47], a[16:19], a[176:179], v[132:135]
    v_exp_f32 v94, v94
    v_mfma_f32_16x16x32_bf16 v[44:47], a[20:23], a[180:183], v[44:47]
    buffer_load_dwordx4 v6, s[20:23], s31 offen sc1 lds
    s_add_u32 s31, s31, 4096
    s_add_u32 m0, s32, 0x1a000
    v_mfma_f32_16x16x32_bf16 v[52:55], a[16:19], a[192:195], v[136:139]
    v_exp_f32 v95, v95
    v_mfma_f32_16x16x32_bf16 v[52:55], a[20:23], a[196:199], v[52:55]
    ds_read_b128 a[4:7], v6 offset:25600
    v_cvt_pk_bf16_f32 v127, v94, v95
    v_mfma_f32_16x16x32_bf16 v[60:63], a[16:19], a[208:211], v[140:143]
    v_mfma_f32_16x16x32_bf16 v[60:63], a[20:23], a[212:215], v[60:63]
    s_waitcnt lgkmcnt(2)
    v_mfma_f32_16x16x32_bf16 v[36:39], a[24:27], a[168:171], v[36:39]
    v_mfma_f32_16x16x32_bf16 v[36:39], a[28:31], a[172:175], v[36:39]
    ds_read_b128 a[8:11], v6 offset:26624
    v_mfma_f32_16x16x32_bf16 v[44:47], a[24:27], a[184:187], v[44:47]
    v_exp_f32 v32, v32
    v_mfma_f32_16x16x32_bf16 v[44:47], a[28:31], a[188:191], v[44:47]
    buffer_load_dwordx4 v6, s[20:23], s31 offen sc1 lds
    s_add_u32 s31, s31, 4096
    s_add_u32 m0, s32, 0x1b000
    v_mfma_f32_16x16x32_bf16 v[52:55], a[24:27], a[200:203], v[52:55]
    v_exp_f32 v33, v33
    v_mfma_f32_16x16x32_bf16 v[52:55], a[28:31], a[204:207], v[52:55]
    ds_read_b128 a[12:15], v6 offset:27648
    v_cvt_pk_bf16_f32 v96, v32, v33
    v_mfma_f32_16x16x32_bf16 v[60:63], a[24:27], a[216:219], v[60:63]
    v_exp_f32 v34, v34
    v_mfma_f32_16x16x32_bf16 v[60:63], a[28:31], a[220:223], v[60:63]
    s_waitcnt lgkmcnt(2)
    v_mfma_f32_16x16x32_bf16 a[32:35], a[0:3], v[112:115], a[32:35]
    v_exp_f32 v35, v35
    v_mfma_f32_16x16x32_bf16 a[36:39], a[0:3], v[116:119], a[36:39]
    ds_read_b128 a[16:19], v6 offset:28672
    v_cvt_pk_bf16_f32 v97, v34, v35
    v_mfma_f32_16x16x32_bf16 a[40:43], a[0:3], v[120:123], a[40:43]
    v_exp_f32 v40, v40
    v_mfma_f32_16x16x32_bf16 a[44:47], a[0:3], v[124:127], a[44:47]
    buffer_load_dwordx4 v6, s[20:23], s31 offen sc1 lds
    s_add_u32 s31, s31, 4096
    s_add_u32 m0, s32, 0x1c000
    v_mfma_f32_16x16x32_bf16 a[48:51], a[4:7], v[112:115], a[48:51]
    v_exp_f32 v41, v41
    v_mfma_f32_16x16x32_bf16 a[52:55], a[4:7], v[116:119], a[52:55]
    ds_read_b128 a[20:23], v6 offset:29696
    v_cvt_pk_bf16_f32 v100, v40, v41
    v_mfma_f32_16x16x32_bf16 a[56:59], a[4:7], v[120:123], a[56:59]
    v_exp_f32 v42, v42
    v_mfma_f32_16x16x32_bf16 a[60:63], a[4:7], v[124:127], a[60:63]
    s_waitcnt lgkmcnt(2)
    v_mfma_f32_16x16x32_bf16 a[64:67], a[8:11], v[112:115], a[64:67]
    v_exp_f32 v43, v43
    v_mfma_f32_16x16x32_bf16 a[68:71], a[8:11], v[116:119], a[68:71]
    ds_read_b128 a[24:27], v6 offset:30720
    v_cvt_pk_bf16_f32 v101, v42, v43
    v_mfma_f32_16x16x32_bf16 a[72:75], a[8:11], v[120:123], a[72:75]
    v_exp_f32 v48, v48
    v_mfma_f32_16x16x32_bf16 a[76:79], a[8:11], v[124:127], a[76:79]
    buffer_load_dwordx4 v6, s[20:23], s31 offen sc1 lds
    s_add_u32 s31, s31, 4096
    s_add_u32 m0, s32, 0x1d000
    v_mfma_f32_16x16x32_bf16 a[80:83], a[12:15], v[112:115], a[80:83]
    v_exp_f32 v49, v49
    v_mfma_f32_16x16x32_bf16 a[84:87], a[12:15], v[116:119], a[84:87]
    ds_read_b128 a[28:31], v6 offset:31744
    v_cvt_pk_bf16_f32 v104, v48, v49
    v_mfma_f32_16x16x32_bf16 a[88:91], a[12:15], v[120:123], a[88:91]
    v_exp_f32 v50, v50
    v_mfma_f32_16x16x32_bf16 a[92:95], a[12:15], v[124:127], a[92:95]
    s_waitcnt lgkmcnt(2)
    v_mfma_f32_16x16x32_bf16 a[96:99], a[16:19], v[112:115], a[96:99]
    v_exp_f32 v51, v51
    v_mfma_f32_16x16x32_bf16 a[100:103], a[16:19], v[116:119], a[100:103]
    ds_read_b128 a[0:3], v6 offset:49152
    v_cvt_pk_bf16_f32 v105, v50, v51
    v_mfma_f32_16x16x32_bf16 a[104:107], a[16:19], v[120:123], a[104:107]
    v_exp_f32 v56, v56
    v_mfma_f32_16x16x32_bf16 a[108:111], a[16:19], v[124:127], a[108:111]
    buffer_load_dwordx4 v6, s[20:23], s31 offen sc1 lds
    s_add_u32 s31, s31, 4096
    s_add_u32 m0, s32, 0x1e000
    v_mfma_f32_16x16x32_bf16 a[112:115], a[20:23], v[112:115], a[112:115]
    v_exp_f32 v57, v57
    v_mfma_f32_16x16x32_bf16 a[116:119], a[20:23], v[116:119], a[116:119]
    ds_read_b128 a[4:7], v6 offset:50176
    v_cvt_pk_bf16_f32 v108, v56, v57
    v_mfma_f32_16x16x32_bf16 a[120:123], a[20:23], v[120:123], a[120:123]
    v_exp_f32 v58, v58
    v_mfma_f32_16x16x32_bf16 a[124:127], a[20:23], v[124:127], a[124:127]
    s_waitcnt lgkmcnt(2)
    v_mfma_f32_16x16x32_bf16 a[128:131], a[24:27], v[112:115], a[128:131]
    v_exp_f32 v59, v59
    v_mfma_f32_16x16x32_bf16 a[132:135], a[24:27], v[116:119], a[132:135]
    ds_read_b128 a[8:11], v6 offset:51200
    v_cvt_pk_bf16_f32 v109, v58, v59
    v_mfma_f32_16x16x32_bf16 a[136:139], a[24:27], v[120:123], a[136:139]
    v_exp_f32 v36, v36
    v_mfma_f32_16x16x32_bf16 a[140:143], a[24:27], v[124:127], a[140:143]
    buffer_load_dwordx4 v6, s[20:23], s31 offen sc1 lds
    s_add_u32 s31, s31, 4096
    s_add_u32 m0, s32, 0x1f000
    v_mfma_f32_16x16x32_bf16 a[144:147], a[28:31], v[112:115], a[144:147]
    v_exp_f32 v37, v37
    v_mfma_f32_16x16x32_bf16 a[148:151], a[28:31], v[116:119], a[148:151]
    ds_read_b128 a[12:15], v6 offset:52224
    v_cvt_pk_bf16_f32 v98, v36, v37
    v_mfma_f32_16x16x32_bf16 a[152:155], a[28:31], v[120:123], a[152:155]
    v_exp_f32 v38, v38
    v_mfma_f32_16x16x32_bf16 a[156:159], a[28:31], v[124:127], a[156:159]
    s_waitcnt lgkmcnt(2)
    v_mfma_f32_16x16x32_bf16 v[16:19], v[10:13], v[112:115], v[16:19]
    v_exp_f32 v39, v39
    v_mfma_f32_16x16x32_bf16 v[20:23], v[10:13], v[116:119], v[20:23]
    v_cvt_pk_bf16_f32 v99, v38, v39
    v_mfma_f32_16x16x32_bf16 v[24:27], v[10:13], v[120:123], v[24:27]
    v_exp_f32 v44, v44
    v_mfma_f32_16x16x32_bf16 v[28:31], v[10:13], v[124:127], v[28:31]
    buffer_load_dwordx4 v6, s[20:23], s31 offen sc1 lds
    s_add_u32 s31, s31, 4096
    v_mfma_f32_16x16x32_bf16 v[64:67], a[0:3], a[160:163], v[128:131]
    v_exp_f32 v45, v45
    v_mfma_f32_16x16x32_bf16 v[64:67], a[4:7], a[164:167], v[64:67]
    ds_read_b128 a[16:19], v6 offset:53248
    v_cvt_pk_bf16_f32 v102, v44, v45
    v_mfma_f32_16x16x32_bf16 v[72:75], a[0:3], a[176:179], v[132:135]
    v_exp_f32 v46, v46
    v_mfma_f32_16x16x32_bf16 v[72:75], a[4:7], a[180:183], v[72:75]
    s_add_u32 m0, s32, 0x20000
    v_mfma_f32_16x16x32_bf16 v[80:83], a[0:3], a[192:195], v[136:139]
    v_exp_f32 v47, v47
    v_mfma_f32_16x16x32_bf16 v[80:83], a[4:7], a[196:199], v[80:83]
    ds_read_b128 a[20:23], v6 offset:54272
    v_cvt_pk_bf16_f32 v103, v46, v47
    v_mfma_f32_16x16x32_bf16 v[88:91], a[0:3], a[208:211], v[140:143]
    v_exp_f32 v52, v52
    v_mfma_f32_16x16x32_bf16 v[88:91], a[4:7], a[212:215], v[88:91]
    s_waitcnt lgkmcnt(2)
    v_mfma_f32_16x16x32_bf16 v[64:67], a[8:11], a[168:171], v[64:67]
    v_exp_f32 v53, v53
    v_mfma_f32_16x16x32_bf16 v[64:67], a[12:15], a[172:175], v[64:67]
    ds_read_b128 a[24:27], v6 offset:55296
    v_cvt_pk_bf16_f32 v106, v52, v53
    v_mfma_f32_16x16x32_bf16 v[72:75], a[8:11], a[184:187], v[72:75]
    v_exp_f32 v54, v54
    v_mfma_f32_16x16x32_bf16 v[72:75], a[12:15], a[188:191], v[72:75]
    buffer_load_dwordx4 v6, s[20:23], s31 offen sc1 lds
    s_add_u32 s31, s31, 4096
    s_add_u32 m0, s32, 0x21000
    v_mfma_f32_16x16x32_bf16 v[80:83], a[8:11], a[200:203], v[80:83]
    v_exp_f32 v55, v55
    v_mfma_f32_16x16x32_bf16 v[80:83], a[12:15], a[204:207], v[80:83]
    ds_read_b128 a[28:31], v6 offset:56320
    v_cvt_pk_bf16_f32 v107, v54, v55
    v_mfma_f32_16x16x32_bf16 v[88:91], a[8:11], a[216:219], v[88:91]
    v_exp_f32 v60, v60
    v_mfma_f32_16x16x32_bf16 v[88:91], a[12:15], a[220:223], v[88:91]
    s_waitcnt lgkmcnt(2)
    v_mfma_f32_16x16x32_bf16 v[68:71], a[16:19], a[160:163], v[128:131]
    v_exp_f32 v61, v61
    v_mfma_f32_16x16x32_bf16 v[68:71], a[20:23], a[164:167], v[68:71]
    ds_read_b128 a[0:3], v6 offset:40960
    v_cvt_pk_bf16_f32 v110, v60, v61
    v_mfma_f32_16x16x32_bf16 v[76:79], a[16:19], a[176:179], v[132:135]
    v_exp_f32 v62, v62
    v_mfma_f32_16x16x32_bf16 v[76:79], a[20:23], a[180:183], v[76:79]
    buffer_load_dwordx4 v6, s[20:23], s31 offen sc1 lds
    s_add_u32 s31, s31, 4096
    s_add_u32 m0, s32, 0x22000
    v_mfma_f32_16x16x32_bf16 v[84:87], a[16:19], a[192:195], v[136:139]
    v_exp_f32 v63, v63
    v_mfma_f32_16x16x32_bf16 v[84:87], a[20:23], a[196:199], v[84:87]
    ds_read_b128 a[4:7], v6 offset:41984
    v_cvt_pk_bf16_f32 v111, v62, v63
    v_mfma_f32_16x16x32_bf16 v[92:95], a[16:19], a[208:211], v[140:143]
    v_mfma_f32_16x16x32_bf16 v[92:95], a[20:23], a[212:215], v[92:95]
    s_waitcnt lgkmcnt(2)
    v_mfma_f32_16x16x32_bf16 v[68:71], a[24:27], a[168:171], v[68:71]
    v_mfma_f32_16x16x32_bf16 v[68:71], a[28:31], a[172:175], v[68:71]
    ds_read_b128 a[8:11], v6 offset:43008
    v_mfma_f32_16x16x32_bf16 v[76:79], a[24:27], a[184:187], v[76:79]
    v_exp_f32 v64, v64
    v_mfma_f32_16x16x32_bf16 v[76:79], a[28:31], a[188:191], v[76:79]
    buffer_load_dwordx4 v6, s[20:23], s31 offen sc1 lds
    s_add_u32 s31, s31, 4096
    s_add_u32 m0, s32, 0x23000
    v_mfma_f32_16x16x32_bf16 v[84:87], a[24:27], a[200:203], v[84:87]
    v_exp_f32 v65, v65
    v_mfma_f32_16x16x32_bf16 v[84:87], a[28:31], a[204:207], v[84:87]
    ds_read_b128 a[12:15], v6 offset:44032
    v_cvt_pk_bf16_f32 v112, v64, v65
    v_mfma_f32_16x16x32_bf16 v[92:95], a[24:27], a[216:219], v[92:95]
    v_exp_f32 v66, v66
    v_mfma_f32_16x16x32_bf16 v[92:95], a[28:31], a[220:223], v[92:95]
    s_waitcnt lgkmcnt(2)
    v_mfma_f32_16x16x32_bf16 a[32:35], a[0:3], v[96:99], a[32:35]
    v_exp_f32 v67, v67
    v_mfma_f32_16x16x32_bf16 a[36:39], a[0:3], v[100:103], a[36:39]
    ds_read_b128 a[16:19], v6 offset:45056
    v_cvt_pk_bf16_f32 v113, v66, v67
    v_mfma_f32_16x16x32_bf16 a[40:43], a[0:3], v[104:107], a[40:43]
    v_exp_f32 v72, v72
    v_mfma_f32_16x16x32_bf16 a[44:47], a[0:3], v[108:111], a[44:47]
    buffer_load_dwordx4 v6, s[20:23], s31 offen sc1 lds
    s_add_u32 s31, s31, 4096
    s_add_u32 m0, s32, 0x24000
    v_mfma_f32_16x16x32_bf16 a[48:51], a[4:7], v[96:99], a[48:51]
    v_exp_f32 v73, v73
    v_mfma_f32_16x16x32_bf16 a[52:55], a[4:7], v[100:103], a[52:55]
    ds_read_b128 a[20:23], v6 offset:46080
    v_cvt_pk_bf16_f32 v116, v72, v73
    v_mfma_f32_16x16x32_bf16 a[56:59], a[4:7], v[104:107], a[56:59]
    v_exp_f32 v74, v74
    v_mfma_f32_16x16x32_bf16 a[60:63], a[4:7], v[108:111], a[60:63]
    s_waitcnt lgkmcnt(2)
    v_mfma_f32_16x16x32_bf16 a[64:67], a[8:11], v[96:99], a[64:67]
    v_exp_f32 v75, v75
    v_mfma_f32_16x16x32_bf16 a[68:71], a[8:11], v[100:103], a[68:71]
    ds_read_b128 a[24:27], v6 offset:47104
    v_cvt_pk_bf16_f32 v117, v74, v75
    v_mfma_f32_16x16x32_bf16 a[72:75], a[8:11], v[104:107], a[72:75]
    v_exp_f32 v80, v80
    v_mfma_f32_16x16x32_bf16 a[76:79], a[8:11], v[108:111], a[76:79]
    buffer_load_dwordx4 v6, s[20:23], s31 offen sc1 lds
    s_add_u32 s31, s31, 4096
    s_add_u32 m0, s32, 0x25000
    v_mfma_f32_16x16x32_bf16 a[80:83], a[12:15], v[96:99], a[80:83]
    v_exp_f32 v81, v81
    v_mfma_f32_16x16x32_bf16 a[84:87], a[12:15], v[100:103], a[84:87]
    ds_read_b128 a[28:31], v6 offset:48128
    v_cvt_pk_bf16_f32 v120, v80, v81
    v_mfma_f32_16x16x32_bf16 a[88:91], a[12:15], v[104:107], a[88:91]
    v_exp_f32 v82, v82
    v_mfma_f32_16x16x32_bf16 a[92:95], a[12:15], v[108:111], a[92:95]
    s_waitcnt lgkmcnt(2)
    v_mfma_f32_16x16x32_bf16 a[96:99], a[16:19], v[96:99], a[96:99]
    v_exp_f32 v83, v83
    v_mfma_f32_16x16x32_bf16 a[100:103], a[16:19], v[100:103], a[100:103]
    ds_read_b128 a[0:3], v7 offset:0
    v_cvt_pk_bf16_f32 v121, v82, v83
    v_mfma_f32_16x16x32_bf16 a[104:107], a[16:19], v[104:107], a[104:107]
    v_exp_f32 v88, v88
    v_mfma_f32_16x16x32_bf16 a[108:111], a[16:19], v[108:111], a[108:111]
    buffer_load_dwordx4 v6, s[20:23], s31 offen sc1 lds
    s_add_u32 s31, s31, 4096
    s_add_u32 m0, s32, 0x26000
    v_mfma_f32_16x16x32_bf16 a[112:115], a[20:23], v[96:99], a[112:115]
    v_exp_f32 v89, v89
    v_mfma_f32_16x16x32_bf16 a[116:119], a[20:23], v[100:103], a[116:119]
    ds_read_b128 a[4:7], v7 offset:1024
    v_cvt_pk_bf16_f32 v124, v88, v89
    v_mfma_f32_16x16x32_bf16 a[120:123], a[20:23], v[104:107], a[120:123]
    v_exp_f32 v90, v90
    v_mfma_f32_16x16x32_bf16 a[124:127], a[20:23], v[108:111], a[124:127]
    s_waitcnt lgkmcnt(2)
    v_mfma_f32_16x16x32_bf16 a[128:131], a[24:27], v[96:99], a[128:131]
    v_exp_f32 v91, v91
    v_mfma_f32_16x16x32_bf16 a[132:135], a[24:27], v[100:103], a[132:135]
    ds_read_b128 a[8:11], v7 offset:2048
    v_cvt_pk_bf16_f32 v125, v90, v91
    v_mfma_f32_16x16x32_bf16 a[136:139], a[24:27], v[104:107], a[136:139]
    v_exp_f32 v68, v68
    v_mfma_f32_16x16x32_bf16 a[140:143], a[24:27], v[108:111], a[140:143]
    buffer_load_dwordx4 v6, s[20:23], s31 offen sc1 lds
    s_add_u32 s31, s31, 4096
    s_add_u32 m0, s32, 0x27000
    v_mfma_f32_16x16x32_bf16 a[144:147], a[28:31], v[96:99], a[144:147]
    v_exp_f32 v69, v69
    v_mfma_f32_16x16x32_bf16 a[148:151], a[28:31], v[100:103], a[148:151]
    ds_read_b128 a[12:15], v7 offset:3072
    v_cvt_pk_bf16_f32 v114, v68, v69
    v_mfma_f32_16x16x32_bf16 a[152:155], a[28:31], v[104:107], a[152:155]
    v_exp_f32 v70, v70
    v_mfma_f32_16x16x32_bf16 a[156:159], a[28:31], v[108:111], a[156:159]
    s_waitcnt lgkmcnt(2)
    v_mfma_f32_16x16x32_bf16 v[16:19], v[10:13], v[96:99], v[16:19]
    v_exp_f32 v71, v71
    v_mfma_f32_16x16x32_bf16 v[20:23], v[10:13], v[100:103], v[20:23]
    v_cvt_pk_bf16_f32 v115, v70, v71
    v_mfma_f32_16x16x32_bf16 v[24:27], v[10:13], v[104:107], v[24:27]
    v_exp_f32 v76, v76
    v_mfma_f32_16x16x32_bf16 v[28:31], v[10:13], v[108:111], v[28:31]
    buffer_load_dwordx4 v6, s[20:23], s31 offen sc1 lds
    s_add_u32 s31, s31, 4096
    v_mfma_f32_16x16x32_bf16 v[32:35], a[0:3], a[160:163], v[128:131]
    v_exp_f32 v77, v77
    v_mfma_f32_16x16x32_bf16 v[32:35], a[4:7], a[164:167], v[32:35]
    ds_read_b128 a[16:19], v7 offset:4096
    v_cvt_pk_bf16_f32 v118, v76, v77
    v_mfma_f32_16x16x32_bf16 v[40:43], a[0:3], a[176:179], v[132:135]
    v_exp_f32 v78, v78
    v_mfma_f32_16x16x32_bf16 v[40:43], a[4:7], a[180:183], v[40:43]
    buffer_load_dwordx4 a[224:227], v14, s[12:15], s28 offen offset:0
    v_mfma_f32_16x16x32_bf16 v[48:51], a[0:3], a[192:195], v[136:139]
    v_exp_f32 v79, v79
    v_mfma_f32_16x16x32_bf16 v[48:51], a[4:7], a[196:199], v[48:51]
    ds_read_b128 a[20:23], v7 offset:5120
    v_cvt_pk_bf16_f32 v119, v78, v79
    v_mfma_f32_16x16x32_bf16 v[56:59], a[0:3], a[208:211], v[140:143]
    v_exp_f32 v84, v84
    v_mfma_f32_16x16x32_bf16 v[56:59], a[4:7], a[212:215], v[56:59]
    s_waitcnt lgkmcnt(2)
    v_mfma_f32_16x16x32_bf16 v[32:35], a[8:11], a[168:171], v[32:35]
    v_exp_f32 v85, v85
    v_mfma_f32_16x16x32_bf16 v[32:35], a[12:15], a[172:175], v[32:35]
    ds_read_b128 a[24:27], v7 offset:6144
    v_cvt_pk_bf16_f32 v122, v84, v85
    v_mfma_f32_16x16x32_bf16 v[40:43], a[8:11], a[184:187], v[40:43]
    v_exp_f32 v86, v86
    v_mfma_f32_16x16x32_bf16 v[40:43], a[12:15], a[188:191], v[40:43]
    buffer_load_dwordx4 a[228:231], v15, s[16:19], s29 offen offset:0
    v_mfma_f32_16x16x32_bf16 v[48:51], a[8:11], a[200:203], v[48:51]
    v_exp_f32 v87, v87
    v_mfma_f32_16x16x32_bf16 v[48:51], a[12:15], a[204:207], v[48:51]
    ds_read_b128 a[28:31], v7 offset:7168
    v_cvt_pk_bf16_f32 v123, v86, v87
    v_mfma_f32_16x16x32_bf16 v[56:59], a[8:11], a[216:219], v[56:59]
    v_exp_f32 v92, v92
    v_mfma_f32_16x16x32_bf16 v[56:59], a[12:15], a[220:223], v[56:59]
    s_waitcnt lgkmcnt(2)
    v_mfma_f32_16x16x32_bf16 v[36:39], a[16:19], a[160:163], v[128:131]
    v_exp_f32 v93, v93
    v_mfma_f32_16x16x32_bf16 v[36:39], a[20:23], a[164:167], v[36:39]
    ds_read_b128 a[0:3], v6 offset:57344
    v_cvt_pk_bf16_f32 v126, v92, v93
    v_mfma_f32_16x16x32_bf16 v[44:47], a[16:19], a[176:179], v[132:135]
    v_exp_f32 v94, v94
    v_mfma_f32_16x16x32_bf16 v[44:47], a[20:23], a[180:183], v[44:47]
    buffer_load_dwordx4 a[232:235], v14, s[12:15], s28 offen offset:1024
    v_mfma_f32_16x16x32_bf16 v[52:55], a[16:19], a[192:195], v[136:139]
    v_exp_f32 v95, v95
    v_mfma_f32_16x16x32_bf16 v[52:55], a[20:23], a[196:199], v[52:55]
    ds_read_b128 a[4:7], v6 offset:58368
    v_cvt_pk_bf16_f32 v127, v94, v95
    v_mfma_f32_16x16x32_bf16 v[60:63], a[16:19], a[208:211], v[140:143]
    v_mfma_f32_16x16x32_bf16 v[60:63], a[20:23], a[212:215], v[60:63]
    s_waitcnt lgkmcnt(2)
    v_mfma_f32_16x16x32_bf16 v[36:39], a[24:27], a[168:171], v[36:39]
    v_mfma_f32_16x16x32_bf16 v[36:39], a[28:31], a[172:175], v[36:39]
    ds_read_b128 a[8:11], v6 offset:59392
    v_mfma_f32_16x16x32_bf16 v[44:47], a[24:27], a[184:187], v[44:47]
    v_exp_f32 v32, v32
    v_mfma_f32_16x16x32_bf16 v[44:47], a[28:31], a[188:191], v[44:47]
    buffer_load_dwordx4 a[236:239], v15, s[16:19], s29 offen offset:896
    s_sub_u32 s28, s28, 0x500000
    s_add_u32 s29, s29, 0x1c0000
    v_mfma_f32_16x16x32_bf16 v[52:55], a[24:27], a[200:203], v[52:55]
    v_exp_f32 v33, v33
    v_mfma_f32_16x16x32_bf16 v[52:55], a[28:31], a[204:207], v[52:55]
    ds_read_b128 a[12:15], v6 offset:60416
    v_cvt_pk_bf16_f32 v96, v32, v33
    v_mfma_f32_16x16x32_bf16 v[60:63], a[24:27], a[216:219], v[60:63]
    v_exp_f32 v34, v34
    v_mfma_f32_16x16x32_bf16 v[60:63], a[28:31], a[220:223], v[60:63]
    s_waitcnt lgkmcnt(2)
    v_mfma_f32_16x16x32_bf16 a[32:35], a[0:3], v[112:115], a[32:35]
    v_exp_f32 v35, v35
    v_mfma_f32_16x16x32_bf16 a[36:39], a[0:3], v[116:119], a[36:39]
    ds_read_b128 a[16:19], v6 offset:61440
    v_cvt_pk_bf16_f32 v97, v34, v35
    v_mfma_f32_16x16x32_bf16 a[40:43], a[0:3], v[120:123], a[40:43]
    v_exp_f32 v40, v40
    v_mfma_f32_16x16x32_bf16 a[44:47], a[0:3], v[124:127], a[44:47]
    v_mfma_f32_16x16x32_bf16 a[48:51], a[4:7], v[112:115], a[48:51]
    v_exp_f32 v41, v41
    v_mfma_f32_16x16x32_bf16 a[52:55], a[4:7], v[116:119], a[52:55]
    ds_read_b128 a[20:23], v6 offset:62464
    v_cvt_pk_bf16_f32 v100, v40, v41
    v_mfma_f32_16x16x32_bf16 a[56:59], a[4:7], v[120:123], a[56:59]
    v_exp_f32 v42, v42
    v_mfma_f32_16x16x32_bf16 a[60:63], a[4:7], v[124:127], a[60:63]
    s_waitcnt lgkmcnt(2)
    v_mfma_f32_16x16x32_bf16 a[64:67], a[8:11], v[112:115], a[64:67]
    v_exp_f32 v43, v43
    v_mfma_f32_16x16x32_bf16 a[68:71], a[8:11], v[116:119], a[68:71]
    ds_read_b128 a[24:27], v6 offset:63488
    v_cvt_pk_bf16_f32 v101, v42, v43
    v_mfma_f32_16x16x32_bf16 a[72:75], a[8:11], v[120:123], a[72:75]
    v_exp_f32 v48, v48
    v_mfma_f32_16x16x32_bf16 a[76:79], a[8:11], v[124:127], a[76:79]
    v_mfma_f32_16x16x32_bf16 a[80:83], a[12:15], v[112:115], a[80:83]
    v_exp_f32 v49, v49
    v_mfma_f32_16x16x32_bf16 a[84:87], a[12:15], v[116:119], a[84:87]
    ds_read_b128 a[28:31], v6 offset:64512
    v_cvt_pk_bf16_f32 v104, v48, v49
    v_mfma_f32_16x16x32_bf16 a[88:91], a[12:15], v[120:123], a[88:91]
    v_exp_f32 v50, v50
    v_mfma_f32_16x16x32_bf16 a[92:95], a[12:15], v[124:127], a[92:95]
    s_waitcnt lgkmcnt(2)
    v_mfma_f32_16x16x32_bf16 a[96:99], a[16:19], v[112:115], a[96:99]
    v_exp_f32 v51, v51
    v_mfma_f32_16x16x32_bf16 a[100:103], a[16:19], v[116:119], a[100:103]
    ds_read_b128 a[0:3], v7 offset:16384
    v_cvt_pk_bf16_f32 v105, v50, v51
    v_mfma_f32_16x16x32_bf16 a[104:107], a[16:19], v[120:123], a[104:107]
    v_exp_f32 v56, v56
    v_mfma_f32_16x16x32_bf16 a[108:111], a[16:19], v[124:127], a[108:111]
    v_mfma_f32_16x16x32_bf16 a[112:115], a[20:23], v[112:115], a[112:115]
    v_exp_f32 v57, v57
    v_mfma_f32_16x16x32_bf16 a[116:119], a[20:23], v[116:119], a[116:119]
    ds_read_b128 a[4:7], v7 offset:17408
    v_cvt_pk_bf16_f32 v108, v56, v57
    v_mfma_f32_16x16x32_bf16 a[120:123], a[20:23], v[120:123], a[120:123]
    v_exp_f32 v58, v58
    v_mfma_f32_16x16x32_bf16 a[124:127], a[20:23], v[124:127], a[124:127]
    s_waitcnt lgkmcnt(2)
    v_mfma_f32_16x16x32_bf16 a[128:131], a[24:27], v[112:115], a[128:131]
    v_exp_f32 v59, v59
    v_mfma_f32_16x16x32_bf16 a[132:135], a[24:27], v[116:119], a[132:135]
    ds_read_b128 a[8:11], v7 offset:18432
    v_cvt_pk_bf16_f32 v109, v58, v59
    v_mfma_f32_16x16x32_bf16 a[136:139], a[24:27], v[120:123], a[136:139]
    v_exp_f32 v36, v36
    v_mfma_f32_16x16x32_bf16 a[140:143], a[24:27], v[124:127], a[140:143]
    v_mfma_f32_16x16x32_bf16 a[144:147], a[28:31], v[112:115], a[144:147]
    v_exp_f32 v37, v37
    v_mfma_f32_16x16x32_bf16 a[148:151], a[28:31], v[116:119], a[148:151]
    ds_read_b128 a[12:15], v7 offset:19456
    v_cvt_pk_bf16_f32 v98, v36, v37
    v_mfma_f32_16x16x32_bf16 a[152:155], a[28:31], v[120:123], a[152:155]
    v_exp_f32 v38, v38
    v_mfma_f32_16x16x32_bf16 a[156:159], a[28:31], v[124:127], a[156:159]
    s_waitcnt lgkmcnt(2)
    v_mfma_f32_16x16x32_bf16 v[16:19], v[10:13], v[112:115], v[16:19]
    v_exp_f32 v39, v39
    v_mfma_f32_16x16x32_bf16 v[20:23], v[10:13], v[116:119], v[20:23]
    v_cvt_pk_bf16_f32 v99, v38, v39
    v_mfma_f32_16x16x32_bf16 v[24:27], v[10:13], v[120:123], v[24:27]
    v_exp_f32 v44, v44
    v_mfma_f32_16x16x32_bf16 v[28:31], v[10:13], v[124:127], v[28:31]
    s_waitcnt vmcnt(4)
    s_barrier
    v_mfma_f32_16x16x32_bf16 v[64:67], a[0:3], a[160:163], v[128:131]
    v_exp_f32 v45, v45
    v_mfma_f32_16x16x32_bf16 v[64:67], a[4:7], a[164:167], v[64:67]
    ds_read_b128 a[16:19], v7 offset:20480
    v_cvt_pk_bf16_f32 v102, v44, v45
    v_mfma_f32_16x16x32_bf16 v[72:75], a[0:3], a[176:179], v[132:135]
    v_exp_f32 v46, v46
    v_mfma_f32_16x16x32_bf16 v[72:75], a[4:7], a[180:183], v[72:75]
    v_lshrrev_b32 v9, 2, v6
    buffer_load_dword v9, v9, s[20:23], s58 offen sc1
    v_mfma_f32_16x16x32_bf16 v[80:83], a[0:3], a[192:195], v[136:139]
    v_exp_f32 v47, v47
    v_mfma_f32_16x16x32_bf16 v[80:83], a[4:7], a[196:199], v[80:83]
    ds_read_b128 a[20:23], v7 offset:21504
    v_cvt_pk_bf16_f32 v103, v46, v47
    v_mfma_f32_16x16x32_bf16 v[88:91], a[0:3], a[208:211], v[140:143]
    v_exp_f32 v52, v52
    v_mfma_f32_16x16x32_bf16 v[88:91], a[4:7], a[212:215], v[88:91]
    s_waitcnt lgkmcnt(2)
    v_mfma_f32_16x16x32_bf16 v[64:67], a[8:11], a[168:171], v[64:67]
    v_exp_f32 v53, v53
    v_mfma_f32_16x16x32_bf16 v[64:67], a[12:15], a[172:175], v[64:67]
    ds_read_b128 a[24:27], v7 offset:22528
    v_cvt_pk_bf16_f32 v106, v52, v53
    v_mfma_f32_16x16x32_bf16 v[72:75], a[8:11], a[184:187], v[72:75]
    v_exp_f32 v54, v54
    v_mfma_f32_16x16x32_bf16 v[72:75], a[12:15], a[188:191], v[72:75]
    v_mfma_f32_16x16x32_bf16 v[80:83], a[8:11], a[200:203], v[80:83]
    v_exp_f32 v55, v55
    v_mfma_f32_16x16x32_bf16 v[80:83], a[12:15], a[204:207], v[80:83]
    ds_read_b128 a[28:31], v7 offset:23552
    v_cvt_pk_bf16_f32 v107, v54, v55
    v_mfma_f32_16x16x32_bf16 v[88:91], a[8:11], a[216:219], v[88:91]
    v_exp_f32 v60, v60
    v_mfma_f32_16x16x32_bf16 v[88:91], a[12:15], a[220:223], v[88:91]
    s_waitcnt lgkmcnt(2)
    v_mfma_f32_16x16x32_bf16 v[68:71], a[16:19], a[160:163], v[128:131]
    v_exp_f32 v61, v61
    v_mfma_f32_16x16x32_bf16 v[68:71], a[20:23], a[164:167], v[68:71]
    ds_read_b128 a[0:3], v7 offset:8192
    v_cvt_pk_bf16_f32 v110, v60, v61
    v_mfma_f32_16x16x32_bf16 v[76:79], a[16:19], a[176:179], v[132:135]
    v_exp_f32 v62, v62
    v_mfma_f32_16x16x32_bf16 v[76:79], a[20:23], a[180:183], v[76:79]
    v_mfma_f32_16x16x32_bf16 v[84:87], a[16:19], a[192:195], v[136:139]
    v_exp_f32 v63, v63
    v_mfma_f32_16x16x32_bf16 v[84:87], a[20:23], a[196:199], v[84:87]
    ds_read_b128 a[4:7], v7 offset:9216
    v_cvt_pk_bf16_f32 v111, v62, v63
    v_mfma_f32_16x16x32_bf16 v[92:95], a[16:19], a[208:211], v[140:143]
    v_mfma_f32_16x16x32_bf16 v[92:95], a[20:23], a[212:215], v[92:95]
    s_waitcnt lgkmcnt(2)
    v_mfma_f32_16x16x32_bf16 v[68:71], a[24:27], a[168:171], v[68:71]
    v_mfma_f32_16x16x32_bf16 v[68:71], a[28:31], a[172:175], v[68:71]
    ds_read_b128 a[8:11], v7 offset:10240
    v_mfma_f32_16x16x32_bf16 v[76:79], a[24:27], a[184:187], v[76:79]
    v_exp_f32 v64, v64
    v_mfma_f32_16x16x32_bf16 v[76:79], a[28:31], a[188:191], v[76:79]
    v_mfma_f32_16x16x32_bf16 v[84:87], a[24:27], a[200:203], v[84:87]
    v_exp_f32 v65, v65
    v_mfma_f32_16x16x32_bf16 v[84:87], a[28:31], a[204:207], v[84:87]
    ds_read_b128 a[12:15], v7 offset:11264
    v_cvt_pk_bf16_f32 v112, v64, v65
    v_mfma_f32_16x16x32_bf16 v[92:95], a[24:27], a[216:219], v[92:95]
    v_exp_f32 v66, v66
    v_mfma_f32_16x16x32_bf16 v[92:95], a[28:31], a[220:223], v[92:95]
    s_waitcnt lgkmcnt(2)
    v_mfma_f32_16x16x32_bf16 a[32:35], a[0:3], v[96:99], a[32:35]
    v_exp_f32 v67, v67
    v_mfma_f32_16x16x32_bf16 a[36:39], a[0:3], v[100:103], a[36:39]
    ds_read_b128 a[16:19], v7 offset:12288
    v_cvt_pk_bf16_f32 v113, v66, v67
    v_mfma_f32_16x16x32_bf16 a[40:43], a[0:3], v[104:107], a[40:43]
    v_exp_f32 v72, v72
    v_mfma_f32_16x16x32_bf16 a[44:47], a[0:3], v[108:111], a[44:47]
    v_mfma_f32_16x16x32_bf16 a[48:51], a[4:7], v[96:99], a[48:51]
    v_exp_f32 v73, v73
    v_mfma_f32_16x16x32_bf16 a[52:55], a[4:7], v[100:103], a[52:55]
    ds_read_b128 a[20:23], v7 offset:13312
    v_cvt_pk_bf16_f32 v116, v72, v73
    v_mfma_f32_16x16x32_bf16 a[56:59], a[4:7], v[104:107], a[56:59]
    v_exp_f32 v74, v74
    v_mfma_f32_16x16x32_bf16 a[60:63], a[4:7], v[108:111], a[60:63]
    s_waitcnt lgkmcnt(2)
    v_mfma_f32_16x16x32_bf16 a[64:67], a[8:11], v[96:99], a[64:67]
    v_exp_f32 v75, v75
    v_mfma_f32_16x16x32_bf16 a[68:71], a[8:11], v[100:103], a[68:71]
    ds_read_b128 a[24:27], v7 offset:14336
    v_cvt_pk_bf16_f32 v117, v74, v75
    v_mfma_f32_16x16x32_bf16 a[72:75], a[8:11], v[104:107], a[72:75]
    v_exp_f32 v80, v80
    v_mfma_f32_16x16x32_bf16 a[76:79], a[8:11], v[108:111], a[76:79]
    v_mfma_f32_16x16x32_bf16 a[80:83], a[12:15], v[96:99], a[80:83]
    v_exp_f32 v81, v81
    v_mfma_f32_16x16x32_bf16 a[84:87], a[12:15], v[100:103], a[84:87]
    ds_read_b128 a[28:31], v7 offset:15360
    v_cvt_pk_bf16_f32 v120, v80, v81
    v_mfma_f32_16x16x32_bf16 a[88:91], a[12:15], v[104:107], a[88:91]
    v_exp_f32 v82, v82
    v_mfma_f32_16x16x32_bf16 a[92:95], a[12:15], v[108:111], a[92:95]
    s_waitcnt lgkmcnt(2)
    v_mfma_f32_16x16x32_bf16 a[96:99], a[16:19], v[96:99], a[96:99]
    v_exp_f32 v83, v83
    v_mfma_f32_16x16x32_bf16 a[100:103], a[16:19], v[100:103], a[100:103]
    ds_read_b128 a[0:3], v7 offset:32768
    v_cvt_pk_bf16_f32 v121, v82, v83
    v_mfma_f32_16x16x32_bf16 a[104:107], a[16:19], v[104:107], a[104:107]
    v_exp_f32 v88, v88
    v_mfma_f32_16x16x32_bf16 a[108:111], a[16:19], v[108:111], a[108:111]
    v_mfma_f32_16x16x32_bf16 a[112:115], a[20:23], v[96:99], a[112:115]
    v_exp_f32 v89, v89
    v_mfma_f32_16x16x32_bf16 a[116:119], a[20:23], v[100:103], a[116:119]
    ds_read_b128 a[4:7], v7 offset:33792
    v_cvt_pk_bf16_f32 v124, v88, v89
    v_mfma_f32_16x16x32_bf16 a[120:123], a[20:23], v[104:107], a[120:123]
    v_exp_f32 v90, v90
    v_mfma_f32_16x16x32_bf16 a[124:127], a[20:23], v[108:111], a[124:127]
    s_waitcnt lgkmcnt(2)
    v_mfma_f32_16x16x32_bf16 a[128:131], a[24:27], v[96:99], a[128:131]
    v_exp_f32 v91, v91
    v_mfma_f32_16x16x32_bf16 a[132:135], a[24:27], v[100:103], a[132:135]
    ds_read_b128 a[8:11], v7 offset:34816
    v_cvt_pk_bf16_f32 v125, v90, v91
    v_mfma_f32_16x16x32_bf16 a[136:139], a[24:27], v[104:107], a[136:139]
    v_exp_f32 v68, v68
    v_mfma_f32_16x16x32_bf16 a[140:143], a[24:27], v[108:111], a[140:143]
    v_mfma_f32_16x16x32_bf16 a[144:147], a[28:31], v[96:99], a[144:147]
    v_exp_f32 v69, v69
    v_mfma_f32_16x16x32_bf16 a[148:151], a[28:31], v[100:103], a[148:151]
    ds_read_b128 a[12:15], v7 offset:35840
    v_cvt_pk_bf16_f32 v114, v68, v69
    v_mfma_f32_16x16x32_bf16 a[152:155], a[28:31], v[104:107], a[152:155]
    v_exp_f32 v70, v70
    v_mfma_f32_16x16x32_bf16 a[156:159], a[28:31], v[108:111], a[156:159]
    s_waitcnt lgkmcnt(2)
    v_mfma_f32_16x16x32_bf16 v[16:19], v[10:13], v[96:99], v[16:19]
    v_exp_f32 v71, v71
    v_mfma_f32_16x16x32_bf16 v[20:23], v[10:13], v[100:103], v[20:23]
    v_cvt_pk_bf16_f32 v115, v70, v71
    v_mfma_f32_16x16x32_bf16 v[24:27], v[10:13], v[104:107], v[24:27]
    v_exp_f32 v76, v76
    v_mfma_f32_16x16x32_bf16 v[28:31], v[10:13], v[108:111], v[28:31]
    v_mfma_f32_16x16x32_bf16 v[32:35], a[0:3], a[160:163], v[128:131]
    v_exp_f32 v77, v77
    v_mfma_f32_16x16x32_bf16 v[32:35], a[4:7], a[164:167], v[32:35]
    ds_read_b128 a[16:19], v7 offset:36864
    v_cvt_pk_bf16_f32 v118, v76, v77
    v_mfma_f32_16x16x32_bf16 v[40:43], a[0:3], a[176:179], v[132:135]
    v_exp_f32 v78, v78
    v_mfma_f32_16x16x32_bf16 v[40:43], a[4:7], a[180:183], v[40:43]
    v_mfma_f32_16x16x32_bf16 v[48:51], a[0:3], a[192:195], v[136:139]
    v_exp_f32 v79, v79
    v_mfma_f32_16x16x32_bf16 v[48:51], a[4:7], a[196:199], v[48:51]
    ds_read_b128 a[20:23], v7 offset:37888
    v_cvt_pk_bf16_f32 v119, v78, v79
    v_mfma_f32_16x16x32_bf16 v[56:59], a[0:3], a[208:211], v[140:143]
    v_exp_f32 v84, v84
    v_mfma_f32_16x16x32_bf16 v[56:59], a[4:7], a[212:215], v[56:59]
    s_waitcnt lgkmcnt(2)
    v_mfma_f32_16x16x32_bf16 v[32:35], a[8:11], a[168:171], v[32:35]
    v_exp_f32 v85, v85
    v_mfma_f32_16x16x32_bf16 v[32:35], a[12:15], a[172:175], v[32:35]
    ds_read_b128 a[24:27], v7 offset:38912
    v_cvt_pk_bf16_f32 v122, v84, v85
    v_mfma_f32_16x16x32_bf16 v[40:43], a[8:11], a[184:187], v[40:43]
    v_exp_f32 v86, v86
    v_mfma_f32_16x16x32_bf16 v[40:43], a[12:15], a[188:191], v[40:43]
    v_mfma_f32_16x16x32_bf16 v[48:51], a[8:11], a[200:203], v[48:51]
    v_exp_f32 v87, v87
    v_mfma_f32_16x16x32_bf16 v[48:51], a[12:15], a[204:207], v[48:51]
    ds_read_b128 a[28:31], v7 offset:39936
    v_cvt_pk_bf16_f32 v123, v86, v87
    v_mfma_f32_16x16x32_bf16 v[56:59], a[8:11], a[216:219], v[56:59]
    v_exp_f32 v92, v92
    v_mfma_f32_16x16x32_bf16 v[56:59], a[12:15], a[220:223], v[56:59]
    s_waitcnt lgkmcnt(2)
    v_mfma_f32_16x16x32_bf16 v[36:39], a[16:19], a[160:163], v[128:131]
    v_exp_f32 v93, v93
    v_mfma_f32_16x16x32_bf16 v[36:39], a[20:23], a[164:167], v[36:39]
    ds_read_b128 a[0:3], v7 offset:24576
    v_cvt_pk_bf16_f32 v126, v92, v93
    v_mfma_f32_16x16x32_bf16 v[44:47], a[16:19], a[176:179], v[132:135]
    v_exp_f32 v94, v94
    v_mfma_f32_16x16x32_bf16 v[44:47], a[20:23], a[180:183], v[44:47]
    v_mfma_f32_16x16x32_bf16 v[52:55], a[16:19], a[192:195], v[136:139]
    v_exp_f32 v95, v95
    v_mfma_f32_16x16x32_bf16 v[52:55], a[20:23], a[196:199], v[52:55]
    ds_read_b128 a[4:7], v7 offset:25600
    v_cvt_pk_bf16_f32 v127, v94, v95
    v_mfma_f32_16x16x32_bf16 v[60:63], a[16:19], a[208:211], v[140:143]
    v_mfma_f32_16x16x32_bf16 v[60:63], a[20:23], a[212:215], v[60:63]
    s_waitcnt lgkmcnt(2)
    v_mfma_f32_16x16x32_bf16 v[36:39], a[24:27], a[168:171], v[36:39]
    v_mfma_f32_16x16x32_bf16 v[36:39], a[28:31], a[172:175], v[36:39]
    ds_read_b128 a[8:11], v7 offset:26624
    v_mfma_f32_16x16x32_bf16 v[44:47], a[24:27], a[184:187], v[44:47]
    v_exp_f32 v32, v32
    v_mfma_f32_16x16x32_bf16 v[44:47], a[28:31], a[188:191], v[44:47]
    v_mfma_f32_16x16x32_bf16 v[52:55], a[24:27], a[200:203], v[52:55]
    v_exp_f32 v33, v33
    v_mfma_f32_16x16x32_bf16 v[52:55], a[28:31], a[204:207], v[52:55]
    ds_read_b128 a[12:15], v7 offset:27648
    v_cvt_pk_bf16_f32 v96, v32, v33
    v_mfma_f32_16x16x32_bf16 v[60:63], a[24:27], a[216:219], v[60:63]
    v_exp_f32 v34, v34
    v_mfma_f32_16x16x32_bf16 v[60:63], a[28:31], a[220:223], v[60:63]
    s_waitcnt lgkmcnt(2)
    v_mfma_f32_16x16x32_bf16 a[32:35], a[0:3], v[112:115], a[32:35]
    v_exp_f32 v35, v35
    v_mfma_f32_16x16x32_bf16 a[36:39], a[0:3], v[116:119], a[36:39]
    ds_read_b128 a[16:19], v7 offset:28672
    v_cvt_pk_bf16_f32 v97, v34, v35
    v_mfma_f32_16x16x32_bf16 a[40:43], a[0:3], v[120:123], a[40:43]
    v_exp_f32 v40, v40
    v_mfma_f32_16x16x32_bf16 a[44:47], a[0:3], v[124:127], a[44:47]
    v_mfma_f32_16x16x32_bf16 a[48:51], a[4:7], v[112:115], a[48:51]
    v_exp_f32 v41, v41
    v_mfma_f32_16x16x32_bf16 a[52:55], a[4:7], v[116:119], a[52:55]
    ds_read_b128 a[20:23], v7 offset:29696
    v_cvt_pk_bf16_f32 v100, v40, v41
    v_mfma_f32_16x16x32_bf16 a[56:59], a[4:7], v[120:123], a[56:59]
    v_exp_f32 v42, v42
    v_mfma_f32_16x16x32_bf16 a[60:63], a[4:7], v[124:127], a[60:63]
    s_waitcnt lgkmcnt(2)
    v_mfma_f32_16x16x32_bf16 a[64:67], a[8:11], v[112:115], a[64:67]
    v_exp_f32 v43, v43
    v_mfma_f32_16x16x32_bf16 a[68:71], a[8:11], v[116:119], a[68:71]
    ds_read_b128 a[24:27], v7 offset:30720
    v_cvt_pk_bf16_f32 v101, v42, v43
    v_mfma_f32_16x16x32_bf16 a[72:75], a[8:11], v[120:123], a[72:75]
    v_exp_f32 v48, v48
    v_mfma_f32_16x16x32_bf16 a[76:79], a[8:11], v[124:127], a[76:79]
    v_mfma_f32_16x16x32_bf16 a[80:83], a[12:15], v[112:115], a[80:83]
    v_exp_f32 v49, v49
    v_mfma_f32_16x16x32_bf16 a[84:87], a[12:15], v[116:119], a[84:87]
    ds_read_b128 a[28:31], v7 offset:31744
    v_cvt_pk_bf16_f32 v104, v48, v49
    v_mfma_f32_16x16x32_bf16 a[88:91], a[12:15], v[120:123], a[88:91]
    v_exp_f32 v50, v50
    v_mfma_f32_16x16x32_bf16 a[92:95], a[12:15], v[124:127], a[92:95]
    s_waitcnt lgkmcnt(2)
    v_mfma_f32_16x16x32_bf16 a[96:99], a[16:19], v[112:115], a[96:99]
    v_exp_f32 v51, v51
    v_mfma_f32_16x16x32_bf16 a[100:103], a[16:19], v[116:119], a[100:103]
    ds_read_b128 a[0:3], v7 offset:49152
    v_cvt_pk_bf16_f32 v105, v50, v51
    v_mfma_f32_16x16x32_bf16 a[104:107], a[16:19], v[120:123], a[104:107]
    v_exp_f32 v56, v56
    v_mfma_f32_16x16x32_bf16 a[108:111], a[16:19], v[124:127], a[108:111]
    v_mfma_f32_16x16x32_bf16 a[112:115], a[20:23], v[112:115], a[112:115]
    v_exp_f32 v57, v57
    v_mfma_f32_16x16x32_bf16 a[116:119], a[20:23], v[116:119], a[116:119]
    ds_read_b128 a[4:7], v7 offset:50176
    v_cvt_pk_bf16_f32 v108, v56, v57
    v_mfma_f32_16x16x32_bf16 a[120:123], a[20:23], v[120:123], a[120:123]
    v_exp_f32 v58, v58
    v_mfma_f32_16x16x32_bf16 a[124:127], a[20:23], v[124:127], a[124:127]
    s_waitcnt lgkmcnt(2)
    v_mfma_f32_16x16x32_bf16 a[128:131], a[24:27], v[112:115], a[128:131]
    v_exp_f32 v59, v59
    v_mfma_f32_16x16x32_bf16 a[132:135], a[24:27], v[116:119], a[132:135]
    ds_read_b128 a[8:11], v7 offset:51200
    v_cvt_pk_bf16_f32 v109, v58, v59
    v_mfma_f32_16x16x32_bf16 a[136:139], a[24:27], v[120:123], a[136:139]
    v_exp_f32 v36, v36
    v_mfma_f32_16x16x32_bf16 a[140:143], a[24:27], v[124:127], a[140:143]
    v_mfma_f32_16x16x32_bf16 a[144:147], a[28:31], v[112:115], a[144:147]
    v_exp_f32 v37, v37
    v_mfma_f32_16x16x32_bf16 a[148:151], a[28:31], v[116:119], a[148:151]
    ds_read_b128 a[12:15], v7 offset:52224
    v_cvt_pk_bf16_f32 v98, v36, v37
    v_mfma_f32_16x16x32_bf16 a[152:155], a[28:31], v[120:123], a[152:155]
    v_exp_f32 v38, v38
    v_mfma_f32_16x16x32_bf16 a[156:159], a[28:31], v[124:127], a[156:159]
    s_waitcnt lgkmcnt(2)
    v_mfma_f32_16x16x32_bf16 v[16:19], v[10:13], v[112:115], v[16:19]
    v_exp_f32 v39, v39
    v_mfma_f32_16x16x32_bf16 v[20:23], v[10:13], v[116:119], v[20:23]
    v_cvt_pk_bf16_f32 v99, v38, v39
    v_mfma_f32_16x16x32_bf16 v[24:27], v[10:13], v[120:123], v[24:27]
    v_exp_f32 v44, v44
    v_mfma_f32_16x16x32_bf16 v[28:31], v[10:13], v[124:127], v[28:31]
    s_waitcnt vmcnt(0)
    s_mov_b32 s79, 0x100000
L_m_cw:
    v_cmp_ne_u32 vcc, s57, v9
    s_nop 4
    s_cbranch_vccz L_m_cok
    v_lshrrev_b32 v9, 2, v6
    buffer_load_dword v9, v9, s[20:23], s58 offen sc1
    s_waitcnt vmcnt(0)
    s_sub_u32 s79, s79, 1
    s_cmp_lg_u32 s79, 0
    s_cbranch_scc1 L_m_cw
L_m_cok:
    s_barrier
    v_mfma_f32_16x16x32_bf16 v[64:67], a[0:3], a[160:163], v[128:131]
    v_exp_f32 v45, v45
    v_mfma_f32_16x16x32_bf16 v[64:67], a[4:7], a[164:167], v[64:67]
    ds_read_b128 a[16:19], v7 offset:53248
    v_cvt_pk_bf16_f32 v102, v44, v45
    v_mfma_f32_16x16x32_bf16 v[72:75], a[0:3], a[176:179], v[132:135]
    v_exp_f32 v46, v46
    v_mfma_f32_16x16x32_bf16 v[72:75], a[4:7], a[180:183], v[72:75]
    s_add_u32 m0, s32, 0x0
    v_mfma_f32_16x16x32_bf16 v[80:83], a[0:3], a[192:195], v[136:139]
    v_exp_f32 v47, v47
    v_mfma_f32_16x16x32_bf16 v[80:83], a[4:7], a[196:199], v[80:83]
    ds_read_b128 a[20:23], v7 offset:54272
    v_cvt_pk_bf16_f32 v103, v46, v47
    v_mfma_f32_16x16x32_bf16 v[88:91], a[0:3], a[208:211], v[140:143]
    v_exp_f32 v52, v52
    v_mfma_f32_16x16x32_bf16 v[88:91], a[4:7], a[212:215], v[88:91]
    s_waitcnt lgkmcnt(2)
    v_mfma_f32_16x16x32_bf16 v[64:67], a[8:11], a[168:171], v[64:67]
    v_exp_f32 v53, v53
    v_mfma_f32_16x16x32_bf16 v[64:67], a[12:15], a[172:175], v[64:67]
    ds_read_b128 a[24:27], v7 offset:55296
    v_cvt_pk_bf16_f32 v106, v52, v53
    v_mfma_f32_16x16x32_bf16 v[72:75], a[8:11], a[184:187], v[72:75]
    v_exp_f32 v54, v54
    v_mfma_f32_16x16x32_bf16 v[72:75], a[12:15], a[188:191], v[72:75]
    buffer_load_dwordx4 v6, s[20:23], s31 offen sc1 lds
    s_add_u32 s31, s31, 4096
    s_add_u32 m0, s32, 0x1000
    v_mfma_f32_16x16x32_bf16 v[80:83], a[8:11], a[200:203], v[80:83]
    v_exp_f32 v55, v55
    v_mfma_f32_16x16x32_bf16 v[80:83], a[12:15], a[204:207], v[80:83]
    ds_read_b128 a[28:31], v7 offset:56320
    v_cvt_pk_bf16_f32 v107, v54, v55
    v_mfma_f32_16x16x32_bf16 v[88:91], a[8:11], a[216:219], v[88:91]
    v_exp_f32 v60, v60
    v_mfma_f32_16x16x32_bf16 v[88:91], a[12:15], a[220:223], v[88:91]
    s_waitcnt lgkmcnt(2)
    v_mfma_f32_16x16x32_bf16 v[68:71], a[16:19], a[160:163], v[128:131]
    v_exp_f32 v61, v61
    v_mfma_f32_16x16x32_bf16 v[68:71], a[20:23], a[164:167], v[68:71]
    ds_read_b128 a[0:3], v7 offset:40960
    v_cvt_pk_bf16_f32 v110, v60, v61
    v_mfma_f32_16x16x32_bf16 v[76:79], a[16:19], a[176:179], v[132:135]
    v_exp_f32 v62, v62
    v_mfma_f32_16x16x32_bf16 v[76:79], a[20:23], a[180:183], v[76:79]
    buffer_load_dwordx4 v6, s[20:23], s31 offen sc1 lds
    s_add_u32 s31, s31, 4096
    s_add_u32 m0, s32, 0x2000
    v_mfma_f32_16x16x32_bf16 v[84:87], a[16:19], a[192:195], v[136:139]
    v_exp_f32 v63, v63
    v_mfma_f32_16x16x32_bf16 v[84:87], a[20:23], a[196:199], v[84:87]
    ds_read_b128 a[4:7], v7 offset:41984
    v_cvt_pk_bf16_f32 v111, v62, v63
    v_mfma_f32_16x16x32_bf16 v[92:95], a[16:19], a[208:211], v[140:143]
    v_mfma_f32_16x16x32_bf16 v[92:95], a[20:23], a[212:215], v[92:95]
    s_waitcnt lgkmcnt(2)
    v_mfma_f32_16x16x32_bf16 v[68:71], a[24:27], a[168:171], v[68:71]
    v_mfma_f32_16x16x32_bf16 v[68:71], a[28:31], a[172:175], v[68:71]
    ds_read_b128 a[8:11], v7 offset:43008
    v_mfma_f32_16x16x32_bf16 v[76:79], a[24:27], a[184:187], v[76:79]
    v_exp_f32 v64, v64
    v_mfma_f32_16x16x32_bf16 v[76:79], a[28:31], a[188:191], v[76:79]
    buffer_load_dwordx4 v6, s[20:23], s31 offen sc1 lds
    s_add_u32 s31, s31, 4096
    s_add_u32 m0, s32, 0x3000
    v_mfma_f32_16x16x32_bf16 v[84:87], a[24:27], a[200:203], v[84:87]
    v_exp_f32 v65, v65
    v_mfma_f32_16x16x32_bf16 v[84:87], a[28:31], a[204:207], v[84:87]
    ds_read_b128 a[12:15], v7 offset:44032
    v_cvt_pk_bf16_f32 v112, v64, v65
    v_mfma_f32_16x16x32_bf16 v[92:95], a[24:27], a[216:219], v[92:95]
    v_exp_f32 v66, v66
    v_mfma_f32_16x16x32_bf16 v[92:95], a[28:31], a[220:223], v[92:95]
    s_waitcnt lgkmcnt(2)
    v_mfma_f32_16x16x32_bf16 a[32:35], a[0:3], v[96:99], a[32:35]
    v_exp_f32 v67, v67
    v_mfma_f32_16x16x32_bf16 a[36:39], a[0:3], v[100:103], a[36:39]
    ds_read_b128 a[16:19], v7 offset:45056
    v_cvt_pk_bf16_f32 v113, v66, v67
    v_mfma_f32_16x16x32_bf16 a[40:43], a[0:3], v[104:107], a[40:43]
    v_exp_f32 v72, v72
    v_mfma_f32_16x16x32_bf16 a[44:47], a[0:3], v[108:111], a[44:47]
    buffer_load_dwordx4 v6, s[20:23], s31 offen sc1 lds
    s_add_u32 s31, s31, 4096
    s_add_u32 m0, s32, 0x4000
    v_mfma_f32_16x16x32_bf16 a[48:51], a[4:7], v[96:99], a[48:51]
    v_exp_f32 v73, v73
    v_mfma_f32_16x16x32_bf16 a[52:55], a[4:7], v[100:103], a[52:55]
    ds_read_b128 a[20:23], v7 offset:46080
    v_cvt_pk_bf16_f32 v116, v72, v73
    v_mfma_f32_16x16x32_bf16 a[56:59], a[4:7], v[104:107], a[56:59]
    v_exp_f32 v74, v74
    v_mfma_f32_16x16x32_bf16 a[60:63], a[4:7], v[108:111], a[60:63]
    s_waitcnt lgkmcnt(2)
    v_mfma_f32_16x16x32_bf16 a[64:67], a[8:11], v[96:99], a[64:67]
    v_exp_f32 v75, v75
    v_mfma_f32_16x16x32_bf16 a[68:71], a[8:11], v[100:103], a[68:71]
    ds_read_b128 a[24:27], v7 offset:47104
    v_cvt_pk_bf16_f32 v117, v74, v75
    v_mfma_f32_16x16x32_bf16 a[72:75], a[8:11], v[104:107], a[72:75]
    v_exp_f32 v80, v80
    v_mfma_f32_16x16x32_bf16 a[76:79], a[8:11], v[108:111], a[76:79]
    buffer_load_dwordx4 v6, s[20:23], s31 offen sc1 lds
    s_add_u32 s31, s31, 4096
    s_add_u32 m0, s32, 0x5000
    v_mfma_f32_16x16x32_bf16 a[80:83], a[12:15], v[96:99], a[80:83]
    v_exp_f32 v81, v81
    v_mfma_f32_16x16x32_bf16 a[84:87], a[12:15], v[100:103], a[84:87]
    ds_read_b128 a[28:31], v7 offset:48128
    v_cvt_pk_bf16_f32 v120, v80, v81
    v_mfma_f32_16x16x32_bf16 a[88:91], a[12:15], v[104:107], a[88:91]
    v_exp_f32 v82, v82
    v_mfma_f32_16x16x32_bf16 a[92:95], a[12:15], v[108:111], a[92:95]
    s_waitcnt lgkmcnt(2)
    v_mfma_f32_16x16x32_bf16 a[96:99], a[16:19], v[96:99], a[96:99]
    v_exp_f32 v83, v83
    v_mfma_f32_16x16x32_bf16 a[100:103], a[16:19], v[100:103], a[100:103]
    ds_read_b128 a[0:3], v8 offset:0
    v_cvt_pk_bf16_f32 v121, v82, v83
    v_mfma_f32_16x16x32_bf16 a[104:107], a[16:19], v[104:107], a[104:107]
    v_exp_f32 v88, v88
    v_mfma_f32_16x16x32_bf16 a[108:111], a[16:19], v[108:111], a[108:111]
    buffer_load_dwordx4 v6, s[20:23], s31 offen sc1 lds
    s_add_u32 s31, s31, 4096
    s_add_u32 m0, s32, 0x6000
    v_mfma_f32_16x16x32_bf16 a[112:115], a[20:23], v[96:99], a[112:115]
    v_exp_f32 v89, v89
    v_mfma_f32_16x16x32_bf16 a[116:119], a[20:23], v[100:103], a[116:119]
    ds_read_b128 a[4:7], v8 offset:1024
    v_cvt_pk_bf16_f32 v124, v88, v89
    v_mfma_f32_16x16x32_bf16 a[120:123], a[20:23], v[104:107], a[120:123]
    v_exp_f32 v90, v90
    v_mfma_f32_16x16x32_bf16 a[124:127], a[20:23], v[108:111], a[124:127]
    s_waitcnt lgkmcnt(2)
    v_mfma_f32_16x16x32_bf16 a[128:131], a[24:27], v[96:99], a[128:131]
    v_exp_f32 v91, v91
    v_mfma_f32_16x16x32_bf16 a[132:135], a[24:27], v[100:103], a[132:135]
    ds_read_b128 a[8:11], v8 offset:2048
    v_cvt_pk_bf16_f32 v125, v90, v91
    v_mfma_f32_16x16x32_bf16 a[136:139], a[24:27], v[104:107], a[136:139]
    v_exp_f32 v68, v68
    v_mfma_f32_16x16x32_bf16 a[140:143], a[24:27], v[108:111], a[140:143]
    buffer_load_dwordx4 v6, s[20:23], s31 offen sc1 lds
    s_add_u32 s31, s31, 4096
    s_add_u32 m0, s32, 0x7000
    v_mfma_f32_16x16x32_bf16 a[144:147], a[28:31], v[96:99], a[144:147]
    v_exp_f32 v69, v69
    v_mfma_f32_16x16x32_bf16 a[148:151], a[28:31], v[100:103], a[148:151]
    ds_read_b128 a[12:15], v8 offset:3072
    v_cvt_pk_bf16_f32 v114, v68, v69
    v_mfma_f32_16x16x32_bf16 a[152:155], a[28:31], v[104:107], a[152:155]
    v_exp_f32 v70, v70
    v_mfma_f32_16x16x32_bf16 a[156:159], a[28:31], v[108:111], a[156:159]
    s_waitcnt lgkmcnt(2)
    v_mfma_f32_16x16x32_bf16 v[16:19], v[10:13], v[96:99], v[16:19]
    v_exp_f32 v71, v71
    v_mfma_f32_16x16x32_bf16 v[20:23], v[10:13], v[100:103], v[20:23]
    v_cvt_pk_bf16_f32 v115, v70, v71
    v_mfma_f32_16x16x32_bf16 v[24:27], v[10:13], v[104:107], v[24:27]
    v_exp_f32 v76, v76
    v_mfma_f32_16x16x32_bf16 v[28:31], v[10:13], v[108:111], v[28:31]
    buffer_load_dwordx4 v6, s[20:23], s31 offen sc1 lds
    s_add_u32 s31, s31, 4096
    v_mfma_f32_16x16x32_bf16 v[32:35], a[0:3], a[160:163], v[128:131]
    v_exp_f32 v77, v77
    v_mfma_f32_16x16x32_bf16 v[32:35], a[4:7], a[164:167], v[32:35]
    ds_read_b128 a[16:19], v8 offset:4096
    v_cvt_pk_bf16_f32 v118, v76, v77
    v_mfma_f32_16x16x32_bf16 v[40:43], a[0:3], a[176:179], v[132:135]
    v_exp_f32 v78, v78
    v_mfma_f32_16x16x32_bf16 v[40:43], a[4:7], a[180:183], v[40:43]
    s_add_u32 m0, s32, 0x8000
    v_mfma_f32_16x16x32_bf16 v[48:51], a[0:3], a[192:195], v[136:139]
    v_exp_f32 v79, v79
    v_mfma_f32_16x16x32_bf16 v[48:51], a[4:7], a[196:199], v[48:51]
    ds_read_b128 a[20:23], v8 offset:5120
    v_cvt_pk_bf16_f32 v119, v78, v79
    v_mfma_f32_16x16x32_bf16 v[56:59], a[0:3], a[208:211], v[140:143]
    v_exp_f32 v84, v84
    v_mfma_f32_16x16x32_bf16 v[56:59], a[4:7], a[212:215], v[56:59]
    s_waitcnt lgkmcnt(2)
    v_mfma_f32_16x16x32_bf16 v[32:35], a[8:11], a[168:171], v[32:35]
    v_exp_f32 v85, v85
    v_mfma_f32_16x16x32_bf16 v[32:35], a[12:15], a[172:175], v[32:35]
    ds_read_b128 a[24:27], v8 offset:6144
    v_cvt_pk_bf16_f32 v122, v84, v85
    v_mfma_f32_16x16x32_bf16 v[40:43], a[8:11], a[184:187], v[40:43]
    v_exp_f32 v86, v86
    v_mfma_f32_16x16x32_bf16 v[40:43], a[12:15], a[188:191], v[40:43]
    buffer_load_dwordx4 v6, s[20:23], s31 offen sc1 lds
    s_add_u32 s31, s31, 4096
    s_add_u32 m0, s32, 0x9000
    v_mfma_f32_16x16x32_bf16 v[48:51], a[8:11], a[200:203], v[48:51]
    v_exp_f32 v87, v87
    v_mfma_f32_16x16x32_bf16 v[48:51], a[12:15], a[204:207], v[48:51]
    ds_read_b128 a[28:31], v8 offset:7168
    v_cvt_pk_bf16_f32 v123, v86, v87
    v_mfma_f32_16x16x32_bf16 v[56:59], a[8:11], a[216:219], v[56:59]
    v_exp_f32 v92, v92
    v_mfma_f32_16x16x32_bf16 v[56:59], a[12:15], a[220:223], v[56:59]
    s_waitcnt lgkmcnt(2)
    v_mfma_f32_16x16x32_bf16 v[36:39], a[16:19], a[160:163], v[128:131]
    v_exp_f32 v93, v93
    v_mfma_f32_16x16x32_bf16 v[36:39], a[20:23], a[164:167], v[36:39]
    ds_read_b128 a[0:3], v7 offset:57344
    v_cvt_pk_bf16_f32 v126, v92, v93
    v_mfma_f32_16x16x32_bf16 v[44:47], a[16:19], a[176:179], v[132:135]
    v_exp_f32 v94, v94
    v_mfma_f32_16x16x32_bf16 v[44:47], a[20:23], a[180:183], v[44:47]
    buffer_load_dwordx4 v6, s[20:23], s31 offen sc1 lds
    s_add_u32 s31, s31, 4096
    s_add_u32 m0, s32, 0xa000
    v_mfma_f32_16x16x32_bf16 v[52:55], a[16:19], a[192:195], v[136:139]
    v_exp_f32 v95, v95
    v_mfma_f32_16x16x32_bf16 v[52:55], a[20:23], a[196:199], v[52:55]
    ds_read_b128 a[4:7], v7 offset:58368
    v_cvt_pk_bf16_f32 v127, v94, v95
    v_mfma_f32_16x16x32_bf16 v[60:63], a[16:19], a[208:211], v[140:143]
    v_mfma_f32_16x16x32_bf16 v[60:63], a[20:23], a[212:215], v[60:63]
    s_waitcnt lgkmcnt(2)
    v_mfma_f32_16x16x32_bf16 v[36:39], a[24:27], a[168:171], v[36:39]
    v_mfma_f32_16x16x32_bf16 v[36:39], a[28:31], a[172:175], v[36:39]
    ds_read_b128 a[8:11], v7 offset:59392
    v_mfma_f32_16x16x32_bf16 v[44:47], a[24:27], a[184:187], v[44:47]
    v_exp_f32 v32, v32
    v_mfma_f32_16x16x32_bf16 v[44:47], a[28:31], a[188:191], v[44:47]
    buffer_load_dwordx4 v6, s[20:23], s31 offen sc1 lds
    s_add_u32 s31, s31, 4096
    s_add_u32 m0, s32, 0xb000
    v_mfma_f32_16x16x32_bf16 v[52:55], a[24:27], a[200:203], v[52:55]
    v_exp_f32 v33, v33
    v_mfma_f32_16x16x32_bf16 v[52:55], a[28:31], a[204:207], v[52:55]
    ds_read_b128 a[12:15], v7 offset:60416
    v_cvt_pk_bf16_f32 v96, v32, v33
    v_mfma_f32_16x16x32_bf16 v[60:63], a[24:27], a[216:219], v[60:63]
    v_exp_f32 v34, v34
    v_mfma_f32_16x16x32_bf16 v[60:63], a[28:31], a[220:223], v[60:63]
    s_waitcnt lgkmcnt(2)
    v_mfma_f32_16x16x32_bf16 a[32:35], a[0:3], v[112:115], a[32:35]
    v_exp_f32 v35, v35
    v_mfma_f32_16x16x32_bf16 a[36:39], a[0:3], v[116:119], a[36:39]
    ds_read_b128 a[16:19], v7 offset:61440
    v_cvt_pk_bf16_f32 v97, v34, v35
    v_mfma_f32_16x16x32_bf16 a[40:43], a[0:3], v[120:123], a[40:43]
    v_exp_f32 v40, v40
    v_mfma_f32_16x16x32_bf16 a[44:47], a[0:3], v[124:127], a[44:47]
    buffer_load_dwordx4 v6, s[20:23], s31 offen sc1 lds
    s_add_u32 s31, s31, 4096
    s_add_u32 m0, s32, 0xc000
    v_mfma_f32_16x16x32_bf16 a[48:51], a[4:7], v[112:115], a[48:51]
    v_exp_f32 v41, v41
    v_mfma_f32_16x16x32_bf16 a[52:55], a[4:7], v[116:119], a[52:55]
    ds_read_b128 a[20:23], v7 offset:62464
    v_cvt_pk_bf16_f32 v100, v40, v41
    v_mfma_f32_16x16x32_bf16 a[56:59], a[4:7], v[120:123], a[56:59]
    v_exp_f32 v42, v42
    v_mfma_f32_16x16x32_bf16 a[60:63], a[4:7], v[124:127], a[60:63]
    s_waitcnt lgkmcnt(2)
    v_mfma_f32_16x16x32_bf16 a[64:67], a[8:11], v[112:115], a[64:67]
    v_exp_f32 v43, v43
    v_mfma_f32_16x16x32_bf16 a[68:71], a[8:11], v[116:119], a[68:71]
    ds_read_b128 a[24:27], v7 offset:63488
    v_cvt_pk_bf16_f32 v101, v42, v43
    v_mfma_f32_16x16x32_bf16 a[72:75], a[8:11], v[120:123], a[72:75]
    v_exp_f32 v48, v48
    v_mfma_f32_16x16x32_bf16 a[76:79], a[8:11], v[124:127], a[76:79]
    buffer_load_dwordx4 v6, s[20:23], s31 offen sc1 lds
    s_add_u32 s31, s31, 4096
    s_add_u32 m0, s32, 0xd000
    v_mfma_f32_16x16x32_bf16 a[80:83], a[12:15], v[112:115], a[80:83]
    v_exp_f32 v49, v49
    v_mfma_f32_16x16x32_bf16 a[84:87], a[12:15], v[116:119], a[84:87]
    ds_read_b128 a[28:31], v7 offset:64512
    v_cvt_pk_bf16_f32 v104, v48, v49
    v_mfma_f32_16x16x32_bf16 a[88:91], a[12:15], v[120:123], a[88:91]
    v_exp_f32 v50, v50
    v_mfma_f32_16x16x32_bf16 a[92:95], a[12:15], v[124:127], a[92:95]
    s_waitcnt lgkmcnt(2)
    v_mfma_f32_16x16x32_bf16 a[96:99], a[16:19], v[112:115], a[96:99]
    v_exp_f32 v51, v51
    v_mfma_f32_16x16x32_bf16 a[100:103], a[16:19], v[116:119], a[100:103]
    ds_read_b128 a[0:3], v8 offset:16384
    v_cvt_pk_bf16_f32 v105, v50, v51
    v_mfma_f32_16x16x32_bf16 a[104:107], a[16:19], v[120:123], a[104:107]
    v_exp_f32 v56, v56
    v_mfma_f32_16x16x32_bf16 a[108:111], a[16:19], v[124:127], a[108:111]
    buffer_load_dwordx4 v6, s[20:23], s31 offen sc1 lds
    s_add_u32 s31, s31, 4096
    s_add_u32 m0, s32, 0xe000
    v_mfma_f32_16x16x32_bf16 a[112:115], a[20:23], v[112:115], a[112:115]
    v_exp_f32 v57, v57
    v_mfma_f32_16x16x32_bf16 a[116:119], a[20:23], v[116:119], a[116:119]
    ds_read_b128 a[4:7], v8 offset:17408
    v_cvt_pk_bf16_f32 v108, v56, v57
    v_mfma_f32_16x16x32_bf16 a[120:123], a[20:23], v[120:123], a[120:123]
    v_exp_f32 v58, v58
    v_mfma_f32_16x16x32_bf16 a[124:127], a[20:23], v[124:127], a[124:127]
    s_waitcnt lgkmcnt(2)
    v_mfma_f32_16x16x32_bf16 a[128:131], a[24:27], v[112:115], a[128:131]
    v_exp_f32 v59, v59
    v_mfma_f32_16x16x32_bf16 a[132:135], a[24:27], v[116:119], a[132:135]
    ds_read_b128 a[8:11], v8 offset:18432
    v_cvt_pk_bf16_f32 v109, v58, v59
    v_mfma_f32_16x16x32_bf16 a[136:139], a[24:27], v[120:123], a[136:139]
    v_exp_f32 v36, v36
    v_mfma_f32_16x16x32_bf16 a[140:143], a[24:27], v[124:127], a[140:143]
    buffer_load_dwordx4 v6, s[20:23], s31 offen sc1 lds
    s_add_u32 s31, s31, 4096
    s_add_u32 m0, s32, 0xf000
    v_mfma_f32_16x16x32_bf16 a[144:147], a[28:31], v[112:115], a[144:147]
    v_exp_f32 v37, v37
    v_mfma_f32_16x16x32_bf16 a[148:151], a[28:31], v[116:119], a[148:151]
    ds_read_b128 a[12:15], v8 offset:19456
    v_cvt_pk_bf16_f32 v98, v36, v37
    v_mfma_f32_16x16x32_bf16 a[152:155], a[28:31], v[120:123], a[152:155]
    v_exp_f32 v38, v38
    v_mfma_f32_16x16x32_bf16 a[156:159], a[28:31], v[124:127], a[156:159]
    s_waitcnt lgkmcnt(2)
    v_mfma_f32_16x16x32_bf16 v[16:19], v[10:13], v[112:115], v[16:19]
    v_exp_f32 v39, v39
    v_mfma_f32_16x16x32_bf16 v[20:23], v[10:13], v[116:119], v[20:23]
    v_cvt_pk_bf16_f32 v99, v38, v39
    v_mfma_f32_16x16x32_bf16 v[24:27], v[10:13], v[120:123], v[24:27]
    v_exp_f32 v44, v44
    v_mfma_f32_16x16x32_bf16 v[28:31], v[10:13], v[124:127], v[28:31]
    buffer_load_dwordx4 v6, s[20:23], s31 offen sc1 lds
    s_add_u32 s31, s31, 4096
    s_waitcnt vmcnt(8)
    s_barrier
    v_mfma_f32_16x16x32_bf16 v[64:67], a[0:3], a[160:163], v[128:131]
    v_exp_f32 v45, v45
    v_mfma_f32_16x16x32_bf16 v[64:67], a[4:7], a[164:167], v[64:67]
    ds_read_b128 a[16:19], v8 offset:20480
    v_cvt_pk_bf16_f32 v102, v44, v45
    v_mfma_f32_16x16x32_bf16 v[72:75], a[0:3], a[176:179], v[132:135]
    v_exp_f32 v46, v46
    v_mfma_f32_16x16x32_bf16 v[72:75], a[4:7], a[180:183], v[72:75]
    s_add_u32 m0, s32, 0x10000
    v_mfma_f32_16x16x32_bf16 v[80:83], a[0:3], a[192:195], v[136:139]
    v_exp_f32 v47, v47
    v_mfma_f32_16x16x32_bf16 v[80:83], a[4:7], a[196:199], v[80:83]
    ds_read_b128 a[20:23], v8 offset:21504
    v_cvt_pk_bf16_f32 v103, v46, v47
    v_mfma_f32_16x16x32_bf16 v[88:91], a[0:3], a[208:211], v[140:143]
    v_exp_f32 v52, v52
    v_mfma_f32_16x16x32_bf16 v[88:91], a[4:7], a[212:215], v[88:91]
    s_waitcnt lgkmcnt(2)
    v_mfma_f32_16x16x32_bf16 v[64:67], a[8:11], a[168:171], v[64:67]
    v_exp_f32 v53, v53
    v_mfma_f32_16x16x32_bf16 v[64:67], a[12:15], a[172:175], v[64:67]
    ds_read_b128 a[24:27], v8 offset:22528
    v_cvt_pk_bf16_f32 v106, v52, v53
    v_mfma_f32_16x16x32_bf16 v[72:75], a[8:11], a[184:187], v[72:75]
    v_exp_f32 v54, v54
    v_mfma_f32_16x16x32_bf16 v[72:75], a[12:15], a[188:191], v[72:75]
    buffer_load_dwordx4 v6, s[20:23], s31 offen sc1 lds
    s_add_u32 s31, s31, 4096
    s_add_u32 m0, s32, 0x11000
    v_mfma_f32_16x16x32_bf16 v[80:83], a[8:11], a[200:203], v[80:83]
    v_exp_f32 v55, v55
    v_mfma_f32_16x16x32_bf16 v[80:83], a[12:15], a[204:207], v[80:83]
    ds_read_b128 a[28:31], v8 offset:23552
    v_cvt_pk_bf16_f32 v107, v54, v55
    v_mfma_f32_16x16x32_bf16 v[88:91], a[8:11], a[216:219], v[88:91]
    v_exp_f32 v60, v60
    v_mfma_f32_16x16x32_bf16 v[88:91], a[12:15], a[220:223], v[88:91]
    s_waitcnt lgkmcnt(2)
    v_mfma_f32_16x16x32_bf16 v[68:71], a[16:19], a[160:163], v[128:131]
    v_exp_f32 v61, v61
    v_mfma_f32_16x16x32_bf16 v[68:71], a[20:23], a[164:167], v[68:71]
    ds_read_b128 a[0:3], v8 offset:8192
    v_cvt_pk_bf16_f32 v110, v60, v61
    v_mfma_f32_16x16x32_bf16 v[76:79], a[16:19], a[176:179], v[132:135]
    v_exp_f32 v62, v62
    v_mfma_f32_16x16x32_bf16 v[76:79], a[20:23], a[180:183], v[76:79]
    buffer_load_dwordx4 v6, s[20:23], s31 offen sc1 lds
    s_add_u32 s31, s31, 4096
    s_add_u32 m0, s32, 0x12000
    v_mfma_f32_16x16x32_bf16 v[84:87], a[16:19], a[192:195], v[136:139]
    v_exp_f32 v63, v63
    v_mfma_f32_16x16x32_bf16 v[84:87], a[20:23], a[196:199], v[84:87]
    ds_read_b128 a[4:7], v8 offset:9216
    v_cvt_pk_bf16_f32 v111, v62, v63
    v_mfma_f32_16x16x32_bf16 v[92:95], a[16:19], a[208:211], v[140:143]
    v_mfma_f32_16x16x32_bf16 v[92:95], a[20:23], a[212:215], v[92:95]
    s_waitcnt lgkmcnt(2)
    v_mfma_f32_16x16x32_bf16 v[68:71], a[24:27], a[168:171], v[68:71]
    v_mfma_f32_16x16x32_bf16 v[68:71], a[28:31], a[172:175], v[68:71]
    ds_read_b128 a[8:11], v8 offset:10240
    v_mfma_f32_16x16x32_bf16 v[76:79], a[24:27], a[184:187], v[76:79]
    v_exp_f32 v64, v64
    v_mfma_f32_16x16x32_bf16 v[76:79], a[28:31], a[188:191], v[76:79]
    buffer_load_dwordx4 v6, s[20:23], s31 offen sc1 lds
    s_add_u32 s31, s31, 4096
    s_add_u32 m0, s32, 0x13000
    v_mfma_f32_16x16x32_bf16 v[84:87], a[24:27], a[200:203], v[84:87]
    v_exp_f32 v65, v65
    v_mfma_f32_16x16x32_bf16 v[84:87], a[28:31], a[204:207], v[84:87]
    ds_read_b128 a[12:15], v8 offset:11264
    v_cvt_pk_bf16_f32 v112, v64, v65
    v_mfma_f32_16x16x32_bf16 v[92:95], a[24:27], a[216:219], v[92:95]
    v_exp_f32 v66, v66
    v_mfma_f32_16x16x32_bf16 v[92:95], a[28:31], a[220:223], v[92:95]
    s_waitcnt lgkmcnt(2)
    v_mfma_f32_16x16x32_bf16 a[32:35], a[0:3], v[96:99], a[32:35]
    v_exp_f32 v67, v67
    v_mfma_f32_16x16x32_bf16 a[36:39], a[0:3], v[100:103], a[36:39]
    ds_read_b128 a[16:19], v8 offset:12288
    v_cvt_pk_bf16_f32 v113, v66, v67
    v_mfma_f32_16x16x32_bf16 a[40:43], a[0:3], v[104:107], a[40:43]
    v_exp_f32 v72, v72
    v_mfma_f32_16x16x32_bf16 a[44:47], a[0:3], v[108:111], a[44:47]
    buffer_load_dwordx4 v6, s[20:23], s31 offen sc1 lds
    s_add_u32 s31, s31, 4096
    s_add_u32 m0, s32, 0x14000
    v_mfma_f32_16x16x32_bf16 a[48:51], a[4:7], v[96:99], a[48:51]
    v_exp_f32 v73, v73
    v_mfma_f32_16x16x32_bf16 a[52:55], a[4:7], v[100:103], a[52:55]
    ds_read_b128 a[20:23], v8 offset:13312
    v_cvt_pk_bf16_f32 v116, v72, v73
    v_mfma_f32_16x16x32_bf16 a[56:59], a[4:7], v[104:107], a[56:59]
    v_exp_f32 v74, v74
    v_mfma_f32_16x16x32_bf16 a[60:63], a[4:7], v[108:111], a[60:63]
    s_waitcnt lgkmcnt(2)
    v_mfma_f32_16x16x32_bf16 a[64:67], a[8:11], v[96:99], a[64:67]
    v_exp_f32 v75, v75
    v_mfma_f32_16x16x32_bf16 a[68:71], a[8:11], v[100:103], a[68:71]
    ds_read_b128 a[24:27], v8 offset:14336
    v_cvt_pk_bf16_f32 v117, v74, v75
    v_mfma_f32_16x16x32_bf16 a[72:75], a[8:11], v[104:107], a[72:75]
    v_exp_f32 v80, v80
    v_mfma_f32_16x16x32_bf16 a[76:79], a[8:11], v[108:111], a[76:79]
    buffer_load_dwordx4 v6, s[20:23], s31 offen sc1 lds
    s_add_u32 s31, s31, 4096
    s_add_u32 m0, s32, 0x15000
    v_mfma_f32_16x16x32_bf16 a[80:83], a[12:15], v[96:99], a[80:83]
    v_exp_f32 v81, v81
    v_mfma_f32_16x16x32_bf16 a[84:87], a[12:15], v[100:103], a[84:87]
    ds_read_b128 a[28:31], v8 offset:15360
    v_cvt_pk_bf16_f32 v120, v80, v81
    v_mfma_f32_16x16x32_bf16 a[88:91], a[12:15], v[104:107], a[88:91]
    v_exp_f32 v82, v82
    v_mfma_f32_16x16x32_bf16 a[92:95], a[12:15], v[108:111], a[92:95]
    s_waitcnt lgkmcnt(2)
    v_mfma_f32_16x16x32_bf16 a[96:99], a[16:19], v[96:99], a[96:99]
    v_exp_f32 v83, v83
    v_mfma_f32_16x16x32_bf16 a[100:103], a[16:19], v[100:103], a[100:103]
    ds_read_b128 a[0:3], v6 offset:0
    v_cvt_pk_bf16_f32 v121, v82, v83
    v_mfma_f32_16x16x32_bf16 a[104:107], a[16:19], v[104:107], a[104:107]
    v_exp_f32 v88, v88
    v_mfma_f32_16x16x32_bf16 a[108:111], a[16:19], v[108:111], a[108:111]
    buffer_load_dwordx4 v6, s[20:23], s31 offen sc1 lds
    s_add_u32 s31, s31, 4096
    s_add_u32 m0, s32, 0x16000
    v_mfma_f32_16x16x32_bf16 a[112:115], a[20:23], v[96:99], a[112:115]
    v_exp_f32 v89, v89
    v_mfma_f32_16x16x32_bf16 a[116:119], a[20:23], v[100:103], a[116:119]
    ds_read_b128 a[4:7], v6 offset:1024
    v_cvt_pk_bf16_f32 v124, v88, v89
    v_mfma_f32_16x16x32_bf16 a[120:123], a[20:23], v[104:107], a[120:123]
    v_exp_f32 v90, v90
    v_mfma_f32_16x16x32_bf16 a[124:127], a[20:23], v[108:111], a[124:127]
    s_waitcnt lgkmcnt(2)
    v_mfma_f32_16x16x32_bf16 a[128:131], a[24:27], v[96:99], a[128:131]
    v_exp_f32 v91, v91
    v_mfma_f32_16x16x32_bf16 a[132:135], a[24:27], v[100:103], a[132:135]
    ds_read_b128 a[8:11], v6 offset:2048
    v_cvt_pk_bf16_f32 v125, v90, v91
    v_mfma_f32_16x16x32_bf16 a[136:139], a[24:27], v[104:107], a[136:139]
    v_exp_f32 v68, v68
    v_mfma_f32_16x16x32_bf16 a[140:143], a[24:27], v[108:111], a[140:143]
    buffer_load_dwordx4 v6, s[20:23], s31 offen sc1 lds
    s_add_u32 s31, s31, 4096
    s_add_u32 m0, s32, 0x17000
    v_mfma_f32_16x16x32_bf16 a[144:147], a[28:31], v[96:99], a[144:147]
    v_exp_f32 v69, v69
    v_mfma_f32_16x16x32_bf16 a[148:151], a[28:31], v[100:103], a[148:151]
    ds_read_b128 a[12:15], v6 offset:3072
    v_cvt_pk_bf16_f32 v114, v68, v69
    v_mfma_f32_16x16x32_bf16 a[152:155], a[28:31], v[104:107], a[152:155]
    v_exp_f32 v70, v70
    v_mfma_f32_16x16x32_bf16 a[156:159], a[28:31], v[108:111], a[156:159]
    s_waitcnt lgkmcnt(2)
    v_mfma_f32_16x16x32_bf16 v[16:19], v[10:13], v[96:99], v[16:19]
    v_exp_f32 v71, v71
    v_mfma_f32_16x16x32_bf16 v[20:23], v[10:13], v[100:103], v[20:23]
    v_cvt_pk_bf16_f32 v115, v70, v71
    v_mfma_f32_16x16x32_bf16 v[24:27], v[10:13], v[104:107], v[24:27]
    v_exp_f32 v76, v76
    v_mfma_f32_16x16x32_bf16 v[28:31], v[10:13], v[108:111], v[28:31]
    buffer_load_dwordx4 v6, s[20:23], s31 offen sc1 lds
    s_add_u32 s31, s31, 4096
    v_mfma_f32_16x16x32_bf16 v[32:35], a[0:3], a[160:163], v[128:131]
    v_exp_f32 v77, v77
    v_mfma_f32_16x16x32_bf16 v[32:35], a[4:7], a[164:167], v[32:35]
    ds_read_b128 a[16:19], v6 offset:4096
    v_cvt_pk_bf16_f32 v118, v76, v77
    v_mfma_f32_16x16x32_bf16 v[40:43], a[0:3], a[176:179], v[132:135]
    v_exp_f32 v78, v78
    v_mfma_f32_16x16x32_bf16 v[40:43], a[4:7], a[180:183], v[40:43]
    buffer_load_dword v9, v5, s[20:23], s47 offen sc1
    v_mfma_f32_16x16x32_bf16 v[48:51], a[0:3], a[192:195], v[136:139]
    v_exp_f32 v79, v79
    v_mfma_f32_16x16x32_bf16 v[48:51], a[4:7], a[196:199], v[48:51]
    ds_read_b128 a[20:23], v6 offset:5120
    v_cvt_pk_bf16_f32 v119, v78, v79
    v_mfma_f32_16x16x32_bf16 v[56:59], a[0:3], a[208:211], v[140:143]
    v_exp_f32 v84, v84
    v_mfma_f32_16x16x32_bf16 v[56:59], a[4:7], a[212:215], v[56:59]
    s_waitcnt lgkmcnt(2)
    v_mfma_f32_16x16x32_bf16 v[32:35], a[8:11], a[168:171], v[32:35]
    v_exp_f32 v85, v85
    v_mfma_f32_16x16x32_bf16 v[32:35], a[12:15], a[172:175], v[32:35]
    ds_read_b128 a[24:27], v6 offset:6144
    v_cvt_pk_bf16_f32 v122, v84, v85
    v_mfma_f32_16x16x32_bf16 v[40:43], a[8:11], a[184:187], v[40:43]
    v_exp_f32 v86, v86
    v_mfma_f32_16x16x32_bf16 v[40:43], a[12:15], a[188:191], v[40:43]
    s_getpc_b64 s[80:81]
    global_load_dword a255, v0, s[80:81] offset:2048
    v_mfma_f32_16x16x32_bf16 v[48:51], a[8:11], a[200:203], v[48:51]
    v_exp_f32 v87, v87
    v_mfma_f32_16x16x32_bf16 v[48:51], a[12:15], a[204:207], v[48:51]
    ds_read_b128 a[28:31], v6 offset:7168
    v_cvt_pk_bf16_f32 v123, v86, v87
    v_mfma_f32_16x16x32_bf16 v[56:59], a[8:11], a[216:219], v[56:59]
    v_exp_f32 v92, v92
    v_mfma_f32_16x16x32_bf16 v[56:59], a[12:15], a[220:223], v[56:59]
    s_waitcnt lgkmcnt(2)
    v_mfma_f32_16x16x32_bf16 v[36:39], a[16:19], a[160:163], v[128:131]
    v_exp_f32 v93, v93
    v_mfma_f32_16x16x32_bf16 v[36:39], a[20:23], a[164:167], v[36:39]
    ds_read_b128 a[0:3], v8 offset:24576
    v_cvt_pk_bf16_f32 v126, v92, v93
    v_mfma_f32_16x16x32_bf16 v[44:47], a[16:19], a[176:179], v[132:135]
    v_exp_f32 v94, v94
    v_mfma_f32_16x16x32_bf16 v[44:47], a[20:23], a[180:183], v[44:47]
    v_mfma_f32_16x16x32_bf16 v[52:55], a[16:19], a[192:195], v[136:139]
    v_exp_f32 v95, v95
    v_mfma_f32_16x16x32_bf16 v[52:55], a[20:23], a[196:199], v[52:55]
    ds_read_b128 a[4:7], v8 offset:25600
    v_cvt_pk_bf16_f32 v127, v94, v95
    v_mfma_f32_16x16x32_bf16 v[60:63], a[16:19], a[208:211], v[140:143]
    v_mfma_f32_16x16x32_bf16 v[60:63], a[20:23], a[212:215], v[60:63]
    s_waitcnt lgkmcnt(2)
    v_mfma_f32_16x16x32_bf16 v[36:39], a[24:27], a[168:171], v[36:39]
    v_mfma_f32_16x16x32_bf16 v[36:39], a[28:31], a[172:175], v[36:39]
    ds_read_b128 a[8:11], v8 offset:26624
    v_mfma_f32_16x16x32_bf16 v[44:47], a[24:27], a[184:187], v[44:47]
    v_exp_f32 v32, v32
    v_mfma_f32_16x16x32_bf16 v[44:47], a[28:31], a[188:191], v[44:47]
    v_mfma_f32_16x16x32_bf16 v[52:55], a[24:27], a[200:203], v[52:55]
    v_exp_f32 v33, v33
    v_mfma_f32_16x16x32_bf16 v[52:55], a[28:31], a[204:207], v[52:55]
    ds_read_b128 a[12:15], v8 offset:27648
    v_cvt_pk_bf16_f32 v96, v32, v33
    v_mfma_f32_16x16x32_bf16 v[60:63], a[24:27], a[216:219], v[60:63]
    v_exp_f32 v34, v34
    v_mfma_f32_16x16x32_bf16 v[60:63], a[28:31], a[220:223], v[60:63]
    s_waitcnt lgkmcnt(2)
    v_mfma_f32_16x16x32_bf16 a[32:35], a[0:3], v[112:115], a[32:35]
    v_exp_f32 v35, v35
    v_mfma_f32_16x16x32_bf16 a[36:39], a[0:3], v[116:119], a[36:39]
    ds_read_b128 a[16:19], v8 offset:28672
    v_cvt_pk_bf16_f32 v97, v34, v35
    v_mfma_f32_16x16x32_bf16 a[40:43], a[0:3], v[120:123], a[40:43]
    v_exp_f32 v40, v40
    v_mfma_f32_16x16x32_bf16 a[44:47], a[0:3], v[124:127], a[44:47]
    v_mfma_f32_16x16x32_bf16 a[48:51], a[4:7], v[112:115], a[48:51]
    v_exp_f32 v41, v41
    v_mfma_f32_16x16x32_bf16 a[52:55], a[4:7], v[116:119], a[52:55]
    ds_read_b128 a[20:23], v8 offset:29696
    v_cvt_pk_bf16_f32 v100, v40, v41
    v_mfma_f32_16x16x32_bf16 a[56:59], a[4:7], v[120:123], a[56:59]
    v_exp_f32 v42, v42
    v_mfma_f32_16x16x32_bf16 a[60:63], a[4:7], v[124:127], a[60:63]
    s_waitcnt lgkmcnt(2)
    v_mfma_f32_16x16x32_bf16 a[64:67], a[8:11], v[112:115], a[64:67]
    v_exp_f32 v43, v43
    v_mfma_f32_16x16x32_bf16 a[68:71], a[8:11], v[116:119], a[68:71]
    ds_read_b128 a[24:27], v8 offset:30720
    v_cvt_pk_bf16_f32 v101, v42, v43
    v_mfma_f32_16x16x32_bf16 a[72:75], a[8:11], v[120:123], a[72:75]
    v_exp_f32 v48, v48
    v_mfma_f32_16x16x32_bf16 a[76:79], a[8:11], v[124:127], a[76:79]
    v_mfma_f32_16x16x32_bf16 a[80:83], a[12:15], v[112:115], a[80:83]
    v_exp_f32 v49, v49
    v_mfma_f32_16x16x32_bf16 a[84:87], a[12:15], v[116:119], a[84:87]
    ds_read_b128 a[28:31], v8 offset:31744
    v_cvt_pk_bf16_f32 v104, v48, v49
    v_mfma_f32_16x16x32_bf16 a[88:91], a[12:15], v[120:123], a[88:91]
    v_exp_f32 v50, v50
    v_mfma_f32_16x16x32_bf16 a[92:95], a[12:15], v[124:127], a[92:95]
    s_waitcnt lgkmcnt(2)
    v_mfma_f32_16x16x32_bf16 a[96:99], a[16:19], v[112:115], a[96:99]
    v_exp_f32 v51, v51
    v_mfma_f32_16x16x32_bf16 a[100:103], a[16:19], v[116:119], a[100:103]
    ds_read_b128 a[0:3], v6 offset:16384
    v_cvt_pk_bf16_f32 v105, v50, v51
    v_mfma_f32_16x16x32_bf16 a[104:107], a[16:19], v[120:123], a[104:107]
    v_exp_f32 v56, v56
    v_mfma_f32_16x16x32_bf16 a[108:111], a[16:19], v[124:127], a[108:111]
    v_mfma_f32_16x16x32_bf16 a[112:115], a[20:23], v[112:115], a[112:115]
    v_exp_f32 v57, v57
    v_mfma_f32_16x16x32_bf16 a[116:119], a[20:23], v[116:119], a[116:119]
    ds_read_b128 a[4:7], v6 offset:17408
    v_cvt_pk_bf16_f32 v108, v56, v57
    v_mfma_f32_16x16x32_bf16 a[120:123], a[20:23], v[120:123], a[120:123]
    v_exp_f32 v58, v58
    v_mfma_f32_16x16x32_bf16 a[124:127], a[20:23], v[124:127], a[124:127]
    s_waitcnt lgkmcnt(2)
    v_mfma_f32_16x16x32_bf16 a[128:131], a[24:27], v[112:115], a[128:131]
    v_exp_f32 v59, v59
    v_mfma_f32_16x16x32_bf16 a[132:135], a[24:27], v[116:119], a[132:135]
    ds_read_b128 a[8:11], v6 offset:18432
    v_cvt_pk_bf16_f32 v109, v58, v59
    v_mfma_f32_16x16x32_bf16 a[136:139], a[24:27], v[120:123], a[136:139]
    v_exp_f32 v36, v36
    v_mfma_f32_16x16x32_bf16 a[140:143], a[24:27], v[124:127], a[140:143]
    v_mfma_f32_16x16x32_bf16 a[144:147], a[28:31], v[112:115], a[144:147]
    v_exp_f32 v37, v37
    v_mfma_f32_16x16x32_bf16 a[148:151], a[28:31], v[116:119], a[148:151]
    ds_read_b128 a[12:15], v6 offset:19456
    v_cvt_pk_bf16_f32 v98, v36, v37
    v_mfma_f32_16x16x32_bf16 a[152:155], a[28:31], v[120:123], a[152:155]
    v_exp_f32 v38, v38
    v_mfma_f32_16x16x32_bf16 a[156:159], a[28:31], v[124:127], a[156:159]
    s_waitcnt lgkmcnt(2)
    v_mfma_f32_16x16x32_bf16 v[16:19], v[10:13], v[112:115], v[16:19]
    v_exp_f32 v39, v39
    v_mfma_f32_16x16x32_bf16 v[20:23], v[10:13], v[116:119], v[20:23]
    v_cvt_pk_bf16_f32 v99, v38, v39
    v_mfma_f32_16x16x32_bf16 v[24:27], v[10:13], v[120:123], v[24:27]
    v_exp_f32 v44, v44
    v_mfma_f32_16x16x32_bf16 v[28:31], v[10:13], v[124:127], v[28:31]
    s_waitcnt vmcnt(2)
    s_barrier
    v_mfma_f32_16x16x32_bf16 v[64:67], a[0:3], a[160:163], v[128:131]
    v_exp_f32 v45, v45
    v_mfma_f32_16x16x32_bf16 v[64:67], a[4:7], a[164:167], v[64:67]
    ds_read_b128 a[16:19], v6 offset:20480
    v_cvt_pk_bf16_f32 v102, v44, v45
    v_mfma_f32_16x16x32_bf16 v[72:75], a[0:3], a[176:179], v[132:135]
    v_exp_f32 v46, v46
    v_mfma_f32_16x16x32_bf16 v[72:75], a[4:7], a[180:183], v[72:75]
    buffer_load_dwordx4 a[224:227], v14, s[12:15], s28 offen offset:0
    v_mfma_f32_16x16x32_bf16 v[80:83], a[0:3], a[192:195], v[136:139]
    v_exp_f32 v47, v47
    v_mfma_f32_16x16x32_bf16 v[80:83], a[4:7], a[196:199], v[80:83]
    ds_read_b128 a[20:23], v6 offset:21504
    v_cvt_pk_bf16_f32 v103, v46, v47
    v_mfma_f32_16x16x32_bf16 v[88:91], a[0:3], a[208:211], v[140:143]
    v_exp_f32 v52, v52
    v_mfma_f32_16x16x32_bf16 v[88:91], a[4:7], a[212:215], v[88:91]
    s_waitcnt lgkmcnt(2)
    v_mfma_f32_16x16x32_bf16 v[64:67], a[8:11], a[168:171], v[64:67]
    v_exp_f32 v53, v53
    v_mfma_f32_16x16x32_bf16 v[64:67], a[12:15], a[172:175], v[64:67]
    ds_read_b128 a[24:27], v6 offset:22528
    v_cvt_pk_bf16_f32 v106, v52, v53
    v_mfma_f32_16x16x32_bf16 v[72:75], a[8:11], a[184:187], v[72:75]
    v_exp_f32 v54, v54
    v_mfma_f32_16x16x32_bf16 v[72:75], a[12:15], a[188:191], v[72:75]
    buffer_load_dwordx4 a[228:231], v15, s[16:19], s29 offen offset:0
    v_mfma_f32_16x16x32_bf16 v[80:83], a[8:11], a[200:203], v[80:83]
    v_exp_f32 v55, v55
    v_mfma_f32_16x16x32_bf16 v[80:83], a[12:15], a[204:207], v[80:83]
    ds_read_b128 a[28:31], v6 offset:23552
    v_cvt_pk_bf16_f32 v107, v54, v55
    v_mfma_f32_16x16x32_bf16 v[88:91], a[8:11], a[216:219], v[88:91]
    v_exp_f32 v60, v60
    v_mfma_f32_16x16x32_bf16 v[88:91], a[12:15], a[220:223], v[88:91]
    s_waitcnt lgkmcnt(2)
    v_mfma_f32_16x16x32_bf16 v[68:71], a[16:19], a[160:163], v[128:131]
    v_exp_f32 v61, v61
    v_mfma_f32_16x16x32_bf16 v[68:71], a[20:23], a[164:167], v[68:71]
    ds_read_b128 a[0:3], v6 offset:8192
    v_cvt_pk_bf16_f32 v110, v60, v61
    v_mfma_f32_16x16x32_bf16 v[76:79], a[16:19], a[176:179], v[132:135]
    v_exp_f32 v62, v62
    v_mfma_f32_16x16x32_bf16 v[76:79], a[20:23], a[180:183], v[76:79]
    buffer_load_dwordx4 a[232:235], v14, s[12:15], s28 offen offset:1024
    v_mfma_f32_16x16x32_bf16 v[84:87], a[16:19], a[192:195], v[136:139]
    v_exp_f32 v63, v63
    v_mfma_f32_16x16x32_bf16 v[84:87], a[20:23], a[196:199], v[84:87]
    ds_read_b128 a[4:7], v6 offset:9216
    v_cvt_pk_bf16_f32 v111, v62, v63
    v_mfma_f32_16x16x32_bf16 v[92:95], a[16:19], a[208:211], v[140:143]
    v_mfma_f32_16x16x32_bf16 v[92:95], a[20:23], a[212:215], v[92:95]
    s_waitcnt lgkmcnt(2)
    v_mfma_f32_16x16x32_bf16 v[68:71], a[24:27], a[168:171], v[68:71]
    v_mfma_f32_16x16x32_bf16 v[68:71], a[28:31], a[172:175], v[68:71]
    ds_read_b128 a[8:11], v6 offset:10240
    v_mfma_f32_16x16x32_bf16 v[76:79], a[24:27], a[184:187], v[76:79]
    v_exp_f32 v64, v64
    v_mfma_f32_16x16x32_bf16 v[76:79], a[28:31], a[188:191], v[76:79]
    buffer_load_dwordx4 a[236:239], v15, s[16:19], s29 offen offset:896
    s_add_u32 s28, s28, 0x400000
    s_add_u32 s29, s29, 0x1c0000
    v_mfma_f32_16x16x32_bf16 v[84:87], a[24:27], a[200:203], v[84:87]
    v_exp_f32 v65, v65
    v_mfma_f32_16x16x32_bf16 v[84:87], a[28:31], a[204:207], v[84:87]
    ds_read_b128 a[12:15], v6 offset:11264
    v_cvt_pk_bf16_f32 v112, v64, v65
    v_mfma_f32_16x16x32_bf16 v[92:95], a[24:27], a[216:219], v[92:95]
    v_exp_f32 v66, v66
    v_mfma_f32_16x16x32_bf16 v[92:95], a[28:31], a[220:223], v[92:95]
    s_waitcnt lgkmcnt(2)
    v_mfma_f32_16x16x32_bf16 a[32:35], a[0:3], v[96:99], a[32:35]
    v_exp_f32 v67, v67
    v_mfma_f32_16x16x32_bf16 a[36:39], a[0:3], v[100:103], a[36:39]
    ds_read_b128 a[16:19], v6 offset:12288
    v_cvt_pk_bf16_f32 v113, v66, v67
    v_mfma_f32_16x16x32_bf16 a[40:43], a[0:3], v[104:107], a[40:43]
    v_exp_f32 v72, v72
    v_mfma_f32_16x16x32_bf16 a[44:47], a[0:3], v[108:111], a[44:47]
    v_mfma_f32_16x16x32_bf16 a[48:51], a[4:7], v[96:99], a[48:51]
    v_exp_f32 v73, v73
    v_mfma_f32_16x16x32_bf16 a[52:55], a[4:7], v[100:103], a[52:55]
    ds_read_b128 a[20:23], v6 offset:13312
    v_cvt_pk_bf16_f32 v116, v72, v73
    v_mfma_f32_16x16x32_bf16 a[56:59], a[4:7], v[104:107], a[56:59]
    v_exp_f32 v74, v74
    v_mfma_f32_16x16x32_bf16 a[60:63], a[4:7], v[108:111], a[60:63]
    s_waitcnt lgkmcnt(2)
    v_mfma_f32_16x16x32_bf16 a[64:67], a[8:11], v[96:99], a[64:67]
    v_exp_f32 v75, v75
    v_mfma_f32_16x16x32_bf16 a[68:71], a[8:11], v[100:103], a[68:71]
    ds_read_b128 a[24:27], v6 offset:14336
    v_cvt_pk_bf16_f32 v117, v74, v75
    v_mfma_f32_16x16x32_bf16 a[72:75], a[8:11], v[104:107], a[72:75]
    v_exp_f32 v80, v80
    v_mfma_f32_16x16x32_bf16 a[76:79], a[8:11], v[108:111], a[76:79]
    v_mfma_f32_16x16x32_bf16 a[80:83], a[12:15], v[96:99], a[80:83]
    v_exp_f32 v81, v81
    v_mfma_f32_16x16x32_bf16 a[84:87], a[12:15], v[100:103], a[84:87]
    ds_read_b128 a[28:31], v6 offset:15360
    v_cvt_pk_bf16_f32 v120, v80, v81
    v_mfma_f32_16x16x32_bf16 a[88:91], a[12:15], v[104:107], a[88:91]
    v_exp_f32 v82, v82
    v_mfma_f32_16x16x32_bf16 a[92:95], a[12:15], v[108:111], a[92:95]
    s_waitcnt lgkmcnt(2)
    v_mfma_f32_16x16x32_bf16 a[96:99], a[16:19], v[96:99], a[96:99]
    v_exp_f32 v83, v83
    v_mfma_f32_16x16x32_bf16 a[100:103], a[16:19], v[100:103], a[100:103]
    ds_read_b128 a[0:3], v6 offset:32768
    v_cvt_pk_bf16_f32 v121, v82, v83
    v_mfma_f32_16x16x32_bf16 a[104:107], a[16:19], v[104:107], a[104:107]
    v_exp_f32 v88, v88
    v_mfma_f32_16x16x32_bf16 a[108:111], a[16:19], v[108:111], a[108:111]
    v_mfma_f32_16x16x32_bf16 a[112:115], a[20:23], v[96:99], a[112:115]
    v_exp_f32 v89, v89
    v_mfma_f32_16x16x32_bf16 a[116:119], a[20:23], v[100:103], a[116:119]
    ds_read_b128 a[4:7], v6 offset:33792
    v_cvt_pk_bf16_f32 v124, v88, v89
    v_mfma_f32_16x16x32_bf16 a[120:123], a[20:23], v[104:107], a[120:123]
    v_exp_f32 v90, v90
    v_mfma_f32_16x16x32_bf16 a[124:127], a[20:23], v[108:111], a[124:127]
    s_waitcnt lgkmcnt(2)
    v_mfma_f32_16x16x32_bf16 a[128:131], a[24:27], v[96:99], a[128:131]
    v_exp_f32 v91, v91
    v_mfma_f32_16x16x32_bf16 a[132:135], a[24:27], v[100:103], a[132:135]
    ds_read_b128 a[8:11], v6 offset:34816
    v_cvt_pk_bf16_f32 v125, v90, v91
    v_mfma_f32_16x16x32_bf16 a[136:139], a[24:27], v[104:107], a[136:139]
    v_exp_f32 v68, v68
    v_mfma_f32_16x16x32_bf16 a[140:143], a[24:27], v[108:111], a[140:143]
    v_mfma_f32_16x16x32_bf16 a[144:147], a[28:31], v[96:99], a[144:147]
    v_exp_f32 v69, v69
    v_mfma_f32_16x16x32_bf16 a[148:151], a[28:31], v[100:103], a[148:151]
    ds_read_b128 a[12:15], v6 offset:35840
    v_cvt_pk_bf16_f32 v114, v68, v69
    v_mfma_f32_16x16x32_bf16 a[152:155], a[28:31], v[104:107], a[152:155]
    v_exp_f32 v70, v70
    v_mfma_f32_16x16x32_bf16 a[156:159], a[28:31], v[108:111], a[156:159]
    s_waitcnt lgkmcnt(2)
    v_mfma_f32_16x16x32_bf16 v[16:19], v[10:13], v[96:99], v[16:19]
    v_exp_f32 v71, v71
    v_mfma_f32_16x16x32_bf16 v[20:23], v[10:13], v[100:103], v[20:23]
    v_cvt_pk_bf16_f32 v115, v70, v71
    v_mfma_f32_16x16x32_bf16 v[24:27], v[10:13], v[104:107], v[24:27]
    v_exp_f32 v76, v76
    v_mfma_f32_16x16x32_bf16 v[28:31], v[10:13], v[108:111], v[28:31]
    v_mfma_f32_16x16x32_bf16 v[32:35], a[0:3], a[160:163], v[128:131]
    v_exp_f32 v77, v77
    v_mfma_f32_16x16x32_bf16 v[32:35], a[4:7], a[164:167], v[32:35]
    ds_read_b128 a[16:19], v6 offset:36864
    v_cvt_pk_bf16_f32 v118, v76, v77
    v_mfma_f32_16x16x32_bf16 v[40:43], a[0:3], a[176:179], v[132:135]
    v_exp_f32 v78, v78
    v_mfma_f32_16x16x32_bf16 v[40:43], a[4:7], a[180:183], v[40:43]
    v_mfma_f32_16x16x32_bf16 v[48:51], a[0:3], a[192:195], v[136:139]
    v_exp_f32 v79, v79
    v_mfma_f32_16x16x32_bf16 v[48:51], a[4:7], a[196:199], v[48:51]
    ds_read_b128 a[20:23], v6 offset:37888
    v_cvt_pk_bf16_f32 v119, v78, v79
    v_mfma_f32_16x16x32_bf16 v[56:59], a[0:3], a[208:211], v[140:143]
    v_exp_f32 v84, v84
    v_mfma_f32_16x16x32_bf16 v[56:59], a[4:7], a[212:215], v[56:59]
    s_waitcnt lgkmcnt(2)
    v_mfma_f32_16x16x32_bf16 v[32:35], a[8:11], a[168:171], v[32:35]
    v_exp_f32 v85, v85
    v_mfma_f32_16x16x32_bf16 v[32:35], a[12:15], a[172:175], v[32:35]
    ds_read_b128 a[24:27], v6 offset:38912
    v_cvt_pk_bf16_f32 v122, v84, v85
    v_mfma_f32_16x16x32_bf16 v[40:43], a[8:11], a[184:187], v[40:43]
    v_exp_f32 v86, v86
    v_mfma_f32_16x16x32_bf16 v[40:43], a[12:15], a[188:191], v[40:43]
    v_mfma_f32_16x16x32_bf16 v[48:51], a[8:11], a[200:203], v[48:51]
    v_exp_f32 v87, v87
    v_mfma_f32_16x16x32_bf16 v[48:51], a[12:15], a[204:207], v[48:51]
    ds_read_b128 a[28:31], v6 offset:39936
    v_cvt_pk_bf16_f32 v123, v86, v87
    v_mfma_f32_16x16x32_bf16 v[56:59], a[8:11], a[216:219], v[56:59]
    v_exp_f32 v92, v92
    v_mfma_f32_16x16x32_bf16 v[56:59], a[12:15], a[220:223], v[56:59]
    s_waitcnt lgkmcnt(2)
    v_mfma_f32_16x16x32_bf16 v[36:39], a[16:19], a[160:163], v[128:131]
    v_exp_f32 v93, v93
    v_mfma_f32_16x16x32_bf16 v[36:39], a[20:23], a[164:167], v[36:39]
    ds_read_b128 a[0:3], v6 offset:24576
    v_cvt_pk_bf16_f32 v126, v92, v93
    v_mfma_f32_16x16x32_bf16 v[44:47], a[16:19], a[176:179], v[132:135]
    v_exp_f32 v94, v94
    v_mfma_f32_16x16x32_bf16 v[44:47], a[20:23], a[180:183], v[44:47]
    v_mfma_f32_16x16x32_bf16 v[52:55], a[16:19], a[192:195], v[136:139]
    v_exp_f32 v95, v95
    v_mfma_f32_16x16x32_bf16 v[52:55], a[20:23], a[196:199], v[52:55]
    ds_read_b128 a[4:7], v6 offset:25600
    v_cvt_pk_bf16_f32 v127, v94, v95
    v_mfma_f32_16x16x32_bf16 v[60:63], a[16:19], a[208:211], v[140:143]
    v_mfma_f32_16x16x32_bf16 v[60:63], a[20:23], a[212:215], v[60:63]
    s_waitcnt lgkmcnt(2)
    v_mfma_f32_16x16x32_bf16 v[36:39], a[24:27], a[168:171], v[36:39]
    v_mfma_f32_16x16x32_bf16 v[36:39], a[28:31], a[172:175], v[36:39]
    ds_read_b128 a[8:11], v6 offset:26624
    v_mfma_f32_16x16x32_bf16 v[44:47], a[24:27], a[184:187], v[44:47]
    v_exp_f32 v32, v32
    v_mfma_f32_16x16x32_bf16 v[44:47], a[28:31], a[188:191], v[44:47]
    v_mfma_f32_16x16x32_bf16 v[52:55], a[24:27], a[200:203], v[52:55]
    v_exp_f32 v33, v33
    v_mfma_f32_16x16x32_bf16 v[52:55], a[28:31], a[204:207], v[52:55]
    ds_read_b128 a[12:15], v6 offset:27648
    v_cvt_pk_bf16_f32 v96, v32, v33
    v_mfma_f32_16x16x32_bf16 v[60:63], a[24:27], a[216:219], v[60:63]
    v_exp_f32 v34, v34
    v_mfma_f32_16x16x32_bf16 v[60:63], a[28:31], a[220:223], v[60:63]
    s_waitcnt lgkmcnt(2)
    v_mfma_f32_16x16x32_bf16 a[32:35], a[0:3], v[112:115], a[32:35]
    v_exp_f32 v35, v35
    v_mfma_f32_16x16x32_bf16 a[36:39], a[0:3], v[116:119], a[36:39]
    ds_read_b128 a[16:19], v6 offset:28672
    v_cvt_pk_bf16_f32 v97, v34, v35
    v_mfma_f32_16x16x32_bf16 a[40:43], a[0:3], v[120:123], a[40:43]
    v_exp_f32 v40, v40
    v_mfma_f32_16x16x32_bf16 a[44:47], a[0:3], v[124:127], a[44:47]
    v_mfma_f32_16x16x32_bf16 a[48:51], a[4:7], v[112:115], a[48:51]
    v_exp_f32 v41, v41
    v_mfma_f32_16x16x32_bf16 a[52:55], a[4:7], v[116:119], a[52:55]
    ds_read_b128 a[20:23], v6 offset:29696
    v_cvt_pk_bf16_f32 v100, v40, v41
    v_mfma_f32_16x16x32_bf16 a[56:59], a[4:7], v[120:123], a[56:59]
    v_exp_f32 v42, v42
    v_mfma_f32_16x16x32_bf16 a[60:63], a[4:7], v[124:127], a[60:63]
    s_waitcnt lgkmcnt(2)
    v_mfma_f32_16x16x32_bf16 a[64:67], a[8:11], v[112:115], a[64:67]
    v_exp_f32 v43, v43
    v_mfma_f32_16x16x32_bf16 a[68:71], a[8:11], v[116:119], a[68:71]
    ds_read_b128 a[24:27], v6 offset:30720
    v_cvt_pk_bf16_f32 v101, v42, v43
    v_mfma_f32_16x16x32_bf16 a[72:75], a[8:11], v[120:123], a[72:75]
    v_exp_f32 v48, v48
    v_mfma_f32_16x16x32_bf16 a[76:79], a[8:11], v[124:127], a[76:79]
    v_mfma_f32_16x16x32_bf16 a[80:83], a[12:15], v[112:115], a[80:83]
    v_exp_f32 v49, v49
    v_mfma_f32_16x16x32_bf16 a[84:87], a[12:15], v[116:119], a[84:87]
    ds_read_b128 a[28:31], v6 offset:31744
    v_cvt_pk_bf16_f32 v104, v48, v49
    v_mfma_f32_16x16x32_bf16 a[88:91], a[12:15], v[120:123], a[88:91]
    v_exp_f32 v50, v50
    v_mfma_f32_16x16x32_bf16 a[92:95], a[12:15], v[124:127], a[92:95]
    s_waitcnt lgkmcnt(2)
    v_mfma_f32_16x16x32_bf16 a[96:99], a[16:19], v[112:115], a[96:99]
    v_exp_f32 v51, v51
    v_mfma_f32_16x16x32_bf16 a[100:103], a[16:19], v[116:119], a[100:103]
    ds_read_b128 a[0:3], v6 offset:49152
    v_cvt_pk_bf16_f32 v105, v50, v51
    v_mfma_f32_16x16x32_bf16 a[104:107], a[16:19], v[120:123], a[104:107]
    v_exp_f32 v56, v56
    v_mfma_f32_16x16x32_bf16 a[108:111], a[16:19], v[124:127], a[108:111]
    v_mfma_f32_16x16x32_bf16 a[112:115], a[20:23], v[112:115], a[112:115]
    v_exp_f32 v57, v57
    v_mfma_f32_16x16x32_bf16 a[116:119], a[20:23], v[116:119], a[116:119]
    ds_read_b128 a[4:7], v6 offset:50176
    v_cvt_pk_bf16_f32 v108, v56, v57
    v_mfma_f32_16x16x32_bf16 a[120:123], a[20:23], v[120:123], a[120:123]
    v_exp_f32 v58, v58
    v_mfma_f32_16x16x32_bf16 a[124:127], a[20:23], v[124:127], a[124:127]
    s_waitcnt lgkmcnt(2)
    v_mfma_f32_16x16x32_bf16 a[128:131], a[24:27], v[112:115], a[128:131]
    v_exp_f32 v59, v59
    v_mfma_f32_16x16x32_bf16 a[132:135], a[24:27], v[116:119], a[132:135]
    ds_read_b128 a[8:11], v6 offset:51200
    v_cvt_pk_bf16_f32 v109, v58, v59
    v_mfma_f32_16x16x32_bf16 a[136:139], a[24:27], v[120:123], a[136:139]
    v_exp_f32 v36, v36
    v_mfma_f32_16x16x32_bf16 a[140:143], a[24:27], v[124:127], a[140:143]
    v_mfma_f32_16x16x32_bf16 a[144:147], a[28:31], v[112:115], a[144:147]
    v_exp_f32 v37, v37
    v_mfma_f32_16x16x32_bf16 a[148:151], a[28:31], v[116:119], a[148:151]
    ds_read_b128 a[12:15], v6 offset:52224
    v_cvt_pk_bf16_f32 v98, v36, v37
    v_mfma_f32_16x16x32_bf16 a[152:155], a[28:31], v[120:123], a[152:155]
    v_exp_f32 v38, v38
    v_mfma_f32_16x16x32_bf16 a[156:159], a[28:31], v[124:127], a[156:159]
    s_waitcnt lgkmcnt(2)
    v_mfma_f32_16x16x32_bf16 v[16:19], v[10:13], v[112:115], v[16:19]
    v_exp_f32 v39, v39
    v_mfma_f32_16x16x32_bf16 v[20:23], v[10:13], v[116:119], v[20:23]
    v_cvt_pk_bf16_f32 v99, v38, v39
    v_mfma_f32_16x16x32_bf16 v[24:27], v[10:13], v[120:123], v[24:27]
    v_exp_f32 v44, v44
    v_mfma_f32_16x16x32_bf16 v[28:31], v[10:13], v[124:127], v[28:31]
    v_mfma_f32_16x16x32_bf16 v[64:67], a[0:3], a[160:163], v[128:131]
    v_exp_f32 v45, v45
    v_mfma_f32_16x16x32_bf16 v[64:67], a[4:7], a[164:167], v[64:67]
    ds_read_b128 a[16:19], v6 offset:53248
    v_cvt_pk_bf16_f32 v102, v44, v45
    v_mfma_f32_16x16x32_bf16 v[72:75], a[0:3], a[176:179], v[132:135]
    v_exp_f32 v46, v46
    v_mfma_f32_16x16x32_bf16 v[72:75], a[4:7], a[180:183], v[72:75]
    s_add_u32 m0, s32, 0x18000
    v_mfma_f32_16x16x32_bf16 v[80:83], a[0:3], a[192:195], v[136:139]
    v_exp_f32 v47, v47
    v_mfma_f32_16x16x32_bf16 v[80:83], a[4:7], a[196:199], v[80:83]
    ds_read_b128 a[20:23], v6 offset:54272
    v_cvt_pk_bf16_f32 v103, v46, v47
    v_mfma_f32_16x16x32_bf16 v[88:91], a[0:3], a[208:211], v[140:143]
    v_exp_f32 v52, v52
    v_mfma_f32_16x16x32_bf16 v[88:91], a[4:7], a[212:215], v[88:91]
    s_waitcnt lgkmcnt(2)
    v_mfma_f32_16x16x32_bf16 v[64:67], a[8:11], a[168:171], v[64:67]
    v_exp_f32 v53, v53
    v_mfma_f32_16x16x32_bf16 v[64:67], a[12:15], a[172:175], v[64:67]
    ds_read_b128 a[24:27], v6 offset:55296
    v_cvt_pk_bf16_f32 v106, v52, v53
    v_mfma_f32_16x16x32_bf16 v[72:75], a[8:11], a[184:187], v[72:75]
    v_exp_f32 v54, v54
    v_mfma_f32_16x16x32_bf16 v[72:75], a[12:15], a[188:191], v[72:75]
    buffer_load_dwordx4 v3, s[24:27], s72 offen offset:0 lds
    s_add_u32 m0, s32, 0x1a000
    v_mfma_f32_16x16x32_bf16 v[80:83], a[8:11], a[200:203], v[80:83]
    v_exp_f32 v55, v55
    v_mfma_f32_16x16x32_bf16 v[80:83], a[12:15], a[204:207], v[80:83]
    ds_read_b128 a[28:31], v6 offset:56320
    v_cvt_pk_bf16_f32 v107, v54, v55
    v_mfma_f32_16x16x32_bf16 v[88:91], a[8:11], a[216:219], v[88:91]
    v_exp_f32 v60, v60
    v_mfma_f32_16x16x32_bf16 v[88:91], a[12:15], a[220:223], v[88:91]
    s_waitcnt lgkmcnt(2)
    v_mfma_f32_16x16x32_bf16 v[68:71], a[16:19], a[160:163], v[128:131]
    v_exp_f32 v61, v61
    v_mfma_f32_16x16x32_bf16 v[68:71], a[20:23], a[164:167], v[68:71]
    ds_read_b128 a[0:3], v6 offset:40960
    v_cvt_pk_bf16_f32 v110, v60, v61
    v_mfma_f32_16x16x32_bf16 v[76:79], a[16:19], a[176:179], v[132:135]
    v_exp_f32 v62, v62
    v_mfma_f32_16x16x32_bf16 v[76:79], a[20:23], a[180:183], v[76:79]
    buffer_load_dwordx4 v2, s[8:11], s68 offen sc1 lds
    s_add_u32 m0, s32, 0x19000
    v_mfma_f32_16x16x32_bf16 v[84:87], a[16:19], a[192:195], v[136:139]
    v_exp_f32 v63, v63
    v_mfma_f32_16x16x32_bf16 v[84:87], a[20:23], a[196:199], v[84:87]
    ds_read_b128 a[4:7], v6 offset:41984
    v_cvt_pk_bf16_f32 v111, v62, v63
    v_mfma_f32_16x16x32_bf16 v[92:95], a[16:19], a[208:211], v[140:143]
    v_mfma_f32_16x16x32_bf16 v[92:95], a[20:23], a[212:215], v[92:95]
    s_waitcnt lgkmcnt(2)
    v_mfma_f32_16x16x32_bf16 v[68:71], a[24:27], a[168:171], v[68:71]
    v_mfma_f32_16x16x32_bf16 v[68:71], a[28:31], a[172:175], v[68:71]
    ds_read_b128 a[8:11], v6 offset:43008
    v_mfma_f32_16x16x32_bf16 v[76:79], a[24:27], a[184:187], v[76:79]
    v_exp_f32 v64, v64
    v_mfma_f32_16x16x32_bf16 v[76:79], a[28:31], a[188:191], v[76:79]
    buffer_load_dwordx4 v3, s[24:27], s73 offen offset:0 lds
    s_add_u32 m0, s32, 0x1b000
    v_mfma_f32_16x16x32_bf16 v[84:87], a[24:27], a[200:203], v[84:87]
    v_exp_f32 v65, v65
    v_mfma_f32_16x16x32_bf16 v[84:87], a[28:31], a[204:207], v[84:87]
    ds_read_b128 a[12:15], v6 offset:44032
    v_cvt_pk_bf16_f32 v112, v64, v65
    v_mfma_f32_16x16x32_bf16 v[92:95], a[24:27], a[216:219], v[92:95]
    v_exp_f32 v66, v66
    v_mfma_f32_16x16x32_bf16 v[92:95], a[28:31], a[220:223], v[92:95]
    s_waitcnt lgkmcnt(2)
    v_mfma_f32_16x16x32_bf16 a[32:35], a[0:3], v[96:99], a[32:35]
    v_exp_f32 v67, v67
    v_mfma_f32_16x16x32_bf16 a[36:39], a[0:3], v[100:103], a[36:39]
    ds_read_b128 a[16:19], v6 offset:45056
    v_cvt_pk_bf16_f32 v113, v66, v67
    v_mfma_f32_16x16x32_bf16 a[40:43], a[0:3], v[104:107], a[40:43]
    v_exp_f32 v72, v72
    v_mfma_f32_16x16x32_bf16 a[44:47], a[0:3], v[108:111], a[44:47]
    buffer_load_dwordx4 v2, s[8:11], s69 offen sc1 lds
    s_add_u32 s72, s72, 0x20000
    s_add_u32 s73, s72, 0x10000
    s_add_u32 s68, s69, s3
    s_add_u32 s69, s68, s3
    s_add_u32 m0, s32, 0x1c000
    v_mfma_f32_16x16x32_bf16 a[48:51], a[4:7], v[96:99], a[48:51]
    v_exp_f32 v73, v73
    v_mfma_f32_16x16x32_bf16 a[52:55], a[4:7], v[100:103], a[52:55]
    ds_read_b128 a[20:23], v6 offset:46080
    v_cvt_pk_bf16_f32 v116, v72, v73
    v_mfma_f32_16x16x32_bf16 a[56:59], a[4:7], v[104:107], a[56:59]
    v_exp_f32 v74, v74
    v_mfma_f32_16x16x32_bf16 a[60:63], a[4:7], v[108:111], a[60:63]
    s_waitcnt lgkmcnt(2)
    v_mfma_f32_16x16x32_bf16 a[64:67], a[8:11], v[96:99], a[64:67]
    v_exp_f32 v75, v75
    v_mfma_f32_16x16x32_bf16 a[68:71], a[8:11], v[100:103], a[68:71]
    ds_read_b128 a[24:27], v6 offset:47104
    v_cvt_pk_bf16_f32 v117, v74, v75
    v_mfma_f32_16x16x32_bf16 a[72:75], a[8:11], v[104:107], a[72:75]
    v_exp_f32 v80, v80
    v_mfma_f32_16x16x32_bf16 a[76:79], a[8:11], v[108:111], a[76:79]
    buffer_load_dwordx4 v3, s[24:27], s72 offen offset:0 lds
    s_add_u32 m0, s32, 0x1e000
    v_mfma_f32_16x16x32_bf16 a[80:83], a[12:15], v[96:99], a[80:83]
    v_exp_f32 v81, v81
    v_mfma_f32_16x16x32_bf16 a[84:87], a[12:15], v[100:103], a[84:87]
    ds_read_b128 a[28:31], v6 offset:48128
    v_cvt_pk_bf16_f32 v120, v80, v81
    v_mfma_f32_16x16x32_bf16 a[88:91], a[12:15], v[104:107], a[88:91]
    v_exp_f32 v82, v82
    v_mfma_f32_16x16x32_bf16 a[92:95], a[12:15], v[108:111], a[92:95]
    s_waitcnt lgkmcnt(2)
    v_mfma_f32_16x16x32_bf16 a[96:99], a[16:19], v[96:99], a[96:99]
    v_exp_f32 v83, v83
    v_mfma_f32_16x16x32_bf16 a[100:103], a[16:19], v[100:103], a[100:103]
    ds_read_b128 a[0:3], v7 offset:0
    v_cvt_pk_bf16_f32 v121, v82, v83
    v_mfma_f32_16x16x32_bf16 a[104:107], a[16:19], v[104:107], a[104:107]
    v_exp_f32 v88, v88
    v_mfma_f32_16x16x32_bf16 a[108:111], a[16:19], v[108:111], a[108:111]
    buffer_load_dwordx4 v2, s[8:11], s68 offen sc1 lds
    s_add_u32 m0, s32, 0x1d000
    v_mfma_f32_16x16x32_bf16 a[112:115], a[20:23], v[96:99], a[112:115]
    v_exp_f32 v89, v89
    v_mfma_f32_16x16x32_bf16 a[116:119], a[20:23], v[100:103], a[116:119]
    ds_read_b128 a[4:7], v7 offset:1024
    v_cvt_pk_bf16_f32 v124, v88, v89
    v_mfma_f32_16x16x32_bf16 a[120:123], a[20:23], v[104:107], a[120:123]
    v_exp_f32 v90, v90
    v_mfma_f32_16x16x32_bf16 a[124:127], a[20:23], v[108:111], a[124:127]
    s_waitcnt lgkmcnt(2)
    v_mfma_f32_16x16x32_bf16 a[128:131], a[24:27], v[96:99], a[128:131]
    v_exp_f32 v91, v91
    v_mfma_f32_16x16x32_bf16 a[132:135], a[24:27], v[100:103], a[132:135]
    ds_read_b128 a[8:11], v7 offset:2048
    v_cvt_pk_bf16_f32 v125, v90, v91
    v_mfma_f32_16x16x32_bf16 a[136:139], a[24:27], v[104:107], a[136:139]
    v_exp_f32 v68, v68
    v_mfma_f32_16x16x32_bf16 a[140:143], a[24:27], v[108:111], a[140:143]
    buffer_load_dwordx4 v3, s[24:27], s73 offen offset:0 lds
    s_add_u32 m0, s32, 0x1f000
    v_mfma_f32_16x16x32_bf16 a[144:147], a[28:31], v[96:99], a[144:147]
    v_exp_f32 v69, v69
    v_mfma_f32_16x16x32_bf16 a[148:151], a[28:31], v[100:103], a[148:151]
    ds_read_b128 a[12:15], v7 offset:3072
    v_cvt_pk_bf16_f32 v114, v68, v69
    v_mfma_f32_16x16x32_bf16 a[152:155], a[28:31], v[104:107], a[152:155]
    v_exp_f32 v70, v70
    v_mfma_f32_16x16x32_bf16 a[156:159], a[28:31], v[108:111], a[156:159]
    s_waitcnt lgkmcnt(2)
    v_mfma_f32_16x16x32_bf16 v[16:19], v[10:13], v[96:99], v[16:19]
    v_exp_f32 v71, v71
    v_mfma_f32_16x16x32_bf16 v[20:23], v[10:13], v[100:103], v[20:23]
    v_cvt_pk_bf16_f32 v115, v70, v71
    v_mfma_f32_16x16x32_bf16 v[24:27], v[10:13], v[104:107], v[24:27]
    v_exp_f32 v76, v76
    v_mfma_f32_16x16x32_bf16 v[28:31], v[10:13], v[108:111], v[28:31]
    buffer_load_dwordx4 v2, s[8:11], s69 offen sc1 lds
    s_add_u32 s72, s72, 0x20000
    s_add_u32 s73, s72, 0x10000
    s_add_u32 s68, s69, s3
    s_add_u32 s69, s68, s3
    v_mfma_f32_16x16x32_bf16 v[32:35], a[0:3], a[160:163], v[128:131]
    v_exp_f32 v77, v77
    v_mfma_f32_16x16x32_bf16 v[32:35], a[4:7], a[164:167], v[32:35]
    ds_read_b128 a[16:19], v7 offset:4096
    v_cvt_pk_bf16_f32 v118, v76, v77
    v_mfma_f32_16x16x32_bf16 v[40:43], a[0:3], a[176:179], v[132:135]
    v_exp_f32 v78, v78
    v_mfma_f32_16x16x32_bf16 v[40:43], a[4:7], a[180:183], v[40:43]
    buffer_load_dwordx4 a[224:227], v14, s[12:15], s28 offen offset:0
    v_mfma_f32_16x16x32_bf16 v[48:51], a[0:3], a[192:195], v[136:139]
    v_exp_f32 v79, v79
    v_mfma_f32_16x16x32_bf16 v[48:51], a[4:7], a[196:199], v[48:51]
    ds_read_b128 a[20:23], v7 offset:5120
    v_cvt_pk_bf16_f32 v119, v78, v79
    v_mfma_f32_16x16x32_bf16 v[56:59], a[0:3], a[208:211], v[140:143]
    v_exp_f32 v84, v84
    v_mfma_f32_16x16x32_bf16 v[56:59], a[4:7], a[212:215], v[56:59]
    s_waitcnt lgkmcnt(2)
    v_mfma_f32_16x16x32_bf16 v[32:35], a[8:11], a[168:171], v[32:35]
    v_exp_f32 v85, v85
    v_mfma_f32_16x16x32_bf16 v[32:35], a[12:15], a[172:175], v[32:35]
    ds_read_b128 a[24:27], v7 offset:6144
    v_cvt_pk_bf16_f32 v122, v84, v85
    v_mfma_f32_16x16x32_bf16 v[40:43], a[8:11], a[184:187], v[40:43]
    v_exp_f32 v86, v86
    v_mfma_f32_16x16x32_bf16 v[40:43], a[12:15], a[188:191], v[40:43]
    buffer_load_dwordx4 a[228:231], v15, s[16:19], s29 offen offset:0
    v_mfma_f32_16x16x32_bf16 v[48:51], a[8:11], a[200:203], v[48:51]
    v_exp_f32 v87, v87
    v_mfma_f32_16x16x32_bf16 v[48:51], a[12:15], a[204:207], v[48:51]
    ds_read_b128 a[28:31], v7 offset:7168
    v_cvt_pk_bf16_f32 v123, v86, v87
    v_mfma_f32_16x16x32_bf16 v[56:59], a[8:11], a[216:219], v[56:59]
    v_exp_f32 v92, v92
    v_mfma_f32_16x16x32_bf16 v[56:59], a[12:15], a[220:223], v[56:59]
    s_waitcnt lgkmcnt(2)
    v_mfma_f32_16x16x32_bf16 v[36:39], a[16:19], a[160:163], v[128:131]
    v_exp_f32 v93, v93
    v_mfma_f32_16x16x32_bf16 v[36:39], a[20:23], a[164:167], v[36:39]
    ds_read_b128 a[0:3], v6 offset:57344
    v_cvt_pk_bf16_f32 v126, v92, v93
    v_mfma_f32_16x16x32_bf16 v[44:47], a[16:19], a[176:179], v[132:135]
    v_exp_f32 v94, v94
    v_mfma_f32_16x16x32_bf16 v[44:47], a[20:23], a[180:183], v[44:47]
    buffer_load_dwordx4 a[232:235], v14, s[12:15], s28 offen offset:1024
    v_mfma_f32_16x16x32_bf16 v[52:55], a[16:19], a[192:195], v[136:139]
    v_exp_f32 v95, v95
    v_mfma_f32_16x16x32_bf16 v[52:55], a[20:23], a[196:199], v[52:55]
    ds_read_b128 a[4:7], v6 offset:58368
    v_cvt_pk_bf16_f32 v127, v94, v95
    v_mfma_f32_16x16x32_bf16 v[60:63], a[16:19], a[208:211], v[140:143]
    v_mfma_f32_16x16x32_bf16 v[60:63], a[20:23], a[212:215], v[60:63]
    s_waitcnt lgkmcnt(2)
    v_mfma_f32_16x16x32_bf16 v[36:39], a[24:27], a[168:171], v[36:39]
    v_mfma_f32_16x16x32_bf16 v[36:39], a[28:31], a[172:175], v[36:39]
    ds_read_b128 a[8:11], v6 offset:59392
    v_mfma_f32_16x16x32_bf16 v[44:47], a[24:27], a[184:187], v[44:47]
    v_exp_f32 v32, v32
    v_mfma_f32_16x16x32_bf16 v[44:47], a[28:31], a[188:191], v[44:47]
    buffer_load_dwordx4 a[236:239], v15, s[16:19], s29 offen offset:896
    s_add_u32 s28, s28, 0x400000
    s_add_u32 s29, s29, 0x1c0000
    v_mfma_f32_16x16x32_bf16 v[52:55], a[24:27], a[200:203], v[52:55]
    v_exp_f32 v33, v33
    v_mfma_f32_16x16x32_bf16 v[52:55], a[28:31], a[204:207], v[52:55]
    ds_read_b128 a[12:15], v6 offset:60416
    v_cvt_pk_bf16_f32 v96, v32, v33
    v_mfma_f32_16x16x32_bf16 v[60:63], a[24:27], a[216:219], v[60:63]
    v_exp_f32 v34, v34
    v_mfma_f32_16x16x32_bf16 v[60:63], a[28:31], a[220:223], v[60:63]
    s_waitcnt lgkmcnt(2)
    v_mfma_f32_16x16x32_bf16 a[32:35], a[0:3], v[112:115], a[32:35]
    v_exp_f32 v35, v35
    v_mfma_f32_16x16x32_bf16 a[36:39], a[0:3], v[116:119], a[36:39]
    ds_read_b128 a[16:19], v6 offset:61440
    v_cvt_pk_bf16_f32 v97, v34, v35
    v_mfma_f32_16x16x32_bf16 a[40:43], a[0:3], v[120:123], a[40:43]
    v_exp_f32 v40, v40
    v_mfma_f32_16x16x32_bf16 a[44:47], a[0:3], v[124:127], a[44:47]
    s_getpc_b64 s[80:81]
    global_load_dword a255, v0, s[80:81] offset:2048
    v_mfma_f32_16x16x32_bf16 a[48:51], a[4:7], v[112:115], a[48:51]
    v_exp_f32 v41, v41
    v_mfma_f32_16x16x32_bf16 a[52:55], a[4:7], v[116:119], a[52:55]
    ds_read_b128 a[20:23], v6 offset:62464
    v_cvt_pk_bf16_f32 v100, v40, v41
    v_mfma_f32_16x16x32_bf16 a[56:59], a[4:7], v[120:123], a[56:59]
    v_exp_f32 v42, v42
    v_mfma_f32_16x16x32_bf16 a[60:63], a[4:7], v[124:127], a[60:63]
    s_waitcnt lgkmcnt(2)
    v_mfma_f32_16x16x32_bf16 a[64:67], a[8:11], v[112:115], a[64:67]
    v_exp_f32 v43, v43
    v_mfma_f32_16x16x32_bf16 a[68:71], a[8:11], v[116:119], a[68:71]
    ds_read_b128 a[24:27], v6 offset:63488
    v_cvt_pk_bf16_f32 v101, v42, v43
    v_mfma_f32_16x16x32_bf16 a[72:75], a[8:11], v[120:123], a[72:75]
    v_exp_f32 v48, v48
    v_mfma_f32_16x16x32_bf16 a[76:79], a[8:11], v[124:127], a[76:79]
    v_mfma_f32_16x16x32_bf16 a[80:83], a[12:15], v[112:115], a[80:83]
    v_exp_f32 v49, v49
    v_mfma_f32_16x16x32_bf16 a[84:87], a[12:15], v[116:119], a[84:87]
    ds_read_b128 a[28:31], v6 offset:64512
    v_cvt_pk_bf16_f32 v104, v48, v49
    v_mfma_f32_16x16x32_bf16 a[88:91], a[12:15], v[120:123], a[88:91]
    v_exp_f32 v50, v50
    v_mfma_f32_16x16x32_bf16 a[92:95], a[12:15], v[124:127], a[92:95]
    s_waitcnt lgkmcnt(2)
    v_mfma_f32_16x16x32_bf16 a[96:99], a[16:19], v[112:115], a[96:99]
    v_exp_f32 v51, v51
    v_mfma_f32_16x16x32_bf16 a[100:103], a[16:19], v[116:119], a[100:103]
    ds_read_b128 a[0:3], v7 offset:16384
    v_cvt_pk_bf16_f32 v105, v50, v51
    v_mfma_f32_16x16x32_bf16 a[104:107], a[16:19], v[120:123], a[104:107]
    v_exp_f32 v56, v56
    v_mfma_f32_16x16x32_bf16 a[108:111], a[16:19], v[124:127], a[108:111]
    v_mfma_f32_16x16x32_bf16 a[112:115], a[20:23], v[112:115], a[112:115]
    v_exp_f32 v57, v57
    v_mfma_f32_16x16x32_bf16 a[116:119], a[20:23], v[116:119], a[116:119]
    ds_read_b128 a[4:7], v7 offset:17408
    v_cvt_pk_bf16_f32 v108, v56, v57
    v_mfma_f32_16x16x32_bf16 a[120:123], a[20:23], v[120:123], a[120:123]
    v_exp_f32 v58, v58
    v_mfma_f32_16x16x32_bf16 a[124:127], a[20:23], v[124:127], a[124:127]
    s_waitcnt lgkmcnt(2)
    v_mfma_f32_16x16x32_bf16 a[128:131], a[24:27], v[112:115], a[128:131]
    v_exp_f32 v59, v59
    v_mfma_f32_16x16x32_bf16 a[132:135], a[24:27], v[116:119], a[132:135]
    ds_read_b128 a[8:11], v7 offset:18432
    v_cvt_pk_bf16_f32 v109, v58, v59
    v_mfma_f32_16x16x32_bf16 a[136:139], a[24:27], v[120:123], a[136:139]
    v_exp_f32 v36, v36
    v_mfma_f32_16x16x32_bf16 a[140:143], a[24:27], v[124:127], a[140:143]
    v_mfma_f32_16x16x32_bf16 a[144:147], a[28:31], v[112:115], a[144:147]
    v_exp_f32 v37, v37
    v_mfma_f32_16x16x32_bf16 a[148:151], a[28:31], v[116:119], a[148:151]
    ds_read_b128 a[12:15], v7 offset:19456
    v_cvt_pk_bf16_f32 v98, v36, v37
    v_mfma_f32_16x16x32_bf16 a[152:155], a[28:31], v[120:123], a[152:155]
    v_exp_f32 v38, v38
    v_mfma_f32_16x16x32_bf16 a[156:159], a[28:31], v[124:127], a[156:159]
    s_waitcnt lgkmcnt(2)
    v_mfma_f32_16x16x32_bf16 v[16:19], v[10:13], v[112:115], v[16:19]
    v_exp_f32 v39, v39
    v_mfma_f32_16x16x32_bf16 v[20:23], v[10:13], v[116:119], v[20:23]
    v_cvt_pk_bf16_f32 v99, v38, v39
    v_mfma_f32_16x16x32_bf16 v[24:27], v[10:13], v[120:123], v[24:27]
    v_exp_f32 v44, v44
    v_mfma_f32_16x16x32_bf16 v[28:31], v[10:13], v[124:127], v[28:31]
    v_mfma_f32_16x16x32_bf16 v[64:67], a[0:3], a[160:163], v[128:131]
    v_exp_f32 v45, v45
    v_mfma_f32_16x16x32_bf16 v[64:67], a[4:7], a[164:167], v[64:67]
    ds_read_b128 a[16:19], v7 offset:20480
    v_cvt_pk_bf16_f32 v102, v44, v45
    v_mfma_f32_16x16x32_bf16 v[72:75], a[0:3], a[176:179], v[132:135]
    v_exp_f32 v46, v46
    v_mfma_f32_16x16x32_bf16 v[72:75], a[4:7], a[180:183], v[72:75]
    s_add_u32 m0, s32, 0x20000
    v_mfma_f32_16x16x32_bf16 v[80:83], a[0:3], a[192:195], v[136:139]
    v_exp_f32 v47, v47
    v_mfma_f32_16x16x32_bf16 v[80:83], a[4:7], a[196:199], v[80:83]
    ds_read_b128 a[20:23], v7 offset:21504
    v_cvt_pk_bf16_f32 v103, v46, v47
    v_mfma_f32_16x16x32_bf16 v[88:91], a[0:3], a[208:211], v[140:143]
    v_exp_f32 v52, v52
    v_mfma_f32_16x16x32_bf16 v[88:91], a[4:7], a[212:215], v[88:91]
    s_waitcnt lgkmcnt(2)
    v_mfma_f32_16x16x32_bf16 v[64:67], a[8:11], a[168:171], v[64:67]
    v_exp_f32 v53, v53
    v_mfma_f32_16x16x32_bf16 v[64:67], a[12:15], a[172:175], v[64:67]
    ds_read_b128 a[24:27], v7 offset:22528
    v_cvt_pk_bf16_f32 v106, v52, v53
    v_mfma_f32_16x16x32_bf16 v[72:75], a[8:11], a[184:187], v[72:75]
    v_exp_f32 v54, v54
    v_mfma_f32_16x16x32_bf16 v[72:75], a[12:15], a[188:191], v[72:75]
    buffer_load_dwordx4 v3, s[24:27], s72 offen offset:0 lds
    s_add_u32 m0, s32, 0x22000
    v_mfma_f32_16x16x32_bf16 v[80:83], a[8:11], a[200:203], v[80:83]
    v_exp_f32 v55, v55
    v_mfma_f32_16x16x32_bf16 v[80:83], a[12:15], a[204:207], v[80:83]
    ds_read_b128 a[28:31], v7 offset:23552
    v_cvt_pk_bf16_f32 v107, v54, v55
    v_mfma_f32_16x16x32_bf16 v[88:91], a[8:11], a[216:219], v[88:91]
    v_exp_f32 v60, v60
    v_mfma_f32_16x16x32_bf16 v[88:91], a[12:15], a[220:223], v[88:91]
    s_waitcnt lgkmcnt(2)
    v_mfma_f32_16x16x32_bf16 v[68:71], a[16:19], a[160:163], v[128:131]
    v_exp_f32 v61, v61
    v_mfma_f32_16x16x32_bf16 v[68:71], a[20:23], a[164:167], v[68:71]
    ds_read_b128 a[0:3], v7 offset:8192
    v_cvt_pk_bf16_f32 v110, v60, v61
    v_mfma_f32_16x16x32_bf16 v[76:79], a[16:19], a[176:179], v[132:135]
    v_exp_f32 v62, v62
    v_mfma_f32_16x16x32_bf16 v[76:79], a[20:23], a[180:183], v[76:79]
    buffer_load_dwordx4 v2, s[8:11], s68 offen sc1 lds
    s_add_u32 m0, s32, 0x21000
    v_mfma_f32_16x16x32_bf16 v[84:87], a[16:19], a[192:195], v[136:139]
    v_exp_f32 v63, v63
    v_mfma_f32_16x16x32_bf16 v[84:87], a[20:23], a[196:199], v[84:87]
    ds_read_b128 a[4:7], v7 offset:9216
    v_cvt_pk_bf16_f32 v111, v62, v63
    v_mfma_f32_16x16x32_bf16 v[92:95], a[16:19], a[208:211], v[140:143]
    v_mfma_f32_16x16x32_bf16 v[92:95], a[20:23], a[212:215], v[92:95]
    s_waitcnt lgkmcnt(2)
    v_mfma_f32_16x16x32_bf16 v[68:71], a[24:27], a[168:171], v[68:71]
    v_mfma_f32_16x16x32_bf16 v[68:71], a[28:31], a[172:175], v[68:71]
    ds_read_b128 a[8:11], v7 offset:10240
    v_mfma_f32_16x16x32_bf16 v[76:79], a[24:27], a[184:187], v[76:79]
    v_exp_f32 v64, v64
    v_mfma_f32_16x16x32_bf16 v[76:79], a[28:31], a[188:191], v[76:79]
    buffer_load_dwordx4 v3, s[24:27], s73 offen offset:0 lds
    s_add_u32 m0, s32, 0x23000
    v_mfma_f32_16x16x32_bf16 v[84:87], a[24:27], a[200:203], v[84:87]
    v_exp_f32 v65, v65
    v_mfma_f32_16x16x32_bf16 v[84:87], a[28:31], a[204:207], v[84:87]
    ds_read_b128 a[12:15], v7 offset:11264
    v_cvt_pk_bf16_f32 v112, v64, v65
    v_mfma_f32_16x16x32_bf16 v[92:95], a[24:27], a[216:219], v[92:95]
    v_exp_f32 v66, v66
    v_mfma_f32_16x16x32_bf16 v[92:95], a[28:31], a[220:223], v[92:95]
    s_waitcnt lgkmcnt(2)
    v_mfma_f32_16x16x32_bf16 a[32:35], a[0:3], v[96:99], a[32:35]
    v_exp_f32 v67, v67
    v_mfma_f32_16x16x32_bf16 a[36:39], a[0:3], v[100:103], a[36:39]
    ds_read_b128 a[16:19], v7 offset:12288
    v_cvt_pk_bf16_f32 v113, v66, v67
    v_mfma_f32_16x16x32_bf16 a[40:43], a[0:3], v[104:107], a[40:43]
    v_exp_f32 v72, v72
    v_mfma_f32_16x16x32_bf16 a[44:47], a[0:3], v[108:111], a[44:47]
    buffer_load_dwordx4 v2, s[8:11], s69 offen sc1 lds
    s_add_u32 s72, s72, 0x20000
    s_add_u32 s73, s72, 0x10000
    s_add_u32 s68, s69, s3
    s_add_u32 s69, s68, s3
    s_add_u32 m0, s32, 0x24000
    v_mfma_f32_16x16x32_bf16 a[48:51], a[4:7], v[96:99], a[48:51]
    v_exp_f32 v73, v73
    v_mfma_f32_16x16x32_bf16 a[52:55], a[4:7], v[100:103], a[52:55]
    ds_read_b128 a[20:23], v7 offset:13312
    v_cvt_pk_bf16_f32 v116, v72, v73
    v_mfma_f32_16x16x32_bf16 a[56:59], a[4:7], v[104:107], a[56:59]
    v_exp_f32 v74, v74
    v_mfma_f32_16x16x32_bf16 a[60:63], a[4:7], v[108:111], a[60:63]
    s_waitcnt lgkmcnt(2)
    v_mfma_f32_16x16x32_bf16 a[64:67], a[8:11], v[96:99], a[64:67]
    v_exp_f32 v75, v75
    v_mfma_f32_16x16x32_bf16 a[68:71], a[8:11], v[100:103], a[68:71]
    ds_read_b128 a[24:27], v7 offset:14336
    v_cvt_pk_bf16_f32 v117, v74, v75
    v_mfma_f32_16x16x32_bf16 a[72:75], a[8:11], v[104:107], a[72:75]
    v_exp_f32 v80, v80
    v_mfma_f32_16x16x32_bf16 a[76:79], a[8:11], v[108:111], a[76:79]
    buffer_load_dwordx4 v3, s[24:27], s72 offen offset:0 lds
    s_add_u32 m0, s32, 0x26000
    v_mfma_f32_16x16x32_bf16 a[80:83], a[12:15], v[96:99], a[80:83]
    v_exp_f32 v81, v81
    v_mfma_f32_16x16x32_bf16 a[84:87], a[12:15], v[100:103], a[84:87]
    ds_read_b128 a[28:31], v7 offset:15360
    v_cvt_pk_bf16_f32 v120, v80, v81
    v_mfma_f32_16x16x32_bf16 a[88:91], a[12:15], v[104:107], a[88:91]
    v_exp_f32 v82, v82
    v_mfma_f32_16x16x32_bf16 a[92:95], a[12:15], v[108:111], a[92:95]
    s_waitcnt lgkmcnt(2)
    v_mfma_f32_16x16x32_bf16 a[96:99], a[16:19], v[96:99], a[96:99]
    v_exp_f32 v83, v83
    v_mfma_f32_16x16x32_bf16 a[100:103], a[16:19], v[100:103], a[100:103]
    ds_read_b128 a[0:3], v7 offset:24576
    v_cvt_pk_bf16_f32 v121, v82, v83
    v_mfma_f32_16x16x32_bf16 a[104:107], a[16:19], v[104:107], a[104:107]
    v_exp_f32 v88, v88
    v_mfma_f32_16x16x32_bf16 a[108:111], a[16:19], v[108:111], a[108:111]
    buffer_load_dwordx4 v2, s[8:11], s68 offen sc1 lds
    s_add_u32 m0, s32, 0x25000
    v_mfma_f32_16x16x32_bf16 a[112:115], a[20:23], v[96:99], a[112:115]
    v_exp_f32 v89, v89
    v_mfma_f32_16x16x32_bf16 a[116:119], a[20:23], v[100:103], a[116:119]
    ds_read_b128 a[4:7], v7 offset:25600
    v_cvt_pk_bf16_f32 v124, v88, v89
    v_mfma_f32_16x16x32_bf16 a[120:123], a[20:23], v[104:107], a[120:123]
    v_exp_f32 v90, v90
    v_mfma_f32_16x16x32_bf16 a[124:127], a[20:23], v[108:111], a[124:127]
    s_waitcnt lgkmcnt(2)
    v_mfma_f32_16x16x32_bf16 a[128:131], a[24:27], v[96:99], a[128:131]
    v_exp_f32 v91, v91
    v_mfma_f32_16x16x32_bf16 a[132:135], a[24:27], v[100:103], a[132:135]
    ds_read_b128 a[8:11], v7 offset:26624
    v_cvt_pk_bf16_f32 v125, v90, v91
    v_mfma_f32_16x16x32_bf16 a[136:139], a[24:27], v[104:107], a[136:139]
    v_exp_f32 v68, v68
    v_mfma_f32_16x16x32_bf16 a[140:143], a[24:27], v[108:111], a[140:143]
    buffer_load_dwordx4 v3, s[24:27], s73 offen offset:0 lds
    s_add_u32 m0, s32, 0x27000
    v_mfma_f32_16x16x32_bf16 a[144:147], a[28:31], v[96:99], a[144:147]
    v_exp_f32 v69, v69
    v_mfma_f32_16x16x32_bf16 a[148:151], a[28:31], v[100:103], a[148:151]
    ds_read_b128 a[12:15], v7 offset:27648
    v_cvt_pk_bf16_f32 v114, v68, v69
    v_mfma_f32_16x16x32_bf16 a[152:155], a[28:31], v[104:107], a[152:155]
    v_exp_f32 v70, v70
    v_mfma_f32_16x16x32_bf16 a[156:159], a[28:31], v[108:111], a[156:159]
    s_waitcnt lgkmcnt(2)
    v_mfma_f32_16x16x32_bf16 v[16:19], v[10:13], v[96:99], v[16:19]
    v_exp_f32 v71, v71
    v_mfma_f32_16x16x32_bf16 v[20:23], v[10:13], v[100:103], v[20:23]
    v_cvt_pk_bf16_f32 v115, v70, v71
    v_mfma_f32_16x16x32_bf16 v[24:27], v[10:13], v[104:107], v[24:27]
    v_exp_f32 v76, v76
    v_mfma_f32_16x16x32_bf16 v[28:31], v[10:13], v[108:111], v[28:31]
    buffer_load_dwordx4 v2, s[8:11], s69 offen sc1 lds
    s_add_u32 s72, s72, 0x20000
    s_add_u32 s73, s72, 0x10000
    s_add_u32 s68, s69, s3
    s_add_u32 s69, s68, s3
    s_waitcnt vmcnt(26)
    v_cmp_ne_u32 vcc, 0, v9
    s_nop 1
    s_and_b32 s78, vcc_lo, s38
    s_cmp_eq_u32 s78, s38
    s_cbranch_scc1 L_m_poll_e_ok
    s_mov_b32 s79, 0x100000
L_m_poll_e:
    buffer_load_dword v9, v5, s[20:23], s47 offen sc1
    s_waitcnt vmcnt(0)
    v_cmp_ne_u32 vcc, 0, v9
    s_nop 1
    s_and_b32 s78, vcc_lo, s38
    s_cmp_eq_u32 s78, s38
    s_cbranch_scc1 L_m_poll_e_ok
    s_sleep 1
    s_sub_u32 s79, s79, 1
    s_cmp_lg_u32 s79, 0
    s_cbranch_scc1 L_m_poll_e
L_m_poll_e_ok:
    v_exp_f32 v77, v77
    v_exp_f32 v78, v78
    v_exp_f32 v79, v79
    v_exp_f32 v84, v84
    v_exp_f32 v85, v85
    v_exp_f32 v86, v86
    v_exp_f32 v87, v87
    v_exp_f32 v92, v92
    v_exp_f32 v93, v93
    v_exp_f32 v94, v94
    v_exp_f32 v95, v95
    s_nop 0
    v_cvt_pk_bf16_f32 v118, v76, v77
    v_cvt_pk_bf16_f32 v119, v78, v79
    v_cvt_pk_bf16_f32 v122, v84, v85
    v_cvt_pk_bf16_f32 v123, v86, v87
    v_cvt_pk_bf16_f32 v126, v92, v93
    v_cvt_pk_bf16_f32 v127, v94, v95
    s_nop 1
    v_mfma_f32_16x16x32_bf16 a[32:35], a[0:3], v[112:115], a[32:35]
    v_mfma_f32_16x16x32_bf16 a[36:39], a[0:3], v[116:119], a[36:39]
    ds_read_b128 a[16:19], v7 offset:28672
    v_mfma_f32_16x16x32_bf16 a[40:43], a[0:3], v[120:123], a[40:43]
    v_mfma_f32_16x16x32_bf16 a[44:47], a[0:3], v[124:127], a[44:47]
    buffer_load_dwordx4 a[224:227], v4, s[20:23], s30 offen offset:0 sc1
    v_mfma_f32_16x16x32_bf16 a[48:51], a[4:7], v[112:115], a[48:51]
    v_mfma_f32_16x16x32_bf16 a[52:55], a[4:7], v[116:119], a[52:55]
    ds_read_b128 a[20:23], v7 offset:29696
    v_mfma_f32_16x16x32_bf16 a[56:59], a[4:7], v[120:123], a[56:59]
    v_mfma_f32_16x16x32_bf16 a[60:63], a[4:7], v[124:127], a[60:63]
    s_waitcnt lgkmcnt(2)
    v_mfma_f32_16x16x32_bf16 a[64:67], a[8:11], v[112:115], a[64:67]
    v_mfma_f32_16x16x32_bf16 a[68:71], a[8:11], v[116:119], a[68:71]
    ds_read_b128 a[24:27], v7 offset:30720
    v_mfma_f32_16x16x32_bf16 a[72:75], a[8:11], v[120:123], a[72:75]
    v_mfma_f32_16x16x32_bf16 a[76:79], a[8:11], v[124:127], a[76:79]
    buffer_load_dwordx4 a[228:231], v4, s[20:23], s30 offen offset:1024 sc1
    v_mfma_f32_16x16x32_bf16 a[80:83], a[12:15], v[112:115], a[80:83]
    v_mfma_f32_16x16x32_bf16 a[84:87], a[12:15], v[116:119], a[84:87]
    ds_read_b128 a[28:31], v7 offset:31744
    v_mfma_f32_16x16x32_bf16 a[88:91], a[12:15], v[120:123], a[88:91]
    v_mfma_f32_16x16x32_bf16 a[92:95], a[12:15], v[124:127], a[92:95]
    s_waitcnt lgkmcnt(2)
    v_mfma_f32_16x16x32_bf16 a[96:99], a[16:19], v[112:115], a[96:99]
    v_mfma_f32_16x16x32_bf16 a[100:103], a[16:19], v[116:119], a[100:103]
    v_mfma_f32_16x16x32_bf16 a[104:107], a[16:19], v[120:123], a[104:107]
    v_mfma_f32_16x16x32_bf16 a[108:111], a[16:19], v[124:127], a[108:111]
    buffer_load_dwordx4 a[232:235], v4, s[20:23], s30 offen offset:2048 sc1
    v_mfma_f32_16x16x32_bf16 a[112:115], a[20:23], v[112:115], a[112:115]
    v_mfma_f32_16x16x32_bf16 a[116:119], a[20:23], v[116:119], a[116:119]
    v_mfma_f32_16x16x32_bf16 a[120:123], a[20:23], v[120:123], a[120:123]
    v_mfma_f32_16x16x32_bf16 a[124:127], a[20:23], v[124:127], a[124:127]
    s_waitcnt lgkmcnt(0)
    v_mfma_f32_16x16x32_bf16 a[128:131], a[24:27], v[112:115], a[128:131]
    v_mfma_f32_16x16x32_bf16 a[132:135], a[24:27], v[116:119], a[132:135]
    v_mfma_f32_16x16x32_bf16 a[136:139], a[24:27], v[120:123], a[136:139]
    v_mfma_f32_16x16x32_bf16 a[140:143], a[24:27], v[124:127], a[140:143]
    buffer_load_dwordx4 a[236:239], v4, s[20:23], s30 offen offset:3072 sc1
    s_add_u32 s30, s30, 4096
    v_mfma_f32_16x16x32_bf16 a[144:147], a[28:31], v[112:115], a[144:147]
    v_mfma_f32_16x16x32_bf16 a[148:151], a[28:31], v[116:119], a[148:151]
    v_mfma_f32_16x16x32_bf16 a[152:155], a[28:31], v[120:123], a[152:155]
    v_mfma_f32_16x16x32_bf16 a[156:159], a[28:31], v[124:127], a[156:159]
    v_mfma_f32_16x16x32_bf16 v[16:19], v[10:13], v[112:115], v[16:19]
    v_mfma_f32_16x16x32_bf16 v[20:23], v[10:13], v[116:119], v[20:23]
    v_mfma_f32_16x16x32_bf16 v[24:27], v[10:13], v[120:123], v[24:27]
    v_mfma_f32_16x16x32_bf16 v[28:31], v[10:13], v[124:127], v[28:31]
    buffer_load_dwordx4 a[240:243], v4, s[20:23], s30 offen offset:0 sc1
    buffer_load_dwordx4 a[244:247], v4, s[20:23], s30 offen offset:1024 sc1
    buffer_load_dwordx4 a[248:251], v4, s[20:23], s30 offen offset:2048 sc1
    buffer_load_dwordx4 a[252:255], v4, s[20:23], s30 offen offset:3072 sc1
    s_add_u32 s30, s30, 4096
    v_mov_b32 v34, 0x71800000
    s_nop 7
    v_add_f32 v32, v16, v20
    v_add_f32 v33, v24, v28
    v_add_f32 v33, v32, v33
    v_cmp_nlt_f32 vcc, v33, v34
    s_nop 4
    s_cbranch_vccnz L_m_slow
L_m_fin:
    v_rcp_f32 v128, v16
    v_rcp_f32 v129, v16
    v_rcp_f32 v130, v20
    v_rcp_f32 v131, v20
    v_rcp_f32 v132, v24
    v_rcp_f32 v133, v24
    v_rcp_f32 v134, v28
    v_rcp_f32 v135, v28
    s_lshl_b32 s61, s37, 13
    s_add_u32 s61, s61, 0x800000
    s_mul_i32 s60, s42, 262144
    s_mul_i32 s62, s59, 262144
    s_add_u32 s60, s60, s61
    s_add_u32 s62, s62, s61
    s_add_u32 s61, s60, 4096
    s_add_u32 s63, s62, 4096
    buffer_load_dwordx4 a[160:163], v4, s[20:23], s30 offen offset:0 sc1
    buffer_load_dwordx4 a[164:167], v4, s[20:23], s30 offen offset:1024 sc1
    buffer_load_dwordx4 a[168:171], v4, s[20:23], s30 offen offset:2048 sc1
    buffer_load_dwordx4 a[172:175], v4, s[20:23], s30 offen offset:3072 sc1
    s_add_u32 s30, s30, 4096
    buffer_load_dwordx4 a[176:179], v4, s[20:23], s30 offen offset:0 sc1
    buffer_load_dwordx4 a[180:183], v4, s[20:23], s30 offen offset:1024 sc1
    buffer_load_dwordx4 a[184:187], v4, s[20:23], s30 offen offset:2048 sc1
    buffer_load_dwordx4 a[188:191], v4, s[20:23], s30 offen offset:3072 sc1
    s_add_u32 s30, s30, 4096
    v_lshrrev_b32 v21, 5, v1
    v_lshlrev_b32 v21, 10, v21
    v_bfe_u32 v20, v1, 2, 3
    v_lshl_add_u32 v21, v20, 6, v21
    v_and_b32 v20, 3, v1
    v_lshl_add_u32 v21, v20, 3, v21
    v_bfe_u32 v20, v1, 4, 1
    v_lshl_add_u32 v20, v20, 5, v21
    v_xor_b32 v21, 32, v20
    v_add_u32 v22, 0x10000, v20
    v_add_u32 v23, 0x10000, v21
    v_add_u32 v24, 0x20000, v20
    v_add_u32 v25, 0x20000, v21
    s_cmp_eq_u32 s51, 0
    s_cbranch_scc1 L_m_tr_s
    v_accvgpr_read_b32 v32, a32
    v_accvgpr_read_b32 v33, a33
    v_accvgpr_read_b32 v34, a34
    v_accvgpr_read_b32 v35, a35
    v_accvgpr_read_b32 v36, a48
    v_accvgpr_read_b32 v37, a49
    v_accvgpr_read_b32 v38, a50
    v_accvgpr_read_b32 v39, a51
    v_pk_mul_f32 v[32:33], v[32:33], v[128:129]
    v_pk_mul_f32 v[34:35], v[34:35], v[128:129]
    v_pk_mul_f32 v[36:37], v[36:37], v[128:129]
    v_pk_mul_f32 v[38:39], v[38:39], v[128:129]
    v_cvt_pk_bf16_f32 v32, v32, v33
    v_cvt_pk_bf16_f32 v33, v34, v35
    v_cvt_pk_bf16_f32 v34, v36, v37
    v_cvt_pk_bf16_f32 v35, v38, v39
    buffer_store_dwordx4 v[32:35], v4, s[20:23], s60 offen offset:0 sc1
    v_accvgpr_read_b32 v40, a36
    v_accvgpr_read_b32 v41, a37
    v_accvgpr_read_b32 v42, a38
    v_accvgpr_read_b32 v43, a39
    v_accvgpr_read_b32 v44, a52
    v_accvgpr_read_b32 v45, a53
    v_accvgpr_read_b32 v46, a54
    v_accvgpr_read_b32 v47, a55
    v_pk_mul_f32 v[40:41], v[40:41], v[130:131]
    v_pk_mul_f32 v[42:43], v[42:43], v[130:131]
    v_pk_mul_f32 v[44:45], v[44:45], v[130:131]
    v_pk_mul_f32 v[46:47], v[46:47], v[130:131]
    v_cvt_pk_bf16_f32 v40, v40, v41
    v_cvt_pk_bf16_f32 v41, v42, v43
    v_cvt_pk_bf16_f32 v42, v44, v45
    v_cvt_pk_bf16_f32 v43, v46, v47
    buffer_store_dwordx4 v[40:43], v4, s[20:23], s60 offen offset:1024 sc1
    v_accvgpr_read_b32 v48, a40
    v_accvgpr_read_b32 v49, a41
    v_accvgpr_read_b32 v50, a42
    v_accvgpr_read_b32 v51, a43
    v_accvgpr_read_b32 v52, a56
    v_accvgpr_read_b32 v53, a57
    v_accvgpr_read_b32 v54, a58
    v_accvgpr_read_b32 v55, a59
    v_pk_mul_f32 v[48:49], v[48:49], v[132:133]
    v_pk_mul_f32 v[50:51], v[50:51], v[132:133]
    v_pk_mul_f32 v[52:53], v[52:53], v[132:133]
    v_pk_mul_f32 v[54:55], v[54:55], v[132:133]
    v_cvt_pk_bf16_f32 v48, v48, v49
    v_cvt_pk_bf16_f32 v49, v50, v51
    v_cvt_pk_bf16_f32 v50, v52, v53
    v_cvt_pk_bf16_f32 v51, v54, v55
    buffer_store_dwordx4 v[48:51], v4, s[20:23], s62 offen offset:0 sc1
    v_accvgpr_read_b32 v56, a44
    v_accvgpr_read_b32 v57, a45
    v_accvgpr_read_b32 v58, a46
    v_accvgpr_read_b32 v59, a47
    v_accvgpr_read_b32 v60, a60
    v_accvgpr_read_b32 v61, a61
    v_accvgpr_read_b32 v62, a62
    v_accvgpr_read_b32 v63, a63
    v_pk_mul_f32 v[56:57], v[56:57], v[134:135]
    v_pk_mul_f32 v[58:59], v[58:59], v[134:135]
    v_pk_mul_f32 v[60:61], v[60:61], v[134:135]
    v_pk_mul_f32 v[62:63], v[62:63], v[134:135]
    v_cvt_pk_bf16_f32 v56, v56, v57
    v_cvt_pk_bf16_f32 v57, v58, v59
    v_cvt_pk_bf16_f32 v58, v60, v61
    v_cvt_pk_bf16_f32 v59, v62, v63
    buffer_store_dwordx4 v[56:59], v4, s[20:23], s62 offen offset:1024 sc1
    v_accvgpr_read_b32 v64, a64
    v_accvgpr_read_b32 v65, a65
    v_accvgpr_read_b32 v66, a66
    v_accvgpr_read_b32 v67, a67
    v_accvgpr_read_b32 v68, a80
    v_accvgpr_read_b32 v69, a81
    v_accvgpr_read_b32 v70, a82
    v_accvgpr_read_b32 v71, a83
    v_pk_mul_f32 v[64:65], v[64:65], v[128:129]
    v_pk_mul_f32 v[66:67], v[66:67], v[128:129]
    v_pk_mul_f32 v[68:69], v[68:69], v[128:129]
    v_pk_mul_f32 v[70:71], v[70:71], v[128:129]
    v_cvt_pk_bf16_f32 v64, v64, v65
    v_cvt_pk_bf16_f32 v65, v66, v67
    v_cvt_pk_bf16_f32 v66, v68, v69
    v_cvt_pk_bf16_f32 v67, v70, v71
    buffer_store_dwordx4 v[64:67], v4, s[20:23], s60 offen offset:2048 sc1
    v_accvgpr_read_b32 v72, a68
    v_accvgpr_read_b32 v73, a69
    v_accvgpr_read_b32 v74, a70
    v_accvgpr_read_b32 v75, a71
    v_accvgpr_read_b32 v76, a84
    v_accvgpr_read_b32 v77, a85
    v_accvgpr_read_b32 v78, a86
    v_accvgpr_read_b32 v79, a87
    v_pk_mul_f32 v[72:73], v[72:73], v[130:131]
    v_pk_mul_f32 v[74:75], v[74:75], v[130:131]
    v_pk_mul_f32 v[76:77], v[76:77], v[130:131]
    v_pk_mul_f32 v[78:79], v[78:79], v[130:131]
    v_cvt_pk_bf16_f32 v72, v72, v73
    v_cvt_pk_bf16_f32 v73, v74, v75
    v_cvt_pk_bf16_f32 v74, v76, v77
    v_cvt_pk_bf16_f32 v75, v78, v79
    buffer_store_dwordx4 v[72:75], v4, s[20:23], s60 offen offset:3072 sc1
    v_accvgpr_read_b32 v80, a72
    v_accvgpr_read_b32 v81, a73
    v_accvgpr_read_b32 v82, a74
    v_accvgpr_read_b32 v83, a75
    v_accvgpr_read_b32 v84, a88
    v_accvgpr_read_b32 v85, a89
    v_accvgpr_read_b32 v86, a90
    v_accvgpr_read_b32 v87, a91
    v_pk_mul_f32 v[80:81], v[80:81], v[132:133]
    v_pk_mul_f32 v[82:83], v[82:83], v[132:133]
    v_pk_mul_f32 v[84:85], v[84:85], v[132:133]
    v_pk_mul_f32 v[86:87], v[86:87], v[132:133]
    v_cvt_pk_bf16_f32 v80, v80, v81
    v_cvt_pk_bf16_f32 v81, v82, v83
    v_cvt_pk_bf16_f32 v82, v84, v85
    v_cvt_pk_bf16_f32 v83, v86, v87
    buffer_store_dwordx4 v[80:83], v4, s[20:23], s62 offen offset:2048 sc1
    v_accvgpr_read_b32 v88, a76
    v_accvgpr_read_b32 v89, a77
    v_accvgpr_read_b32 v90, a78
    v_accvgpr_read_b32 v91, a79
    v_accvgpr_read_b32 v92, a92
    v_accvgpr_read_b32 v93, a93
    v_accvgpr_read_b32 v94, a94
    v_accvgpr_read_b32 v95, a95
    v_pk_mul_f32 v[88:89], v[88:89], v[134:135]
    v_pk_mul_f32 v[90:91], v[90:91], v[134:135]
    v_pk_mul_f32 v[92:93], v[92:93], v[134:135]
    v_pk_mul_f32 v[94:95], v[94:95], v[134:135]
    v_cvt_pk_bf16_f32 v88, v88, v89
    v_cvt_pk_bf16_f32 v89, v90, v91
    v_cvt_pk_bf16_f32 v90, v92, v93
    v_cvt_pk_bf16_f32 v91, v94, v95
    buffer_store_dwordx4 v[88:91], v4, s[20:23], s62 offen offset:3072 sc1
    v_accvgpr_read_b32 v32, a96
    v_accvgpr_read_b32 v33, a97
    v_accvgpr_read_b32 v34, a98
    v_accvgpr_read_b32 v35, a99
    v_accvgpr_read_b32 v36, a112
    v_accvgpr_read_b32 v37, a113
    v_accvgpr_read_b32 v38, a114
    v_accvgpr_read_b32 v39, a115
    v_pk_mul_f32 v[32:33], v[32:33], v[128:129]
    v_pk_mul_f32 v[34:35], v[34:35], v[128:129]
    v_pk_mul_f32 v[36:37], v[36:37], v[128:129]
    v_pk_mul_f32 v[38:39], v[38:39], v[128:129]
    v_cvt_pk_bf16_f32 v32, v32, v33
    v_cvt_pk_bf16_f32 v33, v34, v35
    v_cvt_pk_bf16_f32 v34, v36, v37
    v_cvt_pk_bf16_f32 v35, v38, v39
    buffer_store_dwordx4 v[32:35], v4, s[20:23], s61 offen offset:0 sc1
    v_accvgpr_read_b32 v40, a100
    v_accvgpr_read_b32 v41, a101
    v_accvgpr_read_b32 v42, a102
    v_accvgpr_read_b32 v43, a103
    v_accvgpr_read_b32 v44, a116
    v_accvgpr_read_b32 v45, a117
    v_accvgpr_read_b32 v46, a118
    v_accvgpr_read_b32 v47, a119
    v_pk_mul_f32 v[40:41], v[40:41], v[130:131]
    v_pk_mul_f32 v[42:43], v[42:43], v[130:131]
    v_pk_mul_f32 v[44:45], v[44:45], v[130:131]
    v_pk_mul_f32 v[46:47], v[46:47], v[130:131]
    v_cvt_pk_bf16_f32 v40, v40, v41
    v_cvt_pk_bf16_f32 v41, v42, v43
    v_cvt_pk_bf16_f32 v42, v44, v45
    v_cvt_pk_bf16_f32 v43, v46, v47
    buffer_store_dwordx4 v[40:43], v4, s[20:23], s61 offen offset:1024 sc1
    v_accvgpr_read_b32 v48, a104
    v_accvgpr_read_b32 v49, a105
    v_accvgpr_read_b32 v50, a106
    v_accvgpr_read_b32 v51, a107
    v_accvgpr_read_b32 v52, a120
    v_accvgpr_read_b32 v53, a121
    v_accvgpr_read_b32 v54, a122
    v_accvgpr_read_b32 v55, a123
    v_pk_mul_f32 v[48:49], v[48:49], v[132:133]
    v_pk_mul_f32 v[50:51], v[50:51], v[132:133]
    v_pk_mul_f32 v[52:53], v[52:53], v[132:133]
    v_pk_mul_f32 v[54:55], v[54:55], v[132:133]
    v_cvt_pk_bf16_f32 v48, v48, v49
    v_cvt_pk_bf16_f32 v49, v50, v51
    v_cvt_pk_bf16_f32 v50, v52, v53
    v_cvt_pk_bf16_f32 v51, v54, v55
    buffer_store_dwordx4 v[48:51], v4, s[20:23], s63 offen offset:0 sc1
    v_accvgpr_read_b32 v56, a108
    v_accvgpr_read_b32 v57, a109
    v_accvgpr_read_b32 v58, a110
    v_accvgpr_read_b32 v59, a111
    v_accvgpr_read_b32 v60, a124
    v_accvgpr_read_b32 v61, a125
    v_accvgpr_read_b32 v62, a126
    v_accvgpr_read_b32 v63, a127
    v_pk_mul_f32 v[56:57], v[56:57], v[134:135]
    v_pk_mul_f32 v[58:59], v[58:59], v[134:135]
    v_pk_mul_f32 v[60:61], v[60:61], v[134:135]
    v_pk_mul_f32 v[62:63], v[62:63], v[134:135]
    v_cvt_pk_bf16_f32 v56, v56, v57
    v_cvt_pk_bf16_f32 v57, v58, v59
    v_cvt_pk_bf16_f32 v58, v60, v61
    v_cvt_pk_bf16_f32 v59, v62, v63
    buffer_store_dwordx4 v[56:59], v4, s[20:23], s63 offen offset:1024 sc1
    v_accvgpr_read_b32 v64, a128
    v_accvgpr_read_b32 v65, a129
    v_accvgpr_read_b32 v66, a130
    v_accvgpr_read_b32 v67, a131
    v_accvgpr_read_b32 v68, a144
    v_accvgpr_read_b32 v69, a145
    v_accvgpr_read_b32 v70, a146
    v_accvgpr_read_b32 v71, a147
    v_pk_mul_f32 v[64:65], v[64:65], v[128:129]
    v_pk_mul_f32 v[66:67], v[66:67], v[128:129]
    v_pk_mul_f32 v[68:69], v[68:69], v[128:129]
    v_pk_mul_f32 v[70:71], v[70:71], v[128:129]
    v_cvt_pk_bf16_f32 v64, v64, v65
    v_cvt_pk_bf16_f32 v65, v66, v67
    v_cvt_pk_bf16_f32 v66, v68, v69
    v_cvt_pk_bf16_f32 v67, v70, v71
    buffer_store_dwordx4 v[64:67], v4, s[20:23], s61 offen offset:2048 sc1
    v_accvgpr_read_b32 v72, a132
    v_accvgpr_read_b32 v73, a133
    v_accvgpr_read_b32 v74, a134
    v_accvgpr_read_b32 v75, a135
    v_accvgpr_read_b32 v76, a148
    v_accvgpr_read_b32 v77, a149
    v_accvgpr_read_b32 v78, a150
    v_accvgpr_read_b32 v79, a151
    v_pk_mul_f32 v[72:73], v[72:73], v[130:131]
    v_pk_mul_f32 v[74:75], v[74:75], v[130:131]
    v_pk_mul_f32 v[76:77], v[76:77], v[130:131]
    v_pk_mul_f32 v[78:79], v[78:79], v[130:131]
    v_cvt_pk_bf16_f32 v72, v72, v73
    v_cvt_pk_bf16_f32 v73, v74, v75
    v_cvt_pk_bf16_f32 v74, v76, v77
    v_cvt_pk_bf16_f32 v75, v78, v79
    buffer_store_dwordx4 v[72:75], v4, s[20:23], s61 offen offset:3072 sc1
    v_accvgpr_read_b32 v80, a136
    v_accvgpr_read_b32 v81, a137
    v_accvgpr_read_b32 v82, a138
    v_accvgpr_read_b32 v83, a139
    v_accvgpr_read_b32 v84, a152
    v_accvgpr_read_b32 v85, a153
    v_accvgpr_read_b32 v86, a154
    v_accvgpr_read_b32 v87, a155
    v_pk_mul_f32 v[80:81], v[80:81], v[132:133]
    v_pk_mul_f32 v[82:83], v[82:83], v[132:133]
    v_pk_mul_f32 v[84:85], v[84:85], v[132:133]
    v_pk_mul_f32 v[86:87], v[86:87], v[132:133]
    v_cvt_pk_bf16_f32 v80, v80, v81
    v_cvt_pk_bf16_f32 v81, v82, v83
    v_cvt_pk_bf16_f32 v82, v84, v85
    v_cvt_pk_bf16_f32 v83, v86, v87
    buffer_store_dwordx4 v[80:83], v4, s[20:23], s63 offen offset:2048 sc1
    v_accvgpr_read_b32 v88, a140
    v_accvgpr_read_b32 v89, a141
    v_accvgpr_read_b32 v90, a142
    v_accvgpr_read_b32 v91, a143
    v_accvgpr_read_b32 v92, a156
    v_accvgpr_read_b32 v93, a157
    v_accvgpr_read_b32 v94, a158
    v_accvgpr_read_b32 v95, a159
    v_pk_mul_f32 v[88:89], v[88:89], v[134:135]
    v_pk_mul_f32 v[90:91], v[90:91], v[134:135]
    v_pk_mul_f32 v[92:93], v[92:93], v[134:135]
    v_pk_mul_f32 v[94:95], v[94:95], v[134:135]
    v_cvt_pk_bf16_f32 v88, v88, v89
    v_cvt_pk_bf16_f32 v89, v90, v91
    v_cvt_pk_bf16_f32 v90, v92, v93
    v_cvt_pk_bf16_f32 v91, v94, v95
    buffer_store_dwordx4 v[88:91], v4, s[20:23], s63 offen offset:3072 sc1
    v_pk_mul_f32 v[96:97], v[144:145], s[70:71]
    v_pk_mul_f32 v[98:99], v[146:147], s[70:71]
    v_pk_mul_f32 v[100:101], v[160:161], s[70:71]
    v_pk_mul_f32 v[102:103], v[162:163], s[70:71]
    v_exp_f32 v96, v96
    v_exp_f32 v97, v97
    v_exp_f32 v98, v98
    v_exp_f32 v99, v99
    v_exp_f32 v100, v100
    v_exp_f32 v101, v101
    v_exp_f32 v102, v102
    v_exp_f32 v103, v103
    v_pk_add_f32 v[96:97], v[96:97], 1.0 op_sel_hi:[1,0]
    v_pk_add_f32 v[98:99], v[98:99], 1.0 op_sel_hi:[1,0]
    v_pk_add_f32 v[100:101], v[100:101], 1.0 op_sel_hi:[1,0]
    v_pk_add_f32 v[102:103], v[102:103], 1.0 op_sel_hi:[1,0]
    v_rcp_f32 v96, v96
    v_rcp_f32 v97, v97
    v_rcp_f32 v98, v98
    v_rcp_f32 v99, v99
    v_rcp_f32 v100, v100
    v_rcp_f32 v101, v101
    v_rcp_f32 v102, v102
    v_rcp_f32 v103, v103
    v_pk_mul_f32 v[96:97], v[96:97], v[144:145]
    v_pk_mul_f32 v[98:99], v[98:99], v[146:147]
    v_pk_mul_f32 v[100:101], v[100:101], v[160:161]
    v_pk_mul_f32 v[102:103], v[102:103], v[162:163]
    v_cvt_pk_bf16_f32 v144, v96, v97
    v_cvt_pk_bf16_f32 v145, v98, v99
    v_cvt_pk_bf16_f32 v146, v100, v101
    v_cvt_pk_bf16_f32 v147, v102, v103
    v_pk_mul_f32 v[96:97], v[148:149], s[70:71]
    v_pk_mul_f32 v[98:99], v[150:151], s[70:71]
    v_pk_mul_f32 v[100:101], v[164:165], s[70:71]
    v_pk_mul_f32 v[102:103], v[166:167], s[70:71]
    v_exp_f32 v96, v96
    v_exp_f32 v97, v97
    v_exp_f32 v98, v98
    v_exp_f32 v99, v99
    v_exp_f32 v100, v100
    v_exp_f32 v101, v101
    v_exp_f32 v102, v102
    v_exp_f32 v103, v103
    v_pk_add_f32 v[96:97], v[96:97], 1.0 op_sel_hi:[1,0]
    v_pk_add_f32 v[98:99], v[98:99], 1.0 op_sel_hi:[1,0]
    v_pk_add_f32 v[100:101], v[100:101], 1.0 op_sel_hi:[1,0]
    v_pk_add_f32 v[102:103], v[102:103], 1.0 op_sel_hi:[1,0]
    v_rcp_f32 v96, v96
    v_rcp_f32 v97, v97
    v_rcp_f32 v98, v98
    v_rcp_f32 v99, v99
    v_rcp_f32 v100, v100
    v_rcp_f32 v101, v101
    v_rcp_f32 v102, v102
    v_rcp_f32 v103, v103
    v_pk_mul_f32 v[96:97], v[96:97], v[148:149]
    v_pk_mul_f32 v[98:99], v[98:99], v[150:151]
    v_pk_mul_f32 v[100:101], v[100:101], v[164:165]
    v_pk_mul_f32 v[102:103], v[102:103], v[166:167]
    v_cvt_pk_bf16_f32 v148, v96, v97
    v_cvt_pk_bf16_f32 v149, v98, v99
    v_cvt_pk_bf16_f32 v150, v100, v101
    v_cvt_pk_bf16_f32 v151, v102, v103
    s_waitcnt vmcnt(0)
    v_mov_b32 v26, 1
    s_mov_b64 exec, 1
    buffer_store_dword v26, off, s[20:23], s44 sc1
    s_mov_b64 exec, -1
    v_pk_mul_f32 v[96:97], v[152:153], s[70:71]
    v_pk_mul_f32 v[98:99], v[154:155], s[70:71]
    v_pk_mul_f32 v[100:101], v[168:169], s[70:71]
    v_pk_mul_f32 v[102:103], v[170:171], s[70:71]
    v_exp_f32 v96, v96
    v_exp_f32 v97, v97
    v_exp_f32 v98, v98
    v_exp_f32 v99, v99
    v_exp_f32 v100, v100
    v_exp_f32 v101, v101
    v_exp_f32 v102, v102
    v_exp_f32 v103, v103
    v_pk_add_f32 v[96:97], v[96:97], 1.0 op_sel_hi:[1,0]
    v_pk_add_f32 v[98:99], v[98:99], 1.0 op_sel_hi:[1,0]
    v_pk_add_f32 v[100:101], v[100:101], 1.0 op_sel_hi:[1,0]
    v_pk_add_f32 v[102:103], v[102:103], 1.0 op_sel_hi:[1,0]
    v_rcp_f32 v96, v96
    v_rcp_f32 v97, v97
    v_rcp_f32 v98, v98
    v_rcp_f32 v99, v99
    v_rcp_f32 v100, v100
    v_rcp_f32 v101, v101
    v_rcp_f32 v102, v102
    v_rcp_f32 v103, v103
    v_pk_mul_f32 v[96:97], v[96:97], v[152:153]
    v_pk_mul_f32 v[98:99], v[98:99], v[154:155]
    v_pk_mul_f32 v[100:101], v[100:101], v[168:169]
    v_pk_mul_f32 v[102:103], v[102:103], v[170:171]
    v_cvt_pk_bf16_f32 v152, v96, v97
    v_cvt_pk_bf16_f32 v153, v98, v99
    v_cvt_pk_bf16_f32 v154, v100, v101
    v_cvt_pk_bf16_f32 v155, v102, v103
    v_pk_mul_f32 v[96:97], v[156:157], s[70:71]
    v_pk_mul_f32 v[98:99], v[158:159], s[70:71]
    v_pk_mul_f32 v[100:101], v[172:173], s[70:71]
    v_pk_mul_f32 v[102:103], v[174:175], s[70:71]
    v_exp_f32 v96, v96
    v_exp_f32 v97, v97
    v_exp_f32 v98, v98
    v_exp_f32 v99, v99
    v_exp_f32 v100, v100
    v_exp_f32 v101, v101
    v_exp_f32 v102, v102
    v_exp_f32 v103, v103
    v_pk_add_f32 v[96:97], v[96:97], 1.0 op_sel_hi:[1,0]
    v_pk_add_f32 v[98:99], v[98:99], 1.0 op_sel_hi:[1,0]
    v_pk_add_f32 v[100:101], v[100:101], 1.0 op_sel_hi:[1,0]
    v_pk_add_f32 v[102:103], v[102:103], 1.0 op_sel_hi:[1,0]
    v_rcp_f32 v96, v96
    v_rcp_f32 v97, v97
    v_rcp_f32 v98, v98
    v_rcp_f32 v99, v99
    v_rcp_f32 v100, v100
    v_rcp_f32 v101, v101
    v_rcp_f32 v102, v102
    v_rcp_f32 v103, v103
    v_pk_mul_f32 v[96:97], v[96:97], v[156:157]
    v_pk_mul_f32 v[98:99], v[98:99], v[158:159]
    v_pk_mul_f32 v[100:101], v[100:101], v[172:173]
    v_pk_mul_f32 v[102:103], v[102:103], v[174:175]
    v_cvt_pk_bf16_f32 v156, v96, v97
    v_cvt_pk_bf16_f32 v157, v98, v99
    v_cvt_pk_bf16_f32 v158, v100, v101
    v_cvt_pk_bf16_f32 v159, v102, v103
    v_pk_mul_f32 v[96:97], v[176:177], s[70:71]
    v_pk_mul_f32 v[98:99], v[178:179], s[70:71]
    v_pk_mul_f32 v[100:101], v[192:193], s[70:71]
    v_pk_mul_f32 v[102:103], v[194:195], s[70:71]
    v_exp_f32 v96, v96
    v_exp_f32 v97, v97
    v_exp_f32 v98, v98
    v_exp_f32 v99, v99
    v_exp_f32 v100, v100
    v_exp_f32 v101, v101
    v_exp_f32 v102, v102
    v_exp_f32 v103, v103
    v_pk_add_f32 v[96:97], v[96:97], 1.0 op_sel_hi:[1,0]
    v_pk_add_f32 v[98:99], v[98:99], 1.0 op_sel_hi:[1,0]
    v_pk_add_f32 v[100:101], v[100:101], 1.0 op_sel_hi:[1,0]
    v_pk_add_f32 v[102:103], v[102:103], 1.0 op_sel_hi:[1,0]
    v_rcp_f32 v96, v96
    v_rcp_f32 v97, v97
    v_rcp_f32 v98, v98
    v_rcp_f32 v99, v99
    v_rcp_f32 v100, v100
    v_rcp_f32 v101, v101
    v_rcp_f32 v102, v102
    v_rcp_f32 v103, v103
    v_pk_mul_f32 v[96:97], v[96:97], v[176:177]
    v_pk_mul_f32 v[98:99], v[98:99], v[178:179]
    v_pk_mul_f32 v[100:101], v[100:101], v[192:193]
    v_pk_mul_f32 v[102:103], v[102:103], v[194:195]
    v_cvt_pk_bf16_f32 v176, v96, v97
    v_cvt_pk_bf16_f32 v177, v98, v99
    v_cvt_pk_bf16_f32 v178, v100, v101
    v_cvt_pk_bf16_f32 v179, v102, v103
    v_pk_mul_f32 v[96:97], v[180:181], s[70:71]
    v_pk_mul_f32 v[98:99], v[182:183], s[70:71]
    v_pk_mul_f32 v[100:101], v[196:197], s[70:71]
    v_pk_mul_f32 v[102:103], v[198:199], s[70:71]
    v_exp_f32 v96, v96
    v_exp_f32 v97, v97
    v_exp_f32 v98, v98
    v_exp_f32 v99, v99
    v_exp_f32 v100, v100
    v_exp_f32 v101, v101
    v_exp_f32 v102, v102
    v_exp_f32 v103, v103
    v_pk_add_f32 v[96:97], v[96:97], 1.0 op_sel_hi:[1,0]
    v_pk_add_f32 v[98:99], v[98:99], 1.0 op_sel_hi:[1,0]
    v_pk_add_f32 v[100:101], v[100:101], 1.0 op_sel_hi:[1,0]
    v_pk_add_f32 v[102:103], v[102:103], 1.0 op_sel_hi:[1,0]
    v_rcp_f32 v96, v96
    v_rcp_f32 v97, v97
    v_rcp_f32 v98, v98
    v_rcp_f32 v99, v99
    v_rcp_f32 v100, v100
    v_rcp_f32 v101, v101
    v_rcp_f32 v102, v102
    v_rcp_f32 v103, v103
    v_pk_mul_f32 v[96:97], v[96:97], v[180:181]
    v_pk_mul_f32 v[98:99], v[98:99], v[182:183]
    v_pk_mul_f32 v[100:101], v[100:101], v[196:197]
    v_pk_mul_f32 v[102:103], v[102:103], v[198:199]
    v_cvt_pk_bf16_f32 v180, v96, v97
    v_cvt_pk_bf16_f32 v181, v98, v99
    v_cvt_pk_bf16_f32 v182, v100, v101
    v_cvt_pk_bf16_f32 v183, v102, v103
    v_pk_mul_f32 v[96:97], v[184:185], s[70:71]
    v_pk_mul_f32 v[98:99], v[186:187], s[70:71]
    v_pk_mul_f32 v[100:101], v[200:201], s[70:71]
    v_pk_mul_f32 v[102:103], v[202:203], s[70:71]
    v_exp_f32 v96, v96
    v_exp_f32 v97, v97
    v_exp_f32 v98, v98
    v_exp_f32 v99, v99
    v_exp_f32 v100, v100
    v_exp_f32 v101, v101
    v_exp_f32 v102, v102
    v_exp_f32 v103, v103
    v_pk_add_f32 v[96:97], v[96:97], 1.0 op_sel_hi:[1,0]
    v_pk_add_f32 v[98:99], v[98:99], 1.0 op_sel_hi:[1,0]
    v_pk_add_f32 v[100:101], v[100:101], 1.0 op_sel_hi:[1,0]
    v_pk_add_f32 v[102:103], v[102:103], 1.0 op_sel_hi:[1,0]
    v_rcp_f32 v96, v96
    v_rcp_f32 v97, v97
    v_rcp_f32 v98, v98
    v_rcp_f32 v99, v99
    v_rcp_f32 v100, v100
    v_rcp_f32 v101, v101
    v_rcp_f32 v102, v102
    v_rcp_f32 v103, v103
    v_pk_mul_f32 v[96:97], v[96:97], v[184:185]
    v_pk_mul_f32 v[98:99], v[98:99], v[186:187]
    v_pk_mul_f32 v[100:101], v[100:101], v[200:201]
    v_pk_mul_f32 v[102:103], v[102:103], v[202:203]
    v_cvt_pk_bf16_f32 v184, v96, v97
    v_cvt_pk_bf16_f32 v185, v98, v99
    v_cvt_pk_bf16_f32 v186, v100, v101
    v_cvt_pk_bf16_f32 v187, v102, v103
    v_pk_mul_f32 v[96:97], v[188:189], s[70:71]
    v_pk_mul_f32 v[98:99], v[190:191], s[70:71]
    v_pk_mul_f32 v[100:101], v[204:205], s[70:71]
    v_pk_mul_f32 v[102:103], v[206:207], s[70:71]
    v_exp_f32 v96, v96
    v_exp_f32 v97, v97
    v_exp_f32 v98, v98
    v_exp_f32 v99, v99
    v_exp_f32 v100, v100
    v_exp_f32 v101, v101
    v_exp_f32 v102, v102
    v_exp_f32 v103, v103
    v_pk_add_f32 v[96:97], v[96:97], 1.0 op_sel_hi:[1,0]
    v_pk_add_f32 v[98:99], v[98:99], 1.0 op_sel_hi:[1,0]
    v_pk_add_f32 v[100:101], v[100:101], 1.0 op_sel_hi:[1,0]
    v_pk_add_f32 v[102:103], v[102:103], 1.0 op_sel_hi:[1,0]
    v_rcp_f32 v96, v96
    v_rcp_f32 v97, v97
    v_rcp_f32 v98, v98
    v_rcp_f32 v99, v99
    v_rcp_f32 v100, v100
    v_rcp_f32 v101, v101
    v_rcp_f32 v102, v102
    v_rcp_f32 v103, v103
    v_pk_mul_f32 v[96:97], v[96:97], v[188:189]
    v_pk_mul_f32 v[98:99], v[98:99], v[190:191]
    v_pk_mul_f32 v[100:101], v[100:101], v[204:205]
    v_pk_mul_f32 v[102:103], v[102:103], v[206:207]
    v_cvt_pk_bf16_f32 v188, v96, v97
    v_cvt_pk_bf16_f32 v189, v98, v99
    v_cvt_pk_bf16_f32 v190, v100, v101
    v_cvt_pk_bf16_f32 v191, v102, v103
    v_pk_mul_f32 v[96:97], v[208:209], s[70:71]
    v_pk_mul_f32 v[98:99], v[210:211], s[70:71]
    v_pk_mul_f32 v[100:101], v[224:225], s[70:71]
    v_pk_mul_f32 v[102:103], v[226:227], s[70:71]
    v_exp_f32 v96, v96
    v_exp_f32 v97, v97
    v_exp_f32 v98, v98
    v_exp_f32 v99, v99
    v_exp_f32 v100, v100
    v_exp_f32 v101, v101
    v_exp_f32 v102, v102
    v_exp_f32 v103, v103
    v_pk_add_f32 v[96:97], v[96:97], 1.0 op_sel_hi:[1,0]
    v_pk_add_f32 v[98:99], v[98:99], 1.0 op_sel_hi:[1,0]
    v_pk_add_f32 v[100:101], v[100:101], 1.0 op_sel_hi:[1,0]
    v_pk_add_f32 v[102:103], v[102:103], 1.0 op_sel_hi:[1,0]
    v_rcp_f32 v96, v96
    v_rcp_f32 v97, v97
    v_rcp_f32 v98, v98
    v_rcp_f32 v99, v99
    v_rcp_f32 v100, v100
    v_rcp_f32 v101, v101
    v_rcp_f32 v102, v102
    v_rcp_f32 v103, v103
    v_pk_mul_f32 v[96:97], v[96:97], v[208:209]
    v_pk_mul_f32 v[98:99], v[98:99], v[210:211]
    v_pk_mul_f32 v[100:101], v[100:101], v[224:225]
    v_pk_mul_f32 v[102:103], v[102:103], v[226:227]
    v_cvt_pk_bf16_f32 v208, v96, v97
    v_cvt_pk_bf16_f32 v209, v98, v99
    v_cvt_pk_bf16_f32 v210, v100, v101
    v_cvt_pk_bf16_f32 v211, v102, v103
    v_pk_mul_f32 v[96:97], v[212:213], s[70:71]
    v_pk_mul_f32 v[98:99], v[214:215], s[70:71]
    v_pk_mul_f32 v[100:101], v[228:229], s[70:71]
    v_pk_mul_f32 v[102:103], v[230:231], s[70:71]
    v_exp_f32 v96, v96
    v_exp_f32 v97, v97
    v_exp_f32 v98, v98
    v_exp_f32 v99, v99
    v_exp_f32 v100, v100
    v_exp_f32 v101, v101
    v_exp_f32 v102, v102
    v_exp_f32 v103, v103
    v_pk_add_f32 v[96:97], v[96:97], 1.0 op_sel_hi:[1,0]
    v_pk_add_f32 v[98:99], v[98:99], 1.0 op_sel_hi:[1,0]
    v_pk_add_f32 v[100:101], v[100:101], 1.0 op_sel_hi:[1,0]
    v_pk_add_f32 v[102:103], v[102:103], 1.0 op_sel_hi:[1,0]
    v_rcp_f32 v96, v96
    v_rcp_f32 v97, v97
    v_rcp_f32 v98, v98
    v_rcp_f32 v99, v99
    v_rcp_f32 v100, v100
    v_rcp_f32 v101, v101
    v_rcp_f32 v102, v102
    v_rcp_f32 v103, v103
    v_pk_mul_f32 v[96:97], v[96:97], v[212:213]
    v_pk_mul_f32 v[98:99], v[98:99], v[214:215]
    v_pk_mul_f32 v[100:101], v[100:101], v[228:229]
    v_pk_mul_f32 v[102:103], v[102:103], v[230:231]
    v_cvt_pk_bf16_f32 v212, v96, v97
    v_cvt_pk_bf16_f32 v213, v98, v99
    v_cvt_pk_bf16_f32 v214, v100, v101
    v_cvt_pk_bf16_f32 v215, v102, v103
    v_pk_mul_f32 v[96:97], v[216:217], s[70:71]
    v_pk_mul_f32 v[98:99], v[218:219], s[70:71]
    v_pk_mul_f32 v[100:101], v[232:233], s[70:71]
    v_pk_mul_f32 v[102:103], v[234:235], s[70:71]
    v_exp_f32 v96, v96
    v_exp_f32 v97, v97
    v_exp_f32 v98, v98
    v_exp_f32 v99, v99
    v_exp_f32 v100, v100
    v_exp_f32 v101, v101
    v_exp_f32 v102, v102
    v_exp_f32 v103, v103
    v_pk_add_f32 v[96:97], v[96:97], 1.0 op_sel_hi:[1,0]
    v_pk_add_f32 v[98:99], v[98:99], 1.0 op_sel_hi:[1,0]
    v_pk_add_f32 v[100:101], v[100:101], 1.0 op_sel_hi:[1,0]
    v_pk_add_f32 v[102:103], v[102:103], 1.0 op_sel_hi:[1,0]
    v_rcp_f32 v96, v96
    v_rcp_f32 v97, v97
    v_rcp_f32 v98, v98
    v_rcp_f32 v99, v99
    v_rcp_f32 v100, v100
    v_rcp_f32 v101, v101
    v_rcp_f32 v102, v102
    v_rcp_f32 v103, v103
    v_pk_mul_f32 v[96:97], v[96:97], v[216:217]
    v_pk_mul_f32 v[98:99], v[98:99], v[218:219]
    v_pk_mul_f32 v[100:101], v[100:101], v[232:233]
    v_pk_mul_f32 v[102:103], v[102:103], v[234:235]
    v_cvt_pk_bf16_f32 v216, v96, v97
    v_cvt_pk_bf16_f32 v217, v98, v99
    v_cvt_pk_bf16_f32 v218, v100, v101
    v_cvt_pk_bf16_f32 v219, v102, v103
    v_pk_mul_f32 v[96:97], v[220:221], s[70:71]
    v_pk_mul_f32 v[98:99], v[222:223], s[70:71]
    v_pk_mul_f32 v[100:101], v[236:237], s[70:71]
    v_pk_mul_f32 v[102:103], v[238:239], s[70:71]
    v_exp_f32 v96, v96
    v_exp_f32 v97, v97
    v_exp_f32 v98, v98
    v_exp_f32 v99, v99
    v_exp_f32 v100, v100
    v_exp_f32 v101, v101
    v_exp_f32 v102, v102
    v_exp_f32 v103, v103
    v_pk_add_f32 v[96:97], v[96:97], 1.0 op_sel_hi:[1,0]
    v_pk_add_f32 v[98:99], v[98:99], 1.0 op_sel_hi:[1,0]
    v_pk_add_f32 v[100:101], v[100:101], 1.0 op_sel_hi:[1,0]
    v_pk_add_f32 v[102:103], v[102:103], 1.0 op_sel_hi:[1,0]
    v_rcp_f32 v96, v96
    v_rcp_f32 v97, v97
    v_rcp_f32 v98, v98
    v_rcp_f32 v99, v99
    v_rcp_f32 v100, v100
    v_rcp_f32 v101, v101
    v_rcp_f32 v102, v102
    v_rcp_f32 v103, v103
    v_pk_mul_f32 v[96:97], v[96:97], v[220:221]
    v_pk_mul_f32 v[98:99], v[98:99], v[222:223]
    v_pk_mul_f32 v[100:101], v[100:101], v[236:237]
    v_pk_mul_f32 v[102:103], v[102:103], v[238:239]
    v_cvt_pk_bf16_f32 v220, v96, v97
    v_cvt_pk_bf16_f32 v221, v98, v99
    v_cvt_pk_bf16_f32 v222, v100, v101
    v_cvt_pk_bf16_f32 v223, v102, v103
    v_pk_mul_f32 v[96:97], v[240:241], s[70:71]
    v_pk_mul_f32 v[98:99], v[242:243], s[70:71]
    v_pk_mul_f32 v[100:101], v[248:249], s[70:71]
    v_pk_mul_f32 v[102:103], v[250:251], s[70:71]
    v_exp_f32 v96, v96
    v_exp_f32 v97, v97
    v_exp_f32 v98, v98
    v_exp_f32 v99, v99
    v_exp_f32 v100, v100
    v_exp_f32 v101, v101
    v_exp_f32 v102, v102
    v_exp_f32 v103, v103
    v_pk_add_f32 v[96:97], v[96:97], 1.0 op_sel_hi:[1,0]
    v_pk_add_f32 v[98:99], v[98:99], 1.0 op_sel_hi:[1,0]
    v_pk_add_f32 v[100:101], v[100:101], 1.0 op_sel_hi:[1,0]
    v_pk_add_f32 v[102:103], v[102:103], 1.0 op_sel_hi:[1,0]
    v_rcp_f32 v96, v96
    v_rcp_f32 v97, v97
    v_rcp_f32 v98, v98
    v_rcp_f32 v99, v99
    v_rcp_f32 v100, v100
    v_rcp_f32 v101, v101
    v_rcp_f32 v102, v102
    v_rcp_f32 v103, v103
    v_pk_mul_f32 v[96:97], v[96:97], v[240:241]
    v_pk_mul_f32 v[98:99], v[98:99], v[242:243]
    v_pk_mul_f32 v[100:101], v[100:101], v[248:249]
    v_pk_mul_f32 v[102:103], v[102:103], v[250:251]
    v_cvt_pk_bf16_f32 v240, v96, v97
    v_cvt_pk_bf16_f32 v241, v98, v99
    v_cvt_pk_bf16_f32 v242, v100, v101
    v_cvt_pk_bf16_f32 v243, v102, v103
    v_pk_mul_f32 v[96:97], v[244:245], s[70:71]
    v_pk_mul_f32 v[98:99], v[246:247], s[70:71]
    v_pk_mul_f32 v[100:101], v[252:253], s[70:71]
    v_pk_mul_f32 v[102:103], v[254:255], s[70:71]
    v_exp_f32 v96, v96
    v_exp_f32 v97, v97
    v_exp_f32 v98, v98
    v_exp_f32 v99, v99
    v_exp_f32 v100, v100
    v_exp_f32 v101, v101
    v_exp_f32 v102, v102
    v_exp_f32 v103, v103
    v_pk_add_f32 v[96:97], v[96:97], 1.0 op_sel_hi:[1,0]
    v_pk_add_f32 v[98:99], v[98:99], 1.0 op_sel_hi:[1,0]
    v_pk_add_f32 v[100:101], v[100:101], 1.0 op_sel_hi:[1,0]
    v_pk_add_f32 v[102:103], v[102:103], 1.0 op_sel_hi:[1,0]
    v_rcp_f32 v96, v96
    v_rcp_f32 v97, v97
    v_rcp_f32 v98, v98
    v_rcp_f32 v99, v99
    v_rcp_f32 v100, v100
    v_rcp_f32 v101, v101
    v_rcp_f32 v102, v102
    v_rcp_f32 v103, v103
    v_pk_mul_f32 v[96:97], v[96:97], v[244:245]
    v_pk_mul_f32 v[98:99], v[98:99], v[246:247]
    v_pk_mul_f32 v[100:101], v[100:101], v[252:253]
    v_pk_mul_f32 v[102:103], v[102:103], v[254:255]
    v_cvt_pk_bf16_f32 v244, v96, v97
    v_cvt_pk_bf16_f32 v245, v98, v99
    v_cvt_pk_bf16_f32 v246, v100, v101
    v_cvt_pk_bf16_f32 v247, v102, v103
    s_mov_b32 s37, 0x7f000000
    s_branch L_m_tr_join
L_m_tr_s:
    v_accvgpr_read_b32 v32, a32
    v_accvgpr_read_b32 v33, a33
    v_accvgpr_read_b32 v34, a34
    v_accvgpr_read_b32 v35, a35
    v_accvgpr_read_b32 v36, a48
    v_accvgpr_read_b32 v37, a49
    v_accvgpr_read_b32 v38, a50
    v_accvgpr_read_b32 v39, a51
    v_pk_mul_f32 v[32:33], v[32:33], v[128:129]
    v_pk_mul_f32 v[34:35], v[34:35], v[128:129]
    v_pk_mul_f32 v[36:37], v[36:37], v[128:129]
    v_pk_mul_f32 v[38:39], v[38:39], v[128:129]
    v_cvt_pk_bf16_f32 v144, v32, v33
    v_cvt_pk_bf16_f32 v145, v34, v35
    v_cvt_pk_bf16_f32 v146, v36, v37
    v_cvt_pk_bf16_f32 v147, v38, v39
    v_accvgpr_read_b32 v40, a36
    v_accvgpr_read_b32 v41, a37
    v_accvgpr_read_b32 v42, a38
    v_accvgpr_read_b32 v43, a39
    v_accvgpr_read_b32 v44, a52
    v_accvgpr_read_b32 v45, a53
    v_accvgpr_read_b32 v46, a54
    v_accvgpr_read_b32 v47, a55
    v_pk_mul_f32 v[40:41], v[40:41], v[130:131]
    v_pk_mul_f32 v[42:43], v[42:43], v[130:131]
    v_pk_mul_f32 v[44:45], v[44:45], v[130:131]
    v_pk_mul_f32 v[46:47], v[46:47], v[130:131]
    v_cvt_pk_bf16_f32 v148, v40, v41
    v_cvt_pk_bf16_f32 v149, v42, v43
    v_cvt_pk_bf16_f32 v150, v44, v45
    v_cvt_pk_bf16_f32 v151, v46, v47
    v_accvgpr_read_b32 v48, a40
    v_accvgpr_read_b32 v49, a41
    v_accvgpr_read_b32 v50, a42
    v_accvgpr_read_b32 v51, a43
    v_accvgpr_read_b32 v52, a56
    v_accvgpr_read_b32 v53, a57
    v_accvgpr_read_b32 v54, a58
    v_accvgpr_read_b32 v55, a59
    v_pk_mul_f32 v[48:49], v[48:49], v[132:133]
    v_pk_mul_f32 v[50:51], v[50:51], v[132:133]
    v_pk_mul_f32 v[52:53], v[52:53], v[132:133]
    v_pk_mul_f32 v[54:55], v[54:55], v[132:133]
    v_cvt_pk_bf16_f32 v152, v48, v49
    v_cvt_pk_bf16_f32 v153, v50, v51
    v_cvt_pk_bf16_f32 v154, v52, v53
    v_cvt_pk_bf16_f32 v155, v54, v55
    v_accvgpr_read_b32 v56, a44
    v_accvgpr_read_b32 v57, a45
    v_accvgpr_read_b32 v58, a46
    v_accvgpr_read_b32 v59, a47
    v_accvgpr_read_b32 v60, a60
    v_accvgpr_read_b32 v61, a61
    v_accvgpr_read_b32 v62, a62
    v_accvgpr_read_b32 v63, a63
    v_pk_mul_f32 v[56:57], v[56:57], v[134:135]
    v_pk_mul_f32 v[58:59], v[58:59], v[134:135]
    v_pk_mul_f32 v[60:61], v[60:61], v[134:135]
    v_pk_mul_f32 v[62:63], v[62:63], v[134:135]
    v_cvt_pk_bf16_f32 v156, v56, v57
    v_cvt_pk_bf16_f32 v157, v58, v59
    v_cvt_pk_bf16_f32 v158, v60, v61
    v_cvt_pk_bf16_f32 v159, v62, v63
    v_accvgpr_read_b32 v64, a64
    v_accvgpr_read_b32 v65, a65
    v_accvgpr_read_b32 v66, a66
    v_accvgpr_read_b32 v67, a67
    v_accvgpr_read_b32 v68, a80
    v_accvgpr_read_b32 v69, a81
    v_accvgpr_read_b32 v70, a82
    v_accvgpr_read_b32 v71, a83
    v_pk_mul_f32 v[64:65], v[64:65], v[128:129]
    v_pk_mul_f32 v[66:67], v[66:67], v[128:129]
    v_pk_mul_f32 v[68:69], v[68:69], v[128:129]
    v_pk_mul_f32 v[70:71], v[70:71], v[128:129]
    v_cvt_pk_bf16_f32 v176, v64, v65
    v_cvt_pk_bf16_f32 v177, v66, v67
    v_cvt_pk_bf16_f32 v178, v68, v69
    v_cvt_pk_bf16_f32 v179, v70, v71
    v_accvgpr_read_b32 v72, a68
    v_accvgpr_read_b32 v73, a69
    v_accvgpr_read_b32 v74, a70
    v_accvgpr_read_b32 v75, a71
    v_accvgpr_read_b32 v76, a84
    v_accvgpr_read_b32 v77, a85
    v_accvgpr_read_b32 v78, a86
    v_accvgpr_read_b32 v79, a87
    v_pk_mul_f32 v[72:73], v[72:73], v[130:131]
    v_pk_mul_f32 v[74:75], v[74:75], v[130:131]
    v_pk_mul_f32 v[76:77], v[76:77], v[130:131]
    v_pk_mul_f32 v[78:79], v[78:79], v[130:131]
    v_cvt_pk_bf16_f32 v180, v72, v73
    v_cvt_pk_bf16_f32 v181, v74, v75
    v_cvt_pk_bf16_f32 v182, v76, v77
    v_cvt_pk_bf16_f32 v183, v78, v79
    v_accvgpr_read_b32 v80, a72
    v_accvgpr_read_b32 v81, a73
    v_accvgpr_read_b32 v82, a74
    v_accvgpr_read_b32 v83, a75
    v_accvgpr_read_b32 v84, a88
    v_accvgpr_read_b32 v85, a89
    v_accvgpr_read_b32 v86, a90
    v_accvgpr_read_b32 v87, a91
    v_pk_mul_f32 v[80:81], v[80:81], v[132:133]
    v_pk_mul_f32 v[82:83], v[82:83], v[132:133]
    v_pk_mul_f32 v[84:85], v[84:85], v[132:133]
    v_pk_mul_f32 v[86:87], v[86:87], v[132:133]
    v_cvt_pk_bf16_f32 v184, v80, v81
    v_cvt_pk_bf16_f32 v185, v82, v83
    v_cvt_pk_bf16_f32 v186, v84, v85
    v_cvt_pk_bf16_f32 v187, v86, v87
    v_accvgpr_read_b32 v88, a76
    v_accvgpr_read_b32 v89, a77
    v_accvgpr_read_b32 v90, a78
    v_accvgpr_read_b32 v91, a79
    v_accvgpr_read_b32 v92, a92
    v_accvgpr_read_b32 v93, a93
    v_accvgpr_read_b32 v94, a94
    v_accvgpr_read_b32 v95, a95
    v_pk_mul_f32 v[88:89], v[88:89], v[134:135]
    v_pk_mul_f32 v[90:91], v[90:91], v[134:135]
    v_pk_mul_f32 v[92:93], v[92:93], v[134:135]
    v_pk_mul_f32 v[94:95], v[94:95], v[134:135]
    v_cvt_pk_bf16_f32 v188, v88, v89
    v_cvt_pk_bf16_f32 v189, v90, v91
    v_cvt_pk_bf16_f32 v190, v92, v93
    v_cvt_pk_bf16_f32 v191, v94, v95
    s_mov_b32 s79, 0x100000
L_m_poll_s:
    buffer_load_dword v9, v5, s[20:23], s47 offen sc1
    s_waitcnt vmcnt(0)
    v_cmp_ne_u32 vcc, 0, v9
    s_nop 1
    s_and_b32 s78, vcc_lo, s6
    s_cmp_eq_u32 s78, s6
    s_cbranch_scc1 L_m_poll_s_ok
    s_sleep 1
    s_sub_u32 s79, s79, 1
    s_cmp_lg_u32 s79, 0
    s_cbranch_scc1 L_m_poll_s
L_m_poll_s_ok:
    s_mov_b32 s30, s5
    buffer_load_dwordx4 a[224:227], v4, s[20:23], s30 offen offset:0 sc1
    buffer_load_dwordx4 a[228:231], v4, s[20:23], s30 offen offset:1024 sc1
    buffer_load_dwordx4 a[232:235], v4, s[20:23], s30 offen offset:2048 sc1
    buffer_load_dwordx4 a[236:239], v4, s[20:23], s30 offen offset:3072 sc1
    s_add_u32 s30, s30, 4096
    buffer_load_dwordx4 a[240:243], v4, s[20:23], s30 offen offset:0 sc1
    buffer_load_dwordx4 a[244:247], v4, s[20:23], s30 offen offset:1024 sc1
    buffer_load_dwordx4 a[248:251], v4, s[20:23], s30 offen offset:2048 sc1
    buffer_load_dwordx4 a[252:255], v4, s[20:23], s30 offen offset:3072 sc1
    s_add_u32 s30, s30, 4096
    buffer_load_dwordx4 a[160:163], v4, s[20:23], s30 offen offset:0 sc1
    buffer_load_dwordx4 a[164:167], v4, s[20:23], s30 offen offset:1024 sc1
    buffer_load_dwordx4 a[168:171], v4, s[20:23], s30 offen offset:2048 sc1
    buffer_load_dwordx4 a[172:175], v4, s[20:23], s30 offen offset:3072 sc1
    s_add_u32 s30, s30, 4096
    buffer_load_dwordx4 a[176:179], v4, s[20:23], s30 offen offset:0 sc1
    buffer_load_dwordx4 a[180:183], v4, s[20:23], s30 offen offset:1024 sc1
    buffer_load_dwordx4 a[184:187], v4, s[20:23], s30 offen offset:2048 sc1
    buffer_load_dwordx4 a[188:191], v4, s[20:23], s30 offen offset:3072 sc1
    s_add_u32 s30, s30, 4096
    v_accvgpr_read_b32 v32, a96
    v_accvgpr_read_b32 v33, a97
    v_accvgpr_read_b32 v34, a98
    v_accvgpr_read_b32 v35, a99
    v_accvgpr_read_b32 v36, a112
    v_accvgpr_read_b32 v37, a113
    v_accvgpr_read_b32 v38, a114
    v_accvgpr_read_b32 v39, a115
    v_pk_mul_f32 v[32:33], v[32:33], v[128:129]
    v_pk_mul_f32 v[34:35], v[34:35], v[128:129]
    v_pk_mul_f32 v[36:37], v[36:37], v[128:129]
    v_pk_mul_f32 v[38:39], v[38:39], v[128:129]
    v_cvt_pk_bf16_f32 v208, v32, v33
    v_cvt_pk_bf16_f32 v209, v34, v35
    v_cvt_pk_bf16_f32 v210, v36, v37
    v_cvt_pk_bf16_f32 v211, v38, v39
    v_accvgpr_read_b32 v40, a100
    v_accvgpr_read_b32 v41, a101
    v_accvgpr_read_b32 v42, a102
    v_accvgpr_read_b32 v43, a103
    v_accvgpr_read_b32 v44, a116
    v_accvgpr_read_b32 v45, a117
    v_accvgpr_read_b32 v46, a118
    v_accvgpr_read_b32 v47, a119
    v_pk_mul_f32 v[40:41], v[40:41], v[130:131]
    v_pk_mul_f32 v[42:43], v[42:43], v[130:131]
    v_pk_mul_f32 v[44:45], v[44:45], v[130:131]
    v_pk_mul_f32 v[46:47], v[46:47], v[130:131]
    v_cvt_pk_bf16_f32 v212, v40, v41
    v_cvt_pk_bf16_f32 v213, v42, v43
    v_cvt_pk_bf16_f32 v214, v44, v45
    v_cvt_pk_bf16_f32 v215, v46, v47
    v_accvgpr_read_b32 v48, a104
    v_accvgpr_read_b32 v49, a105
    v_accvgpr_read_b32 v50, a106
    v_accvgpr_read_b32 v51, a107
    v_accvgpr_read_b32 v52, a120
    v_accvgpr_read_b32 v53, a121
    v_accvgpr_read_b32 v54, a122
    v_accvgpr_read_b32 v55, a123
    v_pk_mul_f32 v[48:49], v[48:49], v[132:133]
    v_pk_mul_f32 v[50:51], v[50:51], v[132:133]
    v_pk_mul_f32 v[52:53], v[52:53], v[132:133]
    v_pk_mul_f32 v[54:55], v[54:55], v[132:133]
    v_cvt_pk_bf16_f32 v216, v48, v49
    v_cvt_pk_bf16_f32 v217, v50, v51
    v_cvt_pk_bf16_f32 v218, v52, v53
    v_cvt_pk_bf16_f32 v219, v54, v55
    v_accvgpr_read_b32 v56, a108
    v_accvgpr_read_b32 v57, a109
    v_accvgpr_read_b32 v58, a110
    v_accvgpr_read_b32 v59, a111
    v_accvgpr_read_b32 v60, a124
    v_accvgpr_read_b32 v61, a125
    v_accvgpr_read_b32 v62, a126
    v_accvgpr_read_b32 v63, a127
    v_pk_mul_f32 v[56:57], v[56:57], v[134:135]
    v_pk_mul_f32 v[58:59], v[58:59], v[134:135]
    v_pk_mul_f32 v[60:61], v[60:61], v[134:135]
    v_pk_mul_f32 v[62:63], v[62:63], v[134:135]
    v_cvt_pk_bf16_f32 v220, v56, v57
    v_cvt_pk_bf16_f32 v221, v58, v59
    v_cvt_pk_bf16_f32 v222, v60, v61
    v_cvt_pk_bf16_f32 v223, v62, v63
    v_accvgpr_read_b32 v64, a128
    v_accvgpr_read_b32 v65, a129
    v_accvgpr_read_b32 v66, a130
    v_accvgpr_read_b32 v67, a131
    v_accvgpr_read_b32 v68, a144
    v_accvgpr_read_b32 v69, a145
    v_accvgpr_read_b32 v70, a146
    v_accvgpr_read_b32 v71, a147
    v_pk_mul_f32 v[64:65], v[64:65], v[128:129]
    v_pk_mul_f32 v[66:67], v[66:67], v[128:129]
    v_pk_mul_f32 v[68:69], v[68:69], v[128:129]
    v_pk_mul_f32 v[70:71], v[70:71], v[128:129]
    v_cvt_pk_bf16_f32 v240, v64, v65
    v_cvt_pk_bf16_f32 v241, v66, v67
    v_cvt_pk_bf16_f32 v242, v68, v69
    v_cvt_pk_bf16_f32 v243, v70, v71
    v_accvgpr_read_b32 v72, a132
    v_accvgpr_read_b32 v73, a133
    v_accvgpr_read_b32 v74, a134
    v_accvgpr_read_b32 v75, a135
    v_accvgpr_read_b32 v76, a148
    v_accvgpr_read_b32 v77, a149
    v_accvgpr_read_b32 v78, a150
    v_accvgpr_read_b32 v79, a151
    v_pk_mul_f32 v[72:73], v[72:73], v[130:131]
    v_pk_mul_f32 v[74:75], v[74:75], v[130:131]
    v_pk_mul_f32 v[76:77], v[76:77], v[130:131]
    v_pk_mul_f32 v[78:79], v[78:79], v[130:131]
    v_cvt_pk_bf16_f32 v244, v72, v73
    v_cvt_pk_bf16_f32 v245, v74, v75
    v_cvt_pk_bf16_f32 v246, v76, v77
    v_cvt_pk_bf16_f32 v247, v78, v79
    v_accvgpr_read_b32 v80, a136
    v_accvgpr_read_b32 v81, a137
    v_accvgpr_read_b32 v82, a138
    v_accvgpr_read_b32 v83, a139
    v_accvgpr_read_b32 v84, a152
    v_accvgpr_read_b32 v85, a153
    v_accvgpr_read_b32 v86, a154
    v_accvgpr_read_b32 v87, a155
    v_pk_mul_f32 v[80:81], v[80:81], v[132:133]
    v_pk_mul_f32 v[82:83], v[82:83], v[132:133]
    v_pk_mul_f32 v[84:85], v[84:85], v[132:133]
    v_pk_mul_f32 v[86:87], v[86:87], v[132:133]
    v_cvt_pk_bf16_f32 v248, v80, v81
    v_cvt_pk_bf16_f32 v249, v82, v83
    v_cvt_pk_bf16_f32 v250, v84, v85
    v_cvt_pk_bf16_f32 v251, v86, v87
    v_accvgpr_read_b32 v88, a140
    v_accvgpr_read_b32 v89, a141
    v_accvgpr_read_b32 v90, a142
    v_accvgpr_read_b32 v91, a143
    v_accvgpr_read_b32 v92, a156
    v_accvgpr_read_b32 v93, a157
    v_accvgpr_read_b32 v94, a158
    v_accvgpr_read_b32 v95, a159
    v_pk_mul_f32 v[88:89], v[88:89], v[134:135]
    v_pk_mul_f32 v[90:91], v[90:91], v[134:135]
    v_pk_mul_f32 v[92:93], v[92:93], v[134:135]
    v_pk_mul_f32 v[94:95], v[94:95], v[134:135]
    v_cvt_pk_bf16_f32 v252, v88, v89
    v_cvt_pk_bf16_f32 v253, v90, v91
    v_cvt_pk_bf16_f32 v254, v92, v93
    v_cvt_pk_bf16_f32 v255, v94, v95
    s_mov_b32 s53, s60
    s_mov_b32 s54, s61
    s_mov_b32 s55, s62
    s_mov_b32 s56, s63
    s_add_u32 s43, s61, 2048
    s_add_u32 s37, s63, 2048
L_m_tr_join:
    s_mov_b32 s36, s60
    s_waitcnt vmcnt(12)
    s_barrier
    s_mov_b32 s16, s66
    s_and_b32 s17, s67, 0xffff
    s_mov_b32 s18, 0x400000
    s_mov_b32 s19, 0x00020000
    s_mov_b32 s12, s76
    s_and_b32 s13, s77, 0xffff
    s_mov_b32 s14, 0x400000
    s_mov_b32 s15, 0x00020000
    v_and_b32 v11, 15, v1
    v_lshlrev_b32 v11, 11, v11
    v_bfe_u32 v12, v1, 4, 1
    v_lshl_add_u32 v11, v12, 5, v11
    v_lshrrev_b32 v12, 5, v1
    v_lshl_add_u32 v11, v12, 4, v11
    s_lshl_b32 s28, s40, 16
    s_add_u32 s28, s28, s75
    s_cmp_eq_u32 s51, 0
    s_cselect_b32 s28, s28, 0x7f000000
    s_add_u32 s29, s28, 0x8000
    s_lshl_b32 s31, s41, 7
    s_add_u32 s31, s31, 0x3000000
    s_lshl_b32 s57, 1, s51
    s_xor_b32 s58, s57, 3
    s_lshl_b32 s59, s41, 13
    s_add_u32 s59, s59, 0x2800000
    s_lshl_b32 s60, s51, 22
    s_add_u32 s61, s59, s60
    s_xor_b32 s60, s60, 0x400000
    s_add_u32 s62, s59, s60
    s_add_u32 s63, s61, 4096
    s_add_u32 s64, s62, 4096
    s_sub_u32 s33, s35, 2
    s_mov_b32 s38, 0
    ds_read_b64_tr_b16 a[0:1], v22 offset:32768
    ds_read_b64_tr_b16 a[2:3], v22 offset:34816
    ds_read_b64_tr_b16 a[4:5], v23 offset:32768
    ds_read_b64_tr_b16 a[6:7], v23 offset:34816
    ds_read_b64_tr_b16 a[8:9], v22 offset:33280
    ds_read_b64_tr_b16 a[10:11], v22 offset:35328
    ds_read_b64_tr_b16 a[12:13], v23 offset:33280
    ds_read_b64_tr_b16 a[14:15], v23 offset:35328
    ds_read_b64_tr_b16 a[16:17], v22 offset:40960
    ds_read_b64_tr_b16 a[18:19], v22 offset:43008
    ds_read_b64_tr_b16 a[20:21], v23 offset:40960
    ds_read_b64_tr_b16 a[22:23], v23 offset:43008
    ds_read_b64_tr_b16 a[24:25], v22 offset:41472
    ds_read_b64_tr_b16 a[26:27], v22 offset:43520
    s_waitcnt lgkmcnt(10)
    s_add_u32 m0, s32, 0x0
    v_mfma_f32_16x16x32_bf16 v[64:67], a[0:3], a[224:227], 0
    ds_read_b64_tr_b16 a[28:29], v23 offset:41472
    buffer_load_dwordx4 v3, s[24:27], s72 offen offset:0 lds
    v_mfma_f32_16x16x32_bf16 v[68:71], a[0:3], a[228:231], 0
    ds_read_b64_tr_b16 a[30:31], v23 offset:43520
    v_mfma_f32_16x16x32_bf16 v[72:75], a[4:7], a[224:227], 0
    ds_read_b64_tr_b16 a[0:1], v22 offset:36864
    buffer_load_dwordx4 a[192:195], v4, s[20:23], s30 offen offset:0 sc1
    v_mfma_f32_16x16x32_bf16 v[76:79], a[4:7], a[228:231], 0
    ds_read_b64_tr_b16 a[2:3], v22 offset:38912
    s_waitcnt lgkmcnt(10)
    s_add_u32 m0, s32, 0x2000
    v_mfma_f32_16x16x32_bf16 v[80:83], a[8:11], a[224:227], 0
    ds_read_b64_tr_b16 a[4:5], v23 offset:36864
    buffer_load_dwordx4 v2, s[8:11], s68 offen sc1 lds
    v_mfma_f32_16x16x32_bf16 v[84:87], a[8:11], a[228:231], 0
    ds_read_b64_tr_b16 a[6:7], v23 offset:38912
    v_mfma_f32_16x16x32_bf16 v[88:91], a[12:15], a[224:227], 0
    ds_read_b64_tr_b16 a[8:9], v22 offset:37376
    buffer_load_dwordx4 a[196:199], v4, s[20:23], s30 offen offset:1024 sc1
    v_mfma_f32_16x16x32_bf16 v[92:95], a[12:15], a[228:231], 0
    ds_read_b64_tr_b16 a[10:11], v22 offset:39424
    s_waitcnt lgkmcnt(10)
    s_add_u32 m0, s32, 0x1000
    v_mfma_f32_16x16x32_bf16 v[96:99], a[16:19], a[224:227], 0
    ds_read_b64_tr_b16 a[12:13], v23 offset:37376
    buffer_load_dwordx4 v3, s[24:27], s73 offen offset:0 lds
    v_mfma_f32_16x16x32_bf16 v[100:103], a[16:19], a[228:231], 0
    ds_read_b64_tr_b16 a[14:15], v23 offset:39424
    v_mfma_f32_16x16x32_bf16 v[104:107], a[20:23], a[224:227], 0
    ds_read_b64_tr_b16 a[16:17], v22 offset:45056
    buffer_load_dwordx4 a[200:203], v4, s[20:23], s30 offen offset:2048 sc1
    v_mfma_f32_16x16x32_bf16 v[108:111], a[20:23], a[228:231], 0
    ds_read_b64_tr_b16 a[18:19], v22 offset:47104
    s_waitcnt lgkmcnt(10)
    s_add_u32 m0, s32, 0x3000
    v_mfma_f32_16x16x32_bf16 v[112:115], a[24:27], a[224:227], 0
    ds_read_b64_tr_b16 a[20:21], v23 offset:45056
    buffer_load_dwordx4 v2, s[8:11], s69 offen sc1 lds
    s_add_u32 s72, s72, 0x20000
    s_add_u32 s73, s72, 0x10000
    s_add_u32 s68, s69, s3
    s_add_u32 s69, s68, s3
    v_mfma_f32_16x16x32_bf16 v[116:119], a[24:27], a[228:231], 0
    ds_read_b64_tr_b16 a[22:23], v23 offset:47104
    v_mfma_f32_16x16x32_bf16 v[120:123], a[28:31], a[224:227], 0
    ds_read_b64_tr_b16 a[24:25], v22 offset:45568
    buffer_load_dwordx4 a[204:207], v4, s[20:23], s30 offen offset:3072 sc1
    s_add_u32 s30, s30, 4096
    v_mfma_f32_16x16x32_bf16 v[124:127], a[28:31], a[228:231], 0
    ds_read_b64_tr_b16 a[26:27], v22 offset:47616
    s_waitcnt vmcnt(12)
    s_barrier
    s_waitcnt lgkmcnt(10)
    s_add_u32 m0, s32, 0x4000
    v_mfma_f32_16x16x32_bf16 v[64:67], a[0:3], a[232:235], v[64:67]
    ds_read_b64_tr_b16 a[28:29], v23 offset:45568
    buffer_load_dwordx4 v3, s[24:27], s72 offen offset:0 lds
    v_mfma_f32_16x16x32_bf16 v[68:71], a[0:3], a[236:239], v[68:71]
    ds_read_b64_tr_b16 a[30:31], v23 offset:47616
    v_mfma_f32_16x16x32_bf16 v[72:75], a[4:7], a[232:235], v[72:75]
    ds_read_b64_tr_b16 a[0:1], v22 offset:49152
    buffer_load_dwordx4 a[208:211], v4, s[20:23], s30 offen offset:0 sc1
    v_mfma_f32_16x16x32_bf16 v[76:79], a[4:7], a[236:239], v[76:79]
    ds_read_b64_tr_b16 a[2:3], v22 offset:51200
    s_waitcnt lgkmcnt(10)
    s_add_u32 m0, s32, 0x6000
    v_mfma_f32_16x16x32_bf16 v[80:83], a[8:11], a[232:235], v[80:83]
    ds_read_b64_tr_b16 a[4:5], v23 offset:49152
    buffer_load_dwordx4 v2, s[8:11], s68 offen sc1 lds
    v_mfma_f32_16x16x32_bf16 v[84:87], a[8:11], a[236:239], v[84:87]
    ds_read_b64_tr_b16 a[6:7], v23 offset:51200
    v_mfma_f32_16x16x32_bf16 v[88:91], a[12:15], a[232:235], v[88:91]
    ds_read_b64_tr_b16 a[8:9], v22 offset:49664
    buffer_load_dwordx4 a[212:215], v4, s[20:23], s30 offen offset:1024 sc1
    v_mfma_f32_16x16x32_bf16 v[92:95], a[12:15], a[236:239], v[92:95]
    ds_read_b64_tr_b16 a[10:11], v22 offset:51712
    s_waitcnt lgkmcnt(10)
    s_add_u32 m0, s32, 0x5000
    v_mfma_f32_16x16x32_bf16 v[96:99], a[16:19], a[232:235], v[96:99]
    ds_read_b64_tr_b16 a[12:13], v23 offset:49664
    buffer_load_dwordx4 v3, s[24:27], s73 offen offset:0 lds
    v_mfma_f32_16x16x32_bf16 v[100:103], a[16:19], a[236:239], v[100:103]
    ds_read_b64_tr_b16 a[14:15], v23 offset:51712
    v_mfma_f32_16x16x32_bf16 v[104:107], a[20:23], a[232:235], v[104:107]
    ds_read_b64_tr_b16 a[16:17], v22 offset:57344
    buffer_load_dwordx4 a[216:219], v4, s[20:23], s30 offen offset:2048 sc1
    v_mfma_f32_16x16x32_bf16 v[108:111], a[20:23], a[236:239], v[108:111]
    ds_read_b64_tr_b16 a[18:19], v22 offset:59392
    s_waitcnt lgkmcnt(10)
    s_add_u32 m0, s32, 0x7000
    v_mfma_f32_16x16x32_bf16 v[112:115], a[24:27], a[232:235], v[112:115]
    ds_read_b64_tr_b16 a[20:21], v23 offset:57344
    buffer_load_dwordx4 v2, s[8:11], s69 offen sc1 lds
    s_add_u32 s72, s72, 0x20000
    s_add_u32 s73, s72, 0x10000
    s_add_u32 s68, s69, s3
    s_add_u32 s69, s68, s3
    v_mfma_f32_16x16x32_bf16 v[116:119], a[24:27], a[236:239], v[116:119]
    ds_read_b64_tr_b16 a[22:23], v23 offset:59392
    v_mfma_f32_16x16x32_bf16 v[120:123], a[28:31], a[232:235], v[120:123]
    ds_read_b64_tr_b16 a[24:25], v22 offset:57856
    buffer_load_dwordx4 a[220:223], v4, s[20:23], s30 offen offset:3072 sc1
    s_add_u32 s30, s30, 4096
    v_mfma_f32_16x16x32_bf16 v[124:127], a[28:31], a[236:239], v[124:127]
    ds_read_b64_tr_b16 a[26:27], v22 offset:59904
    s_getpc_b64 s[80:81]
    global_load_dword v28, v0, s[80:81] offset:2048
    s_waitcnt lgkmcnt(10)
    s_add_u32 m0, s32, 0x8000
    v_mfma_f32_16x16x32_bf16 v[64:67], a[0:3], a[240:243], v[64:67]
    ds_read_b64_tr_b16 a[28:29], v23 offset:57856
    buffer_load_dwordx4 v3, s[24:27], s72 offen offset:0 lds
    v_mfma_f32_16x16x32_bf16 v[68:71], a[0:3], a[244:247], v[68:71]
    ds_read_b64_tr_b16 a[30:31], v23 offset:59904
    v_mfma_f32_16x16x32_bf16 v[72:75], a[4:7], a[240:243], v[72:75]
    ds_read_b64_tr_b16 a[0:1], v22 offset:53248
    buffer_load_dwordx4 a[32:35], v4, s[20:23], s30 offen offset:0 sc1
    v_mfma_f32_16x16x32_bf16 v[76:79], a[4:7], a[244:247], v[76:79]
    ds_read_b64_tr_b16 a[2:3], v22 offset:55296
    s_waitcnt lgkmcnt(10)
    s_add_u32 m0, s32, 0xa000
    v_mfma_f32_16x16x32_bf16 v[80:83], a[8:11], a[240:243], v[80:83]
    ds_read_b64_tr_b16 a[4:5], v23 offset:53248
    buffer_load_dwordx4 v2, s[8:11], s68 offen sc1 lds
    v_mfma_f32_16x16x32_bf16 v[84:87], a[8:11], a[244:247], v[84:87]
    ds_read_b64_tr_b16 a[6:7], v23 offset:55296
    v_mfma_f32_16x16x32_bf16 v[88:91], a[12:15], a[240:243], v[88:91]
    ds_read_b64_tr_b16 a[8:9], v22 offset:53760
    buffer_load_dwordx4 a[36:39], v4, s[20:23], s30 offen offset:1024 sc1
    v_mfma_f32_16x16x32_bf16 v[92:95], a[12:15], a[244:247], v[92:95]
    ds_read_b64_tr_b16 a[10:11], v22 offset:55808
    s_waitcnt lgkmcnt(10)
    s_add_u32 m0, s32, 0x9000
    v_mfma_f32_16x16x32_bf16 v[96:99], a[16:19], a[240:243], v[96:99]
    ds_read_b64_tr_b16 a[12:13], v23 offset:53760
    buffer_load_dwordx4 v3, s[24:27], s73 offen offset:0 lds
    v_mfma_f32_16x16x32_bf16 v[100:103], a[16:19], a[244:247], v[100:103]
    ds_read_b64_tr_b16 a[14:15], v23 offset:55808
    v_mfma_f32_16x16x32_bf16 v[104:107], a[20:23], a[240:243], v[104:107]
    ds_read_b64_tr_b16 a[16:17], v22 offset:61440
    buffer_load_dwordx4 a[40:43], v4, s[20:23], s30 offen offset:2048 sc1
    v_mfma_f32_16x16x32_bf16 v[108:111], a[20:23], a[244:247], v[108:111]
    ds_read_b64_tr_b16 a[18:19], v22 offset:63488
    s_waitcnt lgkmcnt(10)
    s_add_u32 m0, s32, 0xb000
    v_mfma_f32_16x16x32_bf16 v[112:115], a[24:27], a[240:243], v[112:115]
    ds_read_b64_tr_b16 a[20:21], v23 offset:61440
    buffer_load_dwordx4 v2, s[8:11], s69 offen sc1 lds
    s_add_u32 s72, s72, 0x20000
    s_add_u32 s73, s72, 0x10000
    s_add_u32 s68, s69, s3
    s_add_u32 s69, s68, s3
    v_mfma_f32_16x16x32_bf16 v[116:119], a[24:27], a[244:247], v[116:119]
    ds_read_b64_tr_b16 a[22:23], v23 offset:63488
    v_mfma_f32_16x16x32_bf16 v[120:123], a[28:31], a[240:243], v[120:123]
    ds_read_b64_tr_b16 a[24:25], v22 offset:61952
    buffer_load_dwordx4 a[44:47], v4, s[20:23], s30 offen offset:3072 sc1
    s_add_u32 s30, s30, 4096
    v_mfma_f32_16x16x32_bf16 v[124:127], a[28:31], a[244:247], v[124:127]
    ds_read_b64_tr_b16 a[26:27], v22 offset:64000
    s_waitcnt lgkmcnt(10)
    s_add_u32 m0, s32, 0xc000
    v_mfma_f32_16x16x32_bf16 v[64:67], a[0:3], a[248:251], v[64:67]
    ds_read_b64_tr_b16 a[28:29], v23 offset:61952
    buffer_load_dwordx4 v3, s[24:27], s72 offen offset:0 lds
    v_mfma_f32_16x16x32_bf16 v[68:71], a[0:3], a[252:255], v[68:71]
    ds_read_b64_tr_b16 a[30:31], v23 offset:64000
    v_mfma_f32_16x16x32_bf16 v[72:75], a[4:7], a[248:251], v[72:75]
    ds_read_b64_tr_b16 a[0:1], v24 offset:0
    buffer_load_dwordx4 a[48:51], v4, s[20:23], s30 offen offset:0 sc1
    v_mfma_f32_16x16x32_bf16 v[76:79], a[4:7], a[252:255], v[76:79]
    ds_read_b64_tr_b16 a[2:3], v24 offset:2048
    s_waitcnt lgkmcnt(10)
    s_add_u32 m0, s32, 0xe000
    v_mfma_f32_16x16x32_bf16 v[80:83], a[8:11], a[248:251], v[80:83]
    ds_read_b64_tr_b16 a[4:5], v25 offset:0
    buffer_load_dwordx4 v2, s[8:11], s68 offen sc1 lds
    v_mfma_f32_16x16x32_bf16 v[84:87], a[8:11], a[252:255], v[84:87]
    ds_read_b64_tr_b16 a[6:7], v25 offset:2048
    v_mfma_f32_16x16x32_bf16 v[88:91], a[12:15], a[248:251], v[88:91]
    ds_read_b64_tr_b16 a[8:9], v24 offset:512
    buffer_load_dwordx4 a[52:55], v4, s[20:23], s30 offen offset:1024 sc1
    v_mfma_f32_16x16x32_bf16 v[92:95], a[12:15], a[252:255], v[92:95]
    ds_read_b64_tr_b16 a[10:11], v24 offset:2560
    s_waitcnt lgkmcnt(10)
    s_add_u32 m0, s32, 0xd000
    v_mfma_f32_16x16x32_bf16 v[96:99], a[16:19], a[248:251], v[96:99]
    ds_read_b64_tr_b16 a[12:13], v25 offset:512
    buffer_load_dwordx4 v3, s[24:27], s73 offen offset:0 lds
    v_mfma_f32_16x16x32_bf16 v[100:103], a[16:19], a[252:255], v[100:103]
    ds_read_b64_tr_b16 a[14:15], v25 offset:2560
    v_mfma_f32_16x16x32_bf16 v[104:107], a[20:23], a[248:251], v[104:107]
    ds_read_b64_tr_b16 a[16:17], v24 offset:8192
    buffer_load_dwordx4 a[56:59], v4, s[20:23], s30 offen offset:2048 sc1
    v_mfma_f32_16x16x32_bf16 v[108:111], a[20:23], a[252:255], v[108:111]
    ds_read_b64_tr_b16 a[18:19], v24 offset:10240
    s_waitcnt lgkmcnt(10)
    s_add_u32 m0, s32, 0xf000
    v_mfma_f32_16x16x32_bf16 v[112:115], a[24:27], a[248:251], v[112:115]
    ds_read_b64_tr_b16 a[20:21], v25 offset:8192
    buffer_load_dwordx4 v2, s[8:11], s69 offen sc1 lds
    s_add_u32 s72, s72, 0x20000
    s_add_u32 s73, s72, 0x10000
    v_mfma_f32_16x16x32_bf16 v[116:119], a[24:27], a[252:255], v[116:119]
    ds_read_b64_tr_b16 a[22:23], v25 offset:10240
    v_mfma_f32_16x16x32_bf16 v[120:123], a[28:31], a[248:251], v[120:123]
    ds_read_b64_tr_b16 a[24:25], v24 offset:8704
    buffer_load_dwordx4 a[60:63], v4, s[20:23], s30 offen offset:3072 sc1
    s_add_u32 s30, s30, 4096
    s_add_u32 s65, s65, 1
    s_add_u32 s78, s65, s74
    s_and_b32 s78, s78, 3
    s_lshl_b32 s79, s78, 1
    s_add_u32 s79, s79, 1
    s_lshl_b32 s7, s65, 1
    s_sub_u32 s7, s7, 8
    s_cmp_lt_u32 s65, 4
    s_cselect_b32 s78, s78, s65
    s_cselect_b32 s79, s79, s7
    s_lshl_b32 s78, s78, 15
    s_add_u32 s78, s78, s4
    s_lshl_b32 s79, s79, 20
    s_add_u32 s79, s79, s75
    s_cmp_eq_u32 s51, 0
    s_cselect_b32 s30, s78, s30
    s_cselect_b32 s72, s79, s72
    s_add_u32 s73, s72, 0x10000
    s_sub_u32 s68, s72, s75
    s_lshr_b32 s68, s68, s49
    s_add_u32 s68, s68, s52
    s_add_u32 s69, s68, s3
    v_mfma_f32_16x16x32_bf16 v[124:127], a[28:31], a[252:255], v[124:127]
    ds_read_b64_tr_b16 a[26:27], v24 offset:10752
    s_waitcnt lgkmcnt(10)
    v_mfma_f32_16x16x32_bf16 v[64:67], a[0:3], a[160:163], v[64:67]
    ds_read_b64_tr_b16 a[28:29], v25 offset:8704
    v_mfma_f32_16x16x32_bf16 v[68:71], a[0:3], a[164:167], v[68:71]
    ds_read_b64_tr_b16 a[30:31], v25 offset:10752
    v_mfma_f32_16x16x32_bf16 v[72:75], a[4:7], a[160:163], v[72:75]
    ds_read_b64_tr_b16 a[0:1], v24 offset:4096
    v_mfma_f32_16x16x32_bf16 v[76:79], a[4:7], a[164:167], v[76:79]
    ds_read_b64_tr_b16 a[2:3], v24 offset:6144
    s_waitcnt lgkmcnt(10)
    v_mfma_f32_16x16x32_bf16 v[80:83], a[8:11], a[160:163], v[80:83]
    ds_read_b64_tr_b16 a[4:5], v25 offset:4096
    v_mfma_f32_16x16x32_bf16 v[84:87], a[8:11], a[164:167], v[84:87]
    ds_read_b64_tr_b16 a[6:7], v25 offset:6144
    v_mfma_f32_16x16x32_bf16 v[88:91], a[12:15], a[160:163], v[88:91]
    ds_read_b64_tr_b16 a[8:9], v24 offset:4608
    v_mfma_f32_16x16x32_bf16 v[92:95], a[12:15], a[164:167], v[92:95]
    ds_read_b64_tr_b16 a[10:11], v24 offset:6656
    s_waitcnt lgkmcnt(10)
    v_mfma_f32_16x16x32_bf16 v[96:99], a[16:19], a[160:163], v[96:99]
    ds_read_b64_tr_b16 a[12:13], v25 offset:4608
    v_mfma_f32_16x16x32_bf16 v[100:103], a[16:19], a[164:167], v[100:103]
    ds_read_b64_tr_b16 a[14:15], v25 offset:6656
    v_mfma_f32_16x16x32_bf16 v[104:107], a[20:23], a[160:163], v[104:107]
    ds_read_b64_tr_b16 a[16:17], v24 offset:12288
    v_mfma_f32_16x16x32_bf16 v[108:111], a[20:23], a[164:167], v[108:111]
    ds_read_b64_tr_b16 a[18:19], v24 offset:14336
    s_waitcnt lgkmcnt(10)
    v_mfma_f32_16x16x32_bf16 v[112:115], a[24:27], a[160:163], v[112:115]
    ds_read_b64_tr_b16 a[20:21], v25 offset:12288
    v_mfma_f32_16x16x32_bf16 v[116:119], a[24:27], a[164:167], v[116:119]
    ds_read_b64_tr_b16 a[22:23], v25 offset:14336
    v_mfma_f32_16x16x32_bf16 v[120:123], a[28:31], a[160:163], v[120:123]
    ds_read_b64_tr_b16 a[24:25], v24 offset:12800
    v_mfma_f32_16x16x32_bf16 v[124:127], a[28:31], a[164:167], v[124:127]
    ds_read_b64_tr_b16 a[26:27], v24 offset:14848
    s_waitcnt vmcnt(25)
    s_barrier
    s_waitcnt lgkmcnt(10)
    v_mfma_f32_16x16x32_bf16 v[64:67], a[0:3], a[168:171], v[64:67]
    ds_read_b64_tr_b16 a[28:29], v25 offset:12800
    v_mfma_f32_16x16x32_bf16 v[68:71], a[0:3], a[172:175], v[68:71]
    ds_read_b64_tr_b16 a[30:31], v25 offset:14848
    v_mfma_f32_16x16x32_bf16 v[72:75], a[4:7], a[168:171], v[72:75]
    ds_read_b64_tr_b16 a[0:1], v24 offset:16384
    v_mfma_f32_16x16x32_bf16 v[76:79], a[4:7], a[172:175], v[76:79]
    ds_read_b64_tr_b16 a[2:3], v24 offset:18432
    s_waitcnt lgkmcnt(10)
    v_mfma_f32_16x16x32_bf16 v[80:83], a[8:11], a[168:171], v[80:83]
    ds_read_b64_tr_b16 a[4:5], v25 offset:16384
    v_mfma_f32_16x16x32_bf16 v[84:87], a[8:11], a[172:175], v[84:87]
    ds_read_b64_tr_b16 a[6:7], v25 offset:18432
    v_mfma_f32_16x16x32_bf16 v[88:91], a[12:15], a[168:171], v[88:91]
    ds_read_b64_tr_b16 a[8:9], v24 offset:16896
    v_mfma_f32_16x16x32_bf16 v[92:95], a[12:15], a[172:175], v[92:95]
    ds_read_b64_tr_b16 a[10:11], v24 offset:18944
    s_waitcnt lgkmcnt(10)
    v_mfma_f32_16x16x32_bf16 v[96:99], a[16:19], a[168:171], v[96:99]
    ds_read_b64_tr_b16 a[12:13], v25 offset:16896
    v_mfma_f32_16x16x32_bf16 v[100:103], a[16:19], a[172:175], v[100:103]
    ds_read_b64_tr_b16 a[14:15], v25 offset:18944
    v_mfma_f32_16x16x32_bf16 v[104:107], a[20:23], a[168:171], v[104:107]
    ds_read_b64_tr_b16 a[16:17], v24 offset:24576
    v_mfma_f32_16x16x32_bf16 v[108:111], a[20:23], a[172:175], v[108:111]
    ds_read_b64_tr_b16 a[18:19], v24 offset:26624
    s_waitcnt lgkmcnt(10)
    v_mfma_f32_16x16x32_bf16 v[112:115], a[24:27], a[168:171], v[112:115]
    ds_read_b64_tr_b16 a[20:21], v25 offset:24576
    v_mfma_f32_16x16x32_bf16 v[116:119], a[24:27], a[172:175], v[116:119]
    ds_read_b64_tr_b16 a[22:23], v25 offset:26624
    v_mfma_f32_16x16x32_bf16 v[120:123], a[28:31], a[168:171], v[120:123]
    ds_read_b64_tr_b16 a[24:25], v24 offset:25088
    buffer_load_dword v9, v5, s[20:23], s47 offen sc1
    v_mfma_f32_16x16x32_bf16 v[124:127], a[28:31], a[172:175], v[124:127]
    ds_read_b64_tr_b16 a[26:27], v24 offset:27136
    s_waitcnt lgkmcnt(10)
    v_mfma_f32_16x16x32_bf16 v[64:67], a[0:3], a[176:179], v[64:67]
    ds_read_b64_tr_b16 a[28:29], v25 offset:25088
    v_mfma_f32_16x16x32_bf16 v[68:71], a[0:3], a[180:183], v[68:71]
    ds_read_b64_tr_b16 a[30:31], v25 offset:27136
    v_mfma_f32_16x16x32_bf16 v[72:75], a[4:7], a[176:179], v[72:75]
    ds_read_b64_tr_b16 a[0:1], v24 offset:20480
    v_mfma_f32_16x16x32_bf16 v[76:79], a[4:7], a[180:183], v[76:79]
    ds_read_b64_tr_b16 a[2:3], v24 offset:22528
    s_waitcnt lgkmcnt(10)
    v_mfma_f32_16x16x32_bf16 v[80:83], a[8:11], a[176:179], v[80:83]
    ds_read_b64_tr_b16 a[4:5], v25 offset:20480
    v_mfma_f32_16x16x32_bf16 v[84:87], a[8:11], a[180:183], v[84:87]
    ds_read_b64_tr_b16 a[6:7], v25 offset:22528
    v_mfma_f32_16x16x32_bf16 v[88:91], a[12:15], a[176:179], v[88:91]
    ds_read_b64_tr_b16 a[8:9], v24 offset:20992
    v_mfma_f32_16x16x32_bf16 v[92:95], a[12:15], a[180:183], v[92:95]
    ds_read_b64_tr_b16 a[10:11], v24 offset:23040
    s_waitcnt lgkmcnt(10)
    v_mfma_f32_16x16x32_bf16 v[96:99], a[16:19], a[176:179], v[96:99]
    ds_read_b64_tr_b16 a[12:13], v25 offset:20992
    v_mfma_f32_16x16x32_bf16 v[100:103], a[16:19], a[180:183], v[100:103]
    ds_read_b64_tr_b16 a[14:15], v25 offset:23040
    v_mfma_f32_16x16x32_bf16 v[104:107], a[20:23], a[176:179], v[104:107]
    ds_read_b64_tr_b16 a[16:17], v24 offset:28672
    v_mfma_f32_16x16x32_bf16 v[108:111], a[20:23], a[180:183], v[108:111]
    ds_read_b64_tr_b16 a[18:19], v24 offset:30720
    s_waitcnt lgkmcnt(10)
    v_mfma_f32_16x16x32_bf16 v[112:115], a[24:27], a[176:179], v[112:115]
    ds_read_b64_tr_b16 a[20:21], v25 offset:28672
    v_mfma_f32_16x16x32_bf16 v[116:119], a[24:27], a[180:183], v[116:119]
    ds_read_b64_tr_b16 a[22:23], v25 offset:30720
    v_mfma_f32_16x16x32_bf16 v[120:123], a[28:31], a[176:179], v[120:123]
    ds_read_b64_tr_b16 a[24:25], v24 offset:29184
    v_mfma_f32_16x16x32_bf16 v[124:127], a[28:31], a[180:183], v[124:127]
    ds_read_b64_tr_b16 a[26:27], v24 offset:31232
    s_waitcnt lgkmcnt(10)
    v_mfma_f32_16x16x32_bf16 v[64:67], a[0:3], a[184:187], v[64:67]
    ds_read_b64_tr_b16 a[28:29], v25 offset:29184
    v_mfma_f32_16x16x32_bf16 v[68:71], a[0:3], a[188:191], v[68:71]
    ds_read_b64_tr_b16 a[30:31], v25 offset:31232
    v_mfma_f32_16x16x32_bf16 v[72:75], a[4:7], a[184:187], v[72:75]
    ds_read_b64_tr_b16 a[0:1], v20 offset:0
    v_mfma_f32_16x16x32_bf16 v[76:79], a[4:7], a[188:191], v[76:79]
    ds_read_b64_tr_b16 a[2:3], v20 offset:2048
    s_waitcnt lgkmcnt(10)
    v_mfma_f32_16x16x32_bf16 v[80:83], a[8:11], a[184:187], v[80:83]
    ds_read_b64_tr_b16 a[4:5], v21 offset:0
    v_mfma_f32_16x16x32_bf16 v[84:87], a[8:11], a[188:191], v[84:87]
    ds_read_b64_tr_b16 a[6:7], v21 offset:2048
    v_mfma_f32_16x16x32_bf16 v[88:91], a[12:15], a[184:187], v[88:91]
    ds_read_b64_tr_b16 a[8:9], v20 offset:512
    v_mfma_f32_16x16x32_bf16 v[92:95], a[12:15], a[188:191], v[92:95]
    ds_read_b64_tr_b16 a[10:11], v20 offset:2560
    s_waitcnt lgkmcnt(10)
    v_mfma_f32_16x16x32_bf16 v[96:99], a[16:19], a[184:187], v[96:99]
    ds_read_b64_tr_b16 a[12:13], v21 offset:512
    v_mfma_f32_16x16x32_bf16 v[100:103], a[16:19], a[188:191], v[100:103]
    ds_read_b64_tr_b16 a[14:15], v21 offset:2560
    v_mfma_f32_16x16x32_bf16 v[104:107], a[20:23], a[184:187], v[104:107]
    ds_read_b64_tr_b16 a[16:17], v20 offset:8192
    v_mfma_f32_16x16x32_bf16 v[108:111], a[20:23], a[188:191], v[108:111]
    ds_read_b64_tr_b16 a[18:19], v20 offset:10240
    s_waitcnt vmcnt(0)
    v_cmp_ne_u32 vcc, 0, v9
    s_nop 1
    s_and_b32 s78, vcc_lo, s39
    s_cmp_eq_u32 s78, s39
    s_cbranch_scc1 L_m_poll_1_ok
    s_mov_b32 s79, 0x100000
L_m_poll_1:
    buffer_load_dword v9, v5, s[20:23], s47 offen sc1
    s_waitcnt vmcnt(0)
    v_cmp_ne_u32 vcc, 0, v9
    s_nop 1
    s_and_b32 s78, vcc_lo, s39
    s_cmp_eq_u32 s78, s39
    s_cbranch_scc1 L_m_poll_1_ok
    s_sleep 1
    s_sub_u32 s79, s79, 1
    s_cmp_lg_u32 s79, 0
    s_cbranch_scc1 L_m_poll_1
L_m_poll_1_ok:
    s_waitcnt lgkmcnt(10)
    v_mfma_f32_16x16x32_bf16 v[112:115], a[24:27], a[184:187], v[112:115]
    ds_read_b64_tr_b16 a[20:21], v21 offset:8192
    v_mfma_f32_16x16x32_bf16 v[116:119], a[24:27], a[188:191], v[116:119]
    ds_read_b64_tr_b16 a[22:23], v21 offset:10240
    v_mfma_f32_16x16x32_bf16 v[120:123], a[28:31], a[184:187], v[120:123]
    ds_read_b64_tr_b16 a[24:25], v20 offset:8704
    v_mfma_f32_16x16x32_bf16 v[124:127], a[28:31], a[188:191], v[124:127]
    ds_read_b64_tr_b16 a[26:27], v20 offset:10752
    s_waitcnt lgkmcnt(10)
    v_mfma_f32_16x16x32_bf16 v[64:67], a[0:3], a[192:195], v[64:67]
    ds_read_b64_tr_b16 a[28:29], v21 offset:8704
    v_mfma_f32_16x16x32_bf16 v[68:71], a[0:3], a[196:199], v[68:71]
    ds_read_b64_tr_b16 a[30:31], v21 offset:10752
    s_add_u32 m0, s32, 0x18000
    v_mfma_f32_16x16x32_bf16 v[72:75], a[4:7], a[192:195], v[72:75]
    ds_read_b64_tr_b16 a[0:1], v20 offset:4096
    buffer_load_dwordx4 v3, s[24:27], s72 offen offset:0 lds
    v_mfma_f32_16x16x32_bf16 v[76:79], a[4:7], a[196:199], v[76:79]
    ds_read_b64_tr_b16 a[2:3], v20 offset:6144
    s_waitcnt lgkmcnt(10)
    v_mfma_f32_16x16x32_bf16 v[80:83], a[8:11], a[192:195], v[80:83]
    ds_read_b64_tr_b16 a[4:5], v21 offset:4096
    v_mfma_f32_16x16x32_bf16 v[84:87], a[8:11], a[196:199], v[84:87]
    ds_read_b64_tr_b16 a[6:7], v21 offset:6144
    v_mfma_f32_16x16x32_bf16 v[88:91], a[12:15], a[192:195], v[88:91]
    ds_read_b64_tr_b16 a[8:9], v20 offset:4608
    buffer_load_dwordx4 a[224:227], v4, s[20:23], s30 offen offset:0 sc1
    v_mfma_f32_16x16x32_bf16 v[92:95], a[12:15], a[196:199], v[92:95]
    ds_read_b64_tr_b16 a[10:11], v20 offset:6656
    s_waitcnt lgkmcnt(10)
    v_mfma_f32_16x16x32_bf16 v[96:99], a[16:19], a[192:195], v[96:99]
    ds_read_b64_tr_b16 a[12:13], v21 offset:4608
    v_mfma_f32_16x16x32_bf16 v[100:103], a[16:19], a[196:199], v[100:103]
    ds_read_b64_tr_b16 a[14:15], v21 offset:6656
    s_add_u32 m0, s32, 0x1a000
    v_mfma_f32_16x16x32_bf16 v[104:107], a[20:23], a[192:195], v[104:107]
    ds_read_b64_tr_b16 a[16:17], v20 offset:12288
    buffer_load_dwordx4 v2, s[8:11], s68 offen sc1 lds
    v_mfma_f32_16x16x32_bf16 v[108:111], a[20:23], a[196:199], v[108:111]
    ds_read_b64_tr_b16 a[18:19], v20 offset:14336
    s_waitcnt lgkmcnt(10)
    v_mfma_f32_16x16x32_bf16 v[112:115], a[24:27], a[192:195], v[112:115]
    ds_read_b64_tr_b16 a[20:21], v21 offset:12288
    v_mfma_f32_16x16x32_bf16 v[116:119], a[24:27], a[196:199], v[116:119]
    ds_read_b64_tr_b16 a[22:23], v21 offset:14336
    v_mfma_f32_16x16x32_bf16 v[120:123], a[28:31], a[192:195], v[120:123]
    ds_read_b64_tr_b16 a[24:25], v20 offset:12800
    buffer_load_dwordx4 a[228:231], v4, s[20:23], s30 offen offset:1024 sc1
    v_mfma_f32_16x16x32_bf16 v[124:127], a[28:31], a[196:199], v[124:127]
    ds_read_b64_tr_b16 a[26:27], v20 offset:14848
    s_waitcnt vmcnt(4)
    s_barrier
    s_waitcnt lgkmcnt(10)
    v_mfma_f32_16x16x32_bf16 v[64:67], a[0:3], a[200:203], v[64:67]
    ds_read_b64_tr_b16 a[28:29], v21 offset:12800
    v_mfma_f32_16x16x32_bf16 v[68:71], a[0:3], a[204:207], v[68:71]
    ds_read_b64_tr_b16 a[30:31], v21 offset:14848
    s_add_u32 m0, s32, 0x19000
    v_mfma_f32_16x16x32_bf16 v[72:75], a[4:7], a[200:203], v[72:75]
    ds_read_b64_tr_b16 a[0:1], v20 offset:16384
    buffer_load_dwordx4 v3, s[24:27], s73 offen offset:0 lds
    v_mfma_f32_16x16x32_bf16 v[76:79], a[4:7], a[204:207], v[76:79]
    ds_read_b64_tr_b16 a[2:3], v20 offset:18432
    s_waitcnt lgkmcnt(10)
    v_mfma_f32_16x16x32_bf16 v[80:83], a[8:11], a[200:203], v[80:83]
    ds_read_b64_tr_b16 a[4:5], v21 offset:16384
    v_mfma_f32_16x16x32_bf16 v[84:87], a[8:11], a[204:207], v[84:87]
    ds_read_b64_tr_b16 a[6:7], v21 offset:18432
    v_mfma_f32_16x16x32_bf16 v[88:91], a[12:15], a[200:203], v[88:91]
    ds_read_b64_tr_b16 a[8:9], v20 offset:16896
    buffer_load_dwordx4 a[232:235], v4, s[20:23], s30 offen offset:2048 sc1
    v_mfma_f32_16x16x32_bf16 v[92:95], a[12:15], a[204:207], v[92:95]
    ds_read_b64_tr_b16 a[10:11], v20 offset:18944
    s_waitcnt lgkmcnt(10)
    v_mfma_f32_16x16x32_bf16 v[96:99], a[16:19], a[200:203], v[96:99]
    ds_read_b64_tr_b16 a[12:13], v21 offset:16896
    v_mfma_f32_16x16x32_bf16 v[100:103], a[16:19], a[204:207], v[100:103]
    ds_read_b64_tr_b16 a[14:15], v21 offset:18944
    s_add_u32 m0, s32, 0x1b000
    v_mfma_f32_16x16x32_bf16 v[104:107], a[20:23], a[200:203], v[104:107]
    ds_read_b64_tr_b16 a[16:17], v20 offset:24576
    buffer_load_dwordx4 v2, s[8:11], s69 offen sc1 lds
    s_add_u32 s72, s72, 0x20000
    s_add_u32 s73, s72, 0x10000
    s_add_u32 s68, s69, s3
    s_add_u32 s69, s68, s3
    v_mfma_f32_16x16x32_bf16 v[108:111], a[20:23], a[204:207], v[108:111]
    ds_read_b64_tr_b16 a[18:19], v20 offset:26624
    s_waitcnt lgkmcnt(10)
    v_mfma_f32_16x16x32_bf16 v[112:115], a[24:27], a[200:203], v[112:115]
    ds_read_b64_tr_b16 a[20:21], v21 offset:24576
    v_mfma_f32_16x16x32_bf16 v[116:119], a[24:27], a[204:207], v[116:119]
    ds_read_b64_tr_b16 a[22:23], v21 offset:26624
    v_mfma_f32_16x16x32_bf16 v[120:123], a[28:31], a[200:203], v[120:123]
    ds_read_b64_tr_b16 a[24:25], v20 offset:25088
    buffer_load_dwordx4 a[236:239], v4, s[20:23], s30 offen offset:3072 sc1
    s_add_u32 s30, s30, 4096
    v_mfma_f32_16x16x32_bf16 v[124:127], a[28:31], a[204:207], v[124:127]
    ds_read_b64_tr_b16 a[26:27], v20 offset:27136
    s_waitcnt lgkmcnt(10)
    v_mfma_f32_16x16x32_bf16 v[64:67], a[0:3], a[208:211], v[64:67]
    ds_read_b64_tr_b16 a[28:29], v21 offset:25088
    v_mfma_f32_16x16x32_bf16 v[68:71], a[0:3], a[212:215], v[68:71]
    ds_read_b64_tr_b16 a[30:31], v21 offset:27136
    s_add_u32 m0, s32, 0x1c000
    v_mfma_f32_16x16x32_bf16 v[72:75], a[4:7], a[208:211], v[72:75]
    ds_read_b64_tr_b16 a[0:1], v20 offset:20480
    buffer_load_dwordx4 v3, s[24:27], s72 offen offset:0 lds
    v_mfma_f32_16x16x32_bf16 v[76:79], a[4:7], a[212:215], v[76:79]
    ds_read_b64_tr_b16 a[2:3], v20 offset:22528
    s_waitcnt lgkmcnt(10)
    v_mfma_f32_16x16x32_bf16 v[80:83], a[8:11], a[208:211], v[80:83]
    ds_read_b64_tr_b16 a[4:5], v21 offset:20480
    buffer_load_dwordx4 a[240:243], v4, s[20:23], s30 offen offset:0 sc1
    v_mfma_f32_16x16x32_bf16 v[84:87], a[8:11], a[212:215], v[84:87]
    ds_read_b64_tr_b16 a[6:7], v21 offset:22528
    v_mfma_f32_16x16x32_bf16 v[88:91], a[12:15], a[208:211], v[88:91]
    ds_read_b64_tr_b16 a[8:9], v20 offset:20992
    v_mfma_f32_16x16x32_bf16 v[92:95], a[12:15], a[212:215], v[92:95]
    ds_read_b64_tr_b16 a[10:11], v20 offset:23040
    s_waitcnt lgkmcnt(10)
    s_add_u32 m0, s32, 0x1e000
    v_mfma_f32_16x16x32_bf16 v[96:99], a[16:19], a[208:211], v[96:99]
    ds_read_b64_tr_b16 a[12:13], v21 offset:20992
    buffer_load_dwordx4 v2, s[8:11], s68 offen sc1 lds
    v_mfma_f32_16x16x32_bf16 v[100:103], a[16:19], a[212:215], v[100:103]
    ds_read_b64_tr_b16 a[14:15], v21 offset:23040
    v_mfma_f32_16x16x32_bf16 v[104:107], a[20:23], a[208:211], v[104:107]
    ds_read_b64_tr_b16 a[16:17], v20 offset:28672
    buffer_load_dwordx4 a[244:247], v4, s[20:23], s30 offen offset:1024 sc1
    v_mfma_f32_16x16x32_bf16 v[108:111], a[20:23], a[212:215], v[108:111]
    ds_read_b64_tr_b16 a[18:19], v20 offset:30720
    s_waitcnt lgkmcnt(10)
    v_mfma_f32_16x16x32_bf16 v[112:115], a[24:27], a[208:211], v[112:115]
    ds_read_b64_tr_b16 a[20:21], v21 offset:28672
    v_mfma_f32_16x16x32_bf16 v[116:119], a[24:27], a[212:215], v[116:119]
    ds_read_b64_tr_b16 a[22:23], v21 offset:30720
    s_add_u32 m0, s32, 0x1d000
    v_mfma_f32_16x16x32_bf16 v[120:123], a[28:31], a[208:211], v[120:123]
    ds_read_b64_tr_b16 a[24:25], v20 offset:29184
    buffer_load_dwordx4 v3, s[24:27], s73 offen offset:0 lds
    v_mfma_f32_16x16x32_bf16 v[124:127], a[28:31], a[212:215], v[124:127]
    ds_read_b64_tr_b16 a[26:27], v20 offset:31232
    s_waitcnt lgkmcnt(10)
    v_mfma_f32_16x16x32_bf16 v[64:67], a[0:3], a[216:219], v[64:67]
    ds_read_b64_tr_b16 a[28:29], v21 offset:29184
    buffer_load_dwordx4 a[248:251], v4, s[20:23], s30 offen offset:2048 sc1
    v_mfma_f32_16x16x32_bf16 v[68:71], a[0:3], a[220:223], v[68:71]
    ds_read_b64_tr_b16 a[30:31], v21 offset:31232
    v_mfma_f32_16x16x32_bf16 v[72:75], a[4:7], a[216:219], v[72:75]
    ds_read_b64_tr_b16 a[0:1], v20 offset:32768
    v_mfma_f32_16x16x32_bf16 v[76:79], a[4:7], a[220:223], v[76:79]
    ds_read_b64_tr_b16 a[2:3], v20 offset:34816
    s_waitcnt lgkmcnt(10)
    s_add_u32 m0, s32, 0x1f000
    v_mfma_f32_16x16x32_bf16 v[80:83], a[8:11], a[216:219], v[80:83]
    ds_read_b64_tr_b16 a[4:5], v21 offset:32768
    buffer_load_dwordx4 v2, s[8:11], s69 offen sc1 lds
    s_add_u32 s72, s72, 0x20000
    s_add_u32 s73, s72, 0x10000
    s_add_u32 s68, s69, s3
    s_add_u32 s69, s68, s3
    v_mfma_f32_16x16x32_bf16 v[84:87], a[8:11], a[220:223], v[84:87]
    ds_read_b64_tr_b16 a[6:7], v21 offset:34816
    v_mfma_f32_16x16x32_bf16 v[88:91], a[12:15], a[216:219], v[88:91]
    ds_read_b64_tr_b16 a[8:9], v20 offset:33280
    buffer_load_dwordx4 a[252:255], v4, s[20:23], s30 offen offset:3072 sc1
    s_add_u32 s30, s30, 4096
    v_mfma_f32_16x16x32_bf16 v[92:95], a[12:15], a[220:223], v[92:95]
    ds_read_b64_tr_b16 a[10:11], v20 offset:35328
    s_waitcnt lgkmcnt(10)
    v_mfma_f32_16x16x32_bf16 v[96:99], a[16:19], a[216:219], v[96:99]
    ds_read_b64_tr_b16 a[12:13], v21 offset:33280
    v_mfma_f32_16x16x32_bf16 v[100:103], a[16:19], a[220:223], v[100:103]
    ds_read_b64_tr_b16 a[14:15], v21 offset:35328
    v_mfma_f32_16x16x32_bf16 v[104:107], a[20:23], a[216:219], v[104:107]
    ds_read_b64_tr_b16 a[16:17], v20 offset:40960
    buffer_store_dwordx4 v[144:147], v4, s[20:23], s53 offen offset:0 sc1
    v_mfma_f32_16x16x32_bf16 v[108:111], a[20:23], a[220:223], v[108:111]
    ds_read_b64_tr_b16 a[18:19], v20 offset:43008
    s_waitcnt lgkmcnt(10)
    v_mfma_f32_16x16x32_bf16 v[112:115], a[24:27], a[216:219], v[112:115]
    ds_read_b64_tr_b16 a[20:21], v21 offset:40960
    buffer_store_dwordx4 v[148:151], v4, s[20:23], s53 offen offset:1024 sc1
    v_mfma_f32_16x16x32_bf16 v[116:119], a[24:27], a[220:223], v[116:119]
    ds_read_b64_tr_b16 a[22:23], v21 offset:43008
    v_mfma_f32_16x16x32_bf16 v[120:123], a[28:31], a[216:219], v[120:123]
    ds_read_b64_tr_b16 a[24:25], v20 offset:41472
    s_getpc_b64 s[80:81]
    global_load_dword v28, v0, s[80:81] offset:2048
    v_mfma_f32_16x16x32_bf16 v[124:127], a[28:31], a[220:223], v[124:127]
    ds_read_b64_tr_b16 a[26:27], v20 offset:43520
    s_waitcnt lgkmcnt(10)
    v_mfma_f32_16x16x32_bf16 v[64:67], a[0:3], a[32:35], v[64:67]
    ds_read_b64_tr_b16 a[28:29], v21 offset:41472
    v_mfma_f32_16x16x32_bf16 v[68:71], a[0:3], a[36:39], v[68:71]
    ds_read_b64_tr_b16 a[30:31], v21 offset:43520
    s_add_u32 m0, s32, 0x20000
    v_mfma_f32_16x16x32_bf16 v[72:75], a[4:7], a[32:35], v[72:75]
    ds_read_b64_tr_b16 a[0:1], v20 offset:36864
    buffer_load_dwordx4 v3, s[24:27], s72 offen offset:0 lds
    v_mfma_f32_16x16x32_bf16 v[76:79], a[4:7], a[36:39], v[76:79]
    ds_read_b64_tr_b16 a[2:3], v20 offset:38912
    s_waitcnt lgkmcnt(10)
    v_mfma_f32_16x16x32_bf16 v[80:83], a[8:11], a[32:35], v[80:83]
    ds_read_b64_tr_b16 a[4:5], v21 offset:36864
    v_mfma_f32_16x16x32_bf16 v[84:87], a[8:11], a[36:39], v[84:87]
    ds_read_b64_tr_b16 a[6:7], v21 offset:38912
    v_mfma_f32_16x16x32_bf16 v[88:91], a[12:15], a[32:35], v[88:91]
    ds_read_b64_tr_b16 a[8:9], v20 offset:37376
    buffer_load_dwordx4 a[160:163], v4, s[20:23], s30 offen offset:0 sc1
    v_mfma_f32_16x16x32_bf16 v[92:95], a[12:15], a[36:39], v[92:95]
    ds_read_b64_tr_b16 a[10:11], v20 offset:39424
    s_waitcnt lgkmcnt(10)
    s_add_u32 m0, s32, 0x22000
    v_mfma_f32_16x16x32_bf16 v[96:99], a[16:19], a[32:35], v[96:99]
    ds_read_b64_tr_b16 a[12:13], v21 offset:37376
    buffer_load_dwordx4 v2, s[8:11], s68 offen sc1 lds
    v_mfma_f32_16x16x32_bf16 v[100:103], a[16:19], a[36:39], v[100:103]
    ds_read_b64_tr_b16 a[14:15], v21 offset:39424
    v_mfma_f32_16x16x32_bf16 v[104:107], a[20:23], a[32:35], v[104:107]
    ds_read_b64_tr_b16 a[16:17], v20 offset:45056
    v_mfma_f32_16x16x32_bf16 v[108:111], a[20:23], a[36:39], v[108:111]
    ds_read_b64_tr_b16 a[18:19], v20 offset:47104
    s_waitcnt lgkmcnt(10)
    v_mfma_f32_16x16x32_bf16 v[112:115], a[24:27], a[32:35], v[112:115]
    ds_read_b64_tr_b16 a[20:21], v21 offset:45056
    buffer_load_dwordx4 a[164:167], v4, s[20:23], s30 offen offset:1024 sc1
    v_mfma_f32_16x16x32_bf16 v[116:119], a[24:27], a[36:39], v[116:119]
    ds_read_b64_tr_b16 a[22:23], v21 offset:47104
    s_add_u32 m0, s32, 0x21000
    v_mfma_f32_16x16x32_bf16 v[120:123], a[28:31], a[32:35], v[120:123]
    ds_read_b64_tr_b16 a[24:25], v20 offset:45568
    buffer_load_dwordx4 v3, s[24:27], s73 offen offset:0 lds
    v_mfma_f32_16x16x32_bf16 v[124:127], a[28:31], a[36:39], v[124:127]
    ds_read_b64_tr_b16 a[26:27], v20 offset:47616
    s_waitcnt vmcnt(16)
    s_barrier
    s_waitcnt lgkmcnt(10)
    v_mfma_f32_16x16x32_bf16 v[64:67], a[0:3], a[40:43], v[64:67]
    ds_read_b64_tr_b16 a[28:29], v21 offset:45568
    v_mfma_f32_16x16x32_bf16 v[68:71], a[0:3], a[44:47], v[68:71]
    ds_read_b64_tr_b16 a[30:31], v21 offset:47616
    v_mfma_f32_16x16x32_bf16 v[72:75], a[4:7], a[40:43], v[72:75]
    ds_read_b64_tr_b16 a[0:1], v20 offset:49152
    buffer_load_dwordx4 a[168:171], v4, s[20:23], s30 offen offset:2048 sc1
    v_mfma_f32_16x16x32_bf16 v[76:79], a[4:7], a[44:47], v[76:79]
    ds_read_b64_tr_b16 a[2:3], v20 offset:51200
    s_waitcnt lgkmcnt(10)
    v_mfma_f32_16x16x32_bf16 v[80:83], a[8:11], a[40:43], v[80:83]
    ds_read_b64_tr_b16 a[4:5], v21 offset:49152
    v_mfma_f32_16x16x32_bf16 v[84:87], a[8:11], a[44:47], v[84:87]
    ds_read_b64_tr_b16 a[6:7], v21 offset:51200
    s_add_u32 m0, s32, 0x23000
    v_mfma_f32_16x16x32_bf16 v[88:91], a[12:15], a[40:43], v[88:91]
    ds_read_b64_tr_b16 a[8:9], v20 offset:49664
    buffer_load_dwordx4 v2, s[8:11], s69 offen sc1 lds
    s_add_u32 s72, s72, 0x20000
    s_add_u32 s73, s72, 0x10000
    s_add_u32 s68, s69, s3
    s_add_u32 s69, s68, s3
    v_mfma_f32_16x16x32_bf16 v[92:95], a[12:15], a[44:47], v[92:95]
    ds_read_b64_tr_b16 a[10:11], v20 offset:51712
    s_waitcnt lgkmcnt(10)
    v_mfma_f32_16x16x32_bf16 v[96:99], a[16:19], a[40:43], v[96:99]
    ds_read_b64_tr_b16 a[12:13], v21 offset:49664
    buffer_load_dwordx4 a[172:175], v4, s[20:23], s30 offen offset:3072 sc1
    s_add_u32 s30, s30, 4096
    v_mfma_f32_16x16x32_bf16 v[100:103], a[16:19], a[44:47], v[100:103]
    ds_read_b64_tr_b16 a[14:15], v21 offset:51712
    v_mfma_f32_16x16x32_bf16 v[104:107], a[20:23], a[40:43], v[104:107]
    ds_read_b64_tr_b16 a[16:17], v20 offset:57344
    v_mfma_f32_16x16x32_bf16 v[108:111], a[20:23], a[44:47], v[108:111]
    ds_read_b64_tr_b16 a[18:19], v20 offset:59392
    s_waitcnt lgkmcnt(10)
    v_mfma_f32_16x16x32_bf16 v[112:115], a[24:27], a[40:43], v[112:115]
    ds_read_b64_tr_b16 a[20:21], v21 offset:57344
    buffer_store_dwordx4 v[152:155], v4, s[20:23], s55 offen offset:0 sc1
    v_mfma_f32_16x16x32_bf16 v[116:119], a[24:27], a[44:47], v[116:119]
    ds_read_b64_tr_b16 a[22:23], v21 offset:59392
    v_mfma_f32_16x16x32_bf16 v[120:123], a[28:31], a[40:43], v[120:123]
    ds_read_b64_tr_b16 a[24:25], v20 offset:57856
    buffer_store_dwordx4 v[156:159], v4, s[20:23], s55 offen offset:1024 sc1
    v_mfma_f32_16x16x32_bf16 v[124:127], a[28:31], a[44:47], v[124:127]
    ds_read_b64_tr_b16 a[26:27], v20 offset:59904
    s_waitcnt lgkmcnt(10)
    v_mfma_f32_16x16x32_bf16 v[64:67], a[0:3], a[48:51], v[64:67]
    ds_read_b64_tr_b16 a[28:29], v21 offset:57856
    v_mfma_f32_16x16x32_bf16 v[68:71], a[0:3], a[52:55], v[68:71]
    ds_read_b64_tr_b16 a[30:31], v21 offset:59904
    s_add_u32 m0, s32, 0x24000
    v_mfma_f32_16x16x32_bf16 v[72:75], a[4:7], a[48:51], v[72:75]
    ds_read_b64_tr_b16 a[0:1], v20 offset:53248
    buffer_load_dwordx4 v3, s[24:27], s72 offen offset:0 lds
    v_mfma_f32_16x16x32_bf16 v[76:79], a[4:7], a[52:55], v[76:79]
    ds_read_b64_tr_b16 a[2:3], v20 offset:55296
    s_waitcnt lgkmcnt(10)
    v_mfma_f32_16x16x32_bf16 v[80:83], a[8:11], a[48:51], v[80:83]
    ds_read_b64_tr_b16 a[4:5], v21 offset:53248
    v_mfma_f32_16x16x32_bf16 v[84:87], a[8:11], a[52:55], v[84:87]
    ds_read_b64_tr_b16 a[6:7], v21 offset:55296
    v_mfma_f32_16x16x32_bf16 v[88:91], a[12:15], a[48:51], v[88:91]
    ds_read_b64_tr_b16 a[8:9], v20 offset:53760
    buffer_load_dwordx4 a[176:179], v4, s[20:23], s30 offen offset:0 sc1
    v_mfma_f32_16x16x32_bf16 v[92:95], a[12:15], a[52:55], v[92:95]
    ds_read_b64_tr_b16 a[10:11], v20 offset:55808
    s_waitcnt lgkmcnt(10)
    s_add_u32 m0, s32, 0x26000
    v_mfma_f32_16x16x32_bf16 v[96:99], a[16:19], a[48:51], v[96:99]
    ds_read_b64_tr_b16 a[12:13], v21 offset:53760
    buffer_load_dwordx4 v2, s[8:11], s68 offen sc1 lds
    v_mfma_f32_16x16x32_bf16 v[100:103], a[16:19], a[52:55], v[100:103]
    ds_read_b64_tr_b16 a[14:15], v21 offset:55808
    v_mfma_f32_16x16x32_bf16 v[104:107], a[20:23], a[48:51], v[104:107]
    ds_read_b64_tr_b16 a[16:17], v20 offset:61440
    v_mfma_f32_16x16x32_bf16 v[108:111], a[20:23], a[52:55], v[108:111]
    ds_read_b64_tr_b16 a[18:19], v20 offset:63488
    s_waitcnt lgkmcnt(10)
    v_mfma_f32_16x16x32_bf16 v[112:115], a[24:27], a[48:51], v[112:115]
    ds_read_b64_tr_b16 a[20:21], v21 offset:61440
    buffer_load_dwordx4 a[180:183], v4, s[20:23], s30 offen offset:1024 sc1
    v_mfma_f32_16x16x32_bf16 v[116:119], a[24:27], a[52:55], v[116:119]
    ds_read_b64_tr_b16 a[22:23], v21 offset:63488
    s_add_u32 m0, s32, 0x25000
    v_mfma_f32_16x16x32_bf16 v[120:123], a[28:31], a[48:51], v[120:123]
    ds_read_b64_tr_b16 a[24:25], v20 offset:61952
    buffer_load_dwordx4 v3, s[24:27], s73 offen offset:0 lds
    v_mfma_f32_16x16x32_bf16 v[124:127], a[28:31], a[52:55], v[124:127]
    ds_read_b64_tr_b16 a[26:27], v20 offset:64000
    s_waitcnt lgkmcnt(10)
    v_mfma_f32_16x16x32_bf16 v[64:67], a[0:3], a[56:59], v[64:67]
    ds_read_b64_tr_b16 a[28:29], v21 offset:61952
    v_mfma_f32_16x16x32_bf16 v[68:71], a[0:3], a[60:63], v[68:71]
    ds_read_b64_tr_b16 a[30:31], v21 offset:64000
    v_mfma_f32_16x16x32_bf16 v[72:75], a[4:7], a[56:59], v[72:75]
    ds_read_b64_tr_b16 a[0:1], v22 offset:32768
    buffer_load_dwordx4 a[184:187], v4, s[20:23], s30 offen offset:2048 sc1
    v_mfma_f32_16x16x32_bf16 v[76:79], a[4:7], a[60:63], v[76:79]
    ds_read_b64_tr_b16 a[2:3], v22 offset:34816
    s_waitcnt lgkmcnt(10)
    v_mfma_f32_16x16x32_bf16 v[80:83], a[8:11], a[56:59], v[80:83]
    ds_read_b64_tr_b16 a[4:5], v23 offset:32768
    v_mfma_f32_16x16x32_bf16 v[84:87], a[8:11], a[60:63], v[84:87]
    ds_read_b64_tr_b16 a[6:7], v23 offset:34816
    s_add_u32 m0, s32, 0x27000
    v_mfma_f32_16x16x32_bf16 v[88:91], a[12:15], a[56:59], v[88:91]
    ds_read_b64_tr_b16 a[8:9], v22 offset:33280
    buffer_load_dwordx4 v2, s[8:11], s69 offen sc1 lds
    s_add_u32 s72, s72, 0x20000
    s_add_u32 s73, s72, 0x10000
    s_add_u32 s68, s69, s3
    s_add_u32 s69, s68, s3
    v_mfma_f32_16x16x32_bf16 v[92:95], a[12:15], a[60:63], v[92:95]
    ds_read_b64_tr_b16 a[10:11], v22 offset:35328
    s_waitcnt lgkmcnt(10)
    v_mfma_f32_16x16x32_bf16 v[96:99], a[16:19], a[56:59], v[96:99]
    ds_read_b64_tr_b16 a[12:13], v23 offset:33280
    buffer_load_dwordx4 a[188:191], v4, s[20:23], s30 offen offset:3072 sc1
    s_add_u32 s30, s30, 4096
    v_mfma_f32_16x16x32_bf16 v[100:103], a[16:19], a[60:63], v[100:103]
    ds_read_b64_tr_b16 a[14:15], v23 offset:35328
    v_mfma_f32_16x16x32_bf16 v[104:107], a[20:23], a[56:59], v[104:107]
    ds_read_b64_tr_b16 a[16:17], v22 offset:40960
    v_mfma_f32_16x16x32_bf16 v[108:111], a[20:23], a[60:63], v[108:111]
    ds_read_b64_tr_b16 a[18:19], v22 offset:43008
    s_waitcnt lgkmcnt(10)
    v_mfma_f32_16x16x32_bf16 v[112:115], a[24:27], a[56:59], v[112:115]
    ds_read_b64_tr_b16 a[20:21], v23 offset:40960
    buffer_store_dwordx4 v[176:179], v4, s[20:23], s53 offen offset:2048 sc1
    v_mfma_f32_16x16x32_bf16 v[116:119], a[24:27], a[60:63], v[116:119]
    ds_read_b64_tr_b16 a[22:23], v23 offset:43008
    v_mfma_f32_16x16x32_bf16 v[120:123], a[28:31], a[56:59], v[120:123]
    ds_read_b64_tr_b16 a[24:25], v22 offset:41472
    buffer_store_dwordx4 v[180:183], v4, s[20:23], s53 offen offset:3072 sc1
    v_mfma_f32_16x16x32_bf16 v[124:127], a[28:31], a[60:63], v[124:127]
    ds_read_b64_tr_b16 a[26:27], v22 offset:43520
    s_sub_u32 s33, s33, 1
    s_mov_b32 s38, -1
    s_waitcnt lgkmcnt(10)
    v_mfma_f32_16x16x32_bf16 v[64:67], a[0:3], a[224:227], v[64:67]
    ds_read_b64_tr_b16 a[28:29], v23 offset:41472
    v_mfma_f32_16x16x32_bf16 v[68:71], a[0:3], a[228:231], v[68:71]
    ds_read_b64_tr_b16 a[30:31], v23 offset:43520
    s_add_u32 m0, s32, 0x0
    v_mfma_f32_16x16x32_bf16 v[72:75], a[4:7], a[224:227], v[72:75]
    ds_read_b64_tr_b16 a[0:1], v22 offset:36864
    buffer_load_dwordx4 v3, s[24:27], s72 offen offset:0 lds
    v_mfma_f32_16x16x32_bf16 v[76:79], a[4:7], a[228:231], v[76:79]
    ds_read_b64_tr_b16 a[2:3], v22 offset:38912
    s_waitcnt lgkmcnt(10)
    v_mfma_f32_16x16x32_bf16 v[80:83], a[8:11], a[224:227], v[80:83]
    ds_read_b64_tr_b16 a[4:5], v23 offset:36864
    buffer_load_dwordx4 a[192:195], v4, s[20:23], s30 offen offset:0 sc1
    v_mfma_f32_16x16x32_bf16 v[84:87], a[8:11], a[228:231], v[84:87]
    ds_read_b64_tr_b16 a[6:7], v23 offset:38912
    v_mfma_f32_16x16x32_bf16 v[88:91], a[12:15], a[224:227], v[88:91]
    ds_read_b64_tr_b16 a[8:9], v22 offset:37376
    v_mfma_f32_16x16x32_bf16 v[92:95], a[12:15], a[228:231], v[92:95]
    ds_read_b64_tr_b16 a[10:11], v22 offset:39424
    s_waitcnt lgkmcnt(10)
    s_add_u32 m0, s32, 0x2000
    v_mfma_f32_16x16x32_bf16 v[96:99], a[16:19], a[224:227], v[96:99]
    ds_read_b64_tr_b16 a[12:13], v23 offset:37376
    buffer_load_dwordx4 v2, s[8:11], s68 offen sc1 lds
    v_mfma_f32_16x16x32_bf16 v[100:103], a[16:19], a[228:231], v[100:103]
    ds_read_b64_tr_b16 a[14:15], v23 offset:39424
    v_mfma_f32_16x16x32_bf16 v[104:107], a[20:23], a[224:227], v[104:107]
    ds_read_b64_tr_b16 a[16:17], v22 offset:45056
    buffer_load_dwordx4 a[196:199], v4, s[20:23], s30 offen offset:1024 sc1
    v_mfma_f32_16x16x32_bf16 v[108:111], a[20:23], a[228:231], v[108:111]
    ds_read_b64_tr_b16 a[18:19], v22 offset:47104
    s_waitcnt lgkmcnt(10)
    v_mfma_f32_16x16x32_bf16 v[112:115], a[24:27], a[224:227], v[112:115]
    ds_read_b64_tr_b16 a[20:21], v23 offset:45056
    v_mfma_f32_16x16x32_bf16 v[116:119], a[24:27], a[228:231], v[116:119]
    ds_read_b64_tr_b16 a[22:23], v23 offset:47104
    s_add_u32 m0, s32, 0x1000
    v_mfma_f32_16x16x32_bf16 v[120:123], a[28:31], a[224:227], v[120:123]
    ds_read_b64_tr_b16 a[24:25], v22 offset:45568
    buffer_load_dwordx4 v3, s[24:27], s73 offen offset:0 lds
    v_mfma_f32_16x16x32_bf16 v[124:127], a[28:31], a[228:231], v[124:127]
    ds_read_b64_tr_b16 a[26:27], v22 offset:47616
    s_waitcnt vmcnt(17)
    s_barrier
    s_waitcnt lgkmcnt(10)
    v_mfma_f32_16x16x32_bf16 v[64:67], a[0:3], a[232:235], v[64:67]
    ds_read_b64_tr_b16 a[28:29], v23 offset:45568
    buffer_load_dwordx4 a[200:203], v4, s[20:23], s30 offen offset:2048 sc1
    v_mfma_f32_16x16x32_bf16 v[68:71], a[0:3], a[236:239], v[68:71]
    ds_read_b64_tr_b16 a[30:31], v23 offset:47616
    v_mfma_f32_16x16x32_bf16 v[72:75], a[4:7], a[232:235], v[72:75]
    ds_read_b64_tr_b16 a[0:1], v22 offset:49152
    v_mfma_f32_16x16x32_bf16 v[76:79], a[4:7], a[236:239], v[76:79]
    ds_read_b64_tr_b16 a[2:3], v22 offset:51200
    s_waitcnt lgkmcnt(10)
    s_add_u32 m0, s32, 0x3000
    v_mfma_f32_16x16x32_bf16 v[80:83], a[8:11], a[232:235], v[80:83]
    ds_read_b64_tr_b16 a[4:5], v23 offset:49152
    buffer_load_dwordx4 v2, s[8:11], s69 offen sc1 lds
    s_add_u32 s72, s72, 0x20000
    s_add_u32 s73, s72, 0x10000
    s_add_u32 s68, s69, s3
    s_add_u32 s69, s68, s3
    v_mfma_f32_16x16x32_bf16 v[84:87], a[8:11], a[236:239], v[84:87]
    ds_read_b64_tr_b16 a[6:7], v23 offset:51200
    v_mfma_f32_16x16x32_bf16 v[88:91], a[12:15], a[232:235], v[88:91]
    ds_read_b64_tr_b16 a[8:9], v22 offset:49664
    buffer_load_dwordx4 a[204:207], v4, s[20:23], s30 offen offset:3072 sc1
    s_add_u32 s30, s30, 4096
    v_mfma_f32_16x16x32_bf16 v[92:95], a[12:15], a[236:239], v[92:95]
    ds_read_b64_tr_b16 a[10:11], v22 offset:51712
    s_waitcnt lgkmcnt(10)
    v_mfma_f32_16x16x32_bf16 v[96:99], a[16:19], a[232:235], v[96:99]
    ds_read_b64_tr_b16 a[12:13], v23 offset:49664
    v_mfma_f32_16x16x32_bf16 v[100:103], a[16:19], a[236:239], v[100:103]
    ds_read_b64_tr_b16 a[14:15], v23 offset:51712
    v_mfma_f32_16x16x32_bf16 v[104:107], a[20:23], a[232:235], v[104:107]
    ds_read_b64_tr_b16 a[16:17], v22 offset:57344
    buffer_store_dwordx4 v[184:187], v4, s[20:23], s55 offen offset:2048 sc1
    v_mfma_f32_16x16x32_bf16 v[108:111], a[20:23], a[236:239], v[108:111]
    ds_read_b64_tr_b16 a[18:19], v22 offset:59392
    s_waitcnt lgkmcnt(10)
    v_mfma_f32_16x16x32_bf16 v[112:115], a[24:27], a[232:235], v[112:115]
    ds_read_b64_tr_b16 a[20:21], v23 offset:57344
    buffer_store_dwordx4 v[188:191], v4, s[20:23], s55 offen offset:3072 sc1
    v_mfma_f32_16x16x32_bf16 v[116:119], a[24:27], a[236:239], v[116:119]
    ds_read_b64_tr_b16 a[22:23], v23 offset:59392
    v_mfma_f32_16x16x32_bf16 v[120:123], a[28:31], a[232:235], v[120:123]
    ds_read_b64_tr_b16 a[24:25], v22 offset:57856
    s_getpc_b64 s[80:81]
    global_load_dword v28, v0, s[80:81] offset:2048
    v_mfma_f32_16x16x32_bf16 v[124:127], a[28:31], a[236:239], v[124:127]
    ds_read_b64_tr_b16 a[26:27], v22 offset:59904
    s_waitcnt lgkmcnt(10)
    v_mfma_f32_16x16x32_bf16 v[64:67], a[0:3], a[240:243], v[64:67]
    ds_read_b64_tr_b16 a[28:29], v23 offset:57856
    v_mfma_f32_16x16x32_bf16 v[68:71], a[0:3], a[244:247], v[68:71]
    ds_read_b64_tr_b16 a[30:31], v23 offset:59904
    s_add_u32 m0, s32, 0x4000
    v_mfma_f32_16x16x32_bf16 v[72:75], a[4:7], a[240:243], v[72:75]
    ds_read_b64_tr_b16 a[0:1], v22 offset:53248
    buffer_load_dwordx4 v3, s[24:27], s72 offen offset:0 lds
    v_mfma_f32_16x16x32_bf16 v[76:79], a[4:7], a[244:247], v[76:79]
    ds_read_b64_tr_b16 a[2:3], v22 offset:55296
    s_waitcnt lgkmcnt(10)
    v_mfma_f32_16x16x32_bf16 v[80:83], a[8:11], a[240:243], v[80:83]
    ds_read_b64_tr_b16 a[4:5], v23 offset:53248
    v_mfma_f32_16x16x32_bf16 v[84:87], a[8:11], a[244:247], v[84:87]
    ds_read_b64_tr_b16 a[6:7], v23 offset:55296
    v_mfma_f32_16x16x32_bf16 v[88:91], a[12:15], a[240:243], v[88:91]
    ds_read_b64_tr_b16 a[8:9], v22 offset:53760
    buffer_load_dwordx4 a[208:211], v4, s[20:23], s30 offen offset:0 sc1
    v_mfma_f32_16x16x32_bf16 v[92:95], a[12:15], a[244:247], v[92:95]
    ds_read_b64_tr_b16 a[10:11], v22 offset:55808
    s_waitcnt lgkmcnt(10)
    s_add_u32 m0, s32, 0x6000
    v_mfma_f32_16x16x32_bf16 v[96:99], a[16:19], a[240:243], v[96:99]
    ds_read_b64_tr_b16 a[12:13], v23 offset:53760
    buffer_load_dwordx4 v2, s[8:11], s68 offen sc1 lds
    v_mfma_f32_16x16x32_bf16 v[100:103], a[16:19], a[244:247], v[100:103]
    ds_read_b64_tr_b16 a[14:15], v23 offset:55808
    v_mfma_f32_16x16x32_bf16 v[104:107], a[20:23], a[240:243], v[104:107]
    ds_read_b64_tr_b16 a[16:17], v22 offset:61440
    v_mfma_f32_16x16x32_bf16 v[108:111], a[20:23], a[244:247], v[108:111]
    ds_read_b64_tr_b16 a[18:19], v22 offset:63488
    s_waitcnt lgkmcnt(10)
    v_mfma_f32_16x16x32_bf16 v[112:115], a[24:27], a[240:243], v[112:115]
    ds_read_b64_tr_b16 a[20:21], v23 offset:61440
    buffer_load_dwordx4 a[212:215], v4, s[20:23], s30 offen offset:1024 sc1
    v_mfma_f32_16x16x32_bf16 v[116:119], a[24:27], a[244:247], v[116:119]
    ds_read_b64_tr_b16 a[22:23], v23 offset:63488
    s_add_u32 m0, s32, 0x5000
    v_mfma_f32_16x16x32_bf16 v[120:123], a[28:31], a[240:243], v[120:123]
    ds_read_b64_tr_b16 a[24:25], v22 offset:61952
    buffer_load_dwordx4 v3, s[24:27], s73 offen offset:0 lds
    v_mfma_f32_16x16x32_bf16 v[124:127], a[28:31], a[244:247], v[124:127]
    ds_read_b64_tr_b16 a[26:27], v22 offset:64000
    s_waitcnt lgkmcnt(10)
    v_mfma_f32_16x16x32_bf16 v[64:67], a[0:3], a[248:251], v[64:67]
    ds_read_b64_tr_b16 a[28:29], v23 offset:61952
    v_mfma_f32_16x16x32_bf16 v[68:71], a[0:3], a[252:255], v[68:71]
    ds_read_b64_tr_b16 a[30:31], v23 offset:64000
    v_mfma_f32_16x16x32_bf16 v[72:75], a[4:7], a[248:251], v[72:75]
    ds_read_b64_tr_b16 a[0:1], v24 offset:0
    buffer_load_dwordx4 a[216:219], v4, s[20:23], s30 offen offset:2048 sc1
    v_mfma_f32_16x16x32_bf16 v[76:79], a[4:7], a[252:255], v[76:79]
    ds_read_b64_tr_b16 a[2:3], v24 offset:2048
    s_waitcnt lgkmcnt(10)
    v_mfma_f32_16x16x32_bf16 v[80:83], a[8:11], a[248:251], v[80:83]
    ds_read_b64_tr_b16 a[4:5], v25 offset:0
    v_mfma_f32_16x16x32_bf16 v[84:87], a[8:11], a[252:255], v[84:87]
    ds_read_b64_tr_b16 a[6:7], v25 offset:2048
    s_add_u32 m0, s32, 0x7000
    v_mfma_f32_16x16x32_bf16 v[88:91], a[12:15], a[248:251], v[88:91]
    ds_read_b64_tr_b16 a[8:9], v24 offset:512
    buffer_load_dwordx4 v2, s[8:11], s69 offen sc1 lds
    s_add_u32 s72, s72, 0x20000
    s_add_u32 s73, s72, 0x10000
    s_add_u32 s68, s69, s3
    s_add_u32 s69, s68, s3
    v_mfma_f32_16x16x32_bf16 v[92:95], a[12:15], a[252:255], v[92:95]
    ds_read_b64_tr_b16 a[10:11], v24 offset:2560
    s_waitcnt lgkmcnt(10)
    v_mfma_f32_16x16x32_bf16 v[96:99], a[16:19], a[248:251], v[96:99]
    ds_read_b64_tr_b16 a[12:13], v25 offset:512
    buffer_load_dwordx4 a[220:223], v4, s[20:23], s30 offen offset:3072 sc1
    s_add_u32 s30, s30, 4096
    v_mfma_f32_16x16x32_bf16 v[100:103], a[16:19], a[252:255], v[100:103]
    ds_read_b64_tr_b16 a[14:15], v25 offset:2560
    v_mfma_f32_16x16x32_bf16 v[104:107], a[20:23], a[248:251], v[104:107]
    ds_read_b64_tr_b16 a[16:17], v24 offset:8192
    v_mfma_f32_16x16x32_bf16 v[108:111], a[20:23], a[252:255], v[108:111]
    ds_read_b64_tr_b16 a[18:19], v24 offset:10240
    s_waitcnt lgkmcnt(10)
    v_mfma_f32_16x16x32_bf16 v[112:115], a[24:27], a[248:251], v[112:115]
    ds_read_b64_tr_b16 a[20:21], v25 offset:8192
    buffer_store_dwordx4 v[208:211], v4, s[20:23], s54 offen offset:0 sc1
    v_mfma_f32_16x16x32_bf16 v[116:119], a[24:27], a[252:255], v[116:119]
    ds_read_b64_tr_b16 a[22:23], v25 offset:10240
    v_mfma_f32_16x16x32_bf16 v[120:123], a[28:31], a[248:251], v[120:123]
    ds_read_b64_tr_b16 a[24:25], v24 offset:8704
    buffer_store_dwordx4 v[212:215], v4, s[20:23], s54 offen offset:1024 sc1
    v_mfma_f32_16x16x32_bf16 v[124:127], a[28:31], a[252:255], v[124:127]
    ds_read_b64_tr_b16 a[26:27], v24 offset:10752
    s_waitcnt lgkmcnt(10)
    v_mfma_f32_16x16x32_bf16 v[64:67], a[0:3], a[160:163], v[64:67]
    ds_read_b64_tr_b16 a[28:29], v25 offset:8704
    v_mfma_f32_16x16x32_bf16 v[68:71], a[0:3], a[164:167], v[68:71]
    ds_read_b64_tr_b16 a[30:31], v25 offset:10752
    s_add_u32 m0, s32, 0x8000
    v_mfma_f32_16x16x32_bf16 v[72:75], a[4:7], a[160:163], v[72:75]
    ds_read_b64_tr_b16 a[0:1], v24 offset:4096
    buffer_load_dwordx4 v3, s[24:27], s72 offen offset:0 lds
    v_mfma_f32_16x16x32_bf16 v[76:79], a[4:7], a[164:167], v[76:79]
    ds_read_b64_tr_b16 a[2:3], v24 offset:6144
    s_waitcnt lgkmcnt(10)
    v_mfma_f32_16x16x32_bf16 v[80:83], a[8:11], a[160:163], v[80:83]
    ds_read_b64_tr_b16 a[4:5], v25 offset:4096
    v_mfma_f32_16x16x32_bf16 v[84:87], a[8:11], a[164:167], v[84:87]
    ds_read_b64_tr_b16 a[6:7], v25 offset:6144
    v_mfma_f32_16x16x32_bf16 v[88:91], a[12:15], a[160:163], v[88:91]
    ds_read_b64_tr_b16 a[8:9], v24 offset:4608
    buffer_load_dwordx4 a[32:35], v4, s[20:23], s30 offen offset:0 sc1
    v_mfma_f32_16x16x32_bf16 v[92:95], a[12:15], a[164:167], v[92:95]
    ds_read_b64_tr_b16 a[10:11], v24 offset:6656
    s_waitcnt lgkmcnt(10)
    s_add_u32 m0, s32, 0xa000
    v_mfma_f32_16x16x32_bf16 v[96:99], a[16:19], a[160:163], v[96:99]
    ds_read_b64_tr_b16 a[12:13], v25 offset:4608
    buffer_load_dwordx4 v2, s[8:11], s68 offen sc1 lds
    v_mfma_f32_16x16x32_bf16 v[100:103], a[16:19], a[164:167], v[100:103]
    ds_read_b64_tr_b16 a[14:15], v25 offset:6656
    v_mfma_f32_16x16x32_bf16 v[104:107], a[20:23], a[160:163], v[104:107]
    ds_read_b64_tr_b16 a[16:17], v24 offset:12288
    v_mfma_f32_16x16x32_bf16 v[108:111], a[20:23], a[164:167], v[108:111]
    ds_read_b64_tr_b16 a[18:19], v24 offset:14336
    s_waitcnt lgkmcnt(10)
    v_mfma_f32_16x16x32_bf16 v[112:115], a[24:27], a[160:163], v[112:115]
    ds_read_b64_tr_b16 a[20:21], v25 offset:12288
    buffer_load_dwordx4 a[36:39], v4, s[20:23], s30 offen offset:1024 sc1
    v_mfma_f32_16x16x32_bf16 v[116:119], a[24:27], a[164:167], v[116:119]
    ds_read_b64_tr_b16 a[22:23], v25 offset:14336
    s_add_u32 m0, s32, 0x9000
    v_mfma_f32_16x16x32_bf16 v[120:123], a[28:31], a[160:163], v[120:123]
    ds_read_b64_tr_b16 a[24:25], v24 offset:12800
    buffer_load_dwordx4 v3, s[24:27], s73 offen offset:0 lds
    v_mfma_f32_16x16x32_bf16 v[124:127], a[28:31], a[164:167], v[124:127]
    ds_read_b64_tr_b16 a[26:27], v24 offset:14848
    s_waitcnt vmcnt(18)
    s_barrier
    s_waitcnt lgkmcnt(10)
    v_mfma_f32_16x16x32_bf16 v[64:67], a[0:3], a[168:171], v[64:67]
    ds_read_b64_tr_b16 a[28:29], v25 offset:12800
    v_mfma_f32_16x16x32_bf16 v[68:71], a[0:3], a[172:175], v[68:71]
    ds_read_b64_tr_b16 a[30:31], v25 offset:14848
    v_mfma_f32_16x16x32_bf16 v[72:75], a[4:7], a[168:171], v[72:75]
    ds_read_b64_tr_b16 a[0:1], v24 offset:16384
    buffer_load_dwordx4 a[40:43], v4, s[20:23], s30 offen offset:2048 sc1
    v_mfma_f32_16x16x32_bf16 v[76:79], a[4:7], a[172:175], v[76:79]
    ds_read_b64_tr_b16 a[2:3], v24 offset:18432
    s_waitcnt lgkmcnt(10)
    v_mfma_f32_16x16x32_bf16 v[80:83], a[8:11], a[168:171], v[80:83]
    ds_read_b64_tr_b16 a[4:5], v25 offset:16384
    v_mfma_f32_16x16x32_bf16 v[84:87], a[8:11], a[172:175], v[84:87]
    ds_read_b64_tr_b16 a[6:7], v25 offset:18432
    s_add_u32 m0, s32, 0xb000
    v_mfma_f32_16x16x32_bf16 v[88:91], a[12:15], a[168:171], v[88:91]
    ds_read_b64_tr_b16 a[8:9], v24 offset:16896
    buffer_load_dwordx4 v2, s[8:11], s69 offen sc1 lds
    s_add_u32 s72, s72, 0x20000
    s_add_u32 s73, s72, 0x10000
    s_add_u32 s68, s69, s3
    s_add_u32 s69, s68, s3
    v_mfma_f32_16x16x32_bf16 v[92:95], a[12:15], a[172:175], v[92:95]
    ds_read_b64_tr_b16 a[10:11], v24 offset:18944
    s_waitcnt lgkmcnt(10)
    v_mfma_f32_16x16x32_bf16 v[96:99], a[16:19], a[168:171], v[96:99]
    ds_read_b64_tr_b16 a[12:13], v25 offset:16896
    buffer_load_dwordx4 a[44:47], v4, s[20:23], s30 offen offset:3072 sc1
    s_add_u32 s30, s30, 4096
    v_mfma_f32_16x16x32_bf16 v[100:103], a[16:19], a[172:175], v[100:103]
    ds_read_b64_tr_b16 a[14:15], v25 offset:18944
    v_mfma_f32_16x16x32_bf16 v[104:107], a[20:23], a[168:171], v[104:107]
    ds_read_b64_tr_b16 a[16:17], v24 offset:24576
    v_mfma_f32_16x16x32_bf16 v[108:111], a[20:23], a[172:175], v[108:111]
    ds_read_b64_tr_b16 a[18:19], v24 offset:26624
    s_waitcnt lgkmcnt(10)
    v_mfma_f32_16x16x32_bf16 v[112:115], a[24:27], a[168:171], v[112:115]
    ds_read_b64_tr_b16 a[20:21], v25 offset:24576
    buffer_store_dwordx4 v[216:219], v4, s[20:23], s56 offen offset:0 sc1
    v_mfma_f32_16x16x32_bf16 v[116:119], a[24:27], a[172:175], v[116:119]
    ds_read_b64_tr_b16 a[22:23], v25 offset:26624
    v_mfma_f32_16x16x32_bf16 v[120:123], a[28:31], a[168:171], v[120:123]
    ds_read_b64_tr_b16 a[24:25], v24 offset:25088
    buffer_store_dwordx4 v[220:223], v4, s[20:23], s56 offen offset:1024 sc1
    v_mfma_f32_16x16x32_bf16 v[124:127], a[28:31], a[172:175], v[124:127]
    ds_read_b64_tr_b16 a[26:27], v24 offset:27136
    s_waitcnt lgkmcnt(10)
    v_mfma_f32_16x16x32_bf16 v[64:67], a[0:3], a[176:179], v[64:67]
    ds_read_b64_tr_b16 a[28:29], v25 offset:25088
    v_mfma_f32_16x16x32_bf16 v[68:71], a[0:3], a[180:183], v[68:71]
    ds_read_b64_tr_b16 a[30:31], v25 offset:27136
    s_add_u32 m0, s32, 0xc000
    v_mfma_f32_16x16x32_bf16 v[72:75], a[4:7], a[176:179], v[72:75]
    ds_read_b64_tr_b16 a[0:1], v24 offset:20480
    buffer_load_dwordx4 v3, s[24:27], s72 offen offset:0 lds
    v_mfma_f32_16x16x32_bf16 v[76:79], a[4:7], a[180:183], v[76:79]
    ds_read_b64_tr_b16 a[2:3], v24 offset:22528
    s_waitcnt lgkmcnt(10)
    v_mfma_f32_16x16x32_bf16 v[80:83], a[8:11], a[176:179], v[80:83]
    ds_read_b64_tr_b16 a[4:5], v25 offset:20480
    v_mfma_f32_16x16x32_bf16 v[84:87], a[8:11], a[180:183], v[84:87]
    ds_read_b64_tr_b16 a[6:7], v25 offset:22528
    v_mfma_f32_16x16x32_bf16 v[88:91], a[12:15], a[176:179], v[88:91]
    ds_read_b64_tr_b16 a[8:9], v24 offset:20992
    buffer_load_dwordx4 a[48:51], v4, s[20:23], s30 offen offset:0 sc1
    v_mfma_f32_16x16x32_bf16 v[92:95], a[12:15], a[180:183], v[92:95]
    ds_read_b64_tr_b16 a[10:11], v24 offset:23040
    s_waitcnt lgkmcnt(10)
    s_add_u32 m0, s32, 0xe000
    v_mfma_f32_16x16x32_bf16 v[96:99], a[16:19], a[176:179], v[96:99]
    ds_read_b64_tr_b16 a[12:13], v25 offset:20992
    buffer_load_dwordx4 v2, s[8:11], s68 offen sc1 lds
    v_mfma_f32_16x16x32_bf16 v[100:103], a[16:19], a[180:183], v[100:103]
    ds_read_b64_tr_b16 a[14:15], v25 offset:23040
    v_mfma_f32_16x16x32_bf16 v[104:107], a[20:23], a[176:179], v[104:107]
    ds_read_b64_tr_b16 a[16:17], v24 offset:28672
    v_mfma_f32_16x16x32_bf16 v[108:111], a[20:23], a[180:183], v[108:111]
    ds_read_b64_tr_b16 a[18:19], v24 offset:30720
    s_waitcnt lgkmcnt(10)
    v_mfma_f32_16x16x32_bf16 v[112:115], a[24:27], a[176:179], v[112:115]
    ds_read_b64_tr_b16 a[20:21], v25 offset:28672
    buffer_load_dwordx4 a[52:55], v4, s[20:23], s30 offen offset:1024 sc1
    v_mfma_f32_16x16x32_bf16 v[116:119], a[24:27], a[180:183], v[116:119]
    ds_read_b64_tr_b16 a[22:23], v25 offset:30720
    s_add_u32 m0, s32, 0xd000
    v_mfma_f32_16x16x32_bf16 v[120:123], a[28:31], a[176:179], v[120:123]
    ds_read_b64_tr_b16 a[24:25], v24 offset:29184
    buffer_load_dwordx4 v3, s[24:27], s73 offen offset:0 lds
    v_mfma_f32_16x16x32_bf16 v[124:127], a[28:31], a[180:183], v[124:127]
    ds_read_b64_tr_b16 a[26:27], v24 offset:31232
    s_waitcnt lgkmcnt(10)
    v_mfma_f32_16x16x32_bf16 v[64:67], a[0:3], a[184:187], v[64:67]
    ds_read_b64_tr_b16 a[28:29], v25 offset:29184
    v_mfma_f32_16x16x32_bf16 v[68:71], a[0:3], a[188:191], v[68:71]
    ds_read_b64_tr_b16 a[30:31], v25 offset:31232
    v_mfma_f32_16x16x32_bf16 v[72:75], a[4:7], a[184:187], v[72:75]
    ds_read_b64_tr_b16 a[0:1], v20 offset:0
    buffer_load_dwordx4 a[56:59], v4, s[20:23], s30 offen offset:2048 sc1
    v_mfma_f32_16x16x32_bf16 v[76:79], a[4:7], a[188:191], v[76:79]
    ds_read_b64_tr_b16 a[2:3], v20 offset:2048
    s_waitcnt lgkmcnt(10)
    v_mfma_f32_16x16x32_bf16 v[80:83], a[8:11], a[184:187], v[80:83]
    ds_read_b64_tr_b16 a[4:5], v21 offset:0
    v_mfma_f32_16x16x32_bf16 v[84:87], a[8:11], a[188:191], v[84:87]
    ds_read_b64_tr_b16 a[6:7], v21 offset:2048
    s_add_u32 m0, s32, 0xf000
    v_mfma_f32_16x16x32_bf16 v[88:91], a[12:15], a[184:187], v[88:91]
    ds_read_b64_tr_b16 a[8:9], v20 offset:512
    buffer_load_dwordx4 v2, s[8:11], s69 offen sc1 lds
    s_add_u32 s72, s72, 0x20000
    s_add_u32 s73, s72, 0x10000
    v_mfma_f32_16x16x32_bf16 v[92:95], a[12:15], a[188:191], v[92:95]
    ds_read_b64_tr_b16 a[10:11], v20 offset:2560
    s_waitcnt lgkmcnt(10)
    v_mfma_f32_16x16x32_bf16 v[96:99], a[16:19], a[184:187], v[96:99]
    ds_read_b64_tr_b16 a[12:13], v21 offset:512
    buffer_load_dwordx4 a[60:63], v4, s[20:23], s30 offen offset:3072 sc1
    s_add_u32 s30, s30, 4096
    s_add_u32 s65, s65, 1
    s_add_u32 s78, s65, s74
    s_and_b32 s78, s78, 3
    s_lshl_b32 s79, s78, 1
    s_add_u32 s79, s79, 1
    s_lshl_b32 s7, s65, 1
    s_sub_u32 s7, s7, 8
    s_cmp_lt_u32 s65, 4
    s_cselect_b32 s78, s78, s65
    s_cselect_b32 s79, s79, s7
    s_lshl_b32 s78, s78, 15
    s_add_u32 s78, s78, s4
    s_lshl_b32 s79, s79, 20
    s_add_u32 s79, s79, s75
    s_cmp_eq_u32 s51, 0
    s_cselect_b32 s30, s78, s30
    s_cselect_b32 s72, s79, s72
    s_add_u32 s73, s72, 0x10000
    s_sub_u32 s68, s72, s75
    s_lshr_b32 s68, s68, s49
    s_add_u32 s68, s68, s52
    s_add_u32 s69, s68, s3
    v_mfma_f32_16x16x32_bf16 v[100:103], a[16:19], a[188:191], v[100:103]
    ds_read_b64_tr_b16 a[14:15], v21 offset:2560
    v_mfma_f32_16x16x32_bf16 v[104:107], a[20:23], a[184:187], v[104:107]
    ds_read_b64_tr_b16 a[16:17], v20 offset:8192
    v_mfma_f32_16x16x32_bf16 v[108:111], a[20:23], a[188:191], v[108:111]
    ds_read_b64_tr_b16 a[18:19], v20 offset:10240
    s_waitcnt lgkmcnt(10)
    v_mfma_f32_16x16x32_bf16 v[112:115], a[24:27], a[184:187], v[112:115]
    ds_read_b64_tr_b16 a[20:21], v21 offset:8192
    buffer_store_dwordx4 v[240:243], v4, s[20:23], s43 offen offset:0 sc1
    v_mfma_f32_16x16x32_bf16 v[116:119], a[24:27], a[188:191], v[116:119]
    ds_read_b64_tr_b16 a[22:23], v21 offset:10240
    v_mfma_f32_16x16x32_bf16 v[120:123], a[28:31], a[184:187], v[120:123]
    ds_read_b64_tr_b16 a[24:25], v20 offset:8704
    buffer_store_dwordx4 v[244:247], v4, s[20:23], s43 offen offset:1024 sc1
    v_mfma_f32_16x16x32_bf16 v[124:127], a[28:31], a[188:191], v[124:127]
    ds_read_b64_tr_b16 a[26:27], v20 offset:10752
    s_waitcnt lgkmcnt(10)
    v_mfma_f32_16x16x32_bf16 v[64:67], a[0:3], a[192:195], v[64:67]
    ds_read_b64_tr_b16 a[28:29], v21 offset:8704
    v_mfma_f32_16x16x32_bf16 v[68:71], a[0:3], a[196:199], v[68:71]
    ds_read_b64_tr_b16 a[30:31], v21 offset:10752
    s_add_u32 m0, s32, 0x18000
    v_mfma_f32_16x16x32_bf16 v[72:75], a[4:7], a[192:195], v[72:75]
    ds_read_b64_tr_b16 a[0:1], v20 offset:4096
    buffer_load_dwordx4 v3, s[24:27], s72 offen offset:0 lds
    v_mfma_f32_16x16x32_bf16 v[76:79], a[4:7], a[196:199], v[76:79]
    ds_read_b64_tr_b16 a[2:3], v20 offset:6144
    s_waitcnt lgkmcnt(10)
    v_mfma_f32_16x16x32_bf16 v[80:83], a[8:11], a[192:195], v[80:83]
    ds_read_b64_tr_b16 a[4:5], v21 offset:4096
    v_mfma_f32_16x16x32_bf16 v[84:87], a[8:11], a[196:199], v[84:87]
    ds_read_b64_tr_b16 a[6:7], v21 offset:6144
    v_mfma_f32_16x16x32_bf16 v[88:91], a[12:15], a[192:195], v[88:91]
    ds_read_b64_tr_b16 a[8:9], v20 offset:4608
    buffer_load_dwordx4 a[224:227], v4, s[20:23], s30 offen offset:0 sc1
    v_mfma_f32_16x16x32_bf16 v[92:95], a[12:15], a[196:199], v[92:95]
    ds_read_b64_tr_b16 a[10:11], v20 offset:6656
    s_waitcnt lgkmcnt(10)
    s_add_u32 m0, s32, 0x1a000
    v_mfma_f32_16x16x32_bf16 v[96:99], a[16:19], a[192:195], v[96:99]
    ds_read_b64_tr_b16 a[12:13], v21 offset:4608
    buffer_load_dwordx4 v2, s[8:11], s68 offen sc1 lds
    v_mfma_f32_16x16x32_bf16 v[100:103], a[16:19], a[196:199], v[100:103]
    ds_read_b64_tr_b16 a[14:15], v21 offset:6656
    v_mfma_f32_16x16x32_bf16 v[104:107], a[20:23], a[192:195], v[104:107]
    ds_read_b64_tr_b16 a[16:17], v20 offset:12288
    v_mfma_f32_16x16x32_bf16 v[108:111], a[20:23], a[196:199], v[108:111]
    ds_read_b64_tr_b16 a[18:19], v20 offset:14336
    s_waitcnt lgkmcnt(10)
    v_mfma_f32_16x16x32_bf16 v[112:115], a[24:27], a[192:195], v[112:115]
    ds_read_b64_tr_b16 a[20:21], v21 offset:12288
    buffer_load_dwordx4 a[228:231], v4, s[20:23], s30 offen offset:1024 sc1
    v_mfma_f32_16x16x32_bf16 v[116:119], a[24:27], a[196:199], v[116:119]
    ds_read_b64_tr_b16 a[22:23], v21 offset:14336
    s_add_u32 m0, s32, 0x19000
    v_mfma_f32_16x16x32_bf16 v[120:123], a[28:31], a[192:195], v[120:123]
    ds_read_b64_tr_b16 a[24:25], v20 offset:12800
    buffer_load_dwordx4 v3, s[24:27], s73 offen offset:0 lds
    v_mfma_f32_16x16x32_bf16 v[124:127], a[28:31], a[196:199], v[124:127]
    ds_read_b64_tr_b16 a[26:27], v20 offset:14848
    s_waitcnt vmcnt(17)
    s_barrier
    s_waitcnt lgkmcnt(10)
    v_mfma_f32_16x16x32_bf16 v[64:67], a[0:3], a[200:203], v[64:67]
    ds_read_b64_tr_b16 a[28:29], v21 offset:12800
    v_mfma_f32_16x16x32_bf16 v[68:71], a[0:3], a[204:207], v[68:71]
    ds_read_b64_tr_b16 a[30:31], v21 offset:14848
    v_mfma_f32_16x16x32_bf16 v[72:75], a[4:7], a[200:203], v[72:75]
    ds_read_b64_tr_b16 a[0:1], v20 offset:16384
    buffer_load_dwordx4 a[232:235], v4, s[20:23], s30 offen offset:2048 sc1
    v_mfma_f32_16x16x32_bf16 v[76:79], a[4:7], a[204:207], v[76:79]
    ds_read_b64_tr_b16 a[2:3], v20 offset:18432
    s_waitcnt lgkmcnt(10)
    v_mfma_f32_16x16x32_bf16 v[80:83], a[8:11], a[200:203], v[80:83]
    ds_read_b64_tr_b16 a[4:5], v21 offset:16384
    v_mfma_f32_16x16x32_bf16 v[84:87], a[8:11], a[204:207], v[84:87]
    ds_read_b64_tr_b16 a[6:7], v21 offset:18432
    s_add_u32 m0, s32, 0x1b000
    v_mfma_f32_16x16x32_bf16 v[88:91], a[12:15], a[200:203], v[88:91]
    ds_read_b64_tr_b16 a[8:9], v20 offset:16896
    buffer_load_dwordx4 v2, s[8:11], s69 offen sc1 lds
    s_add_u32 s72, s72, 0x20000
    s_add_u32 s73, s72, 0x10000
    s_add_u32 s68, s69, s3
    s_add_u32 s69, s68, s3
    v_mfma_f32_16x16x32_bf16 v[92:95], a[12:15], a[204:207], v[92:95]
    ds_read_b64_tr_b16 a[10:11], v20 offset:18944
    s_waitcnt lgkmcnt(10)
    v_mfma_f32_16x16x32_bf16 v[96:99], a[16:19], a[200:203], v[96:99]
    ds_read_b64_tr_b16 a[12:13], v21 offset:16896
    buffer_load_dwordx4 a[236:239], v4, s[20:23], s30 offen offset:3072 sc1
    s_add_u32 s30, s30, 4096
    v_mfma_f32_16x16x32_bf16 v[100:103], a[16:19], a[204:207], v[100:103]
    ds_read_b64_tr_b16 a[14:15], v21 offset:18944
    v_mfma_f32_16x16x32_bf16 v[104:107], a[20:23], a[200:203], v[104:107]
    ds_read_b64_tr_b16 a[16:17], v20 offset:24576
    v_mfma_f32_16x16x32_bf16 v[108:111], a[20:23], a[204:207], v[108:111]
    ds_read_b64_tr_b16 a[18:19], v20 offset:26624
    s_waitcnt lgkmcnt(10)
    v_mfma_f32_16x16x32_bf16 v[112:115], a[24:27], a[200:203], v[112:115]
    ds_read_b64_tr_b16 a[20:21], v21 offset:24576
    buffer_store_dwordx4 v[248:251], v4, s[20:23], s37 offen offset:0 sc1
    v_mfma_f32_16x16x32_bf16 v[116:119], a[24:27], a[204:207], v[116:119]
    ds_read_b64_tr_b16 a[22:23], v21 offset:26624
    v_mfma_f32_16x16x32_bf16 v[120:123], a[28:31], a[200:203], v[120:123]
    ds_read_b64_tr_b16 a[24:25], v20 offset:25088
    buffer_store_dwordx4 v[252:255], v4, s[20:23], s37 offen offset:1024 sc1
    v_mfma_f32_16x16x32_bf16 v[124:127], a[28:31], a[204:207], v[124:127]
    ds_read_b64_tr_b16 a[26:27], v20 offset:27136
    s_waitcnt lgkmcnt(10)
    v_mfma_f32_16x16x32_bf16 v[64:67], a[0:3], a[208:211], v[64:67]
    ds_read_b64_tr_b16 a[28:29], v21 offset:25088
    v_mfma_f32_16x16x32_bf16 v[68:71], a[0:3], a[212:215], v[68:71]
    ds_read_b64_tr_b16 a[30:31], v21 offset:27136
    s_add_u32 m0, s32, 0x1c000
    v_mfma_f32_16x16x32_bf16 v[72:75], a[4:7], a[208:211], v[72:75]
    ds_read_b64_tr_b16 a[0:1], v20 offset:20480
    buffer_load_dwordx4 v3, s[24:27], s72 offen offset:0 lds
    v_mfma_f32_16x16x32_bf16 v[76:79], a[4:7], a[212:215], v[76:79]
    ds_read_b64_tr_b16 a[2:3], v20 offset:22528
    s_waitcnt lgkmcnt(10)
    v_mfma_f32_16x16x32_bf16 v[80:83], a[8:11], a[208:211], v[80:83]
    ds_read_b64_tr_b16 a[4:5], v21 offset:20480
    v_mfma_f32_16x16x32_bf16 v[84:87], a[8:11], a[212:215], v[84:87]
    ds_read_b64_tr_b16 a[6:7], v21 offset:22528
    v_mfma_f32_16x16x32_bf16 v[88:91], a[12:15], a[208:211], v[88:91]
    ds_read_b64_tr_b16 a[8:9], v20 offset:20992
    buffer_load_dwordx4 a[240:243], v4, s[20:23], s30 offen offset:0 sc1
    v_mfma_f32_16x16x32_bf16 v[92:95], a[12:15], a[212:215], v[92:95]
    ds_read_b64_tr_b16 a[10:11], v20 offset:23040
    s_waitcnt lgkmcnt(10)
    v_mfma_f32_16x16x32_bf16 v[96:99], a[16:19], a[208:211], v[96:99]
    ds_read_b64_tr_b16 a[12:13], v21 offset:20992
    v_mfma_f32_16x16x32_bf16 v[100:103], a[16:19], a[212:215], v[100:103]
    ds_read_b64_tr_b16 a[14:15], v21 offset:23040
    s_add_u32 m0, s32, 0x1e000
    v_mfma_f32_16x16x32_bf16 v[104:107], a[20:23], a[208:211], v[104:107]
    ds_read_b64_tr_b16 a[16:17], v20 offset:28672
    buffer_load_dwordx4 v2, s[8:11], s68 offen sc1 lds
    v_mfma_f32_16x16x32_bf16 v[108:111], a[20:23], a[212:215], v[108:111]
    ds_read_b64_tr_b16 a[18:19], v20 offset:30720
    s_waitcnt lgkmcnt(10)
    v_mfma_f32_16x16x32_bf16 v[112:115], a[24:27], a[208:211], v[112:115]
    ds_read_b64_tr_b16 a[20:21], v21 offset:28672
    v_mfma_f32_16x16x32_bf16 v[116:119], a[24:27], a[212:215], v[116:119]
    ds_read_b64_tr_b16 a[22:23], v21 offset:30720
    v_mfma_f32_16x16x32_bf16 v[120:123], a[28:31], a[208:211], v[120:123]
    ds_read_b64_tr_b16 a[24:25], v20 offset:29184
    buffer_load_dwordx4 a[244:247], v4, s[20:23], s30 offen offset:1024 sc1
    v_mfma_f32_16x16x32_bf16 v[124:127], a[28:31], a[212:215], v[124:127]
    ds_read_b64_tr_b16 a[26:27], v20 offset:31232
    s_waitcnt lgkmcnt(10)
    s_add_u32 m0, s32, 0x1d000
    v_mfma_f32_16x16x32_bf16 v[64:67], a[0:3], a[216:219], v[64:67]
    ds_read_b64_tr_b16 a[28:29], v21 offset:29184
    buffer_load_dwordx4 v3, s[24:27], s73 offen offset:0 lds
    v_mfma_f32_16x16x32_bf16 v[68:71], a[0:3], a[220:223], v[68:71]
    ds_read_b64_tr_b16 a[30:31], v21 offset:31232
    v_mfma_f32_16x16x32_bf16 v[72:75], a[4:7], a[216:219], v[72:75]
    ds_read_b64_tr_b16 a[0:1], v20 offset:32768
    v_mfma_f32_16x16x32_bf16 v[76:79], a[4:7], a[220:223], v[76:79]
    ds_read_b64_tr_b16 a[2:3], v20 offset:34816
    s_waitcnt lgkmcnt(10)
    v_mfma_f32_16x16x32_bf16 v[80:83], a[8:11], a[216:219], v[80:83]
    ds_read_b64_tr_b16 a[4:5], v21 offset:32768
    buffer_load_dwordx4 a[248:251], v4, s[20:23], s30 offen offset:2048 sc1
    v_mfma_f32_16x16x32_bf16 v[84:87], a[8:11], a[220:223], v[84:87]
    ds_read_b64_tr_b16 a[6:7], v21 offset:34816
    v_mfma_f32_16x16x32_bf16 v[88:91], a[12:15], a[216:219], v[88:91]
    ds_read_b64_tr_b16 a[8:9], v20 offset:33280
    v_mfma_f32_16x16x32_bf16 v[92:95], a[12:15], a[220:223], v[92:95]
    ds_read_b64_tr_b16 a[10:11], v20 offset:35328
    s_waitcnt lgkmcnt(10)
    s_add_u32 m0, s32, 0x1f000
    v_mfma_f32_16x16x32_bf16 v[96:99], a[16:19], a[216:219], v[96:99]
    ds_read_b64_tr_b16 a[12:13], v21 offset:33280
    buffer_load_dwordx4 v2, s[8:11], s69 offen sc1 lds
    s_add_u32 s72, s72, 0x20000
    s_add_u32 s73, s72, 0x10000
    s_add_u32 s68, s69, s3
    s_add_u32 s69, s68, s3
    v_mfma_f32_16x16x32_bf16 v[100:103], a[16:19], a[220:223], v[100:103]
    ds_read_b64_tr_b16 a[14:15], v21 offset:35328
    v_mfma_f32_16x16x32_bf16 v[104:107], a[20:23], a[216:219], v[104:107]
    ds_read_b64_tr_b16 a[16:17], v20 offset:40960
    v_mfma_f32_16x16x32_bf16 v[108:111], a[20:23], a[220:223], v[108:111]
    ds_read_b64_tr_b16 a[18:19], v20 offset:43008
    s_waitcnt lgkmcnt(10)
    v_mfma_f32_16x16x32_bf16 v[112:115], a[24:27], a[216:219], v[112:115]
    ds_read_b64_tr_b16 a[20:21], v21 offset:40960
    buffer_load_dwordx4 a[252:255], v4, s[20:23], s30 offen offset:3072 sc1
    s_add_u32 s30, s30, 4096
    v_mfma_f32_16x16x32_bf16 v[116:119], a[24:27], a[220:223], v[116:119]
    ds_read_b64_tr_b16 a[22:23], v21 offset:43008
    v_mfma_f32_16x16x32_bf16 v[120:123], a[28:31], a[216:219], v[120:123]
    ds_read_b64_tr_b16 a[24:25], v20 offset:41472
    s_getpc_b64 s[80:81]
    global_load_dword v28, v0, s[80:81] offset:2048
    v_mfma_f32_16x16x32_bf16 v[124:127], a[28:31], a[220:223], v[124:127]
    ds_read_b64_tr_b16 a[26:27], v20 offset:43520
    s_waitcnt lgkmcnt(10)
    v_mfma_f32_16x16x32_bf16 v[64:67], a[0:3], a[32:35], v[64:67]
    ds_read_b64_tr_b16 a[28:29], v21 offset:41472
    v_mfma_f32_16x16x32_bf16 v[68:71], a[0:3], a[36:39], v[68:71]
    ds_read_b64_tr_b16 a[30:31], v21 offset:43520
    s_add_u32 m0, s32, 0x20000
    v_mfma_f32_16x16x32_bf16 v[72:75], a[4:7], a[32:35], v[72:75]
    ds_read_b64_tr_b16 a[0:1], v20 offset:36864
    buffer_load_dwordx4 v3, s[24:27], s72 offen offset:0 lds
    v_mfma_f32_16x16x32_bf16 v[76:79], a[4:7], a[36:39], v[76:79]
    ds_read_b64_tr_b16 a[2:3], v20 offset:38912
    s_waitcnt lgkmcnt(10)
    v_mfma_f32_16x16x32_bf16 v[80:83], a[8:11], a[32:35], v[80:83]
    ds_read_b64_tr_b16 a[4:5], v21 offset:36864
    v_mfma_f32_16x16x32_bf16 v[84:87], a[8:11], a[36:39], v[84:87]
    ds_read_b64_tr_b16 a[6:7], v21 offset:38912
    v_mfma_f32_16x16x32_bf16 v[88:91], a[12:15], a[32:35], v[88:91]
    ds_read_b64_tr_b16 a[8:9], v20 offset:37376
    buffer_load_dwordx4 a[160:163], v4, s[20:23], s30 offen offset:0 sc1
    v_mfma_f32_16x16x32_bf16 v[92:95], a[12:15], a[36:39], v[92:95]
    ds_read_b64_tr_b16 a[10:11], v20 offset:39424
    s_waitcnt lgkmcnt(10)
    v_mfma_f32_16x16x32_bf16 v[96:99], a[16:19], a[32:35], v[96:99]
    ds_read_b64_tr_b16 a[12:13], v21 offset:37376
    v_mfma_f32_16x16x32_bf16 v[100:103], a[16:19], a[36:39], v[100:103]
    ds_read_b64_tr_b16 a[14:15], v21 offset:39424
    s_add_u32 m0, s32, 0x22000
    v_mfma_f32_16x16x32_bf16 v[104:107], a[20:23], a[32:35], v[104:107]
    ds_read_b64_tr_b16 a[16:17], v20 offset:45056
    buffer_load_dwordx4 v2, s[8:11], s68 offen sc1 lds
    v_mfma_f32_16x16x32_bf16 v[108:111], a[20:23], a[36:39], v[108:111]
    ds_read_b64_tr_b16 a[18:19], v20 offset:47104
    s_waitcnt lgkmcnt(10)
    v_mfma_f32_16x16x32_bf16 v[112:115], a[24:27], a[32:35], v[112:115]
    ds_read_b64_tr_b16 a[20:21], v21 offset:45056
    v_mfma_f32_16x16x32_bf16 v[116:119], a[24:27], a[36:39], v[116:119]
    ds_read_b64_tr_b16 a[22:23], v21 offset:47104
    v_mfma_f32_16x16x32_bf16 v[120:123], a[28:31], a[32:35], v[120:123]
    ds_read_b64_tr_b16 a[24:25], v20 offset:45568
    buffer_load_dwordx4 a[164:167], v4, s[20:23], s30 offen offset:1024 sc1
    v_mfma_f32_16x16x32_bf16 v[124:127], a[28:31], a[36:39], v[124:127]
    ds_read_b64_tr_b16 a[26:27], v20 offset:47616
    s_waitcnt vmcnt(15)
    s_barrier
    s_waitcnt lgkmcnt(10)
    v_mfma_f32_16x16x32_bf16 v[64:67], a[0:3], a[40:43], v[64:67]
    ds_read_b64_tr_b16 a[28:29], v21 offset:45568
    v_mfma_f32_16x16x32_bf16 v[68:71], a[0:3], a[44:47], v[68:71]
    ds_read_b64_tr_b16 a[30:31], v21 offset:47616
    s_add_u32 m0, s32, 0x21000
    v_mfma_f32_16x16x32_bf16 v[72:75], a[4:7], a[40:43], v[72:75]
    ds_read_b64_tr_b16 a[0:1], v20 offset:49152
    buffer_load_dwordx4 v3, s[24:27], s73 offen offset:0 lds
    v_mfma_f32_16x16x32_bf16 v[76:79], a[4:7], a[44:47], v[76:79]
    ds_read_b64_tr_b16 a[2:3], v20 offset:51200
    s_waitcnt lgkmcnt(10)
    v_mfma_f32_16x16x32_bf16 v[80:83], a[8:11], a[40:43], v[80:83]
    ds_read_b64_tr_b16 a[4:5], v21 offset:49152
    v_mfma_f32_16x16x32_bf16 v[84:87], a[8:11], a[44:47], v[84:87]
    ds_read_b64_tr_b16 a[6:7], v21 offset:51200
    v_mfma_f32_16x16x32_bf16 v[88:91], a[12:15], a[40:43], v[88:91]
    ds_read_b64_tr_b16 a[8:9], v20 offset:49664
    buffer_load_dwordx4 a[168:171], v4, s[20:23], s30 offen offset:2048 sc1
    v_mfma_f32_16x16x32_bf16 v[92:95], a[12:15], a[44:47], v[92:95]
    ds_read_b64_tr_b16 a[10:11], v20 offset:51712
    s_waitcnt lgkmcnt(10)
    v_mfma_f32_16x16x32_bf16 v[96:99], a[16:19], a[40:43], v[96:99]
    ds_read_b64_tr_b16 a[12:13], v21 offset:49664
    v_mfma_f32_16x16x32_bf16 v[100:103], a[16:19], a[44:47], v[100:103]
    ds_read_b64_tr_b16 a[14:15], v21 offset:51712
    s_add_u32 m0, s32, 0x23000
    v_mfma_f32_16x16x32_bf16 v[104:107], a[20:23], a[40:43], v[104:107]
    ds_read_b64_tr_b16 a[16:17], v20 offset:57344
    buffer_load_dwordx4 v2, s[8:11], s69 offen sc1 lds
    s_add_u32 s72, s72, 0x20000
    s_add_u32 s73, s72, 0x10000
    s_add_u32 s68, s69, s3
    s_add_u32 s69, s68, s3
    v_mfma_f32_16x16x32_bf16 v[108:111], a[20:23], a[44:47], v[108:111]
    ds_read_b64_tr_b16 a[18:19], v20 offset:59392
    s_waitcnt lgkmcnt(10)
    v_mfma_f32_16x16x32_bf16 v[112:115], a[24:27], a[40:43], v[112:115]
    ds_read_b64_tr_b16 a[20:21], v21 offset:57344
    v_mfma_f32_16x16x32_bf16 v[116:119], a[24:27], a[44:47], v[116:119]
    ds_read_b64_tr_b16 a[22:23], v21 offset:59392
    v_mfma_f32_16x16x32_bf16 v[120:123], a[28:31], a[40:43], v[120:123]
    ds_read_b64_tr_b16 a[24:25], v20 offset:57856
    buffer_load_dwordx4 a[172:175], v4, s[20:23], s30 offen offset:3072 sc1
    s_add_u32 s30, s30, 4096
    v_mfma_f32_16x16x32_bf16 v[124:127], a[28:31], a[44:47], v[124:127]
    ds_read_b64_tr_b16 a[26:27], v20 offset:59904
    s_waitcnt lgkmcnt(10)
    v_mfma_f32_16x16x32_bf16 v[64:67], a[0:3], a[48:51], v[64:67]
    ds_read_b64_tr_b16 a[28:29], v21 offset:57856
    v_mfma_f32_16x16x32_bf16 v[68:71], a[0:3], a[52:55], v[68:71]
    ds_read_b64_tr_b16 a[30:31], v21 offset:59904
    s_add_u32 m0, s32, 0x24000
    v_mfma_f32_16x16x32_bf16 v[72:75], a[4:7], a[48:51], v[72:75]
    ds_read_b64_tr_b16 a[0:1], v20 offset:53248
    buffer_load_dwordx4 v3, s[24:27], s72 offen offset:0 lds
    v_mfma_f32_16x16x32_bf16 v[76:79], a[4:7], a[52:55], v[76:79]
    ds_read_b64_tr_b16 a[2:3], v20 offset:55296
    s_waitcnt lgkmcnt(10)
    v_mfma_f32_16x16x32_bf16 v[80:83], a[8:11], a[48:51], v[80:83]
    ds_read_b64_tr_b16 a[4:5], v21 offset:53248
    v_mfma_f32_16x16x32_bf16 v[84:87], a[8:11], a[52:55], v[84:87]
    ds_read_b64_tr_b16 a[6:7], v21 offset:55296
    v_mfma_f32_16x16x32_bf16 v[88:91], a[12:15], a[48:51], v[88:91]
    ds_read_b64_tr_b16 a[8:9], v20 offset:53760
    buffer_load_dwordx4 a[176:179], v4, s[20:23], s30 offen offset:0 sc1
    v_mfma_f32_16x16x32_bf16 v[92:95], a[12:15], a[52:55], v[92:95]
    ds_read_b64_tr_b16 a[10:11], v20 offset:55808
    s_waitcnt lgkmcnt(10)
    v_mfma_f32_16x16x32_bf16 v[96:99], a[16:19], a[48:51], v[96:99]
    ds_read_b64_tr_b16 a[12:13], v21 offset:53760
    v_mfma_f32_16x16x32_bf16 v[100:103], a[16:19], a[52:55], v[100:103]
    ds_read_b64_tr_b16 a[14:15], v21 offset:55808
    s_add_u32 m0, s32, 0x26000
    v_mfma_f32_16x16x32_bf16 v[104:107], a[20:23], a[48:51], v[104:107]
    ds_read_b64_tr_b16 a[16:17], v20 offset:61440
    buffer_load_dwordx4 v2, s[8:11], s68 offen sc1 lds
    v_mfma_f32_16x16x32_bf16 v[108:111], a[20:23], a[52:55], v[108:111]
    ds_read_b64_tr_b16 a[18:19], v20 offset:63488
    s_waitcnt lgkmcnt(10)
    v_mfma_f32_16x16x32_bf16 v[112:115], a[24:27], a[48:51], v[112:115]
    ds_read_b64_tr_b16 a[20:21], v21 offset:61440
    v_mfma_f32_16x16x32_bf16 v[116:119], a[24:27], a[52:55], v[116:119]
    ds_read_b64_tr_b16 a[22:23], v21 offset:63488
    v_mfma_f32_16x16x32_bf16 v[120:123], a[28:31], a[48:51], v[120:123]
    ds_read_b64_tr_b16 a[24:25], v20 offset:61952
    buffer_load_dwordx4 a[180:183], v4, s[20:23], s30 offen offset:1024 sc1
    v_mfma_f32_16x16x32_bf16 v[124:127], a[28:31], a[52:55], v[124:127]
    ds_read_b64_tr_b16 a[26:27], v20 offset:64000
    s_waitcnt lgkmcnt(10)
    v_mfma_f32_16x16x32_bf16 v[64:67], a[0:3], a[56:59], v[64:67]
    ds_read_b64_tr_b16 a[28:29], v21 offset:61952
    v_mfma_f32_16x16x32_bf16 v[68:71], a[0:3], a[60:63], v[68:71]
    ds_read_b64_tr_b16 a[30:31], v21 offset:64000
    s_add_u32 m0, s32, 0x25000
    v_mfma_f32_16x16x32_bf16 v[72:75], a[4:7], a[56:59], v[72:75]
    ds_read_b64_tr_b16 a[0:1], v22 offset:32768
    buffer_load_dwordx4 v3, s[24:27], s73 offen offset:0 lds
    v_mfma_f32_16x16x32_bf16 v[76:79], a[4:7], a[60:63], v[76:79]
    ds_read_b64_tr_b16 a[2:3], v22 offset:34816
    s_waitcnt lgkmcnt(10)
    v_mfma_f32_16x16x32_bf16 v[80:83], a[8:11], a[56:59], v[80:83]
    ds_read_b64_tr_b16 a[4:5], v23 offset:32768
    v_mfma_f32_16x16x32_bf16 v[84:87], a[8:11], a[60:63], v[84:87]
    ds_read_b64_tr_b16 a[6:7], v23 offset:34816
    v_mfma_f32_16x16x32_bf16 v[88:91], a[12:15], a[56:59], v[88:91]
    ds_read_b64_tr_b16 a[8:9], v22 offset:33280
    buffer_load_dwordx4 a[184:187], v4, s[20:23], s30 offen offset:2048 sc1
    v_mfma_f32_16x16x32_bf16 v[92:95], a[12:15], a[60:63], v[92:95]
    ds_read_b64_tr_b16 a[10:11], v22 offset:35328
    s_waitcnt lgkmcnt(10)
    v_mfma_f32_16x16x32_bf16 v[96:99], a[16:19], a[56:59], v[96:99]
    ds_read_b64_tr_b16 a[12:13], v23 offset:33280
    v_mfma_f32_16x16x32_bf16 v[100:103], a[16:19], a[60:63], v[100:103]
    ds_read_b64_tr_b16 a[14:15], v23 offset:35328
    s_waitcnt vmcnt(23)
    v_mov_b32 v26, 1
    s_mov_b64 exec, 1
    buffer_store_dword v26, off, s[20:23], s46 sc1
    s_mov_b64 exec, -1
    s_add_u32 m0, s32, 0x27000
    v_mfma_f32_16x16x32_bf16 v[104:107], a[20:23], a[56:59], v[104:107]
    ds_read_b64_tr_b16 a[16:17], v22 offset:40960
    buffer_load_dwordx4 v2, s[8:11], s69 offen sc1 lds
    s_add_u32 s72, s72, 0x20000
    s_add_u32 s73, s72, 0x10000
    s_add_u32 s68, s69, s3
    s_add_u32 s69, s68, s3
    v_mfma_f32_16x16x32_bf16 v[108:111], a[20:23], a[60:63], v[108:111]
    ds_read_b64_tr_b16 a[18:19], v22 offset:43008
    s_waitcnt lgkmcnt(10)
    v_mfma_f32_16x16x32_bf16 v[112:115], a[24:27], a[56:59], v[112:115]
    ds_read_b64_tr_b16 a[20:21], v23 offset:40960
    v_mfma_f32_16x16x32_bf16 v[116:119], a[24:27], a[60:63], v[116:119]
    ds_read_b64_tr_b16 a[22:23], v23 offset:43008
    v_mfma_f32_16x16x32_bf16 v[120:123], a[28:31], a[56:59], v[120:123]
    ds_read_b64_tr_b16 a[24:25], v22 offset:41472
    buffer_load_dwordx4 a[188:191], v4, s[20:23], s30 offen offset:3072 sc1
    s_add_u32 s30, s30, 4096
    v_mfma_f32_16x16x32_bf16 v[124:127], a[28:31], a[60:63], v[124:127]
    ds_read_b64_tr_b16 a[26:27], v22 offset:43520
.p2align 6
L_m_loop:
    s_waitcnt lgkmcnt(10)
    v_mfma_f32_16x16x32_bf16 v[64:67], a[0:3], a[224:227], v[64:67]
    ds_read_b64_tr_b16 a[28:29], v23 offset:41472
    v_mfma_f32_16x16x32_bf16 v[68:71], a[0:3], a[228:231], v[68:71]
    ds_read_b64_tr_b16 a[30:31], v23 offset:43520
    s_add_u32 m0, s32, 0x0
    v_mfma_f32_16x16x32_bf16 v[72:75], a[4:7], a[224:227], v[72:75]
    ds_read_b64_tr_b16 a[0:1], v22 offset:36864
    buffer_load_dwordx4 v3, s[24:27], s72 offen offset:0 lds
    v_mfma_f32_16x16x32_bf16 v[76:79], a[4:7], a[228:231], v[76:79]
    ds_read_b64_tr_b16 a[2:3], v22 offset:38912
    s_waitcnt lgkmcnt(10)
    v_mfma_f32_16x16x32_bf16 v[80:83], a[8:11], a[224:227], v[80:83]
    ds_read_b64_tr_b16 a[4:5], v23 offset:36864
    v_mfma_f32_16x16x32_bf16 v[84:87], a[8:11], a[228:231], v[84:87]
    ds_read_b64_tr_b16 a[6:7], v23 offset:38912
    v_mfma_f32_16x16x32_bf16 v[88:91], a[12:15], a[224:227], v[88:91]
    ds_read_b64_tr_b16 a[8:9], v22 offset:37376
    buffer_load_dwordx4 a[192:195], v4, s[20:23], s30 offen offset:0 sc1
    v_mfma_f32_16x16x32_bf16 v[92:95], a[12:15], a[228:231], v[92:95]
    ds_read_b64_tr_b16 a[10:11], v22 offset:39424
    s_waitcnt lgkmcnt(10)
    v_mfma_f32_16x16x32_bf16 v[96:99], a[16:19], a[224:227], v[96:99]
    ds_read_b64_tr_b16 a[12:13], v23 offset:37376
    v_mfma_f32_16x16x32_bf16 v[100:103], a[16:19], a[228:231], v[100:103]
    ds_read_b64_tr_b16 a[14:15], v23 offset:39424
    s_add_u32 m0, s32, 0x2000
    v_mfma_f32_16x16x32_bf16 v[104:107], a[20:23], a[224:227], v[104:107]
    ds_read_b64_tr_b16 a[16:17], v22 offset:45056
    buffer_load_dwordx4 v2, s[8:11], s68 offen sc1 lds
    v_mfma_f32_16x16x32_bf16 v[108:111], a[20:23], a[228:231], v[108:111]
    ds_read_b64_tr_b16 a[18:19], v22 offset:47104
    s_waitcnt lgkmcnt(10)
    v_mfma_f32_16x16x32_bf16 v[112:115], a[24:27], a[224:227], v[112:115]
    ds_read_b64_tr_b16 a[20:21], v23 offset:45056
    v_mfma_f32_16x16x32_bf16 v[116:119], a[24:27], a[228:231], v[116:119]
    ds_read_b64_tr_b16 a[22:23], v23 offset:47104
    v_mfma_f32_16x16x32_bf16 v[120:123], a[28:31], a[224:227], v[120:123]
    ds_read_b64_tr_b16 a[24:25], v22 offset:45568
    buffer_load_dwordx4 a[196:199], v4, s[20:23], s30 offen offset:1024 sc1
    v_mfma_f32_16x16x32_bf16 v[124:127], a[28:31], a[228:231], v[124:127]
    ds_read_b64_tr_b16 a[26:27], v22 offset:47616
    s_waitcnt vmcnt(12)
    s_barrier
    s_waitcnt lgkmcnt(10)
    v_mfma_f32_16x16x32_bf16 v[64:67], a[0:3], a[232:235], v[64:67]
    ds_read_b64_tr_b16 a[28:29], v23 offset:45568
    v_mfma_f32_16x16x32_bf16 v[68:71], a[0:3], a[236:239], v[68:71]
    ds_read_b64_tr_b16 a[30:31], v23 offset:47616
    s_add_u32 m0, s32, 0x1000
    v_mfma_f32_16x16x32_bf16 v[72:75], a[4:7], a[232:235], v[72:75]
    ds_read_b64_tr_b16 a[0:1], v22 offset:49152
    buffer_load_dwordx4 v3, s[24:27], s73 offen offset:0 lds
    v_mfma_f32_16x16x32_bf16 v[76:79], a[4:7], a[236:239], v[76:79]
    ds_read_b64_tr_b16 a[2:3], v22 offset:51200
    s_waitcnt lgkmcnt(10)
    v_mfma_f32_16x16x32_bf16 v[80:83], a[8:11], a[232:235], v[80:83]
    ds_read_b64_tr_b16 a[4:5], v23 offset:49152
    v_mfma_f32_16x16x32_bf16 v[84:87], a[8:11], a[236:239], v[84:87]
    ds_read_b64_tr_b16 a[6:7], v23 offset:51200
    v_mfma_f32_16x16x32_bf16 v[88:91], a[12:15], a[232:235], v[88:91]
    ds_read_b64_tr_b16 a[8:9], v22 offset:49664
    buffer_load_dwordx4 a[200:203], v4, s[20:23], s30 offen offset:2048 sc1
    v_mfma_f32_16x16x32_bf16 v[92:95], a[12:15], a[236:239], v[92:95]
    ds_read_b64_tr_b16 a[10:11], v22 offset:51712
    s_waitcnt lgkmcnt(10)
    v_mfma_f32_16x16x32_bf16 v[96:99], a[16:19], a[232:235], v[96:99]
    ds_read_b64_tr_b16 a[12:13], v23 offset:49664
    v_mfma_f32_16x16x32_bf16 v[100:103], a[16:19], a[236:239], v[100:103]
    ds_read_b64_tr_b16 a[14:15], v23 offset:51712
    s_add_u32 m0, s32, 0x3000
    v_mfma_f32_16x16x32_bf16 v[104:107], a[20:23], a[232:235], v[104:107]
    ds_read_b64_tr_b16 a[16:17], v22 offset:57344
    buffer_load_dwordx4 v2, s[8:11], s69 offen sc1 lds
    s_add_u32 s72, s72, 0x20000
    s_add_u32 s73, s72, 0x10000
    s_add_u32 s68, s69, s3
    s_add_u32 s69, s68, s3
    v_mfma_f32_16x16x32_bf16 v[108:111], a[20:23], a[236:239], v[108:111]
    ds_read_b64_tr_b16 a[18:19], v22 offset:59392
    s_waitcnt lgkmcnt(10)
    v_mfma_f32_16x16x32_bf16 v[112:115], a[24:27], a[232:235], v[112:115]
    ds_read_b64_tr_b16 a[20:21], v23 offset:57344
    v_mfma_f32_16x16x32_bf16 v[116:119], a[24:27], a[236:239], v[116:119]
    ds_read_b64_tr_b16 a[22:23], v23 offset:59392
    v_mfma_f32_16x16x32_bf16 v[120:123], a[28:31], a[232:235], v[120:123]
    ds_read_b64_tr_b16 a[24:25], v22 offset:57856
    buffer_load_dwordx4 a[204:207], v4, s[20:23], s30 offen offset:3072 sc1
    s_add_u32 s30, s30, 4096
    v_mfma_f32_16x16x32_bf16 v[124:127], a[28:31], a[236:239], v[124:127]
    ds_read_b64_tr_b16 a[26:27], v22 offset:59904
    s_waitcnt lgkmcnt(10)
    v_mfma_f32_16x16x32_bf16 v[64:67], a[0:3], a[240:243], v[64:67]
    ds_read_b64_tr_b16 a[28:29], v23 offset:57856
    v_mfma_f32_16x16x32_bf16 v[68:71], a[0:3], a[244:247], v[68:71]
    ds_read_b64_tr_b16 a[30:31], v23 offset:59904
    s_add_u32 m0, s32, 0x4000
    v_mfma_f32_16x16x32_bf16 v[72:75], a[4:7], a[240:243], v[72:75]
    ds_read_b64_tr_b16 a[0:1], v22 offset:53248
    buffer_load_dwordx4 v3, s[24:27], s72 offen offset:0 lds
    v_mfma_f32_16x16x32_bf16 v[76:79], a[4:7], a[244:247], v[76:79]
    ds_read_b64_tr_b16 a[2:3], v22 offset:55296
    s_waitcnt lgkmcnt(10)
    v_mfma_f32_16x16x32_bf16 v[80:83], a[8:11], a[240:243], v[80:83]
    ds_read_b64_tr_b16 a[4:5], v23 offset:53248
    v_mfma_f32_16x16x32_bf16 v[84:87], a[8:11], a[244:247], v[84:87]
    ds_read_b64_tr_b16 a[6:7], v23 offset:55296
    v_mfma_f32_16x16x32_bf16 v[88:91], a[12:15], a[240:243], v[88:91]
    ds_read_b64_tr_b16 a[8:9], v22 offset:53760
    buffer_load_dwordx4 a[208:211], v4, s[20:23], s30 offen offset:0 sc1
    v_mfma_f32_16x16x32_bf16 v[92:95], a[12:15], a[244:247], v[92:95]
    ds_read_b64_tr_b16 a[10:11], v22 offset:55808
    s_waitcnt lgkmcnt(10)
    v_mfma_f32_16x16x32_bf16 v[96:99], a[16:19], a[240:243], v[96:99]
    ds_read_b64_tr_b16 a[12:13], v23 offset:53760
    v_mfma_f32_16x16x32_bf16 v[100:103], a[16:19], a[244:247], v[100:103]
    ds_read_b64_tr_b16 a[14:15], v23 offset:55808
    s_add_u32 m0, s32, 0x6000
    v_mfma_f32_16x16x32_bf16 v[104:107], a[20:23], a[240:243], v[104:107]
    ds_read_b64_tr_b16 a[16:17], v22 offset:61440
    buffer_load_dwordx4 v2, s[8:11], s68 offen sc1 lds
    v_mfma_f32_16x16x32_bf16 v[108:111], a[20:23], a[244:247], v[108:111]
    ds_read_b64_tr_b16 a[18:19], v22 offset:63488
    s_waitcnt lgkmcnt(10)
    v_mfma_f32_16x16x32_bf16 v[112:115], a[24:27], a[240:243], v[112:115]
    ds_read_b64_tr_b16 a[20:21], v23 offset:61440
    v_mfma_f32_16x16x32_bf16 v[116:119], a[24:27], a[244:247], v[116:119]
    ds_read_b64_tr_b16 a[22:23], v23 offset:63488
    v_mfma_f32_16x16x32_bf16 v[120:123], a[28:31], a[240:243], v[120:123]
    ds_read_b64_tr_b16 a[24:25], v22 offset:61952
    buffer_load_dwordx4 a[212:215], v4, s[20:23], s30 offen offset:1024 sc1
    v_mfma_f32_16x16x32_bf16 v[124:127], a[28:31], a[244:247], v[124:127]
    ds_read_b64_tr_b16 a[26:27], v22 offset:64000
    s_waitcnt lgkmcnt(10)
    v_mfma_f32_16x16x32_bf16 v[64:67], a[0:3], a[248:251], v[64:67]
    ds_read_b64_tr_b16 a[28:29], v23 offset:61952
    v_mfma_f32_16x16x32_bf16 v[68:71], a[0:3], a[252:255], v[68:71]
    ds_read_b64_tr_b16 a[30:31], v23 offset:64000
    s_add_u32 m0, s32, 0x5000
    v_mfma_f32_16x16x32_bf16 v[72:75], a[4:7], a[248:251], v[72:75]
    ds_read_b64_tr_b16 a[0:1], v24 offset:0
    buffer_load_dwordx4 v3, s[24:27], s73 offen offset:0 lds
    v_mfma_f32_16x16x32_bf16 v[76:79], a[4:7], a[252:255], v[76:79]
    ds_read_b64_tr_b16 a[2:3], v24 offset:2048
    s_waitcnt lgkmcnt(10)
    v_mfma_f32_16x16x32_bf16 v[80:83], a[8:11], a[248:251], v[80:83]
    ds_read_b64_tr_b16 a[4:5], v25 offset:0
    v_mfma_f32_16x16x32_bf16 v[84:87], a[8:11], a[252:255], v[84:87]
    ds_read_b64_tr_b16 a[6:7], v25 offset:2048
    v_mfma_f32_16x16x32_bf16 v[88:91], a[12:15], a[248:251], v[88:91]
    ds_read_b64_tr_b16 a[8:9], v24 offset:512
    buffer_load_dwordx4 a[216:219], v4, s[20:23], s30 offen offset:2048 sc1
    v_mfma_f32_16x16x32_bf16 v[92:95], a[12:15], a[252:255], v[92:95]
    ds_read_b64_tr_b16 a[10:11], v24 offset:2560
    s_waitcnt lgkmcnt(10)
    v_mfma_f32_16x16x32_bf16 v[96:99], a[16:19], a[248:251], v[96:99]
    ds_read_b64_tr_b16 a[12:13], v25 offset:512
    v_mfma_f32_16x16x32_bf16 v[100:103], a[16:19], a[252:255], v[100:103]
    ds_read_b64_tr_b16 a[14:15], v25 offset:2560
    s_add_u32 m0, s32, 0x7000
    v_mfma_f32_16x16x32_bf16 v[104:107], a[20:23], a[248:251], v[104:107]
    ds_read_b64_tr_b16 a[16:17], v24 offset:8192
    buffer_load_dwordx4 v2, s[8:11], s69 offen sc1 lds
    s_add_u32 s72, s72, 0x20000
    s_add_u32 s73, s72, 0x10000
    s_add_u32 s68, s69, s3
    s_add_u32 s69, s68, s3
    v_mfma_f32_16x16x32_bf16 v[108:111], a[20:23], a[252:255], v[108:111]
    ds_read_b64_tr_b16 a[18:19], v24 offset:10240
    s_waitcnt lgkmcnt(10)
    v_mfma_f32_16x16x32_bf16 v[112:115], a[24:27], a[248:251], v[112:115]
    ds_read_b64_tr_b16 a[20:21], v25 offset:8192
    v_mfma_f32_16x16x32_bf16 v[116:119], a[24:27], a[252:255], v[116:119]
    ds_read_b64_tr_b16 a[22:23], v25 offset:10240
    v_mfma_f32_16x16x32_bf16 v[120:123], a[28:31], a[248:251], v[120:123]
    ds_read_b64_tr_b16 a[24:25], v24 offset:8704
    buffer_load_dwordx4 a[220:223], v4, s[20:23], s30 offen offset:3072 sc1
    s_add_u32 s30, s30, 4096
    v_mfma_f32_16x16x32_bf16 v[124:127], a[28:31], a[252:255], v[124:127]
    ds_read_b64_tr_b16 a[26:27], v24 offset:10752
    s_waitcnt lgkmcnt(10)
    v_mfma_f32_16x16x32_bf16 v[64:67], a[0:3], a[160:163], v[64:67]
    ds_read_b64_tr_b16 a[28:29], v25 offset:8704
    v_mfma_f32_16x16x32_bf16 v[68:71], a[0:3], a[164:167], v[68:71]
    ds_read_b64_tr_b16 a[30:31], v25 offset:10752
    s_add_u32 m0, s32, 0x8000
    v_mfma_f32_16x16x32_bf16 v[72:75], a[4:7], a[160:163], v[72:75]
    ds_read_b64_tr_b16 a[0:1], v24 offset:4096
    buffer_load_dwordx4 v3, s[24:27], s72 offen offset:0 lds
    v_mfma_f32_16x16x32_bf16 v[76:79], a[4:7], a[164:167], v[76:79]
    ds_read_b64_tr_b16 a[2:3], v24 offset:6144
    s_waitcnt lgkmcnt(10)
    v_mfma_f32_16x16x32_bf16 v[80:83], a[8:11], a[160:163], v[80:83]
    ds_read_b64_tr_b16 a[4:5], v25 offset:4096
    v_mfma_f32_16x16x32_bf16 v[84:87], a[8:11], a[164:167], v[84:87]
    ds_read_b64_tr_b16 a[6:7], v25 offset:6144
    v_mfma_f32_16x16x32_bf16 v[88:91], a[12:15], a[160:163], v[88:91]
    ds_read_b64_tr_b16 a[8:9], v24 offset:4608
    buffer_load_dwordx4 a[32:35], v4, s[20:23], s30 offen offset:0 sc1
    v_mfma_f32_16x16x32_bf16 v[92:95], a[12:15], a[164:167], v[92:95]
    ds_read_b64_tr_b16 a[10:11], v24 offset:6656
    s_waitcnt lgkmcnt(10)
    v_mfma_f32_16x16x32_bf16 v[96:99], a[16:19], a[160:163], v[96:99]
    ds_read_b64_tr_b16 a[12:13], v25 offset:4608
    v_mfma_f32_16x16x32_bf16 v[100:103], a[16:19], a[164:167], v[100:103]
    ds_read_b64_tr_b16 a[14:15], v25 offset:6656
    s_add_u32 m0, s32, 0xa000
    v_mfma_f32_16x16x32_bf16 v[104:107], a[20:23], a[160:163], v[104:107]
    ds_read_b64_tr_b16 a[16:17], v24 offset:12288
    buffer_load_dwordx4 v2, s[8:11], s68 offen sc1 lds
    v_mfma_f32_16x16x32_bf16 v[108:111], a[20:23], a[164:167], v[108:111]
    ds_read_b64_tr_b16 a[18:19], v24 offset:14336
    s_waitcnt lgkmcnt(10)
    v_mfma_f32_16x16x32_bf16 v[112:115], a[24:27], a[160:163], v[112:115]
    ds_read_b64_tr_b16 a[20:21], v25 offset:12288
    v_mfma_f32_16x16x32_bf16 v[116:119], a[24:27], a[164:167], v[116:119]
    ds_read_b64_tr_b16 a[22:23], v25 offset:14336
    v_mfma_f32_16x16x32_bf16 v[120:123], a[28:31], a[160:163], v[120:123]
    ds_read_b64_tr_b16 a[24:25], v24 offset:12800
    buffer_load_dwordx4 a[36:39], v4, s[20:23], s30 offen offset:1024 sc1
    v_mfma_f32_16x16x32_bf16 v[124:127], a[28:31], a[164:167], v[124:127]
    ds_read_b64_tr_b16 a[26:27], v24 offset:14848
    s_waitcnt vmcnt(12)
    s_barrier
    s_waitcnt lgkmcnt(10)
    v_mfma_f32_16x16x32_bf16 v[64:67], a[0:3], a[168:171], v[64:67]
    ds_read_b64_tr_b16 a[28:29], v25 offset:12800
    v_mfma_f32_16x16x32_bf16 v[68:71], a[0:3], a[172:175], v[68:71]
    ds_read_b64_tr_b16 a[30:31], v25 offset:14848
    s_add_u32 m0, s32, 0x9000
    v_mfma_f32_16x16x32_bf16 v[72:75], a[4:7], a[168:171], v[72:75]
    ds_read_b64_tr_b16 a[0:1], v24 offset:16384
    buffer_load_dwordx4 v3, s[24:27], s73 offen offset:0 lds
    v_mfma_f32_16x16x32_bf16 v[76:79], a[4:7], a[172:175], v[76:79]
    ds_read_b64_tr_b16 a[2:3], v24 offset:18432
    s_waitcnt lgkmcnt(10)
    v_mfma_f32_16x16x32_bf16 v[80:83], a[8:11], a[168:171], v[80:83]
    ds_read_b64_tr_b16 a[4:5], v25 offset:16384
    v_mfma_f32_16x16x32_bf16 v[84:87], a[8:11], a[172:175], v[84:87]
    ds_read_b64_tr_b16 a[6:7], v25 offset:18432
    v_mfma_f32_16x16x32_bf16 v[88:91], a[12:15], a[168:171], v[88:91]
    ds_read_b64_tr_b16 a[8:9], v24 offset:16896
    buffer_load_dwordx4 a[40:43], v4, s[20:23], s30 offen offset:2048 sc1
    v_mfma_f32_16x16x32_bf16 v[92:95], a[12:15], a[172:175], v[92:95]
    ds_read_b64_tr_b16 a[10:11], v24 offset:18944
    s_waitcnt lgkmcnt(10)
    v_mfma_f32_16x16x32_bf16 v[96:99], a[16:19], a[168:171], v[96:99]
    ds_read_b64_tr_b16 a[12:13], v25 offset:16896
    v_mfma_f32_16x16x32_bf16 v[100:103], a[16:19], a[172:175], v[100:103]
    ds_read_b64_tr_b16 a[14:15], v25 offset:18944
    s_add_u32 m0, s32, 0xb000
    v_mfma_f32_16x16x32_bf16 v[104:107], a[20:23], a[168:171], v[104:107]
    ds_read_b64_tr_b16 a[16:17], v24 offset:24576
    buffer_load_dwordx4 v2, s[8:11], s69 offen sc1 lds
    s_add_u32 s72, s72, 0x20000
    s_add_u32 s73, s72, 0x10000
    s_add_u32 s68, s69, s3
    s_add_u32 s69, s68, s3
    v_mfma_f32_16x16x32_bf16 v[108:111], a[20:23], a[172:175], v[108:111]
    ds_read_b64_tr_b16 a[18:19], v24 offset:26624
    s_waitcnt lgkmcnt(10)
    v_mfma_f32_16x16x32_bf16 v[112:115], a[24:27], a[168:171], v[112:115]
    ds_read_b64_tr_b16 a[20:21], v25 offset:24576
    v_mfma_f32_16x16x32_bf16 v[116:119], a[24:27], a[172:175], v[116:119]
    ds_read_b64_tr_b16 a[22:23], v25 offset:26624
    v_mfma_f32_16x16x32_bf16 v[120:123], a[28:31], a[168:171], v[120:123]
    ds_read_b64_tr_b16 a[24:25], v24 offset:25088
    buffer_load_dwordx4 a[44:47], v4, s[20:23], s30 offen offset:3072 sc1
    s_add_u32 s30, s30, 4096
    v_mfma_f32_16x16x32_bf16 v[124:127], a[28:31], a[172:175], v[124:127]
    ds_read_b64_tr_b16 a[26:27], v24 offset:27136
    s_waitcnt lgkmcnt(10)
    v_mfma_f32_16x16x32_bf16 v[64:67], a[0:3], a[176:179], v[64:67]
    ds_read_b64_tr_b16 a[28:29], v25 offset:25088
    v_mfma_f32_16x16x32_bf16 v[68:71], a[0:3], a[180:183], v[68:71]
    ds_read_b64_tr_b16 a[30:31], v25 offset:27136
    s_add_u32 m0, s32, 0xc000
    v_mfma_f32_16x16x32_bf16 v[72:75], a[4:7], a[176:179], v[72:75]
    ds_read_b64_tr_b16 a[0:1], v24 offset:20480
    buffer_load_dwordx4 v3, s[24:27], s72 offen offset:0 lds
    v_mfma_f32_16x16x32_bf16 v[76:79], a[4:7], a[180:183], v[76:79]
    ds_read_b64_tr_b16 a[2:3], v24 offset:22528
    s_waitcnt lgkmcnt(10)
    v_mfma_f32_16x16x32_bf16 v[80:83], a[8:11], a[176:179], v[80:83]
    ds_read_b64_tr_b16 a[4:5], v25 offset:20480
    v_mfma_f32_16x16x32_bf16 v[84:87], a[8:11], a[180:183], v[84:87]
    ds_read_b64_tr_b16 a[6:7], v25 offset:22528
    v_mfma_f32_16x16x32_bf16 v[88:91], a[12:15], a[176:179], v[88:91]
    ds_read_b64_tr_b16 a[8:9], v24 offset:20992
    buffer_load_dwordx4 a[48:51], v4, s[20:23], s30 offen offset:0 sc1
    v_mfma_f32_16x16x32_bf16 v[92:95], a[12:15], a[180:183], v[92:95]
    ds_read_b64_tr_b16 a[10:11], v24 offset:23040
    s_waitcnt lgkmcnt(10)
    v_mfma_f32_16x16x32_bf16 v[96:99], a[16:19], a[176:179], v[96:99]
    ds_read_b64_tr_b16 a[12:13], v25 offset:20992
    v_mfma_f32_16x16x32_bf16 v[100:103], a[16:19], a[180:183], v[100:103]
    ds_read_b64_tr_b16 a[14:15], v25 offset:23040
    s_add_u32 m0, s32, 0xe000
    v_mfma_f32_16x16x32_bf16 v[104:107], a[20:23], a[176:179], v[104:107]
    ds_read_b64_tr_b16 a[16:17], v24 offset:28672
    buffer_load_dwordx4 v2, s[8:11], s68 offen sc1 lds
    v_mfma_f32_16x16x32_bf16 v[108:111], a[20:23], a[180:183], v[108:111]
    ds_read_b64_tr_b16 a[18:19], v24 offset:30720
    s_waitcnt lgkmcnt(10)
    v_mfma_f32_16x16x32_bf16 v[112:115], a[24:27], a[176:179], v[112:115]
    ds_read_b64_tr_b16 a[20:21], v25 offset:28672
    v_mfma_f32_16x16x32_bf16 v[116:119], a[24:27], a[180:183], v[116:119]
    ds_read_b64_tr_b16 a[22:23], v25 offset:30720
    v_mfma_f32_16x16x32_bf16 v[120:123], a[28:31], a[176:179], v[120:123]
    ds_read_b64_tr_b16 a[24:25], v24 offset:29184
    buffer_load_dwordx4 a[52:55], v4, s[20:23], s30 offen offset:1024 sc1
    v_mfma_f32_16x16x32_bf16 v[124:127], a[28:31], a[180:183], v[124:127]
    ds_read_b64_tr_b16 a[26:27], v24 offset:31232
    s_waitcnt lgkmcnt(10)
    v_mfma_f32_16x16x32_bf16 v[64:67], a[0:3], a[184:187], v[64:67]
    ds_read_b64_tr_b16 a[28:29], v25 offset:29184
    v_mfma_f32_16x16x32_bf16 v[68:71], a[0:3], a[188:191], v[68:71]
    ds_read_b64_tr_b16 a[30:31], v25 offset:31232
    s_add_u32 m0, s32, 0xd000
    v_mfma_f32_16x16x32_bf16 v[72:75], a[4:7], a[184:187], v[72:75]
    ds_read_b64_tr_b16 a[0:1], v20 offset:0
    buffer_load_dwordx4 v3, s[24:27], s73 offen offset:0 lds
    v_mfma_f32_16x16x32_bf16 v[76:79], a[4:7], a[188:191], v[76:79]
    ds_read_b64_tr_b16 a[2:3], v20 offset:2048
    s_waitcnt lgkmcnt(10)
    v_mfma_f32_16x16x32_bf16 v[80:83], a[8:11], a[184:187], v[80:83]
    ds_read_b64_tr_b16 a[4:5], v21 offset:0
    v_mfma_f32_16x16x32_bf16 v[84:87], a[8:11], a[188:191], v[84:87]
    ds_read_b64_tr_b16 a[6:7], v21 offset:2048
    v_mfma_f32_16x16x32_bf16 v[88:91], a[12:15], a[184:187], v[88:91]
    ds_read_b64_tr_b16 a[8:9], v20 offset:512
    buffer_load_dwordx4 a[56:59], v4, s[20:23], s30 offen offset:2048 sc1
    v_mfma_f32_16x16x32_bf16 v[92:95], a[12:15], a[188:191], v[92:95]
    ds_read_b64_tr_b16 a[10:11], v20 offset:2560
    s_waitcnt lgkmcnt(10)
    v_mfma_f32_16x16x32_bf16 v[96:99], a[16:19], a[184:187], v[96:99]
    ds_read_b64_tr_b16 a[12:13], v21 offset:512
    v_mfma_f32_16x16x32_bf16 v[100:103], a[16:19], a[188:191], v[100:103]
    ds_read_b64_tr_b16 a[14:15], v21 offset:2560
    s_add_u32 m0, s32, 0xf000
    v_mfma_f32_16x16x32_bf16 v[104:107], a[20:23], a[184:187], v[104:107]
    ds_read_b64_tr_b16 a[16:17], v20 offset:8192
    buffer_load_dwordx4 v2, s[8:11], s69 offen sc1 lds
    s_add_u32 s72, s72, 0x20000
    s_add_u32 s73, s72, 0x10000
    v_mfma_f32_16x16x32_bf16 v[108:111], a[20:23], a[188:191], v[108:111]
    ds_read_b64_tr_b16 a[18:19], v20 offset:10240
    s_waitcnt lgkmcnt(10)
    v_mfma_f32_16x16x32_bf16 v[112:115], a[24:27], a[184:187], v[112:115]
    ds_read_b64_tr_b16 a[20:21], v21 offset:8192
    v_mfma_f32_16x16x32_bf16 v[116:119], a[24:27], a[188:191], v[116:119]
    ds_read_b64_tr_b16 a[22:23], v21 offset:10240
    v_mfma_f32_16x16x32_bf16 v[120:123], a[28:31], a[184:187], v[120:123]
    ds_read_b64_tr_b16 a[24:25], v20 offset:8704
    buffer_load_dwordx4 a[60:63], v4, s[20:23], s30 offen offset:3072 sc1
    s_add_u32 s30, s30, 4096
    s_add_u32 s65, s65, 1
    s_add_u32 s78, s65, s74
    s_and_b32 s78, s78, 3
    s_lshl_b32 s79, s78, 1
    s_add_u32 s79, s79, 1
    s_lshl_b32 s7, s65, 1
    s_sub_u32 s7, s7, 8
    s_cmp_lt_u32 s65, 4
    s_cselect_b32 s78, s78, s65
    s_cselect_b32 s79, s79, s7
    s_lshl_b32 s78, s78, 15
    s_add_u32 s78, s78, s4
    s_lshl_b32 s79, s79, 20
    s_add_u32 s79, s79, s75
    s_cmp_eq_u32 s51, 0
    s_cselect_b32 s30, s78, s30
    s_cselect_b32 s72, s79, s72
    s_add_u32 s73, s72, 0x10000
    s_sub_u32 s68, s72, s75
    s_lshr_b32 s68, s68, s49
    s_add_u32 s68, s68, s52
    s_add_u32 s69, s68, s3
    v_mfma_f32_16x16x32_bf16 v[124:127], a[28:31], a[188:191], v[124:127]
    ds_read_b64_tr_b16 a[26:27], v20 offset:10752
    s_waitcnt lgkmcnt(10)
    v_mfma_f32_16x16x32_bf16 v[64:67], a[0:3], a[192:195], v[64:67]
    ds_read_b64_tr_b16 a[28:29], v21 offset:8704
    v_mfma_f32_16x16x32_bf16 v[68:71], a[0:3], a[196:199], v[68:71]
    ds_read_b64_tr_b16 a[30:31], v21 offset:10752
    s_add_u32 m0, s32, 0x18000
    v_mfma_f32_16x16x32_bf16 v[72:75], a[4:7], a[192:195], v[72:75]
    ds_read_b64_tr_b16 a[0:1], v20 offset:4096
    buffer_load_dwordx4 v3, s[24:27], s72 offen offset:0 lds
    v_mfma_f32_16x16x32_bf16 v[76:79], a[4:7], a[196:199], v[76:79]
    ds_read_b64_tr_b16 a[2:3], v20 offset:6144
    s_waitcnt lgkmcnt(10)
    v_mfma_f32_16x16x32_bf16 v[80:83], a[8:11], a[192:195], v[80:83]
    ds_read_b64_tr_b16 a[4:5], v21 offset:4096
    v_mfma_f32_16x16x32_bf16 v[84:87], a[8:11], a[196:199], v[84:87]
    ds_read_b64_tr_b16 a[6:7], v21 offset:6144
    v_mfma_f32_16x16x32_bf16 v[88:91], a[12:15], a[192:195], v[88:91]
    ds_read_b64_tr_b16 a[8:9], v20 offset:4608
    buffer_load_dwordx4 a[224:227], v4, s[20:23], s30 offen offset:0 sc1
    v_mfma_f32_16x16x32_bf16 v[92:95], a[12:15], a[196:199], v[92:95]
    ds_read_b64_tr_b16 a[10:11], v20 offset:6656
    s_waitcnt lgkmcnt(10)
    v_mfma_f32_16x16x32_bf16 v[96:99], a[16:19], a[192:195], v[96:99]
    ds_read_b64_tr_b16 a[12:13], v21 offset:4608
    v_mfma_f32_16x16x32_bf16 v[100:103], a[16:19], a[196:199], v[100:103]
    ds_read_b64_tr_b16 a[14:15], v21 offset:6656
    s_add_u32 m0, s32, 0x1a000
    v_mfma_f32_16x16x32_bf16 v[104:107], a[20:23], a[192:195], v[104:107]
    ds_read_b64_tr_b16 a[16:17], v20 offset:12288
    buffer_load_dwordx4 v2, s[8:11], s68 offen sc1 lds
    v_mfma_f32_16x16x32_bf16 v[108:111], a[20:23], a[196:199], v[108:111]
    ds_read_b64_tr_b16 a[18:19], v20 offset:14336
    s_waitcnt lgkmcnt(10)
    v_mfma_f32_16x16x32_bf16 v[112:115], a[24:27], a[192:195], v[112:115]
    ds_read_b64_tr_b16 a[20:21], v21 offset:12288
    v_mfma_f32_16x16x32_bf16 v[116:119], a[24:27], a[196:199], v[116:119]
    ds_read_b64_tr_b16 a[22:23], v21 offset:14336
    v_mfma_f32_16x16x32_bf16 v[120:123], a[28:31], a[192:195], v[120:123]
    ds_read_b64_tr_b16 a[24:25], v20 offset:12800
    buffer_load_dwordx4 a[228:231], v4, s[20:23], s30 offen offset:1024 sc1
    v_mfma_f32_16x16x32_bf16 v[124:127], a[28:31], a[196:199], v[124:127]
    ds_read_b64_tr_b16 a[26:27], v20 offset:14848
    s_waitcnt vmcnt(12)
    s_barrier
    s_waitcnt lgkmcnt(10)
    v_mfma_f32_16x16x32_bf16 v[64:67], a[0:3], a[200:203], v[64:67]
    ds_read_b64_tr_b16 a[28:29], v21 offset:12800
    v_mfma_f32_16x16x32_bf16 v[68:71], a[0:3], a[204:207], v[68:71]
    ds_read_b64_tr_b16 a[30:31], v21 offset:14848
    s_add_u32 m0, s32, 0x19000
    v_mfma_f32_16x16x32_bf16 v[72:75], a[4:7], a[200:203], v[72:75]
    ds_read_b64_tr_b16 a[0:1], v20 offset:16384
    buffer_load_dwordx4 v3, s[24:27], s73 offen offset:0 lds
    v_mfma_f32_16x16x32_bf16 v[76:79], a[4:7], a[204:207], v[76:79]
    ds_read_b64_tr_b16 a[2:3], v20 offset:18432
    s_waitcnt lgkmcnt(10)
    v_mfma_f32_16x16x32_bf16 v[80:83], a[8:11], a[200:203], v[80:83]
    ds_read_b64_tr_b16 a[4:5], v21 offset:16384
    v_mfma_f32_16x16x32_bf16 v[84:87], a[8:11], a[204:207], v[84:87]
    ds_read_b64_tr_b16 a[6:7], v21 offset:18432
    v_mfma_f32_16x16x32_bf16 v[88:91], a[12:15], a[200:203], v[88:91]
    ds_read_b64_tr_b16 a[8:9], v20 offset:16896
    buffer_load_dwordx4 a[232:235], v4, s[20:23], s30 offen offset:2048 sc1
    v_mfma_f32_16x16x32_bf16 v[92:95], a[12:15], a[204:207], v[92:95]
    ds_read_b64_tr_b16 a[10:11], v20 offset:18944
    s_waitcnt lgkmcnt(10)
    v_mfma_f32_16x16x32_bf16 v[96:99], a[16:19], a[200:203], v[96:99]
    ds_read_b64_tr_b16 a[12:13], v21 offset:16896
    v_mfma_f32_16x16x32_bf16 v[100:103], a[16:19], a[204:207], v[100:103]
    ds_read_b64_tr_b16 a[14:15], v21 offset:18944
    s_add_u32 m0, s32, 0x1b000
    v_mfma_f32_16x16x32_bf16 v[104:107], a[20:23], a[200:203], v[104:107]
    ds_read_b64_tr_b16 a[16:17], v20 offset:24576
    buffer_load_dwordx4 v2, s[8:11], s69 offen sc1 lds
    s_add_u32 s72, s72, 0x20000
    s_add_u32 s73, s72, 0x10000
    s_add_u32 s68, s69, s3
    s_add_u32 s69, s68, s3
    v_mfma_f32_16x16x32_bf16 v[108:111], a[20:23], a[204:207], v[108:111]
    ds_read_b64_tr_b16 a[18:19], v20 offset:26624
    s_waitcnt lgkmcnt(10)
    v_mfma_f32_16x16x32_bf16 v[112:115], a[24:27], a[200:203], v[112:115]
    ds_read_b64_tr_b16 a[20:21], v21 offset:24576
    v_mfma_f32_16x16x32_bf16 v[116:119], a[24:27], a[204:207], v[116:119]
    ds_read_b64_tr_b16 a[22:23], v21 offset:26624
    v_mfma_f32_16x16x32_bf16 v[120:123], a[28:31], a[200:203], v[120:123]
    ds_read_b64_tr_b16 a[24:25], v20 offset:25088
    buffer_load_dwordx4 a[236:239], v4, s[20:23], s30 offen offset:3072 sc1
    s_add_u32 s30, s30, 4096
    v_mfma_f32_16x16x32_bf16 v[124:127], a[28:31], a[204:207], v[124:127]
    ds_read_b64_tr_b16 a[26:27], v20 offset:27136
    s_waitcnt lgkmcnt(10)
    v_mfma_f32_16x16x32_bf16 v[64:67], a[0:3], a[208:211], v[64:67]
    ds_read_b64_tr_b16 a[28:29], v21 offset:25088
    v_mfma_f32_16x16x32_bf16 v[68:71], a[0:3], a[212:215], v[68:71]
    ds_read_b64_tr_b16 a[30:31], v21 offset:27136
    v_mfma_f32_16x16x32_bf16 v[72:75], a[4:7], a[208:211], v[72:75]
    ds_read_b64_tr_b16 a[0:1], v20 offset:20480
    buffer_load_dword v9, v5, s[20:23], s47 offen sc1
    v_mfma_f32_16x16x32_bf16 v[76:79], a[4:7], a[212:215], v[76:79]
    ds_read_b64_tr_b16 a[2:3], v20 offset:22528
    s_waitcnt lgkmcnt(10)
    v_mfma_f32_16x16x32_bf16 v[80:83], a[8:11], a[208:211], v[80:83]
    ds_read_b64_tr_b16 a[4:5], v21 offset:20480
    v_mfma_f32_16x16x32_bf16 v[84:87], a[8:11], a[212:215], v[84:87]
    ds_read_b64_tr_b16 a[6:7], v21 offset:22528
    s_add_u32 m0, s32, 0x1c000
    v_mfma_f32_16x16x32_bf16 v[88:91], a[12:15], a[208:211], v[88:91]
    ds_read_b64_tr_b16 a[8:9], v20 offset:20992
    buffer_load_dwordx4 v3, s[24:27], s72 offen offset:0 lds
    v_mfma_f32_16x16x32_bf16 v[92:95], a[12:15], a[212:215], v[92:95]
    ds_read_b64_tr_b16 a[10:11], v20 offset:23040
    s_waitcnt lgkmcnt(10)
    v_mfma_f32_16x16x32_bf16 v[96:99], a[16:19], a[208:211], v[96:99]
    ds_read_b64_tr_b16 a[12:13], v21 offset:20992
    v_mfma_f32_16x16x32_bf16 v[100:103], a[16:19], a[212:215], v[100:103]
    ds_read_b64_tr_b16 a[14:15], v21 offset:23040
    v_mfma_f32_16x16x32_bf16 v[104:107], a[20:23], a[208:211], v[104:107]
    ds_read_b64_tr_b16 a[16:17], v20 offset:28672
    buffer_load_dwordx4 a[240:243], v4, s[20:23], s30 offen offset:0 sc1
    v_mfma_f32_16x16x32_bf16 v[108:111], a[20:23], a[212:215], v[108:111]
    ds_read_b64_tr_b16 a[18:19], v20 offset:30720
    s_waitcnt lgkmcnt(10)
    v_mfma_f32_16x16x32_bf16 v[112:115], a[24:27], a[208:211], v[112:115]
    ds_read_b64_tr_b16 a[20:21], v21 offset:28672
    v_mfma_f32_16x16x32_bf16 v[116:119], a[24:27], a[212:215], v[116:119]
    ds_read_b64_tr_b16 a[22:23], v21 offset:30720
    s_add_u32 m0, s32, 0x1e000
    v_mfma_f32_16x16x32_bf16 v[120:123], a[28:31], a[208:211], v[120:123]
    ds_read_b64_tr_b16 a[24:25], v20 offset:29184
    buffer_load_dwordx4 v2, s[8:11], s68 offen sc1 lds
    v_mfma_f32_16x16x32_bf16 v[124:127], a[28:31], a[212:215], v[124:127]
    ds_read_b64_tr_b16 a[26:27], v20 offset:31232
    s_waitcnt lgkmcnt(10)
    v_mfma_f32_16x16x32_bf16 v[64:67], a[0:3], a[216:219], v[64:67]
    ds_read_b64_tr_b16 a[28:29], v21 offset:29184
    buffer_load_dwordx4 a[244:247], v4, s[20:23], s30 offen offset:1024 sc1
    v_mfma_f32_16x16x32_bf16 v[68:71], a[0:3], a[220:223], v[68:71]
    ds_read_b64_tr_b16 a[30:31], v21 offset:31232
    v_mfma_f32_16x16x32_bf16 v[72:75], a[4:7], a[216:219], v[72:75]
    ds_read_b64_tr_b16 a[0:1], v20 offset:32768
    v_mfma_f32_16x16x32_bf16 v[76:79], a[4:7], a[220:223], v[76:79]
    ds_read_b64_tr_b16 a[2:3], v20 offset:34816
    s_waitcnt lgkmcnt(10)
    s_add_u32 m0, s32, 0x1d000
    v_mfma_f32_16x16x32_bf16 v[80:83], a[8:11], a[216:219], v[80:83]
    ds_read_b64_tr_b16 a[4:5], v21 offset:32768
    buffer_load_dwordx4 v3, s[24:27], s73 offen offset:0 lds
    v_mfma_f32_16x16x32_bf16 v[84:87], a[8:11], a[220:223], v[84:87]
    ds_read_b64_tr_b16 a[6:7], v21 offset:34816
    v_mfma_f32_16x16x32_bf16 v[88:91], a[12:15], a[216:219], v[88:91]
    ds_read_b64_tr_b16 a[8:9], v20 offset:33280
    v_mfma_f32_16x16x32_bf16 v[92:95], a[12:15], a[220:223], v[92:95]
    ds_read_b64_tr_b16 a[10:11], v20 offset:35328
    s_waitcnt lgkmcnt(10)
    v_mfma_f32_16x16x32_bf16 v[96:99], a[16:19], a[216:219], v[96:99]
    ds_read_b64_tr_b16 a[12:13], v21 offset:33280
    buffer_load_dwordx4 a[248:251], v4, s[20:23], s30 offen offset:2048 sc1
    v_mfma_f32_16x16x32_bf16 v[100:103], a[16:19], a[220:223], v[100:103]
    ds_read_b64_tr_b16 a[14:15], v21 offset:35328
    v_mfma_f32_16x16x32_bf16 v[104:107], a[20:23], a[216:219], v[104:107]
    ds_read_b64_tr_b16 a[16:17], v20 offset:40960
    v_mfma_f32_16x16x32_bf16 v[108:111], a[20:23], a[220:223], v[108:111]
    ds_read_b64_tr_b16 a[18:19], v20 offset:43008
    s_waitcnt lgkmcnt(10)
    s_add_u32 m0, s32, 0x1f000
    v_mfma_f32_16x16x32_bf16 v[112:115], a[24:27], a[216:219], v[112:115]
    ds_read_b64_tr_b16 a[20:21], v21 offset:40960
    buffer_load_dwordx4 v2, s[8:11], s69 offen sc1 lds
    s_add_u32 s72, s72, 0x20000
    s_add_u32 s73, s72, 0x10000
    s_add_u32 s68, s69, s3
    s_add_u32 s69, s68, s3
    v_mfma_f32_16x16x32_bf16 v[116:119], a[24:27], a[220:223], v[116:119]
    ds_read_b64_tr_b16 a[22:23], v21 offset:43008
    v_mfma_f32_16x16x32_bf16 v[120:123], a[28:31], a[216:219], v[120:123]
    ds_read_b64_tr_b16 a[24:25], v20 offset:41472
    buffer_load_dwordx4 a[252:255], v4, s[20:23], s30 offen offset:3072 sc1
    s_add_u32 s30, s30, 4096
    v_mfma_f32_16x16x32_bf16 v[124:127], a[28:31], a[220:223], v[124:127]
    ds_read_b64_tr_b16 a[26:27], v20 offset:43520
    s_waitcnt lgkmcnt(10)
    v_mfma_f32_16x16x32_bf16 v[64:67], a[0:3], a[32:35], v[64:67]
    ds_read_b64_tr_b16 a[28:29], v21 offset:41472
    v_mfma_f32_16x16x32_bf16 v[68:71], a[0:3], a[36:39], v[68:71]
    ds_read_b64_tr_b16 a[30:31], v21 offset:43520
    s_add_u32 m0, s32, 0x20000
    v_mfma_f32_16x16x32_bf16 v[72:75], a[4:7], a[32:35], v[72:75]
    ds_read_b64_tr_b16 a[0:1], v20 offset:36864
    buffer_load_dwordx4 v3, s[24:27], s72 offen offset:0 lds
    v_mfma_f32_16x16x32_bf16 v[76:79], a[4:7], a[36:39], v[76:79]
    ds_read_b64_tr_b16 a[2:3], v20 offset:38912
    s_waitcnt lgkmcnt(10)
    v_mfma_f32_16x16x32_bf16 v[80:83], a[8:11], a[32:35], v[80:83]
    ds_read_b64_tr_b16 a[4:5], v21 offset:36864
    v_mfma_f32_16x16x32_bf16 v[84:87], a[8:11], a[36:39], v[84:87]
    ds_read_b64_tr_b16 a[6:7], v21 offset:38912
    v_mfma_f32_16x16x32_bf16 v[88:91], a[12:15], a[32:35], v[88:91]
    ds_read_b64_tr_b16 a[8:9], v20 offset:37376
    buffer_load_dwordx4 a[160:163], v4, s[20:23], s30 offen offset:0 sc1
    v_mfma_f32_16x16x32_bf16 v[92:95], a[12:15], a[36:39], v[92:95]
    ds_read_b64_tr_b16 a[10:11], v20 offset:39424
    s_waitcnt lgkmcnt(10)
    v_mfma_f32_16x16x32_bf16 v[96:99], a[16:19], a[32:35], v[96:99]
    ds_read_b64_tr_b16 a[12:13], v21 offset:37376
    v_mfma_f32_16x16x32_bf16 v[100:103], a[16:19], a[36:39], v[100:103]
    ds_read_b64_tr_b16 a[14:15], v21 offset:39424
    s_add_u32 m0, s32, 0x22000
    v_mfma_f32_16x16x32_bf16 v[104:107], a[20:23], a[32:35], v[104:107]
    ds_read_b64_tr_b16 a[16:17], v20 offset:45056
    buffer_load_dwordx4 v2, s[8:11], s68 offen sc1 lds
    v_mfma_f32_16x16x32_bf16 v[108:111], a[20:23], a[36:39], v[108:111]
    ds_read_b64_tr_b16 a[18:19], v20 offset:47104
    s_waitcnt lgkmcnt(10)
    v_mfma_f32_16x16x32_bf16 v[112:115], a[24:27], a[32:35], v[112:115]
    ds_read_b64_tr_b16 a[20:21], v21 offset:45056
    v_mfma_f32_16x16x32_bf16 v[116:119], a[24:27], a[36:39], v[116:119]
    ds_read_b64_tr_b16 a[22:23], v21 offset:47104
    v_mfma_f32_16x16x32_bf16 v[120:123], a[28:31], a[32:35], v[120:123]
    ds_read_b64_tr_b16 a[24:25], v20 offset:45568
    buffer_load_dwordx4 a[164:167], v4, s[20:23], s30 offen offset:1024 sc1
    v_mfma_f32_16x16x32_bf16 v[124:127], a[28:31], a[36:39], v[124:127]
    ds_read_b64_tr_b16 a[26:27], v20 offset:47616
    s_waitcnt vmcnt(13)
    s_barrier
    s_waitcnt lgkmcnt(10)
    s_add_u32 m0, s32, 0x21000
    v_mfma_f32_16x16x32_bf16 v[64:67], a[0:3], a[40:43], v[64:67]
    ds_read_b64_tr_b16 a[28:29], v21 offset:45568
    buffer_load_dwordx4 v3, s[24:27], s73 offen offset:0 lds
    v_mfma_f32_16x16x32_bf16 v[68:71], a[0:3], a[44:47], v[68:71]
    ds_read_b64_tr_b16 a[30:31], v21 offset:47616
    v_mfma_f32_16x16x32_bf16 v[72:75], a[4:7], a[40:43], v[72:75]
    ds_read_b64_tr_b16 a[0:1], v20 offset:49152
    v_mfma_f32_16x16x32_bf16 v[76:79], a[4:7], a[44:47], v[76:79]
    ds_read_b64_tr_b16 a[2:3], v20 offset:51200
    s_waitcnt lgkmcnt(10)
    v_mfma_f32_16x16x32_bf16 v[80:83], a[8:11], a[40:43], v[80:83]
    ds_read_b64_tr_b16 a[4:5], v21 offset:49152
    buffer_load_dwordx4 a[168:171], v4, s[20:23], s30 offen offset:2048 sc1
    v_mfma_f32_16x16x32_bf16 v[84:87], a[8:11], a[44:47], v[84:87]
    ds_read_b64_tr_b16 a[6:7], v21 offset:51200
    v_mfma_f32_16x16x32_bf16 v[88:91], a[12:15], a[40:43], v[88:91]
    ds_read_b64_tr_b16 a[8:9], v20 offset:49664
    v_mfma_f32_16x16x32_bf16 v[92:95], a[12:15], a[44:47], v[92:95]
    ds_read_b64_tr_b16 a[10:11], v20 offset:51712
    s_waitcnt lgkmcnt(10)
    s_add_u32 m0, s32, 0x23000
    v_mfma_f32_16x16x32_bf16 v[96:99], a[16:19], a[40:43], v[96:99]
    ds_read_b64_tr_b16 a[12:13], v21 offset:49664
    buffer_load_dwordx4 v2, s[8:11], s69 offen sc1 lds
    s_add_u32 s72, s72, 0x20000
    s_add_u32 s73, s72, 0x10000
    s_add_u32 s68, s69, s3
    s_add_u32 s69, s68, s3
    v_mfma_f32_16x16x32_bf16 v[100:103], a[16:19], a[44:47], v[100:103]
    ds_read_b64_tr_b16 a[14:15], v21 offset:51712
    v_mfma_f32_16x16x32_bf16 v[104:107], a[20:23], a[40:43], v[104:107]
    ds_read_b64_tr_b16 a[16:17], v20 offset:57344
    v_mfma_f32_16x16x32_bf16 v[108:111], a[20:23], a[44:47], v[108:111]
    ds_read_b64_tr_b16 a[18:19], v20 offset:59392
    s_waitcnt lgkmcnt(10)
    v_mfma_f32_16x16x32_bf16 v[112:115], a[24:27], a[40:43], v[112:115]
    ds_read_b64_tr_b16 a[20:21], v21 offset:57344
    buffer_load_dwordx4 a[172:175], v4, s[20:23], s30 offen offset:3072 sc1
    s_add_u32 s30, s30, 4096
    v_mfma_f32_16x16x32_bf16 v[116:119], a[24:27], a[44:47], v[116:119]
    ds_read_b64_tr_b16 a[22:23], v21 offset:59392
    v_mfma_f32_16x16x32_bf16 v[120:123], a[28:31], a[40:43], v[120:123]
    ds_read_b64_tr_b16 a[24:25], v20 offset:57856
    s_getpc_b64 s[80:81]
    global_load_dword v28, v0, s[80:81] offset:2048
    v_mfma_f32_16x16x32_bf16 v[124:127], a[28:31], a[44:47], v[124:127]
    ds_read_b64_tr_b16 a[26:27], v20 offset:59904
    s_waitcnt lgkmcnt(10)
    v_mfma_f32_16x16x32_bf16 v[64:67], a[0:3], a[48:51], v[64:67]
    ds_read_b64_tr_b16 a[28:29], v21 offset:57856
    v_mfma_f32_16x16x32_bf16 v[68:71], a[0:3], a[52:55], v[68:71]
    ds_read_b64_tr_b16 a[30:31], v21 offset:59904
    s_add_u32 m0, s32, 0x24000
    v_mfma_f32_16x16x32_bf16 v[72:75], a[4:7], a[48:51], v[72:75]
    ds_read_b64_tr_b16 a[0:1], v20 offset:53248
    buffer_load_dwordx4 v3, s[24:27], s72 offen offset:0 lds
    v_mfma_f32_16x16x32_bf16 v[76:79], a[4:7], a[52:55], v[76:79]
    ds_read_b64_tr_b16 a[2:3], v20 offset:55296
    s_waitcnt lgkmcnt(10)
    v_mfma_f32_16x16x32_bf16 v[80:83], a[8:11], a[48:51], v[80:83]
    ds_read_b64_tr_b16 a[4:5], v21 offset:53248
    v_mfma_f32_16x16x32_bf16 v[84:87], a[8:11], a[52:55], v[84:87]
    ds_read_b64_tr_b16 a[6:7], v21 offset:55296
    v_mfma_f32_16x16x32_bf16 v[88:91], a[12:15], a[48:51], v[88:91]
    ds_read_b64_tr_b16 a[8:9], v20 offset:53760
    buffer_load_dwordx4 a[176:179], v4, s[20:23], s30 offen offset:0 sc1
    v_mfma_f32_16x16x32_bf16 v[92:95], a[12:15], a[52:55], v[92:95]
    ds_read_b64_tr_b16 a[10:11], v20 offset:55808
    s_waitcnt lgkmcnt(10)
    v_mfma_f32_16x16x32_bf16 v[96:99], a[16:19], a[48:51], v[96:99]
    ds_read_b64_tr_b16 a[12:13], v21 offset:53760
    v_mfma_f32_16x16x32_bf16 v[100:103], a[16:19], a[52:55], v[100:103]
    ds_read_b64_tr_b16 a[14:15], v21 offset:55808
    s_add_u32 m0, s32, 0x26000
    v_mfma_f32_16x16x32_bf16 v[104:107], a[20:23], a[48:51], v[104:107]
    ds_read_b64_tr_b16 a[16:17], v20 offset:61440
    buffer_load_dwordx4 v2, s[8:11], s68 offen sc1 lds
    v_mfma_f32_16x16x32_bf16 v[108:111], a[20:23], a[52:55], v[108:111]
    ds_read_b64_tr_b16 a[18:19], v20 offset:63488
    s_waitcnt lgkmcnt(10)
    v_mfma_f32_16x16x32_bf16 v[112:115], a[24:27], a[48:51], v[112:115]
    ds_read_b64_tr_b16 a[20:21], v21 offset:61440
    v_mfma_f32_16x16x32_bf16 v[116:119], a[24:27], a[52:55], v[116:119]
    ds_read_b64_tr_b16 a[22:23], v21 offset:63488
    v_mfma_f32_16x16x32_bf16 v[120:123], a[28:31], a[48:51], v[120:123]
    ds_read_b64_tr_b16 a[24:25], v20 offset:61952
    buffer_load_dwordx4 a[180:183], v4, s[20:23], s30 offen offset:1024 sc1
    v_mfma_f32_16x16x32_bf16 v[124:127], a[28:31], a[52:55], v[124:127]
    ds_read_b64_tr_b16 a[26:27], v20 offset:64000
    s_waitcnt lgkmcnt(10)
    v_mfma_f32_16x16x32_bf16 v[64:67], a[0:3], a[56:59], v[64:67]
    ds_read_b64_tr_b16 a[28:29], v21 offset:61952
    v_mfma_f32_16x16x32_bf16 v[68:71], a[0:3], a[60:63], v[68:71]
    ds_read_b64_tr_b16 a[30:31], v21 offset:64000
    s_add_u32 m0, s32, 0x25000
    v_mfma_f32_16x16x32_bf16 v[72:75], a[4:7], a[56:59], v[72:75]
    ds_read_b64_tr_b16 a[0:1], v22 offset:32768
    buffer_load_dwordx4 v3, s[24:27], s73 offen offset:0 lds
    v_mfma_f32_16x16x32_bf16 v[76:79], a[4:7], a[60:63], v[76:79]
    ds_read_b64_tr_b16 a[2:3], v22 offset:34816
    s_waitcnt vmcnt(22)
    v_cmp_ne_u32 vcc, 0, v9
    s_nop 1
    s_and_b32 s78, vcc_lo, s38
    s_cmp_eq_u32 s78, s38
    s_cbranch_scc1 L_m_poll_2_ok
    s_mov_b32 s79, 0x100000
L_m_poll_2:
    buffer_load_dword v9, v5, s[20:23], s47 offen sc1
    s_waitcnt vmcnt(0)
    v_cmp_ne_u32 vcc, 0, v9
    s_nop 1
    s_and_b32 s78, vcc_lo, s38
    s_cmp_eq_u32 s78, s38
    s_cbranch_scc1 L_m_poll_2_ok
    s_sleep 1
    s_sub_u32 s79, s79, 1
    s_cmp_lg_u32 s79, 0
    s_cbranch_scc1 L_m_poll_2
L_m_poll_2_ok:
    s_waitcnt lgkmcnt(10)
    v_mfma_f32_16x16x32_bf16 v[80:83], a[8:11], a[56:59], v[80:83]
    ds_read_b64_tr_b16 a[4:5], v23 offset:32768
    v_mfma_f32_16x16x32_bf16 v[84:87], a[8:11], a[60:63], v[84:87]
    ds_read_b64_tr_b16 a[6:7], v23 offset:34816
    v_mfma_f32_16x16x32_bf16 v[88:91], a[12:15], a[56:59], v[88:91]
    ds_read_b64_tr_b16 a[8:9], v22 offset:33280
    buffer_load_dwordx4 a[184:187], v4, s[20:23], s30 offen offset:2048 sc1
    v_mfma_f32_16x16x32_bf16 v[92:95], a[12:15], a[60:63], v[92:95]
    ds_read_b64_tr_b16 a[10:11], v22 offset:35328
    s_waitcnt lgkmcnt(10)
    v_mfma_f32_16x16x32_bf16 v[96:99], a[16:19], a[56:59], v[96:99]
    ds_read_b64_tr_b16 a[12:13], v23 offset:33280
    v_mfma_f32_16x16x32_bf16 v[100:103], a[16:19], a[60:63], v[100:103]
    ds_read_b64_tr_b16 a[14:15], v23 offset:35328
    s_add_u32 m0, s32, 0x27000
    v_mfma_f32_16x16x32_bf16 v[104:107], a[20:23], a[56:59], v[104:107]
    ds_read_b64_tr_b16 a[16:17], v22 offset:40960
    buffer_load_dwordx4 v2, s[8:11], s69 offen sc1 lds
    s_add_u32 s72, s72, 0x20000
    s_add_u32 s73, s72, 0x10000
    s_add_u32 s68, s69, s3
    s_add_u32 s69, s68, s3
    v_mfma_f32_16x16x32_bf16 v[108:111], a[20:23], a[60:63], v[108:111]
    ds_read_b64_tr_b16 a[18:19], v22 offset:43008
    s_waitcnt lgkmcnt(10)
    v_mfma_f32_16x16x32_bf16 v[112:115], a[24:27], a[56:59], v[112:115]
    ds_read_b64_tr_b16 a[20:21], v23 offset:40960
    v_mfma_f32_16x16x32_bf16 v[116:119], a[24:27], a[60:63], v[116:119]
    ds_read_b64_tr_b16 a[22:23], v23 offset:43008
    v_mfma_f32_16x16x32_bf16 v[120:123], a[28:31], a[56:59], v[120:123]
    ds_read_b64_tr_b16 a[24:25], v22 offset:41472
    buffer_load_dwordx4 a[188:191], v4, s[20:23], s30 offen offset:3072 sc1
    s_add_u32 s30, s30, 4096
    v_mfma_f32_16x16x32_bf16 v[124:127], a[28:31], a[60:63], v[124:127]
    ds_read_b64_tr_b16 a[26:27], v22 offset:43520
    s_mov_b32 s38, -1
    s_sub_u32 s33, s33, 1
    s_cmp_lg_u32 s33, 0
    s_cbranch_scc1 L_m_loop
    s_waitcnt lgkmcnt(10)
    v_mfma_f32_16x16x32_bf16 v[64:67], a[0:3], a[224:227], v[64:67]
    ds_read_b64_tr_b16 a[28:29], v23 offset:41472
    v_mfma_f32_16x16x32_bf16 v[68:71], a[0:3], a[228:231], v[68:71]
    ds_read_b64_tr_b16 a[30:31], v23 offset:43520
    s_add_u32 m0, s32, 0x0
    v_mfma_f32_16x16x32_bf16 v[72:75], a[4:7], a[224:227], v[72:75]
    ds_read_b64_tr_b16 a[0:1], v22 offset:36864
    buffer_load_dwordx4 v3, s[24:27], s72 offen offset:0 lds
    v_mfma_f32_16x16x32_bf16 v[76:79], a[4:7], a[228:231], v[76:79]
    ds_read_b64_tr_b16 a[2:3], v22 offset:38912
    s_waitcnt lgkmcnt(10)
    v_mfma_f32_16x16x32_bf16 v[80:83], a[8:11], a[224:227], v[80:83]
    ds_read_b64_tr_b16 a[4:5], v23 offset:36864
    v_mfma_f32_16x16x32_bf16 v[84:87], a[8:11], a[228:231], v[84:87]
    ds_read_b64_tr_b16 a[6:7], v23 offset:38912
    v_mfma_f32_16x16x32_bf16 v[88:91], a[12:15], a[224:227], v[88:91]
    ds_read_b64_tr_b16 a[8:9], v22 offset:37376
    buffer_load_dwordx4 a[192:195], v4, s[20:23], s30 offen offset:0 sc1
    v_mfma_f32_16x16x32_bf16 v[92:95], a[12:15], a[228:231], v[92:95]
    ds_read_b64_tr_b16 a[10:11], v22 offset:39424
    s_waitcnt lgkmcnt(10)
    v_mfma_f32_16x16x32_bf16 v[96:99], a[16:19], a[224:227], v[96:99]
    ds_read_b64_tr_b16 a[12:13], v23 offset:37376
    v_mfma_f32_16x16x32_bf16 v[100:103], a[16:19], a[228:231], v[100:103]
    ds_read_b64_tr_b16 a[14:15], v23 offset:39424
    s_add_u32 m0, s32, 0x2000
    v_mfma_f32_16x16x32_bf16 v[104:107], a[20:23], a[224:227], v[104:107]
    ds_read_b64_tr_b16 a[16:17], v22 offset:45056
    buffer_load_dwordx4 v2, s[8:11], s68 offen sc1 lds
    v_mfma_f32_16x16x32_bf16 v[108:111], a[20:23], a[228:231], v[108:111]
    ds_read_b64_tr_b16 a[18:19], v22 offset:47104
    s_waitcnt lgkmcnt(10)
    v_mfma_f32_16x16x32_bf16 v[112:115], a[24:27], a[224:227], v[112:115]
    ds_read_b64_tr_b16 a[20:21], v23 offset:45056
    v_mfma_f32_16x16x32_bf16 v[116:119], a[24:27], a[228:231], v[116:119]
    ds_read_b64_tr_b16 a[22:23], v23 offset:47104
    v_mfma_f32_16x16x32_bf16 v[120:123], a[28:31], a[224:227], v[120:123]
    ds_read_b64_tr_b16 a[24:25], v22 offset:45568
    buffer_load_dwordx4 a[196:199], v4, s[20:23], s30 offen offset:1024 sc1
    v_mfma_f32_16x16x32_bf16 v[124:127], a[28:31], a[228:231], v[124:127]
    ds_read_b64_tr_b16 a[26:27], v22 offset:47616
    s_waitcnt vmcnt(12)
    s_barrier
    s_waitcnt lgkmcnt(10)
    v_mfma_f32_16x16x32_bf16 v[64:67], a[0:3], a[232:235], v[64:67]
    ds_read_b64_tr_b16 a[28:29], v23 offset:45568
    v_mfma_f32_16x16x32_bf16 v[68:71], a[0:3], a[236:239], v[68:71]
    ds_read_b64_tr_b16 a[30:31], v23 offset:47616
    s_add_u32 m0, s32, 0x1000
    v_mfma_f32_16x16x32_bf16 v[72:75], a[4:7], a[232:235], v[72:75]
    ds_read_b64_tr_b16 a[0:1], v22 offset:49152
    buffer_load_dwordx4 v3, s[24:27], s73 offen offset:0 lds
    v_mfma_f32_16x16x32_bf16 v[76:79], a[4:7], a[236:239], v[76:79]
    ds_read_b64_tr_b16 a[2:3], v22 offset:51200
    s_waitcnt lgkmcnt(10)
    v_mfma_f32_16x16x32_bf16 v[80:83], a[8:11], a[232:235], v[80:83]
    ds_read_b64_tr_b16 a[4:5], v23 offset:49152
    v_mfma_f32_16x16x32_bf16 v[84:87], a[8:11], a[236:239], v[84:87]
    ds_read_b64_tr_b16 a[6:7], v23 offset:51200
    v_mfma_f32_16x16x32_bf16 v[88:91], a[12:15], a[232:235], v[88:91]
    ds_read_b64_tr_b16 a[8:9], v22 offset:49664
    buffer_load_dwordx4 a[200:203], v4, s[20:23], s30 offen offset:2048 sc1
    v_mfma_f32_16x16x32_bf16 v[92:95], a[12:15], a[236:239], v[92:95]
    ds_read_b64_tr_b16 a[10:11], v22 offset:51712
    s_waitcnt lgkmcnt(10)
    v_mfma_f32_16x16x32_bf16 v[96:99], a[16:19], a[232:235], v[96:99]
    ds_read_b64_tr_b16 a[12:13], v23 offset:49664
    v_mfma_f32_16x16x32_bf16 v[100:103], a[16:19], a[236:239], v[100:103]
    ds_read_b64_tr_b16 a[14:15], v23 offset:51712
    s_add_u32 m0, s32, 0x3000
    v_mfma_f32_16x16x32_bf16 v[104:107], a[20:23], a[232:235], v[104:107]
    ds_read_b64_tr_b16 a[16:17], v22 offset:57344
    buffer_load_dwordx4 v2, s[8:11], s69 offen sc1 lds
    s_add_u32 s72, s72, 0x20000
    s_add_u32 s73, s72, 0x10000
    s_add_u32 s68, s69, s3
    s_add_u32 s69, s68, s3
    v_mfma_f32_16x16x32_bf16 v[108:111], a[20:23], a[236:239], v[108:111]
    ds_read_b64_tr_b16 a[18:19], v22 offset:59392
    s_waitcnt lgkmcnt(10)
    v_mfma_f32_16x16x32_bf16 v[112:115], a[24:27], a[232:235], v[112:115]
    ds_read_b64_tr_b16 a[20:21], v23 offset:57344
    v_mfma_f32_16x16x32_bf16 v[116:119], a[24:27], a[236:239], v[116:119]
    ds_read_b64_tr_b16 a[22:23], v23 offset:59392
    v_mfma_f32_16x16x32_bf16 v[120:123], a[28:31], a[232:235], v[120:123]
    ds_read_b64_tr_b16 a[24:25], v22 offset:57856
    buffer_load_dwordx4 a[204:207], v4, s[20:23], s30 offen offset:3072 sc1
    s_add_u32 s30, s30, 4096
    v_mfma_f32_16x16x32_bf16 v[124:127], a[28:31], a[236:239], v[124:127]
    ds_read_b64_tr_b16 a[26:27], v22 offset:59904
    s_waitcnt lgkmcnt(10)
    v_mfma_f32_16x16x32_bf16 v[64:67], a[0:3], a[240:243], v[64:67]
    ds_read_b64_tr_b16 a[28:29], v23 offset:57856
    v_mfma_f32_16x16x32_bf16 v[68:71], a[0:3], a[244:247], v[68:71]
    ds_read_b64_tr_b16 a[30:31], v23 offset:59904
    s_add_u32 m0, s32, 0x4000
    v_mfma_f32_16x16x32_bf16 v[72:75], a[4:7], a[240:243], v[72:75]
    ds_read_b64_tr_b16 a[0:1], v22 offset:53248
    buffer_load_dwordx4 v3, s[24:27], s72 offen offset:0 lds
    v_mfma_f32_16x16x32_bf16 v[76:79], a[4:7], a[244:247], v[76:79]
    ds_read_b64_tr_b16 a[2:3], v22 offset:55296
    s_waitcnt lgkmcnt(10)
    v_mfma_f32_16x16x32_bf16 v[80:83], a[8:11], a[240:243], v[80:83]
    ds_read_b64_tr_b16 a[4:5], v23 offset:53248
    v_mfma_f32_16x16x32_bf16 v[84:87], a[8:11], a[244:247], v[84:87]
    ds_read_b64_tr_b16 a[6:7], v23 offset:55296
    v_mfma_f32_16x16x32_bf16 v[88:91], a[12:15], a[240:243], v[88:91]
    ds_read_b64_tr_b16 a[8:9], v22 offset:53760
    buffer_load_dwordx4 a[208:211], v4, s[20:23], s30 offen offset:0 sc1
    v_mfma_f32_16x16x32_bf16 v[92:95], a[12:15], a[244:247], v[92:95]
    ds_read_b64_tr_b16 a[10:11], v22 offset:55808
    s_waitcnt lgkmcnt(10)
    v_mfma_f32_16x16x32_bf16 v[96:99], a[16:19], a[240:243], v[96:99]
    ds_read_b64_tr_b16 a[12:13], v23 offset:53760
    v_mfma_f32_16x16x32_bf16 v[100:103], a[16:19], a[244:247], v[100:103]
    ds_read_b64_tr_b16 a[14:15], v23 offset:55808
    s_add_u32 m0, s32, 0x6000
    v_mfma_f32_16x16x32_bf16 v[104:107], a[20:23], a[240:243], v[104:107]
    ds_read_b64_tr_b16 a[16:17], v22 offset:61440
    buffer_load_dwordx4 v2, s[8:11], s68 offen sc1 lds
    v_mfma_f32_16x16x32_bf16 v[108:111], a[20:23], a[244:247], v[108:111]
    ds_read_b64_tr_b16 a[18:19], v22 offset:63488
    s_waitcnt lgkmcnt(10)
    v_mfma_f32_16x16x32_bf16 v[112:115], a[24:27], a[240:243], v[112:115]
    ds_read_b64_tr_b16 a[20:21], v23 offset:61440
    v_mfma_f32_16x16x32_bf16 v[116:119], a[24:27], a[244:247], v[116:119]
    ds_read_b64_tr_b16 a[22:23], v23 offset:63488
    v_mfma_f32_16x16x32_bf16 v[120:123], a[28:31], a[240:243], v[120:123]
    ds_read_b64_tr_b16 a[24:25], v22 offset:61952
    buffer_load_dwordx4 a[212:215], v4, s[20:23], s30 offen offset:1024 sc1
    v_mfma_f32_16x16x32_bf16 v[124:127], a[28:31], a[244:247], v[124:127]
    ds_read_b64_tr_b16 a[26:27], v22 offset:64000
    s_waitcnt lgkmcnt(10)
    v_mfma_f32_16x16x32_bf16 v[64:67], a[0:3], a[248:251], v[64:67]
    ds_read_b64_tr_b16 a[28:29], v23 offset:61952
    v_mfma_f32_16x16x32_bf16 v[68:71], a[0:3], a[252:255], v[68:71]
    ds_read_b64_tr_b16 a[30:31], v23 offset:64000
    s_add_u32 m0, s32, 0x5000
    v_mfma_f32_16x16x32_bf16 v[72:75], a[4:7], a[248:251], v[72:75]
    ds_read_b64_tr_b16 a[0:1], v24 offset:0
    buffer_load_dwordx4 v3, s[24:27], s73 offen offset:0 lds
    v_mfma_f32_16x16x32_bf16 v[76:79], a[4:7], a[252:255], v[76:79]
    ds_read_b64_tr_b16 a[2:3], v24 offset:2048
    s_waitcnt lgkmcnt(10)
    v_mfma_f32_16x16x32_bf16 v[80:83], a[8:11], a[248:251], v[80:83]
    ds_read_b64_tr_b16 a[4:5], v25 offset:0
    v_mfma_f32_16x16x32_bf16 v[84:87], a[8:11], a[252:255], v[84:87]
    ds_read_b64_tr_b16 a[6:7], v25 offset:2048
    v_mfma_f32_16x16x32_bf16 v[88:91], a[12:15], a[248:251], v[88:91]
    ds_read_b64_tr_b16 a[8:9], v24 offset:512
    buffer_load_dwordx4 a[216:219], v4, s[20:23], s30 offen offset:2048 sc1
    v_mfma_f32_16x16x32_bf16 v[92:95], a[12:15], a[252:255], v[92:95]
    ds_read_b64_tr_b16 a[10:11], v24 offset:2560
    s_waitcnt lgkmcnt(10)
    v_mfma_f32_16x16x32_bf16 v[96:99], a[16:19], a[248:251], v[96:99]
    ds_read_b64_tr_b16 a[12:13], v25 offset:512
    v_mfma_f32_16x16x32_bf16 v[100:103], a[16:19], a[252:255], v[100:103]
    ds_read_b64_tr_b16 a[14:15], v25 offset:2560
    s_add_u32 m0, s32, 0x7000
    v_mfma_f32_16x16x32_bf16 v[104:107], a[20:23], a[248:251], v[104:107]
    ds_read_b64_tr_b16 a[16:17], v24 offset:8192
    buffer_load_dwordx4 v2, s[8:11], s69 offen sc1 lds
    s_add_u32 s72, s72, 0x20000
    s_add_u32 s73, s72, 0x10000
    s_add_u32 s68, s69, s3
    s_add_u32 s69, s68, s3
    v_mfma_f32_16x16x32_bf16 v[108:111], a[20:23], a[252:255], v[108:111]
    ds_read_b64_tr_b16 a[18:19], v24 offset:10240
    s_waitcnt lgkmcnt(10)
    v_mfma_f32_16x16x32_bf16 v[112:115], a[24:27], a[248:251], v[112:115]
    ds_read_b64_tr_b16 a[20:21], v25 offset:8192
    v_mfma_f32_16x16x32_bf16 v[116:119], a[24:27], a[252:255], v[116:119]
    ds_read_b64_tr_b16 a[22:23], v25 offset:10240
    v_mfma_f32_16x16x32_bf16 v[120:123], a[28:31], a[248:251], v[120:123]
    ds_read_b64_tr_b16 a[24:25], v24 offset:8704
    buffer_load_dwordx4 a[220:223], v4, s[20:23], s30 offen offset:3072 sc1
    s_add_u32 s30, s30, 4096
    v_mfma_f32_16x16x32_bf16 v[124:127], a[28:31], a[252:255], v[124:127]
    ds_read_b64_tr_b16 a[26:27], v24 offset:10752
    s_waitcnt lgkmcnt(10)
    v_mfma_f32_16x16x32_bf16 v[64:67], a[0:3], a[160:163], v[64:67]
    ds_read_b64_tr_b16 a[28:29], v25 offset:8704
    v_mfma_f32_16x16x32_bf16 v[68:71], a[0:3], a[164:167], v[68:71]
    ds_read_b64_tr_b16 a[30:31], v25 offset:10752
    s_add_u32 m0, s32, 0x8000
    v_mfma_f32_16x16x32_bf16 v[72:75], a[4:7], a[160:163], v[72:75]
    ds_read_b64_tr_b16 a[0:1], v24 offset:4096
    buffer_load_dwordx4 v3, s[24:27], s72 offen offset:0 lds
    v_mfma_f32_16x16x32_bf16 v[76:79], a[4:7], a[164:167], v[76:79]
    ds_read_b64_tr_b16 a[2:3], v24 offset:6144
    s_waitcnt lgkmcnt(10)
    v_mfma_f32_16x16x32_bf16 v[80:83], a[8:11], a[160:163], v[80:83]
    ds_read_b64_tr_b16 a[4:5], v25 offset:4096
    v_mfma_f32_16x16x32_bf16 v[84:87], a[8:11], a[164:167], v[84:87]
    ds_read_b64_tr_b16 a[6:7], v25 offset:6144
    v_mfma_f32_16x16x32_bf16 v[88:91], a[12:15], a[160:163], v[88:91]
    ds_read_b64_tr_b16 a[8:9], v24 offset:4608
    buffer_load_dwordx4 a[32:35], v4, s[20:23], s30 offen offset:0 sc1
    v_mfma_f32_16x16x32_bf16 v[92:95], a[12:15], a[164:167], v[92:95]
    ds_read_b64_tr_b16 a[10:11], v24 offset:6656
    s_waitcnt lgkmcnt(10)
    v_mfma_f32_16x16x32_bf16 v[96:99], a[16:19], a[160:163], v[96:99]
    ds_read_b64_tr_b16 a[12:13], v25 offset:4608
    v_mfma_f32_16x16x32_bf16 v[100:103], a[16:19], a[164:167], v[100:103]
    ds_read_b64_tr_b16 a[14:15], v25 offset:6656
    s_add_u32 m0, s32, 0xa000
    v_mfma_f32_16x16x32_bf16 v[104:107], a[20:23], a[160:163], v[104:107]
    ds_read_b64_tr_b16 a[16:17], v24 offset:12288
    buffer_load_dwordx4 v2, s[8:11], s68 offen sc1 lds
    v_mfma_f32_16x16x32_bf16 v[108:111], a[20:23], a[164:167], v[108:111]
    ds_read_b64_tr_b16 a[18:19], v24 offset:14336
    s_waitcnt lgkmcnt(10)
    v_mfma_f32_16x16x32_bf16 v[112:115], a[24:27], a[160:163], v[112:115]
    ds_read_b64_tr_b16 a[20:21], v25 offset:12288
    v_mfma_f32_16x16x32_bf16 v[116:119], a[24:27], a[164:167], v[116:119]
    ds_read_b64_tr_b16 a[22:23], v25 offset:14336
    v_mfma_f32_16x16x32_bf16 v[120:123], a[28:31], a[160:163], v[120:123]
    ds_read_b64_tr_b16 a[24:25], v24 offset:12800
    buffer_load_dwordx4 a[36:39], v4, s[20:23], s30 offen offset:1024 sc1
    v_mfma_f32_16x16x32_bf16 v[124:127], a[28:31], a[164:167], v[124:127]
    ds_read_b64_tr_b16 a[26:27], v24 offset:14848
    s_waitcnt vmcnt(12)
    s_barrier
    s_waitcnt lgkmcnt(10)
    v_mfma_f32_16x16x32_bf16 v[64:67], a[0:3], a[168:171], v[64:67]
    ds_read_b64_tr_b16 a[28:29], v25 offset:12800
    v_mfma_f32_16x16x32_bf16 v[68:71], a[0:3], a[172:175], v[68:71]
    ds_read_b64_tr_b16 a[30:31], v25 offset:14848
    s_add_u32 m0, s32, 0x9000
    v_mfma_f32_16x16x32_bf16 v[72:75], a[4:7], a[168:171], v[72:75]
    ds_read_b64_tr_b16 a[0:1], v24 offset:16384
    buffer_load_dwordx4 v3, s[24:27], s73 offen offset:0 lds
    v_mfma_f32_16x16x32_bf16 v[76:79], a[4:7], a[172:175], v[76:79]
    ds_read_b64_tr_b16 a[2:3], v24 offset:18432
    s_waitcnt lgkmcnt(10)
    v_mfma_f32_16x16x32_bf16 v[80:83], a[8:11], a[168:171], v[80:83]
    ds_read_b64_tr_b16 a[4:5], v25 offset:16384
    v_mfma_f32_16x16x32_bf16 v[84:87], a[8:11], a[172:175], v[84:87]
    ds_read_b64_tr_b16 a[6:7], v25 offset:18432
    v_mfma_f32_16x16x32_bf16 v[88:91], a[12:15], a[168:171], v[88:91]
    ds_read_b64_tr_b16 a[8:9], v24 offset:16896
    buffer_load_dwordx4 a[40:43], v4, s[20:23], s30 offen offset:2048 sc1
    v_mfma_f32_16x16x32_bf16 v[92:95], a[12:15], a[172:175], v[92:95]
    ds_read_b64_tr_b16 a[10:11], v24 offset:18944
    s_waitcnt lgkmcnt(10)
    v_mfma_f32_16x16x32_bf16 v[96:99], a[16:19], a[168:171], v[96:99]
    ds_read_b64_tr_b16 a[12:13], v25 offset:16896
    v_mfma_f32_16x16x32_bf16 v[100:103], a[16:19], a[172:175], v[100:103]
    ds_read_b64_tr_b16 a[14:15], v25 offset:18944
    s_add_u32 m0, s32, 0xb000
    v_mfma_f32_16x16x32_bf16 v[104:107], a[20:23], a[168:171], v[104:107]
    ds_read_b64_tr_b16 a[16:17], v24 offset:24576
    buffer_load_dwordx4 v2, s[8:11], s69 offen sc1 lds
    s_add_u32 s72, s72, 0x20000
    s_add_u32 s73, s72, 0x10000
    s_add_u32 s68, s69, s3
    s_add_u32 s69, s68, s3
    v_mfma_f32_16x16x32_bf16 v[108:111], a[20:23], a[172:175], v[108:111]
    ds_read_b64_tr_b16 a[18:19], v24 offset:26624
    s_waitcnt lgkmcnt(10)
    v_mfma_f32_16x16x32_bf16 v[112:115], a[24:27], a[168:171], v[112:115]
    ds_read_b64_tr_b16 a[20:21], v25 offset:24576
    v_mfma_f32_16x16x32_bf16 v[116:119], a[24:27], a[172:175], v[116:119]
    ds_read_b64_tr_b16 a[22:23], v25 offset:26624
    v_mfma_f32_16x16x32_bf16 v[120:123], a[28:31], a[168:171], v[120:123]
    ds_read_b64_tr_b16 a[24:25], v24 offset:25088
    buffer_load_dwordx4 a[44:47], v4, s[20:23], s30 offen offset:3072 sc1
    s_add_u32 s30, s30, 4096
    v_mfma_f32_16x16x32_bf16 v[124:127], a[28:31], a[172:175], v[124:127]
    ds_read_b64_tr_b16 a[26:27], v24 offset:27136
    s_waitcnt lgkmcnt(10)
    s_add_u32 m0, s32, 0xc000
    v_mfma_f32_16x16x32_bf16 v[64:67], a[0:3], a[176:179], v[64:67]
    ds_read_b64_tr_b16 a[28:29], v25 offset:25088
    buffer_load_dwordx4 v3, s[24:27], s72 offen offset:0 lds
    v_mfma_f32_16x16x32_bf16 v[68:71], a[0:3], a[180:183], v[68:71]
    ds_read_b64_tr_b16 a[30:31], v25 offset:27136
    v_mfma_f32_16x16x32_bf16 v[72:75], a[4:7], a[176:179], v[72:75]
    ds_read_b64_tr_b16 a[0:1], v24 offset:20480
    buffer_load_dwordx4 a[48:51], v4, s[20:23], s30 offen offset:0 sc1
    v_mfma_f32_16x16x32_bf16 v[76:79], a[4:7], a[180:183], v[76:79]
    ds_read_b64_tr_b16 a[2:3], v24 offset:22528
    s_waitcnt lgkmcnt(10)
    s_add_u32 m0, s32, 0xe000
    v_mfma_f32_16x16x32_bf16 v[80:83], a[8:11], a[176:179], v[80:83]
    ds_read_b64_tr_b16 a[4:5], v25 offset:20480
    buffer_load_dwordx4 v2, s[8:11], s68 offen sc1 lds
    v_mfma_f32_16x16x32_bf16 v[84:87], a[8:11], a[180:183], v[84:87]
    ds_read_b64_tr_b16 a[6:7], v25 offset:22528
    v_mfma_f32_16x16x32_bf16 v[88:91], a[12:15], a[176:179], v[88:91]
    ds_read_b64_tr_b16 a[8:9], v24 offset:20992
    buffer_load_dwordx4 a[52:55], v4, s[20:23], s30 offen offset:1024 sc1
    v_mfma_f32_16x16x32_bf16 v[92:95], a[12:15], a[180:183], v[92:95]
    ds_read_b64_tr_b16 a[10:11], v24 offset:23040
    s_waitcnt lgkmcnt(10)
    s_add_u32 m0, s32, 0xd000
    v_mfma_f32_16x16x32_bf16 v[96:99], a[16:19], a[176:179], v[96:99]
    ds_read_b64_tr_b16 a[12:13], v25 offset:20992
    buffer_load_dwordx4 v3, s[24:27], s73 offen offset:0 lds
    v_mfma_f32_16x16x32_bf16 v[100:103], a[16:19], a[180:183], v[100:103]
    ds_read_b64_tr_b16 a[14:15], v25 offset:23040
    v_mfma_f32_16x16x32_bf16 v[104:107], a[20:23], a[176:179], v[104:107]
    ds_read_b64_tr_b16 a[16:17], v24 offset:28672
    buffer_load_dwordx4 a[56:59], v4, s[20:23], s30 offen offset:2048 sc1
    v_mfma_f32_16x16x32_bf16 v[108:111], a[20:23], a[180:183], v[108:111]
    ds_read_b64_tr_b16 a[18:19], v24 offset:30720
    s_waitcnt lgkmcnt(10)
    s_add_u32 m0, s32, 0xf000
    v_mfma_f32_16x16x32_bf16 v[112:115], a[24:27], a[176:179], v[112:115]
    ds_read_b64_tr_b16 a[20:21], v25 offset:28672
    buffer_load_dwordx4 v2, s[8:11], s69 offen sc1 lds
    s_add_u32 s72, s72, 0x20000
    s_add_u32 s73, s72, 0x10000
    v_mfma_f32_16x16x32_bf16 v[116:119], a[24:27], a[180:183], v[116:119]
    ds_read_b64_tr_b16 a[22:23], v25 offset:30720
    v_mfma_f32_16x16x32_bf16 v[120:123], a[28:31], a[176:179], v[120:123]
    ds_read_b64_tr_b16 a[24:25], v24 offset:29184
    buffer_load_dwordx4 a[60:63], v4, s[20:23], s30 offen offset:3072 sc1
    s_add_u32 s30, s30, 4096
    s_add_u32 s65, s65, 1
    s_add_u32 s78, s65, s74
    s_and_b32 s78, s78, 3
    s_lshl_b32 s79, s78, 1
    s_add_u32 s79, s79, 1
    s_lshl_b32 s7, s65, 1
    s_sub_u32 s7, s7, 8
    s_cmp_lt_u32 s65, 4
    s_cselect_b32 s78, s78, s65
    s_cselect_b32 s79, s79, s7
    s_lshl_b32 s78, s78, 15
    s_add_u32 s78, s78, s4
    s_lshl_b32 s79, s79, 20
    s_add_u32 s79, s79, s75
    s_cmp_eq_u32 s51, 0
    s_cselect_b32 s30, s78, s30
    s_cselect_b32 s72, s79, s72
    s_add_u32 s73, s72, 0x10000
    s_sub_u32 s68, s72, s75
    s_lshr_b32 s68, s68, s49
    s_add_u32 s68, s68, s52
    s_add_u32 s69, s68, s3
    v_mfma_f32_16x16x32_bf16 v[124:127], a[28:31], a[180:183], v[124:127]
    ds_read_b64_tr_b16 a[26:27], v24 offset:31232
    s_waitcnt lgkmcnt(10)
    v_mfma_f32_16x16x32_bf16 v[64:67], a[0:3], a[184:187], v[64:67]
    ds_read_b64_tr_b16 a[28:29], v25 offset:29184
    buffer_load_dwordx4 v[128:131], v11, s[16:19], s28 offen offset:0
    v_mfma_f32_16x16x32_bf16 v[68:71], a[0:3], a[188:191], v[68:71]
    ds_read_b64_tr_b16 a[30:31], v25 offset:31232
    v_mfma_f32_16x16x32_bf16 v[72:75], a[4:7], a[184:187], v[72:75]
    ds_read_b64_tr_b16 a[0:1], v20 offset:0
    buffer_load_dwordx4 v[132:135], v11, s[16:19], s29 offen offset:0
    v_mfma_f32_16x16x32_bf16 v[76:79], a[4:7], a[188:191], v[76:79]
    ds_read_b64_tr_b16 a[2:3], v20 offset:2048
    s_waitcnt lgkmcnt(10)
    v_mfma_f32_16x16x32_bf16 v[80:83], a[8:11], a[184:187], v[80:83]
    ds_read_b64_tr_b16 a[4:5], v21 offset:0
    buffer_load_dwordx4 v[136:139], v11, s[16:19], s28 offen offset:64
    v_mfma_f32_16x16x32_bf16 v[84:87], a[8:11], a[188:191], v[84:87]
    ds_read_b64_tr_b16 a[6:7], v21 offset:2048
    v_mfma_f32_16x16x32_bf16 v[88:91], a[12:15], a[184:187], v[88:91]
    ds_read_b64_tr_b16 a[8:9], v20 offset:512
    buffer_load_dwordx4 v[140:143], v11, s[16:19], s29 offen offset:64
    v_mfma_f32_16x16x32_bf16 v[92:95], a[12:15], a[188:191], v[92:95]
    ds_read_b64_tr_b16 a[10:11], v20 offset:2560
    s_waitcnt lgkmcnt(10)
    v_mfma_f32_16x16x32_bf16 v[96:99], a[16:19], a[184:187], v[96:99]
    ds_read_b64_tr_b16 a[12:13], v21 offset:512
    buffer_load_dwordx4 v[144:147], v11, s[16:19], s28 offen offset:128
    v_mfma_f32_16x16x32_bf16 v[100:103], a[16:19], a[188:191], v[100:103]
    ds_read_b64_tr_b16 a[14:15], v21 offset:2560
    v_mfma_f32_16x16x32_bf16 v[104:107], a[20:23], a[184:187], v[104:107]
    ds_read_b64_tr_b16 a[16:17], v20 offset:8192
    buffer_load_dwordx4 v[148:151], v11, s[16:19], s29 offen offset:128
    v_mfma_f32_16x16x32_bf16 v[108:111], a[20:23], a[188:191], v[108:111]
    ds_read_b64_tr_b16 a[18:19], v20 offset:10240
    s_waitcnt lgkmcnt(10)
    v_mfma_f32_16x16x32_bf16 v[112:115], a[24:27], a[184:187], v[112:115]
    ds_read_b64_tr_b16 a[20:21], v21 offset:8192
    buffer_load_dwordx4 v[152:155], v11, s[16:19], s28 offen offset:192
    v_mfma_f32_16x16x32_bf16 v[116:119], a[24:27], a[188:191], v[116:119]
    ds_read_b64_tr_b16 a[22:23], v21 offset:10240
    v_mfma_f32_16x16x32_bf16 v[120:123], a[28:31], a[184:187], v[120:123]
    ds_read_b64_tr_b16 a[24:25], v20 offset:8704
    buffer_load_dwordx4 v[156:159], v11, s[16:19], s29 offen offset:192
    v_mfma_f32_16x16x32_bf16 v[124:127], a[28:31], a[188:191], v[124:127]
    ds_read_b64_tr_b16 a[26:27], v20 offset:10752
    s_waitcnt lgkmcnt(10)
    v_mfma_f32_16x16x32_bf16 v[64:67], a[0:3], a[192:195], v[64:67]
    ds_read_b64_tr_b16 a[28:29], v21 offset:8704
    v_mfma_f32_16x16x32_bf16 v[68:71], a[0:3], a[196:199], v[68:71]
    ds_read_b64_tr_b16 a[30:31], v21 offset:10752
    v_mfma_f32_16x16x32_bf16 v[72:75], a[4:7], a[192:195], v[72:75]
    ds_read_b64_tr_b16 a[0:1], v20 offset:4096
    v_mfma_f32_16x16x32_bf16 v[76:79], a[4:7], a[196:199], v[76:79]
    ds_read_b64_tr_b16 a[2:3], v20 offset:6144
    s_waitcnt lgkmcnt(10)
    v_mfma_f32_16x16x32_bf16 v[80:83], a[8:11], a[192:195], v[80:83]
    ds_read_b64_tr_b16 a[4:5], v21 offset:4096
    v_mfma_f32_16x16x32_bf16 v[84:87], a[8:11], a[196:199], v[84:87]
    ds_read_b64_tr_b16 a[6:7], v21 offset:6144
    v_mfma_f32_16x16x32_bf16 v[88:91], a[12:15], a[192:195], v[88:91]
    ds_read_b64_tr_b16 a[8:9], v20 offset:4608
    v_mfma_f32_16x16x32_bf16 v[92:95], a[12:15], a[196:199], v[92:95]
    ds_read_b64_tr_b16 a[10:11], v20 offset:6656
    s_waitcnt lgkmcnt(10)
    v_mfma_f32_16x16x32_bf16 v[96:99], a[16:19], a[192:195], v[96:99]
    ds_read_b64_tr_b16 a[12:13], v21 offset:4608
    v_mfma_f32_16x16x32_bf16 v[100:103], a[16:19], a[196:199], v[100:103]
    ds_read_b64_tr_b16 a[14:15], v21 offset:6656
    v_mfma_f32_16x16x32_bf16 v[104:107], a[20:23], a[192:195], v[104:107]
    ds_read_b64_tr_b16 a[16:17], v20 offset:12288
    v_mfma_f32_16x16x32_bf16 v[108:111], a[20:23], a[196:199], v[108:111]
    ds_read_b64_tr_b16 a[18:19], v20 offset:14336
    s_waitcnt lgkmcnt(10)
    v_mfma_f32_16x16x32_bf16 v[112:115], a[24:27], a[192:195], v[112:115]
    ds_read_b64_tr_b16 a[20:21], v21 offset:12288
    v_mfma_f32_16x16x32_bf16 v[116:119], a[24:27], a[196:199], v[116:119]
    ds_read_b64_tr_b16 a[22:23], v21 offset:14336
    v_mfma_f32_16x16x32_bf16 v[120:123], a[28:31], a[192:195], v[120:123]
    ds_read_b64_tr_b16 a[24:25], v20 offset:12800
    v_mfma_f32_16x16x32_bf16 v[124:127], a[28:31], a[196:199], v[124:127]
    ds_read_b64_tr_b16 a[26:27], v20 offset:14848
    s_waitcnt vmcnt(16)
    s_barrier
    s_waitcnt lgkmcnt(10)
    v_mfma_f32_16x16x32_bf16 v[64:67], a[0:3], a[200:203], v[64:67]
    ds_read_b64_tr_b16 a[28:29], v21 offset:12800
    v_mfma_f32_16x16x32_bf16 v[68:71], a[0:3], a[204:207], v[68:71]
    ds_read_b64_tr_b16 a[30:31], v21 offset:14848
    v_mfma_f32_16x16x32_bf16 v[72:75], a[4:7], a[200:203], v[72:75]
    ds_read_b64_tr_b16 a[0:1], v20 offset:16384
    v_mfma_f32_16x16x32_bf16 v[76:79], a[4:7], a[204:207], v[76:79]
    ds_read_b64_tr_b16 a[2:3], v20 offset:18432
    s_waitcnt lgkmcnt(10)
    v_mfma_f32_16x16x32_bf16 v[80:83], a[8:11], a[200:203], v[80:83]
    ds_read_b64_tr_b16 a[4:5], v21 offset:16384
    v_mfma_f32_16x16x32_bf16 v[84:87], a[8:11], a[204:207], v[84:87]
    ds_read_b64_tr_b16 a[6:7], v21 offset:18432
    v_mfma_f32_16x16x32_bf16 v[88:91], a[12:15], a[200:203], v[88:91]
    ds_read_b64_tr_b16 a[8:9], v20 offset:16896
    v_mfma_f32_16x16x32_bf16 v[92:95], a[12:15], a[204:207], v[92:95]
    ds_read_b64_tr_b16 a[10:11], v20 offset:18944
    s_waitcnt lgkmcnt(10)
    v_mfma_f32_16x16x32_bf16 v[96:99], a[16:19], a[200:203], v[96:99]
    ds_read_b64_tr_b16 a[12:13], v21 offset:16896
    v_mfma_f32_16x16x32_bf16 v[100:103], a[16:19], a[204:207], v[100:103]
    ds_read_b64_tr_b16 a[14:15], v21 offset:18944
    v_mfma_f32_16x16x32_bf16 v[104:107], a[20:23], a[200:203], v[104:107]
    ds_read_b64_tr_b16 a[16:17], v20 offset:24576
    v_mfma_f32_16x16x32_bf16 v[108:111], a[20:23], a[204:207], v[108:111]
    ds_read_b64_tr_b16 a[18:19], v20 offset:26624
    s_waitcnt lgkmcnt(10)
    v_mfma_f32_16x16x32_bf16 v[112:115], a[24:27], a[200:203], v[112:115]
    ds_read_b64_tr_b16 a[20:21], v21 offset:24576
    v_mfma_f32_16x16x32_bf16 v[116:119], a[24:27], a[204:207], v[116:119]
    ds_read_b64_tr_b16 a[22:23], v21 offset:26624
    v_mfma_f32_16x16x32_bf16 v[120:123], a[28:31], a[200:203], v[120:123]
    ds_read_b64_tr_b16 a[24:25], v20 offset:25088
    v_mfma_f32_16x16x32_bf16 v[124:127], a[28:31], a[204:207], v[124:127]
    ds_read_b64_tr_b16 a[26:27], v20 offset:27136
    s_waitcnt lgkmcnt(10)
    v_mfma_f32_16x16x32_bf16 v[64:67], a[0:3], a[208:211], v[64:67]
    ds_read_b64_tr_b16 a[28:29], v21 offset:25088
    v_mfma_f32_16x16x32_bf16 v[68:71], a[0:3], a[212:215], v[68:71]
    ds_read_b64_tr_b16 a[30:31], v21 offset:27136
    v_mfma_f32_16x16x32_bf16 v[72:75], a[4:7], a[208:211], v[72:75]
    ds_read_b64_tr_b16 a[0:1], v20 offset:20480
    v_mfma_f32_16x16x32_bf16 v[76:79], a[4:7], a[212:215], v[76:79]
    ds_read_b64_tr_b16 a[2:3], v20 offset:22528
    s_waitcnt lgkmcnt(10)
    v_mfma_f32_16x16x32_bf16 v[80:83], a[8:11], a[208:211], v[80:83]
    ds_read_b64_tr_b16 a[4:5], v21 offset:20480
    v_mfma_f32_16x16x32_bf16 v[84:87], a[8:11], a[212:215], v[84:87]
    ds_read_b64_tr_b16 a[6:7], v21 offset:22528
    v_mfma_f32_16x16x32_bf16 v[88:91], a[12:15], a[208:211], v[88:91]
    ds_read_b64_tr_b16 a[8:9], v20 offset:20992
    v_mfma_f32_16x16x32_bf16 v[92:95], a[12:15], a[212:215], v[92:95]
    ds_read_b64_tr_b16 a[10:11], v20 offset:23040
    s_waitcnt lgkmcnt(10)
    v_mfma_f32_16x16x32_bf16 v[96:99], a[16:19], a[208:211], v[96:99]
    ds_read_b64_tr_b16 a[12:13], v21 offset:20992
    v_mfma_f32_16x16x32_bf16 v[100:103], a[16:19], a[212:215], v[100:103]
    ds_read_b64_tr_b16 a[14:15], v21 offset:23040
    v_mfma_f32_16x16x32_bf16 v[104:107], a[20:23], a[208:211], v[104:107]
    ds_read_b64_tr_b16 a[16:17], v20 offset:28672
    v_mfma_f32_16x16x32_bf16 v[108:111], a[20:23], a[212:215], v[108:111]
    ds_read_b64_tr_b16 a[18:19], v20 offset:30720
    s_waitcnt lgkmcnt(10)
    v_mfma_f32_16x16x32_bf16 v[112:115], a[24:27], a[208:211], v[112:115]
    ds_read_b64_tr_b16 a[20:21], v21 offset:28672
    v_mfma_f32_16x16x32_bf16 v[116:119], a[24:27], a[212:215], v[116:119]
    ds_read_b64_tr_b16 a[22:23], v21 offset:30720
    v_mfma_f32_16x16x32_bf16 v[120:123], a[28:31], a[208:211], v[120:123]
    ds_read_b64_tr_b16 a[24:25], v20 offset:29184
    v_mfma_f32_16x16x32_bf16 v[124:127], a[28:31], a[212:215], v[124:127]
    ds_read_b64_tr_b16 a[26:27], v20 offset:31232
    s_waitcnt lgkmcnt(10)
    v_mfma_f32_16x16x32_bf16 v[64:67], a[0:3], a[216:219], v[64:67]
    ds_read_b64_tr_b16 a[28:29], v21 offset:29184
    v_mfma_f32_16x16x32_bf16 v[68:71], a[0:3], a[220:223], v[68:71]
    ds_read_b64_tr_b16 a[30:31], v21 offset:31232
    v_mfma_f32_16x16x32_bf16 v[72:75], a[4:7], a[216:219], v[72:75]
    ds_read_b64_tr_b16 a[0:1], v20 offset:32768
    v_mfma_f32_16x16x32_bf16 v[76:79], a[4:7], a[220:223], v[76:79]
    ds_read_b64_tr_b16 a[2:3], v20 offset:34816
    s_waitcnt lgkmcnt(10)
    v_mfma_f32_16x16x32_bf16 v[80:83], a[8:11], a[216:219], v[80:83]
    ds_read_b64_tr_b16 a[4:5], v21 offset:32768
    v_mfma_f32_16x16x32_bf16 v[84:87], a[8:11], a[220:223], v[84:87]
    ds_read_b64_tr_b16 a[6:7], v21 offset:34816
    v_mfma_f32_16x16x32_bf16 v[88:91], a[12:15], a[216:219], v[88:91]
    ds_read_b64_tr_b16 a[8:9], v20 offset:33280
    v_mfma_f32_16x16x32_bf16 v[92:95], a[12:15], a[220:223], v[92:95]
    ds_read_b64_tr_b16 a[10:11], v20 offset:35328
    s_waitcnt lgkmcnt(10)
    v_mfma_f32_16x16x32_bf16 v[96:99], a[16:19], a[216:219], v[96:99]
    ds_read_b64_tr_b16 a[12:13], v21 offset:33280
    v_mfma_f32_16x16x32_bf16 v[100:103], a[16:19], a[220:223], v[100:103]
    ds_read_b64_tr_b16 a[14:15], v21 offset:35328
    v_mfma_f32_16x16x32_bf16 v[104:107], a[20:23], a[216:219], v[104:107]
    ds_read_b64_tr_b16 a[16:17], v20 offset:40960
    v_mfma_f32_16x16x32_bf16 v[108:111], a[20:23], a[220:223], v[108:111]
    ds_read_b64_tr_b16 a[18:19], v20 offset:43008
    s_waitcnt lgkmcnt(10)
    v_mfma_f32_16x16x32_bf16 v[112:115], a[24:27], a[216:219], v[112:115]
    ds_read_b64_tr_b16 a[20:21], v21 offset:40960
    v_mfma_f32_16x16x32_bf16 v[116:119], a[24:27], a[220:223], v[116:119]
    ds_read_b64_tr_b16 a[22:23], v21 offset:43008
    v_mfma_f32_16x16x32_bf16 v[120:123], a[28:31], a[216:219], v[120:123]
    ds_read_b64_tr_b16 a[24:25], v20 offset:41472
    buffer_load_dword v12, off, s[20:23], s31 sc1
    v_mfma_f32_16x16x32_bf16 v[124:127], a[28:31], a[220:223], v[124:127]
    ds_read_b64_tr_b16 a[26:27], v20 offset:43520
    s_waitcnt lgkmcnt(10)
    v_mfma_f32_16x16x32_bf16 v[64:67], a[0:3], a[32:35], v[64:67]
    ds_read_b64_tr_b16 a[28:29], v21 offset:41472
    v_mfma_f32_16x16x32_bf16 v[68:71], a[0:3], a[36:39], v[68:71]
    ds_read_b64_tr_b16 a[30:31], v21 offset:43520
    v_mfma_f32_16x16x32_bf16 v[72:75], a[4:7], a[32:35], v[72:75]
    ds_read_b64_tr_b16 a[0:1], v20 offset:36864
    v_mfma_f32_16x16x32_bf16 v[76:79], a[4:7], a[36:39], v[76:79]
    ds_read_b64_tr_b16 a[2:3], v20 offset:38912
    s_waitcnt lgkmcnt(10)
    v_mfma_f32_16x16x32_bf16 v[80:83], a[8:11], a[32:35], v[80:83]
    ds_read_b64_tr_b16 a[4:5], v21 offset:36864
    v_mfma_f32_16x16x32_bf16 v[84:87], a[8:11], a[36:39], v[84:87]
    ds_read_b64_tr_b16 a[6:7], v21 offset:38912
    v_mfma_f32_16x16x32_bf16 v[88:91], a[12:15], a[32:35], v[88:91]
    ds_read_b64_tr_b16 a[8:9], v20 offset:37376
    v_mfma_f32_16x16x32_bf16 v[92:95], a[12:15], a[36:39], v[92:95]
    ds_read_b64_tr_b16 a[10:11], v20 offset:39424
    s_waitcnt lgkmcnt(10)
    v_mfma_f32_16x16x32_bf16 v[96:99], a[16:19], a[32:35], v[96:99]
    ds_read_b64_tr_b16 a[12:13], v21 offset:37376
    v_mfma_f32_16x16x32_bf16 v[100:103], a[16:19], a[36:39], v[100:103]
    ds_read_b64_tr_b16 a[14:15], v21 offset:39424
    v_mfma_f32_16x16x32_bf16 v[104:107], a[20:23], a[32:35], v[104:107]
    ds_read_b64_tr_b16 a[16:17], v20 offset:45056
    v_mfma_f32_16x16x32_bf16 v[108:111], a[20:23], a[36:39], v[108:111]
    ds_read_b64_tr_b16 a[18:19], v20 offset:47104
    s_waitcnt lgkmcnt(10)
    v_mfma_f32_16x16x32_bf16 v[112:115], a[24:27], a[32:35], v[112:115]
    ds_read_b64_tr_b16 a[20:21], v21 offset:45056
    v_mfma_f32_16x16x32_bf16 v[116:119], a[24:27], a[36:39], v[116:119]
    ds_read_b64_tr_b16 a[22:23], v21 offset:47104
    v_mfma_f32_16x16x32_bf16 v[120:123], a[28:31], a[32:35], v[120:123]
    ds_read_b64_tr_b16 a[24:25], v20 offset:45568
    v_mfma_f32_16x16x32_bf16 v[124:127], a[28:31], a[36:39], v[124:127]
    ds_read_b64_tr_b16 a[26:27], v20 offset:47616
    s_waitcnt vmcnt(9)
    s_barrier
    s_waitcnt lgkmcnt(10)
    v_mfma_f32_16x16x32_bf16 v[64:67], a[0:3], a[40:43], v[64:67]
    ds_read_b64_tr_b16 a[28:29], v21 offset:45568
    v_mfma_f32_16x16x32_bf16 v[68:71], a[0:3], a[44:47], v[68:71]
    ds_read_b64_tr_b16 a[30:31], v21 offset:47616
    v_mfma_f32_16x16x32_bf16 v[72:75], a[4:7], a[40:43], v[72:75]
    ds_read_b64_tr_b16 a[0:1], v20 offset:49152
    v_mfma_f32_16x16x32_bf16 v[76:79], a[4:7], a[44:47], v[76:79]
    ds_read_b64_tr_b16 a[2:3], v20 offset:51200
    s_waitcnt lgkmcnt(10)
    v_mfma_f32_16x16x32_bf16 v[80:83], a[8:11], a[40:43], v[80:83]
    ds_read_b64_tr_b16 a[4:5], v21 offset:49152
    v_mfma_f32_16x16x32_bf16 v[84:87], a[8:11], a[44:47], v[84:87]
    ds_read_b64_tr_b16 a[6:7], v21 offset:51200
    v_mfma_f32_16x16x32_bf16 v[88:91], a[12:15], a[40:43], v[88:91]
    ds_read_b64_tr_b16 a[8:9], v20 offset:49664
    v_mfma_f32_16x16x32_bf16 v[92:95], a[12:15], a[44:47], v[92:95]
    ds_read_b64_tr_b16 a[10:11], v20 offset:51712
    s_waitcnt lgkmcnt(10)
    v_mfma_f32_16x16x32_bf16 v[96:99], a[16:19], a[40:43], v[96:99]
    ds_read_b64_tr_b16 a[12:13], v21 offset:49664
    v_mfma_f32_16x16x32_bf16 v[100:103], a[16:19], a[44:47], v[100:103]
    ds_read_b64_tr_b16 a[14:15], v21 offset:51712
    v_mfma_f32_16x16x32_bf16 v[104:107], a[20:23], a[40:43], v[104:107]
    ds_read_b64_tr_b16 a[16:17], v20 offset:57344
    v_mfma_f32_16x16x32_bf16 v[108:111], a[20:23], a[44:47], v[108:111]
    ds_read_b64_tr_b16 a[18:19], v20 offset:59392
    s_waitcnt lgkmcnt(10)
    v_mfma_f32_16x16x32_bf16 v[112:115], a[24:27], a[40:43], v[112:115]
    ds_read_b64_tr_b16 a[20:21], v21 offset:57344
    v_mfma_f32_16x16x32_bf16 v[116:119], a[24:27], a[44:47], v[116:119]
    ds_read_b64_tr_b16 a[22:23], v21 offset:59392
    v_mfma_f32_16x16x32_bf16 v[120:123], a[28:31], a[40:43], v[120:123]
    ds_read_b64_tr_b16 a[24:25], v20 offset:57856
    v_mfma_f32_16x16x32_bf16 v[124:127], a[28:31], a[44:47], v[124:127]
    ds_read_b64_tr_b16 a[26:27], v20 offset:59904
    s_waitcnt vmcnt(0)
    v_readfirstlane_b32 s56, v12
    s_cmp_lg_u32 s56, 0
    s_cselect_b32 s42, s62, 0x7f000000
    s_cselect_b32 s43, s64, 0x7f000000
    s_waitcnt lgkmcnt(10)
    v_mfma_f32_16x16x32_bf16 v[64:67], a[0:3], a[48:51], v[64:67]
    ds_read_b64_tr_b16 a[28:29], v21 offset:57856
    v_mfma_f32_16x16x32_bf16 v[68:71], a[0:3], a[52:55], v[68:71]
    ds_read_b64_tr_b16 a[30:31], v21 offset:59904
    v_mfma_f32_16x16x32_bf16 v[72:75], a[4:7], a[48:51], v[72:75]
    ds_read_b64_tr_b16 a[0:1], v20 offset:53248
    buffer_load_dwordx4 v[160:163], v6, s[20:23], s42 offen offset:0 sc1
    v_mfma_f32_16x16x32_bf16 v[76:79], a[4:7], a[52:55], v[76:79]
    ds_read_b64_tr_b16 a[2:3], v20 offset:55296
    s_waitcnt lgkmcnt(10)
    v_mfma_f32_16x16x32_bf16 v[80:83], a[8:11], a[48:51], v[80:83]
    ds_read_b64_tr_b16 a[4:5], v21 offset:53248
    v_mfma_f32_16x16x32_bf16 v[84:87], a[8:11], a[52:55], v[84:87]
    ds_read_b64_tr_b16 a[6:7], v21 offset:55296
    v_mfma_f32_16x16x32_bf16 v[88:91], a[12:15], a[48:51], v[88:91]
    ds_read_b64_tr_b16 a[8:9], v20 offset:53760
    buffer_load_dwordx4 v[164:167], v6, s[20:23], s42 offen offset:1024 sc1
    v_mfma_f32_16x16x32_bf16 v[92:95], a[12:15], a[52:55], v[92:95]
    ds_read_b64_tr_b16 a[10:11], v20 offset:55808
    s_waitcnt lgkmcnt(10)
    v_mfma_f32_16x16x32_bf16 v[96:99], a[16:19], a[48:51], v[96:99]
    ds_read_b64_tr_b16 a[12:13], v21 offset:53760
    v_mfma_f32_16x16x32_bf16 v[100:103], a[16:19], a[52:55], v[100:103]
    ds_read_b64_tr_b16 a[14:15], v21 offset:55808
    v_mfma_f32_16x16x32_bf16 v[104:107], a[20:23], a[48:51], v[104:107]
    ds_read_b64_tr_b16 a[16:17], v20 offset:61440
    buffer_load_dwordx4 v[168:171], v6, s[20:23], s42 offen offset:2048 sc1
    v_mfma_f32_16x16x32_bf16 v[108:111], a[20:23], a[52:55], v[108:111]
    ds_read_b64_tr_b16 a[18:19], v20 offset:63488
    s_waitcnt lgkmcnt(10)
    v_mfma_f32_16x16x32_bf16 v[112:115], a[24:27], a[48:51], v[112:115]
    ds_read_b64_tr_b16 a[20:21], v21 offset:61440
    v_mfma_f32_16x16x32_bf16 v[116:119], a[24:27], a[52:55], v[116:119]
    ds_read_b64_tr_b16 a[22:23], v21 offset:63488
    v_mfma_f32_16x16x32_bf16 v[120:123], a[28:31], a[48:51], v[120:123]
    ds_read_b64_tr_b16 a[24:25], v20 offset:61952
    buffer_load_dwordx4 v[172:175], v6, s[20:23], s42 offen offset:3072 sc1
    v_mfma_f32_16x16x32_bf16 v[124:127], a[28:31], a[52:55], v[124:127]
    ds_read_b64_tr_b16 a[26:27], v20 offset:64000
    s_waitcnt lgkmcnt(10)
    v_mfma_f32_16x16x32_bf16 v[64:67], a[0:3], a[56:59], v[64:67]
    ds_read_b64_tr_b16 a[28:29], v21 offset:61952
    v_mfma_f32_16x16x32_bf16 v[68:71], a[0:3], a[60:63], v[68:71]
    ds_read_b64_tr_b16 a[30:31], v21 offset:64000
    v_mfma_f32_16x16x32_bf16 v[72:75], a[4:7], a[56:59], v[72:75]
    buffer_load_dwordx4 v[176:179], v6, s[20:23], s43 offen offset:0 sc1
    v_mfma_f32_16x16x32_bf16 v[76:79], a[4:7], a[60:63], v[76:79]
    s_waitcnt lgkmcnt(8)
    v_mfma_f32_16x16x32_bf16 v[80:83], a[8:11], a[56:59], v[80:83]
    v_mfma_f32_16x16x32_bf16 v[84:87], a[8:11], a[60:63], v[84:87]
    v_mfma_f32_16x16x32_bf16 v[88:91], a[12:15], a[56:59], v[88:91]
    buffer_load_dwordx4 v[180:183], v6, s[20:23], s43 offen offset:1024 sc1
    v_mfma_f32_16x16x32_bf16 v[92:95], a[12:15], a[60:63], v[92:95]
    s_waitcnt lgkmcnt(4)
    v_mfma_f32_16x16x32_bf16 v[96:99], a[16:19], a[56:59], v[96:99]
    v_mfma_f32_16x16x32_bf16 v[100:103], a[16:19], a[60:63], v[100:103]
    v_mfma_f32_16x16x32_bf16 v[104:107], a[20:23], a[56:59], v[104:107]
    buffer_load_dwordx4 v[184:187], v6, s[20:23], s43 offen offset:2048 sc1
    v_mfma_f32_16x16x32_bf16 v[108:111], a[20:23], a[60:63], v[108:111]
    s_waitcnt lgkmcnt(0)
    v_mfma_f32_16x16x32_bf16 v[112:115], a[24:27], a[56:59], v[112:115]
    v_mfma_f32_16x16x32_bf16 v[116:119], a[24:27], a[60:63], v[116:119]
    v_mfma_f32_16x16x32_bf16 v[120:123], a[28:31], a[56:59], v[120:123]
    buffer_load_dwordx4 v[188:191], v6, s[20:23], s43 offen offset:3072 sc1
    v_mfma_f32_16x16x32_bf16 v[124:127], a[28:31], a[60:63], v[124:127]
    s_cmp_eq_u32 s51, 0
    s_cbranch_scc0 L_m_silu
    s_cmp_lg_u32 s56, 0
    s_cbranch_scc1 L_m_have_g
    s_mov_b32 s79, 0x100000
L_m_gw:
    buffer_load_dword v12, off, s[20:23], s31 sc1
    s_waitcnt vmcnt(0)
    v_readfirstlane_b32 s56, v12
    s_sub_u32 s79, s79, 1
    s_cselect_b32 s56, 1, s56
    s_cmp_lg_u32 s56, 0
    s_cbranch_scc0 L_m_gw
    buffer_load_dwordx4 v[160:163], v6, s[20:23], s62 offen offset:0 sc1
    buffer_load_dwordx4 v[164:167], v6, s[20:23], s62 offen offset:1024 sc1
    buffer_load_dwordx4 v[168:171], v6, s[20:23], s62 offen offset:2048 sc1
    buffer_load_dwordx4 v[172:175], v6, s[20:23], s62 offen offset:3072 sc1
    buffer_load_dwordx4 v[176:179], v6, s[20:23], s64 offen offset:0 sc1
    buffer_load_dwordx4 v[180:183], v6, s[20:23], s64 offen offset:1024 sc1
    buffer_load_dwordx4 v[184:187], v6, s[20:23], s64 offen offset:2048 sc1
    buffer_load_dwordx4 v[188:191], v6, s[20:23], s64 offen offset:3072 sc1
L_m_have_g:
    v_permlane16_swap_b32 v128, v130
    v_permlane16_swap_b32 v129, v131
    v_permlane16_swap_b32 v132, v134
    v_permlane16_swap_b32 v133, v135
    v_permlane16_swap_b32 v136, v138
    v_permlane16_swap_b32 v137, v139
    v_permlane16_swap_b32 v140, v142
    v_permlane16_swap_b32 v141, v143
    v_permlane16_swap_b32 v144, v146
    v_permlane16_swap_b32 v145, v147
    v_permlane16_swap_b32 v148, v150
    v_permlane16_swap_b32 v149, v151
    v_permlane16_swap_b32 v152, v154
    v_permlane16_swap_b32 v153, v155
    v_permlane16_swap_b32 v156, v158
    v_permlane16_swap_b32 v157, v159
    v_lshlrev_b32 v192, 16, v128
    v_and_b32 v193, s50, v128
    v_lshlrev_b32 v194, 16, v129
    v_and_b32 v195, s50, v129
    v_lshlrev_b32 v196, 16, v132
    v_and_b32 v197, s50, v132
    v_lshlrev_b32 v198, 16, v133
    v_and_b32 v199, s50, v133
    v_lshlrev_b32 v200, 16, v130
    v_and_b32 v201, s50, v130
    v_lshlrev_b32 v202, 16, v131
    v_and_b32 v203, s50, v131
    v_lshlrev_b32 v204, 16, v134
    v_and_b32 v205, s50, v134
    v_lshlrev_b32 v206, 16, v135
    v_and_b32 v207, s50, v135
    v_lshlrev_b32 v208, 16, v136
    v_and_b32 v209, s50, v136
    v_lshlrev_b32 v210, 16, v137
    v_and_b32 v211, s50, v137
    v_lshlrev_b32 v212, 16, v140
    v_and_b32 v213, s50, v140
    v_lshlrev_b32 v214, 16, v141
    v_and_b32 v215, s50, v141
    v_lshlrev_b32 v216, 16, v138
    v_and_b32 v217, s50, v138
    v_lshlrev_b32 v218, 16, v139
    v_and_b32 v219, s50, v139
    v_lshlrev_b32 v220, 16, v142
    v_and_b32 v221, s50, v142
    v_lshlrev_b32 v222, 16, v143
    v_and_b32 v223, s50, v143
    v_lshlrev_b32 v224, 16, v144
    v_and_b32 v225, s50, v144
    v_lshlrev_b32 v226, 16, v145
    v_and_b32 v227, s50, v145
    v_lshlrev_b32 v228, 16, v148
    v_and_b32 v229, s50, v148
    v_lshlrev_b32 v230, 16, v149
    v_and_b32 v231, s50, v149
    v_lshlrev_b32 v232, 16, v146
    v_and_b32 v233, s50, v146
    v_lshlrev_b32 v234, 16, v147
    v_and_b32 v235, s50, v147
    v_lshlrev_b32 v236, 16, v150
    v_and_b32 v237, s50, v150
    v_lshlrev_b32 v238, 16, v151
    v_and_b32 v239, s50, v151
    v_lshlrev_b32 v240, 16, v152
    v_and_b32 v241, s50, v152
    v_lshlrev_b32 v242, 16, v153
    v_and_b32 v243, s50, v153
    v_lshlrev_b32 v244, 16, v156
    v_and_b32 v245, s50, v156
    v_lshlrev_b32 v246, 16, v157
    v_and_b32 v247, s50, v157
    v_lshlrev_b32 v248, 16, v154
    v_and_b32 v249, s50, v154
    v_lshlrev_b32 v250, 16, v155
    v_and_b32 v251, s50, v155
    v_lshlrev_b32 v252, 16, v158
    v_and_b32 v253, s50, v158
    v_lshlrev_b32 v254, 16, v159
    v_and_b32 v255, s50, v159
    s_waitcnt vmcnt(6)
    v_lshlrev_b32 v16, 16, v160
    v_and_b32 v17, s50, v160
    v_pk_fma_f32 v[16:17], v[64:65], v[16:17], v[192:193]
    v_cvt_pk_bf16_f32 v32, v16, v17
    v_lshlrev_b32 v18, 16, v161
    v_and_b32 v19, s50, v161
    v_pk_fma_f32 v[18:19], v[66:67], v[18:19], v[194:195]
    v_cvt_pk_bf16_f32 v33, v18, v19
    v_lshlrev_b32 v20, 16, v162
    v_and_b32 v21, s50, v162
    v_pk_fma_f32 v[20:21], v[68:69], v[20:21], v[196:197]
    v_cvt_pk_bf16_f32 v36, v20, v21
    v_lshlrev_b32 v22, 16, v163
    v_and_b32 v23, s50, v163
    v_pk_fma_f32 v[22:23], v[70:71], v[22:23], v[198:199]
    v_cvt_pk_bf16_f32 v37, v22, v23
    v_lshlrev_b32 v24, 16, v164
    v_and_b32 v25, s50, v164
    v_pk_fma_f32 v[24:25], v[72:73], v[24:25], v[200:201]
    v_cvt_pk_bf16_f32 v34, v24, v25
    v_lshlrev_b32 v26, 16, v165
    v_and_b32 v27, s50, v165
    v_pk_fma_f32 v[26:27], v[74:75], v[26:27], v[202:203]
    v_cvt_pk_bf16_f32 v35, v26, v27
    v_lshlrev_b32 v28, 16, v166
    v_and_b32 v29, s50, v166
    v_pk_fma_f32 v[28:29], v[76:77], v[28:29], v[204:205]
    v_cvt_pk_bf16_f32 v38, v28, v29
    v_lshlrev_b32 v30, 16, v167
    v_and_b32 v31, s50, v167
    v_pk_fma_f32 v[30:31], v[78:79], v[30:31], v[206:207]
    v_cvt_pk_bf16_f32 v39, v30, v31
    s_nop 1
    v_permlane16_swap_b32 v32, v34
    v_permlane16_swap_b32 v33, v35
    v_permlane16_swap_b32 v36, v38
    v_permlane16_swap_b32 v37, v39
    buffer_store_dwordx4 v[32:35], v11, s[12:15], s28 offen offset:0
    buffer_store_dwordx4 v[36:39], v11, s[12:15], s29 offen offset:0
    s_waitcnt vmcnt(6)
    v_lshlrev_b32 v16, 16, v168
    v_and_b32 v17, s50, v168
    v_pk_fma_f32 v[16:17], v[80:81], v[16:17], v[208:209]
    v_cvt_pk_bf16_f32 v40, v16, v17
    v_lshlrev_b32 v18, 16, v169
    v_and_b32 v19, s50, v169
    v_pk_fma_f32 v[18:19], v[82:83], v[18:19], v[210:211]
    v_cvt_pk_bf16_f32 v41, v18, v19
    v_lshlrev_b32 v20, 16, v170
    v_and_b32 v21, s50, v170
    v_pk_fma_f32 v[20:21], v[84:85], v[20:21], v[212:213]
    v_cvt_pk_bf16_f32 v44, v20, v21
    v_lshlrev_b32 v22, 16, v171
    v_and_b32 v23, s50, v171
    v_pk_fma_f32 v[22:23], v[86:87], v[22:23], v[214:215]
    v_cvt_pk_bf16_f32 v45, v22, v23
    v_lshlrev_b32 v24, 16, v172
    v_and_b32 v25, s50, v172
    v_pk_fma_f32 v[24:25], v[88:89], v[24:25], v[216:217]
    v_cvt_pk_bf16_f32 v42, v24, v25
    v_lshlrev_b32 v26, 16, v173
    v_and_b32 v27, s50, v173
    v_pk_fma_f32 v[26:27], v[90:91], v[26:27], v[218:219]
    v_cvt_pk_bf16_f32 v43, v26, v27
    v_lshlrev_b32 v28, 16, v174
    v_and_b32 v29, s50, v174
    v_pk_fma_f32 v[28:29], v[92:93], v[28:29], v[220:221]
    v_cvt_pk_bf16_f32 v46, v28, v29
    v_lshlrev_b32 v30, 16, v175
    v_and_b32 v31, s50, v175
    v_pk_fma_f32 v[30:31], v[94:95], v[30:31], v[222:223]
    v_cvt_pk_bf16_f32 v47, v30, v31
    s_nop 1
    v_permlane16_swap_b32 v40, v42
    v_permlane16_swap_b32 v41, v43
    v_permlane16_swap_b32 v44, v46
    v_permlane16_swap_b32 v45, v47
    buffer_store_dwordx4 v[40:43], v11, s[12:15], s28 offen offset:64
    buffer_store_dwordx4 v[44:47], v11, s[12:15], s29 offen offset:64
    s_waitcnt vmcnt(6)
    v_lshlrev_b32 v16, 16, v176
    v_and_b32 v17, s50, v176
    v_pk_fma_f32 v[16:17], v[96:97], v[16:17], v[224:225]
    v_cvt_pk_bf16_f32 v48, v16, v17
    v_lshlrev_b32 v18, 16, v177
    v_and_b32 v19, s50, v177
    v_pk_fma_f32 v[18:19], v[98:99], v[18:19], v[226:227]
    v_cvt_pk_bf16_f32 v49, v18, v19
    v_lshlrev_b32 v20, 16, v178
    v_and_b32 v21, s50, v178
    v_pk_fma_f32 v[20:21], v[100:101], v[20:21], v[228:229]
    v_cvt_pk_bf16_f32 v52, v20, v21
    v_lshlrev_b32 v22, 16, v179
    v_and_b32 v23, s50, v179
    v_pk_fma_f32 v[22:23], v[102:103], v[22:23], v[230:231]
    v_cvt_pk_bf16_f32 v53, v22, v23
    v_lshlrev_b32 v24, 16, v180
    v_and_b32 v25, s50, v180
    v_pk_fma_f32 v[24:25], v[104:105], v[24:25], v[232:233]
    v_cvt_pk_bf16_f32 v50, v24, v25
    v_lshlrev_b32 v26, 16, v181
    v_and_b32 v27, s50, v181
    v_pk_fma_f32 v[26:27], v[106:107], v[26:27], v[234:235]
    v_cvt_pk_bf16_f32 v51, v26, v27
    v_lshlrev_b32 v28, 16, v182
    v_and_b32 v29, s50, v182
    v_pk_fma_f32 v[28:29], v[108:109], v[28:29], v[236:237]
    v_cvt_pk_bf16_f32 v54, v28, v29
    v_lshlrev_b32 v30, 16, v183
    v_and_b32 v31, s50, v183
    v_pk_fma_f32 v[30:31], v[110:111], v[30:31], v[238:239]
    v_cvt_pk_bf16_f32 v55, v30, v31
    s_nop 1
    v_permlane16_swap_b32 v48, v50
    v_permlane16_swap_b32 v49, v51
    v_permlane16_swap_b32 v52, v54
    v_permlane16_swap_b32 v53, v55
    buffer_store_dwordx4 v[48:51], v11, s[12:15], s28 offen offset:128
    buffer_store_dwordx4 v[52:55], v11, s[12:15], s29 offen offset:128
    s_waitcnt vmcnt(6)
    v_lshlrev_b32 v16, 16, v184
    v_and_b32 v17, s50, v184
    v_pk_fma_f32 v[16:17], v[112:113], v[16:17], v[240:241]
    v_cvt_pk_bf16_f32 v56, v16, v17
    v_lshlrev_b32 v18, 16, v185
    v_and_b32 v19, s50, v185
    v_pk_fma_f32 v[18:19], v[114:115], v[18:19], v[242:243]
    v_cvt_pk_bf16_f32 v57, v18, v19
    v_lshlrev_b32 v20, 16, v186
    v_and_b32 v21, s50, v186
    v_pk_fma_f32 v[20:21], v[116:117], v[20:21], v[244:245]
    v_cvt_pk_bf16_f32 v60, v20, v21
    v_lshlrev_b32 v22, 16, v187
    v_and_b32 v23, s50, v187
    v_pk_fma_f32 v[22:23], v[118:119], v[22:23], v[246:247]
    v_cvt_pk_bf16_f32 v61, v22, v23
    v_lshlrev_b32 v24, 16, v188
    v_and_b32 v25, s50, v188
    v_pk_fma_f32 v[24:25], v[120:121], v[24:25], v[248:249]
    v_cvt_pk_bf16_f32 v58, v24, v25
    v_lshlrev_b32 v26, 16, v189
    v_and_b32 v27, s50, v189
    v_pk_fma_f32 v[26:27], v[122:123], v[26:27], v[250:251]
    v_cvt_pk_bf16_f32 v59, v26, v27
    v_lshlrev_b32 v28, 16, v190
    v_and_b32 v29, s50, v190
    v_pk_fma_f32 v[28:29], v[124:125], v[28:29], v[252:253]
    v_cvt_pk_bf16_f32 v62, v28, v29
    v_lshlrev_b32 v30, 16, v191
    v_and_b32 v31, s50, v191
    v_pk_fma_f32 v[30:31], v[126:127], v[30:31], v[254:255]
    v_cvt_pk_bf16_f32 v63, v30, v31
    s_nop 1
    v_permlane16_swap_b32 v56, v58
    v_permlane16_swap_b32 v57, v59
    v_permlane16_swap_b32 v60, v62
    v_permlane16_swap_b32 v61, v63
    buffer_store_dwordx4 v[56:59], v11, s[12:15], s28 offen offset:192
    buffer_store_dwordx4 v[60:63], v11, s[12:15], s29 offen offset:192
    s_branch L_m_done
L_m_silu:
    s_nop 4
    v_pk_mul_f32 v[16:17], v[64:65], s[70:71]
    v_pk_mul_f32 v[18:19], v[66:67], s[70:71]
    v_pk_mul_f32 v[20:21], v[68:69], s[70:71]
    v_pk_mul_f32 v[22:23], v[70:71], s[70:71]
    v_exp_f32 v16, v16
    v_exp_f32 v17, v17
    v_exp_f32 v18, v18
    v_exp_f32 v19, v19
    v_exp_f32 v20, v20
    v_exp_f32 v21, v21
    v_exp_f32 v22, v22
    v_exp_f32 v23, v23
    v_pk_add_f32 v[16:17], v[16:17], 1.0 op_sel_hi:[1,0]
    v_pk_add_f32 v[18:19], v[18:19], 1.0 op_sel_hi:[1,0]
    v_pk_add_f32 v[20:21], v[20:21], 1.0 op_sel_hi:[1,0]
    v_pk_add_f32 v[22:23], v[22:23], 1.0 op_sel_hi:[1,0]
    v_rcp_f32 v16, v16
    v_rcp_f32 v17, v17
    v_rcp_f32 v18, v18
    v_rcp_f32 v19, v19
    v_rcp_f32 v20, v20
    v_rcp_f32 v21, v21
    v_rcp_f32 v22, v22
    v_rcp_f32 v23, v23
    v_pk_mul_f32 v[16:17], v[16:17], v[64:65]
    v_pk_mul_f32 v[18:19], v[18:19], v[66:67]
    v_pk_mul_f32 v[20:21], v[20:21], v[68:69]
    v_pk_mul_f32 v[22:23], v[22:23], v[70:71]
    v_cvt_pk_bf16_f32 v32, v16, v17
    v_cvt_pk_bf16_f32 v33, v18, v19
    v_cvt_pk_bf16_f32 v34, v20, v21
    v_cvt_pk_bf16_f32 v35, v22, v23
    buffer_store_dwordx4 v[32:35], v6, s[20:23], s61 offen offset:0 sc1
    v_pk_mul_f32 v[24:25], v[72:73], s[70:71]
    v_pk_mul_f32 v[26:27], v[74:75], s[70:71]
    v_pk_mul_f32 v[28:29], v[76:77], s[70:71]
    v_pk_mul_f32 v[30:31], v[78:79], s[70:71]
    v_exp_f32 v24, v24
    v_exp_f32 v25, v25
    v_exp_f32 v26, v26
    v_exp_f32 v27, v27
    v_exp_f32 v28, v28
    v_exp_f32 v29, v29
    v_exp_f32 v30, v30
    v_exp_f32 v31, v31
    v_pk_add_f32 v[24:25], v[24:25], 1.0 op_sel_hi:[1,0]
    v_pk_add_f32 v[26:27], v[26:27], 1.0 op_sel_hi:[1,0]
    v_pk_add_f32 v[28:29], v[28:29], 1.0 op_sel_hi:[1,0]
    v_pk_add_f32 v[30:31], v[30:31], 1.0 op_sel_hi:[1,0]
    v_rcp_f32 v24, v24
    v_rcp_f32 v25, v25
    v_rcp_f32 v26, v26
    v_rcp_f32 v27, v27
    v_rcp_f32 v28, v28
    v_rcp_f32 v29, v29
    v_rcp_f32 v30, v30
    v_rcp_f32 v31, v31
    v_pk_mul_f32 v[24:25], v[24:25], v[72:73]
    v_pk_mul_f32 v[26:27], v[26:27], v[74:75]
    v_pk_mul_f32 v[28:29], v[28:29], v[76:77]
    v_pk_mul_f32 v[30:31], v[30:31], v[78:79]
    v_cvt_pk_bf16_f32 v36, v24, v25
    v_cvt_pk_bf16_f32 v37, v26, v27
    v_cvt_pk_bf16_f32 v38, v28, v29
    v_cvt_pk_bf16_f32 v39, v30, v31
    buffer_store_dwordx4 v[36:39], v6, s[20:23], s61 offen offset:1024 sc1
    v_pk_mul_f32 v[16:17], v[80:81], s[70:71]
    v_pk_mul_f32 v[18:19], v[82:83], s[70:71]
    v_pk_mul_f32 v[20:21], v[84:85], s[70:71]
    v_pk_mul_f32 v[22:23], v[86:87], s[70:71]
    v_exp_f32 v16, v16
    v_exp_f32 v17, v17
    v_exp_f32 v18, v18
    v_exp_f32 v19, v19
    v_exp_f32 v20, v20
    v_exp_f32 v21, v21
    v_exp_f32 v22, v22
    v_exp_f32 v23, v23
    v_pk_add_f32 v[16:17], v[16:17], 1.0 op_sel_hi:[1,0]
    v_pk_add_f32 v[18:19], v[18:19], 1.0 op_sel_hi:[1,0]
    v_pk_add_f32 v[20:21], v[20:21], 1.0 op_sel_hi:[1,0]
    v_pk_add_f32 v[22:23], v[22:23], 1.0 op_sel_hi:[1,0]
    v_rcp_f32 v16, v16
    v_rcp_f32 v17, v17
    v_rcp_f32 v18, v18
    v_rcp_f32 v19, v19
    v_rcp_f32 v20, v20
    v_rcp_f32 v21, v21
    v_rcp_f32 v22, v22
    v_rcp_f32 v23, v23
    v_pk_mul_f32 v[16:17], v[16:17], v[80:81]
    v_pk_mul_f32 v[18:19], v[18:19], v[82:83]
    v_pk_mul_f32 v[20:21], v[20:21], v[84:85]
    v_pk_mul_f32 v[22:23], v[22:23], v[86:87]
    v_cvt_pk_bf16_f32 v40, v16, v17
    v_cvt_pk_bf16_f32 v41, v18, v19
    v_cvt_pk_bf16_f32 v42, v20, v21
    v_cvt_pk_bf16_f32 v43, v22, v23
    buffer_store_dwordx4 v[40:43], v6, s[20:23], s61 offen offset:2048 sc1
    v_pk_mul_f32 v[24:25], v[88:89], s[70:71]
    v_pk_mul_f32 v[26:27], v[90:91], s[70:71]
    v_pk_mul_f32 v[28:29], v[92:93], s[70:71]
    v_pk_mul_f32 v[30:31], v[94:95], s[70:71]
    v_exp_f32 v24, v24
    v_exp_f32 v25, v25
    v_exp_f32 v26, v26
    v_exp_f32 v27, v27
    v_exp_f32 v28, v28
    v_exp_f32 v29, v29
    v_exp_f32 v30, v30
    v_exp_f32 v31, v31
    v_pk_add_f32 v[24:25], v[24:25], 1.0 op_sel_hi:[1,0]
    v_pk_add_f32 v[26:27], v[26:27], 1.0 op_sel_hi:[1,0]
    v_pk_add_f32 v[28:29], v[28:29], 1.0 op_sel_hi:[1,0]
    v_pk_add_f32 v[30:31], v[30:31], 1.0 op_sel_hi:[1,0]
    v_rcp_f32 v24, v24
    v_rcp_f32 v25, v25
    v_rcp_f32 v26, v26
    v_rcp_f32 v27, v27
    v_rcp_f32 v28, v28
    v_rcp_f32 v29, v29
    v_rcp_f32 v30, v30
    v_rcp_f32 v31, v31
    v_pk_mul_f32 v[24:25], v[24:25], v[88:89]
    v_pk_mul_f32 v[26:27], v[26:27], v[90:91]
    v_pk_mul_f32 v[28:29], v[28:29], v[92:93]
    v_pk_mul_f32 v[30:31], v[30:31], v[94:95]
    v_cvt_pk_bf16_f32 v44, v24, v25
    v_cvt_pk_bf16_f32 v45, v26, v27
    v_cvt_pk_bf16_f32 v46, v28, v29
    v_cvt_pk_bf16_f32 v47, v30, v31
    buffer_store_dwordx4 v[44:47], v6, s[20:23], s61 offen offset:3072 sc1
    v_pk_mul_f32 v[16:17], v[96:97], s[70:71]
    v_pk_mul_f32 v[18:19], v[98:99], s[70:71]
    v_pk_mul_f32 v[20:21], v[100:101], s[70:71]
    v_pk_mul_f32 v[22:23], v[102:103], s[70:71]
    v_exp_f32 v16, v16
    v_exp_f32 v17, v17
    v_exp_f32 v18, v18
    v_exp_f32 v19, v19
    v_exp_f32 v20, v20
    v_exp_f32 v21, v21
    v_exp_f32 v22, v22
    v_exp_f32 v23, v23
    v_pk_add_f32 v[16:17], v[16:17], 1.0 op_sel_hi:[1,0]
    v_pk_add_f32 v[18:19], v[18:19], 1.0 op_sel_hi:[1,0]
    v_pk_add_f32 v[20:21], v[20:21], 1.0 op_sel_hi:[1,0]
    v_pk_add_f32 v[22:23], v[22:23], 1.0 op_sel_hi:[1,0]
    v_rcp_f32 v16, v16
    v_rcp_f32 v17, v17
    v_rcp_f32 v18, v18
    v_rcp_f32 v19, v19
    v_rcp_f32 v20, v20
    v_rcp_f32 v21, v21
    v_rcp_f32 v22, v22
    v_rcp_f32 v23, v23
    v_pk_mul_f32 v[16:17], v[16:17], v[96:97]
    v_pk_mul_f32 v[18:19], v[18:19], v[98:99]
    v_pk_mul_f32 v[20:21], v[20:21], v[100:101]
    v_pk_mul_f32 v[22:23], v[22:23], v[102:103]
    v_cvt_pk_bf16_f32 v48, v16, v17
    v_cvt_pk_bf16_f32 v49, v18, v19
    v_cvt_pk_bf16_f32 v50, v20, v21
    v_cvt_pk_bf16_f32 v51, v22, v23
    buffer_store_dwordx4 v[48:51], v6, s[20:23], s63 offen offset:0 sc1
    v_pk_mul_f32 v[24:25], v[104:105], s[70:71]
    v_pk_mul_f32 v[26:27], v[106:107], s[70:71]
    v_pk_mul_f32 v[28:29], v[108:109], s[70:71]
    v_pk_mul_f32 v[30:31], v[110:111], s[70:71]
    v_exp_f32 v24, v24
    v_exp_f32 v25, v25
    v_exp_f32 v26, v26
    v_exp_f32 v27, v27
    v_exp_f32 v28, v28
    v_exp_f32 v29, v29
    v_exp_f32 v30, v30
    v_exp_f32 v31, v31
    v_pk_add_f32 v[24:25], v[24:25], 1.0 op_sel_hi:[1,0]
    v_pk_add_f32 v[26:27], v[26:27], 1.0 op_sel_hi:[1,0]
    v_pk_add_f32 v[28:29], v[28:29], 1.0 op_sel_hi:[1,0]
    v_pk_add_f32 v[30:31], v[30:31], 1.0 op_sel_hi:[1,0]
    v_rcp_f32 v24, v24
    v_rcp_f32 v25, v25
    v_rcp_f32 v26, v26
    v_rcp_f32 v27, v27
    v_rcp_f32 v28, v28
    v_rcp_f32 v29, v29
    v_rcp_f32 v30, v30
    v_rcp_f32 v31, v31
    v_pk_mul_f32 v[24:25], v[24:25], v[104:105]
    v_pk_mul_f32 v[26:27], v[26:27], v[106:107]
    v_pk_mul_f32 v[28:29], v[28:29], v[108:109]
    v_pk_mul_f32 v[30:31], v[30:31], v[110:111]
    v_cvt_pk_bf16_f32 v52, v24, v25
    v_cvt_pk_bf16_f32 v53, v26, v27
    v_cvt_pk_bf16_f32 v54, v28, v29
    v_cvt_pk_bf16_f32 v55, v30, v31
    buffer_store_dwordx4 v[52:55], v6, s[20:23], s63 offen offset:1024 sc1
    v_pk_mul_f32 v[16:17], v[112:113], s[70:71]
    v_pk_mul_f32 v[18:19], v[114:115], s[70:71]
    v_pk_mul_f32 v[20:21], v[116:117], s[70:71]
    v_pk_mul_f32 v[22:23], v[118:119], s[70:71]
    v_exp_f32 v16, v16
    v_exp_f32 v17, v17
    v_exp_f32 v18, v18
    v_exp_f32 v19, v19
    v_exp_f32 v20, v20
    v_exp_f32 v21, v21
    v_exp_f32 v22, v22
    v_exp_f32 v23, v23
    v_pk_add_f32 v[16:17], v[16:17], 1.0 op_sel_hi:[1,0]
    v_pk_add_f32 v[18:19], v[18:19], 1.0 op_sel_hi:[1,0]
    v_pk_add_f32 v[20:21], v[20:21], 1.0 op_sel_hi:[1,0]
    v_pk_add_f32 v[22:23], v[22:23], 1.0 op_sel_hi:[1,0]
    v_rcp_f32 v16, v16
    v_rcp_f32 v17, v17
    v_rcp_f32 v18, v18
    v_rcp_f32 v19, v19
    v_rcp_f32 v20, v20
    v_rcp_f32 v21, v21
    v_rcp_f32 v22, v22
    v_rcp_f32 v23, v23
    v_pk_mul_f32 v[16:17], v[16:17], v[112:113]
    v_pk_mul_f32 v[18:19], v[18:19], v[114:115]
    v_pk_mul_f32 v[20:21], v[20:21], v[116:117]
    v_pk_mul_f32 v[22:23], v[22:23], v[118:119]
    v_cvt_pk_bf16_f32 v56, v16, v17
    v_cvt_pk_bf16_f32 v57, v18, v19
    v_cvt_pk_bf16_f32 v58, v20, v21
    v_cvt_pk_bf16_f32 v59, v22, v23
    buffer_store_dwordx4 v[56:59], v6, s[20:23], s63 offen offset:2048 sc1
    v_pk_mul_f32 v[24:25], v[120:121], s[70:71]
    v_pk_mul_f32 v[26:27], v[122:123], s[70:71]
    v_pk_mul_f32 v[28:29], v[124:125], s[70:71]
    v_pk_mul_f32 v[30:31], v[126:127], s[70:71]
    v_exp_f32 v24, v24
    v_exp_f32 v25, v25
    v_exp_f32 v26, v26
    v_exp_f32 v27, v27
    v_exp_f32 v28, v28
    v_exp_f32 v29, v29
    v_exp_f32 v30, v30
    v_exp_f32 v31, v31
    v_pk_add_f32 v[24:25], v[24:25], 1.0 op_sel_hi:[1,0]
    v_pk_add_f32 v[26:27], v[26:27], 1.0 op_sel_hi:[1,0]
    v_pk_add_f32 v[28:29], v[28:29], 1.0 op_sel_hi:[1,0]
    v_pk_add_f32 v[30:31], v[30:31], 1.0 op_sel_hi:[1,0]
    v_rcp_f32 v24, v24
    v_rcp_f32 v25, v25
    v_rcp_f32 v26, v26
    v_rcp_f32 v27, v27
    v_rcp_f32 v28, v28
    v_rcp_f32 v29, v29
    v_rcp_f32 v30, v30
    v_rcp_f32 v31, v31
    v_pk_mul_f32 v[24:25], v[24:25], v[120:121]
    v_pk_mul_f32 v[26:27], v[26:27], v[122:123]
    v_pk_mul_f32 v[28:29], v[28:29], v[124:125]
    v_pk_mul_f32 v[30:31], v[30:31], v[126:127]
    v_cvt_pk_bf16_f32 v60, v24, v25
    v_cvt_pk_bf16_f32 v61, v26, v27
    v_cvt_pk_bf16_f32 v62, v28, v29
    v_cvt_pk_bf16_f32 v63, v30, v31
    buffer_store_dwordx4 v[60:63], v6, s[20:23], s63 offen offset:3072 sc1
    s_waitcnt vmcnt(0)
    v_mov_b32 v12, 1
    s_mov_b64 exec, 1
    buffer_store_dword v12, off, s[20:23], s31 sc1
    s_mov_b64 exec, -1
L_m_done:
L_m_end:
    s_endpgm
L_m_slow:
    s_waitcnt vmcnt(0) lgkmcnt(0)
    v_mov_b32 v24, 0xff800000
    v_mov_b32 v25, 0xff800000
    v_mov_b32 v26, 0xff800000
    v_mov_b32 v27, 0xff800000
    s_mov_b32 s33, 16
    s_mov_b32 s63, s48
L_m_slow_max:
    s_add_u32 s64, s63, 4096
    buffer_load_dwordx4 a[0:3], v6, s[20:23], s63 offen offset:0 sc1
    buffer_load_dwordx4 a[4:7], v6, s[20:23], s63 offen offset:1024 sc1
    buffer_load_dwordx4 a[8:11], v6, s[20:23], s63 offen offset:2048 sc1
    buffer_load_dwordx4 a[12:15], v6, s[20:23], s63 offen offset:3072 sc1
    buffer_load_dwordx4 a[16:19], v6, s[20:23], s64 offen offset:0 sc1
    buffer_load_dwordx4 a[20:23], v6, s[20:23], s64 offen offset:1024 sc1
    buffer_load_dwordx4 a[24:27], v6, s[20:23], s64 offen offset:2048 sc1
    buffer_load_dwordx4 a[28:31], v6, s[20:23], s64 offen offset:3072 sc1
    s_waitcnt vmcnt(0)
    v_mfma_f32_16x16x32_bf16 v[32:35], a[0:3], a[160:163], 0
    v_mfma_f32_16x16x32_bf16 v[32:35], a[4:7], a[164:167], v[32:35]
    v_mfma_f32_16x16x32_bf16 v[40:43], a[0:3], a[176:179], 0
    v_mfma_f32_16x16x32_bf16 v[40:43], a[4:7], a[180:183], v[40:43]
    v_mfma_f32_16x16x32_bf16 v[48:51], a[0:3], a[192:195], 0
    v_mfma_f32_16x16x32_bf16 v[48:51], a[4:7], a[196:199], v[48:51]
    v_mfma_f32_16x16x32_bf16 v[56:59], a[0:3], a[208:211], 0
    v_mfma_f32_16x16x32_bf16 v[56:59], a[4:7], a[212:215], v[56:59]
    v_mfma_f32_16x16x32_bf16 v[32:35], a[8:11], a[168:171], v[32:35]
    v_mfma_f32_16x16x32_bf16 v[32:35], a[12:15], a[172:175], v[32:35]
    v_mfma_f32_16x16x32_bf16 v[40:43], a[8:11], a[184:187], v[40:43]
    v_mfma_f32_16x16x32_bf16 v[40:43], a[12:15], a[188:191], v[40:43]
    v_mfma_f32_16x16x32_bf16 v[48:51], a[8:11], a[200:203], v[48:51]
    v_mfma_f32_16x16x32_bf16 v[48:51], a[12:15], a[204:207], v[48:51]
    v_mfma_f32_16x16x32_bf16 v[56:59], a[8:11], a[216:219], v[56:59]
    v_mfma_f32_16x16x32_bf16 v[56:59], a[12:15], a[220:223], v[56:59]
    v_mfma_f32_16x16x32_bf16 v[36:39], a[16:19], a[160:163], 0
    v_mfma_f32_16x16x32_bf16 v[36:39], a[20:23], a[164:167], v[36:39]
    v_mfma_f32_16x16x32_bf16 v[44:47], a[16:19], a[176:179], 0
    v_mfma_f32_16x16x32_bf16 v[44:47], a[20:23], a[180:183], v[44:47]
    v_mfma_f32_16x16x32_bf16 v[52:55], a[16:19], a[192:195], 0
    v_mfma_f32_16x16x32_bf16 v[52:55], a[20:23], a[196:199], v[52:55]
    v_mfma_f32_16x16x32_bf16 v[60:63], a[16:19], a[208:211], 0
    v_mfma_f32_16x16x32_bf16 v[60:63], a[20:23], a[212:215], v[60:63]
    v_mfma_f32_16x16x32_bf16 v[36:39], a[24:27], a[168:171], v[36:39]
    v_mfma_f32_16x16x32_bf16 v[36:39], a[28:31], a[172:175], v[36:39]
    v_mfma_f32_16x16x32_bf16 v[44:47], a[24:27], a[184:187], v[44:47]
    v_mfma_f32_16x16x32_bf16 v[44:47], a[28:31], a[188:191], v[44:47]
    v_mfma_f32_16x16x32_bf16 v[52:55], a[24:27], a[200:203], v[52:55]
    v_mfma_f32_16x16x32_bf16 v[52:55], a[28:31], a[204:207], v[52:55]
    v_mfma_f32_16x16x32_bf16 v[60:63], a[24:27], a[216:219], v[60:63]
    v_mfma_f32_16x16x32_bf16 v[60:63], a[28:31], a[220:223], v[60:63]
    s_nop 15
    v_max3_f32 v20, v32, v33, v34
    v_max3_f32 v20, v20, v35, v36
    v_max3_f32 v20, v20, v37, v38
    v_max_f32 v20, v20, v39
    v_max3_f32 v21, v40, v41, v42
    v_max3_f32 v21, v21, v43, v44
    v_max3_f32 v21, v21, v45, v46
    v_max_f32 v21, v21, v47
    v_max3_f32 v22, v48, v49, v50
    v_max3_f32 v22, v22, v51, v52
    v_max3_f32 v22, v22, v53, v54
    v_max_f32 v22, v22, v55
    v_max3_f32 v23, v56, v57, v58
    v_max3_f32 v23, v23, v59, v60
    v_max3_f32 v23, v23, v61, v62
    v_max_f32 v23, v23, v63
    v_max_f32 v24, v24, v20
    v_max_f32 v25, v25, v21
    v_max_f32 v26, v26, v22
    v_max_f32 v27, v27, v23
    s_add_u32 s63, s63, 16384
    s_sub_u32 s33, s33, 1
    s_cmp_lg_u32 s33, 0
    s_cbranch_scc1 L_m_slow_max
    v_mov_b32 v16, v24
    v_mov_b32 v17, v25
    v_mov_b32 v18, v26
    v_mov_b32 v19, v27
    s_nop 1
    v_permlane16_swap_b32 v24, v16
    v_permlane16_swap_b32 v25, v17
    v_permlane16_swap_b32 v26, v18
    v_permlane16_swap_b32 v27, v19
    s_nop 1
    v_max_f32 v24, v24, v16
    v_max_f32 v25, v25, v17
    v_max_f32 v26, v26, v18
    v_max_f32 v27, v27, v19
    v_mov_b32 v16, v24
    v_mov_b32 v17, v25
    v_mov_b32 v18, v26
    v_mov_b32 v19, v27
    s_nop 1
    v_permlane32_swap_b32 v24, v16
    v_permlane32_swap_b32 v25, v17
    v_permlane32_swap_b32 v26, v18
    v_permlane32_swap_b32 v27, v19
    s_nop 1
    v_max_f32 v24, v24, v16
    v_max_f32 v25, v25, v17
    v_max_f32 v26, v26, v18
    v_max_f32 v27, v27, v19
    v_sub_f32 v128, 0, v24
    v_sub_f32 v129, 0, v24
    v_sub_f32 v130, 0, v24
    v_sub_f32 v131, 0, v24
    v_sub_f32 v132, 0, v25
    v_sub_f32 v133, 0, v25
    v_sub_f32 v134, 0, v25
    v_sub_f32 v135, 0, v25
    v_sub_f32 v136, 0, v26
    v_sub_f32 v137, 0, v26
    v_sub_f32 v138, 0, v26
    v_sub_f32 v139, 0, v26
    v_sub_f32 v140, 0, v27
    v_sub_f32 v141, 0, v27
    v_sub_f32 v142, 0, v27
    v_sub_f32 v143, 0, v27
    v_accvgpr_write_b32 a32, 0
    v_accvgpr_write_b32 a33, 0
    v_accvgpr_write_b32 a34, 0
    v_accvgpr_write_b32 a35, 0
    v_accvgpr_write_b32 a36, 0
    v_accvgpr_write_b32 a37, 0
    v_accvgpr_write_b32 a38, 0
    v_accvgpr_write_b32 a39, 0
    v_accvgpr_write_b32 a40, 0
    v_accvgpr_write_b32 a41, 0
    v_accvgpr_write_b32 a42, 0
    v_accvgpr_write_b32 a43, 0
    v_accvgpr_write_b32 a44, 0
    v_accvgpr_write_b32 a45, 0
    v_accvgpr_write_b32 a46, 0
    v_accvgpr_write_b32 a47, 0
    v_accvgpr_write_b32 a48, 0
    v_accvgpr_write_b32 a49, 0
    v_accvgpr_write_b32 a50, 0
    v_accvgpr_write_b32 a51, 0
    v_accvgpr_write_b32 a52, 0
    v_accvgpr_write_b32 a53, 0
    v_accvgpr_write_b32 a54, 0
    v_accvgpr_write_b32 a55, 0
    v_accvgpr_write_b32 a56, 0
    v_accvgpr_write_b32 a57, 0
    v_accvgpr_write_b32 a58, 0
    v_accvgpr_write_b32 a59, 0
    v_accvgpr_write_b32 a60, 0
    v_accvgpr_write_b32 a61, 0
    v_accvgpr_write_b32 a62, 0
    v_accvgpr_write_b32 a63, 0
    v_accvgpr_write_b32 a64, 0
    v_accvgpr_write_b32 a65, 0
    v_accvgpr_write_b32 a66, 0
    v_accvgpr_write_b32 a67, 0
    v_accvgpr_write_b32 a68, 0
    v_accvgpr_write_b32 a69, 0
    v_accvgpr_write_b32 a70, 0
    v_accvgpr_write_b32 a71, 0
    v_accvgpr_write_b32 a72, 0
    v_accvgpr_write_b32 a73, 0
    v_accvgpr_write_b32 a74, 0
    v_accvgpr_write_b32 a75, 0
    v_accvgpr_write_b32 a76, 0
    v_accvgpr_write_b32 a77, 0
    v_accvgpr_write_b32 a78, 0
    v_accvgpr_write_b32 a79, 0
    v_accvgpr_write_b32 a80, 0
    v_accvgpr_write_b32 a81, 0
    v_accvgpr_write_b32 a82, 0
    v_accvgpr_write_b32 a83, 0
    v_accvgpr_write_b32 a84, 0
    v_accvgpr_write_b32 a85, 0
    v_accvgpr_write_b32 a86, 0
    v_accvgpr_write_b32 a87, 0
    v_accvgpr_write_b32 a88, 0
    v_accvgpr_write_b32 a89, 0
    v_accvgpr_write_b32 a90, 0
    v_accvgpr_write_b32 a91, 0
    v_accvgpr_write_b32 a92, 0
    v_accvgpr_write_b32 a93, 0
    v_accvgpr_write_b32 a94, 0
    v_accvgpr_write_b32 a95, 0
    v_accvgpr_write_b32 a96, 0
    v_accvgpr_write_b32 a97, 0
    v_accvgpr_write_b32 a98, 0
    v_accvgpr_write_b32 a99, 0
    v_accvgpr_write_b32 a100, 0
    v_accvgpr_write_b32 a101, 0
    v_accvgpr_write_b32 a102, 0
    v_accvgpr_write_b32 a103, 0
    v_accvgpr_write_b32 a104, 0
    v_accvgpr_write_b32 a105, 0
    v_accvgpr_write_b32 a106, 0
    v_accvgpr_write_b32 a107, 0
    v_accvgpr_write_b32 a108, 0
    v_accvgpr_write_b32 a109, 0
    v_accvgpr_write_b32 a110, 0
    v_accvgpr_write_b32 a111, 0
    v_accvgpr_write_b32 a112, 0
    v_accvgpr_write_b32 a113, 0
    v_accvgpr_write_b32 a114, 0
    v_accvgpr_write_b32 a115, 0
    v_accvgpr_write_b32 a116, 0
    v_accvgpr_write_b32 a117, 0
    v_accvgpr_write_b32 a118, 0
    v_accvgpr_write_b32 a119, 0
    v_accvgpr_write_b32 a120, 0
    v_accvgpr_write_b32 a121, 0
    v_accvgpr_write_b32 a122, 0
    v_accvgpr_write_b32 a123, 0
    v_accvgpr_write_b32 a124, 0
    v_accvgpr_write_b32 a125, 0
    v_accvgpr_write_b32 a126, 0
    v_accvgpr_write_b32 a127, 0
    v_accvgpr_write_b32 a128, 0
    v_accvgpr_write_b32 a129, 0
    v_accvgpr_write_b32 a130, 0
    v_accvgpr_write_b32 a131, 0
    v_accvgpr_write_b32 a132, 0
    v_accvgpr_write_b32 a133, 0
    v_accvgpr_write_b32 a134, 0
    v_accvgpr_write_b32 a135, 0
    v_accvgpr_write_b32 a136, 0
    v_accvgpr_write_b32 a137, 0
    v_accvgpr_write_b32 a138, 0
    v_accvgpr_write_b32 a139, 0
    v_accvgpr_write_b32 a140, 0
    v_accvgpr_write_b32 a141, 0
    v_accvgpr_write_b32 a142, 0
    v_accvgpr_write_b32 a143, 0
    v_accvgpr_write_b32 a144, 0
    v_accvgpr_write_b32 a145, 0
    v_accvgpr_write_b32 a146, 0
    v_accvgpr_write_b32 a147, 0
    v_accvgpr_write_b32 a148, 0
    v_accvgpr_write_b32 a149, 0
    v_accvgpr_write_b32 a150, 0
    v_accvgpr_write_b32 a151, 0
    v_accvgpr_write_b32 a152, 0
    v_accvgpr_write_b32 a153, 0
    v_accvgpr_write_b32 a154, 0
    v_accvgpr_write_b32 a155, 0
    v_accvgpr_write_b32 a156, 0
    v_accvgpr_write_b32 a157, 0
    v_accvgpr_write_b32 a158, 0
    v_accvgpr_write_b32 a159, 0
    v_mov_b32 v16, 0
    v_mov_b32 v17, 0
    v_mov_b32 v18, 0
    v_mov_b32 v19, 0
    v_mov_b32 v20, 0
    v_mov_b32 v21, 0
    v_mov_b32 v22, 0
    v_mov_b32 v23, 0
    v_mov_b32 v24, 0
    v_mov_b32 v25, 0
    v_mov_b32 v26, 0
    v_mov_b32 v27, 0
    v_mov_b32 v28, 0
    v_mov_b32 v29, 0
    v_mov_b32 v30, 0
    v_mov_b32 v31, 0
    s_mov_b32 s33, 16
    s_mov_b32 s63, s48
L_m_slow_pv:
    s_add_u32 s64, s63, 4096
    buffer_load_dwordx4 a[0:3], v6, s[20:23], s63 offen offset:0 sc1
    buffer_load_dwordx4 a[4:7], v6, s[20:23], s63 offen offset:1024 sc1
    buffer_load_dwordx4 a[8:11], v6, s[20:23], s63 offen offset:2048 sc1
    buffer_load_dwordx4 a[12:15], v6, s[20:23], s63 offen offset:3072 sc1
    buffer_load_dwordx4 a[16:19], v6, s[20:23], s64 offen offset:0 sc1
    buffer_load_dwordx4 a[20:23], v6, s[20:23], s64 offen offset:1024 sc1
    buffer_load_dwordx4 a[24:27], v6, s[20:23], s64 offen offset:2048 sc1
    buffer_load_dwordx4 a[28:31], v6, s[20:23], s64 offen offset:3072 sc1
    s_waitcnt vmcnt(0)
    v_mfma_f32_16x16x32_bf16 v[32:35], a[0:3], a[160:163], v[128:131]
    v_mfma_f32_16x16x32_bf16 v[32:35], a[4:7], a[164:167], v[32:35]
    v_mfma_f32_16x16x32_bf16 v[40:43], a[0:3], a[176:179], v[132:135]
    v_mfma_f32_16x16x32_bf16 v[40:43], a[4:7], a[180:183], v[40:43]
    v_mfma_f32_16x16x32_bf16 v[48:51], a[0:3], a[192:195], v[136:139]
    v_mfma_f32_16x16x32_bf16 v[48:51], a[4:7], a[196:199], v[48:51]
    v_mfma_f32_16x16x32_bf16 v[56:59], a[0:3], a[208:211], v[140:143]
    v_mfma_f32_16x16x32_bf16 v[56:59], a[4:7], a[212:215], v[56:59]
    v_mfma_f32_16x16x32_bf16 v[32:35], a[8:11], a[168:171], v[32:35]
    v_mfma_f32_16x16x32_bf16 v[32:35], a[12:15], a[172:175], v[32:35]
    v_mfma_f32_16x16x32_bf16 v[40:43], a[8:11], a[184:187], v[40:43]
    v_mfma_f32_16x16x32_bf16 v[40:43], a[12:15], a[188:191], v[40:43]
    v_mfma_f32_16x16x32_bf16 v[48:51], a[8:11], a[200:203], v[48:51]
    v_mfma_f32_16x16x32_bf16 v[48:51], a[12:15], a[204:207], v[48:51]
    v_mfma_f32_16x16x32_bf16 v[56:59], a[8:11], a[216:219], v[56:59]
    v_mfma_f32_16x16x32_bf16 v[56:59], a[12:15], a[220:223], v[56:59]
    v_mfma_f32_16x16x32_bf16 v[36:39], a[16:19], a[160:163], v[128:131]
    v_mfma_f32_16x16x32_bf16 v[36:39], a[20:23], a[164:167], v[36:39]
    v_mfma_f32_16x16x32_bf16 v[44:47], a[16:19], a[176:179], v[132:135]
    v_mfma_f32_16x16x32_bf16 v[44:47], a[20:23], a[180:183], v[44:47]
    v_mfma_f32_16x16x32_bf16 v[52:55], a[16:19], a[192:195], v[136:139]
    v_mfma_f32_16x16x32_bf16 v[52:55], a[20:23], a[196:199], v[52:55]
    v_mfma_f32_16x16x32_bf16 v[60:63], a[16:19], a[208:211], v[140:143]
    v_mfma_f32_16x16x32_bf16 v[60:63], a[20:23], a[212:215], v[60:63]
    v_mfma_f32_16x16x32_bf16 v[36:39], a[24:27], a[168:171], v[36:39]
    v_mfma_f32_16x16x32_bf16 v[36:39], a[28:31], a[172:175], v[36:39]
    v_mfma_f32_16x16x32_bf16 v[44:47], a[24:27], a[184:187], v[44:47]
    v_mfma_f32_16x16x32_bf16 v[44:47], a[28:31], a[188:191], v[44:47]
    v_mfma_f32_16x16x32_bf16 v[52:55], a[24:27], a[200:203], v[52:55]
    v_mfma_f32_16x16x32_bf16 v[52:55], a[28:31], a[204:207], v[52:55]
    v_mfma_f32_16x16x32_bf16 v[60:63], a[24:27], a[216:219], v[60:63]
    v_mfma_f32_16x16x32_bf16 v[60:63], a[28:31], a[220:223], v[60:63]
    s_add_u32 s62, s63, 8192
    s_add_u32 s64, s63, 12288
    s_nop 15
    buffer_load_dwordx4 a[0:3], v6, s[20:23], s62 offen offset:0 sc1
    buffer_load_dwordx4 a[4:7], v6, s[20:23], s62 offen offset:1024 sc1
    buffer_load_dwordx4 a[8:11], v6, s[20:23], s62 offen offset:2048 sc1
    buffer_load_dwordx4 a[12:15], v6, s[20:23], s62 offen offset:3072 sc1
    buffer_load_dwordx4 a[16:19], v6, s[20:23], s64 offen offset:0 sc1
    buffer_load_dwordx4 a[20:23], v6, s[20:23], s64 offen offset:1024 sc1
    buffer_load_dwordx4 a[24:27], v6, s[20:23], s64 offen offset:2048 sc1
    buffer_load_dwordx4 a[28:31], v6, s[20:23], s64 offen offset:3072 sc1
    v_exp_f32 v32, v32
    v_exp_f32 v33, v33
    v_exp_f32 v34, v34
    s_nop 0
    v_exp_f32 v35, v35
    v_cvt_pk_bf16_f32 v96, v32, v33
    v_exp_f32 v40, v40
    s_nop 0
    v_exp_f32 v41, v41
    v_cvt_pk_bf16_f32 v97, v34, v35
    v_exp_f32 v42, v42
    s_nop 0
    v_exp_f32 v43, v43
    v_cvt_pk_bf16_f32 v100, v40, v41
    v_exp_f32 v48, v48
    s_nop 0
    v_exp_f32 v49, v49
    v_cvt_pk_bf16_f32 v101, v42, v43
    v_exp_f32 v50, v50
    s_nop 0
    v_exp_f32 v51, v51
    v_cvt_pk_bf16_f32 v104, v48, v49
    v_exp_f32 v56, v56
    s_nop 0
    v_exp_f32 v57, v57
    v_cvt_pk_bf16_f32 v105, v50, v51
    v_exp_f32 v58, v58
    s_nop 0
    v_exp_f32 v59, v59
    v_cvt_pk_bf16_f32 v108, v56, v57
    v_exp_f32 v36, v36
    s_nop 0
    v_exp_f32 v37, v37
    v_cvt_pk_bf16_f32 v109, v58, v59
    v_exp_f32 v38, v38
    s_nop 0
    v_exp_f32 v39, v39
    v_cvt_pk_bf16_f32 v98, v36, v37
    v_exp_f32 v44, v44
    s_nop 0
    v_exp_f32 v45, v45
    v_cvt_pk_bf16_f32 v99, v38, v39
    v_exp_f32 v46, v46
    s_nop 0
    v_exp_f32 v47, v47
    v_cvt_pk_bf16_f32 v102, v44, v45
    v_exp_f32 v52, v52
    s_nop 0
    v_exp_f32 v53, v53
    v_cvt_pk_bf16_f32 v103, v46, v47
    v_exp_f32 v54, v54
    s_nop 0
    v_exp_f32 v55, v55
    v_cvt_pk_bf16_f32 v106, v52, v53
    v_exp_f32 v60, v60
    s_nop 0
    v_exp_f32 v61, v61
    v_cvt_pk_bf16_f32 v107, v54, v55
    v_exp_f32 v62, v62
    s_nop 0
    v_exp_f32 v63, v63
    v_cvt_pk_bf16_f32 v110, v60, v61
    s_nop 0
    v_cvt_pk_bf16_f32 v111, v62, v63
    s_waitcnt vmcnt(0)
    s_nop 1
    v_mfma_f32_16x16x32_bf16 a[32:35], a[0:3], v[96:99], a[32:35]
    v_mfma_f32_16x16x32_bf16 a[36:39], a[0:3], v[100:103], a[36:39]
    v_mfma_f32_16x16x32_bf16 a[40:43], a[0:3], v[104:107], a[40:43]
    v_mfma_f32_16x16x32_bf16 a[44:47], a[0:3], v[108:111], a[44:47]
    v_mfma_f32_16x16x32_bf16 a[48:51], a[4:7], v[96:99], a[48:51]
    v_mfma_f32_16x16x32_bf16 a[52:55], a[4:7], v[100:103], a[52:55]
    v_mfma_f32_16x16x32_bf16 a[56:59], a[4:7], v[104:107], a[56:59]
    v_mfma_f32_16x16x32_bf16 a[60:63], a[4:7], v[108:111], a[60:63]
    v_mfma_f32_16x16x32_bf16 a[64:67], a[8:11], v[96:99], a[64:67]
    v_mfma_f32_16x16x32_bf16 a[68:71], a[8:11], v[100:103], a[68:71]
    v_mfma_f32_16x16x32_bf16 a[72:75], a[8:11], v[104:107], a[72:75]
    v_mfma_f32_16x16x32_bf16 a[76:79], a[8:11], v[108:111], a[76:79]
    v_mfma_f32_16x16x32_bf16 a[80:83], a[12:15], v[96:99], a[80:83]
    v_mfma_f32_16x16x32_bf16 a[84:87], a[12:15], v[100:103], a[84:87]
    v_mfma_f32_16x16x32_bf16 a[88:91], a[12:15], v[104:107], a[88:91]
    v_mfma_f32_16x16x32_bf16 a[92:95], a[12:15], v[108:111], a[92:95]
    v_mfma_f32_16x16x32_bf16 a[96:99], a[16:19], v[96:99], a[96:99]
    v_mfma_f32_16x16x32_bf16 a[100:103], a[16:19], v[100:103], a[100:103]
    v_mfma_f32_16x16x32_bf16 a[104:107], a[16:19], v[104:107], a[104:107]
    v_mfma_f32_16x16x32_bf16 a[108:111], a[16:19], v[108:111], a[108:111]
    v_mfma_f32_16x16x32_bf16 a[112:115], a[20:23], v[96:99], a[112:115]
    v_mfma_f32_16x16x32_bf16 a[116:119], a[20:23], v[100:103], a[116:119]
    v_mfma_f32_16x16x32_bf16 a[120:123], a[20:23], v[104:107], a[120:123]
    v_mfma_f32_16x16x32_bf16 a[124:127], a[20:23], v[108:111], a[124:127]
    v_mfma_f32_16x16x32_bf16 a[128:131], a[24:27], v[96:99], a[128:131]
    v_mfma_f32_16x16x32_bf16 a[132:135], a[24:27], v[100:103], a[132:135]
    v_mfma_f32_16x16x32_bf16 a[136:139], a[24:27], v[104:107], a[136:139]
    v_mfma_f32_16x16x32_bf16 a[140:143], a[24:27], v[108:111], a[140:143]
    v_mfma_f32_16x16x32_bf16 a[144:147], a[28:31], v[96:99], a[144:147]
    v_mfma_f32_16x16x32_bf16 a[148:151], a[28:31], v[100:103], a[148:151]
    v_mfma_f32_16x16x32_bf16 a[152:155], a[28:31], v[104:107], a[152:155]
    v_mfma_f32_16x16x32_bf16 a[156:159], a[28:31], v[108:111], a[156:159]
    v_mfma_f32_16x16x32_bf16 v[16:19], v[10:13], v[96:99], v[16:19]
    v_mfma_f32_16x16x32_bf16 v[20:23], v[10:13], v[100:103], v[20:23]
    v_mfma_f32_16x16x32_bf16 v[24:27], v[10:13], v[104:107], v[24:27]
    v_mfma_f32_16x16x32_bf16 v[28:31], v[10:13], v[108:111], v[28:31]
    s_nop 15
    s_add_u32 s63, s63, 16384
    s_sub_u32 s33, s33, 1
    s_cmp_lg_u32 s33, 0
    s_cbranch_scc1 L_m_slow_pv
    s_branch L_m_fin
.fill 5120, 4, 0xbf800000
    s_endpgm
L_text_end:
.section .rodata,"a"
.p2align 6
.amdhsa_kernel recurrent_scan__sliding_block_cached__dense_activation_silu__prompt_kernel
  .amdhsa_next_free_vgpr 512
  .amdhsa_next_free_sgpr 84
  .amdhsa_accum_offset 256
  .amdhsa_group_segment_fixed_size 0
  .amdhsa_kernarg_size 88
  .amdhsa_user_sgpr_count 2
  .amdhsa_user_sgpr_kernarg_segment_ptr 1
  .amdhsa_system_sgpr_workgroup_id_x 1
  .amdhsa_float_denorm_mode_32 3
  .amdhsa_float_denorm_mode_16_64 3
.end_amdhsa_kernel
```
